```python
import torch

def _softmax(x, axis=-1):
    return torch.softmax(x, dim=axis)

def _gelu(x):
    return torch.nn.functional.gelu(x, approximate='tanh')

def _silu(x):
    return torch.nn.functional.silu(x)

def _sigmoid(x):
    return torch.sigmoid(x)

def _layernorm(x, axis=-1, eps=1e-05):
    m = x.mean(dim=axis, keepdim=True)
    v = x.var(dim=axis, keepdim=True, unbiased=False)
    return (x - m) / torch.sqrt(v + eps)

def _scatter_add(tgt, idx, src, axis=0):
    return tgt.clone().index_add_(axis, idx, src)

def _segment_sum(src, seg, n):
    out = torch.zeros((n,) + src.shape[1:], dtype=src.dtype)
    return out.index_add_(0, seg, src)

def _pad(x, pw):
    flat = tuple((v for pair in reversed(pw) for v in pair))
    return torch.nn.functional.pad(x, flat)
kernel_name = 'sequential_preLN__memory_aug_recurrent_mem_tr__glu_gated_reglu__prompt'

def setup_inputs():

    _w = lambda a: (lambda t: t.to(torch.bfloat16) if t.is_floating_point() else t)(torch.as_tensor(a))

    def _A_setup():
        B, S, Dm = (1, 2048, 640)
        H, Dh = (32, 128)
        M, seg = (8, 32)
        seg = min(seg, S)
        S = S // seg * seg
        return {'x': _w((lambda *s: torch.randn(*s, dtype=torch.bfloat16) * 0.05)(B, S, Dm)), 'mem0': _w((lambda *s: torch.randn(*s, dtype=torch.bfloat16) * 0.2)(B, M, Dm)), 'Wq': _w((lambda *s: torch.randn(*s, dtype=torch.bfloat16) * 1.6)(Dm, H, Dh) * Dm ** (-0.5)), 'Wk': _w((lambda *s: torch.randn(*s, dtype=torch.bfloat16) * 1.6)(Dm, H, Dh) * Dm ** (-0.5)), 'Wv': _w((lambda *s: torch.randn(*s, dtype=torch.bfloat16) * 0.2)(Dm, H, Dh) * Dm ** (-0.5)), 'Wo': _w((lambda *s: torch.randn(*s, dtype=torch.bfloat16) * 0.2)(H, Dh, Dm) * (H * Dh) ** (-0.5)), 'seg_len': seg}
    _A_in = _A_setup()

    def _B_setup():
        B, S, D, F = (1, 2048, 640, 1728)
        return {'x': _w((lambda *s: torch.randn(*s, dtype=torch.bfloat16) * 0.05)(B, S, D)), 'W_gate': _w((lambda *s: torch.randn(*s, dtype=torch.bfloat16) * 0.2)(D, F) * (2.0 / D) ** 0.5), 'W_up': _w((lambda *s: torch.randn(*s, dtype=torch.bfloat16) * 0.2)(D, F) * (2.0 / D) ** 0.5), 'W_down': _w((lambda *s: torch.randn(*s, dtype=torch.bfloat16) * 0.2)(F, D) * (1.0 / F) ** 0.5)}
    _B_in = _B_setup()
    return {'A_x': _A_in['x'], 'A_mem0': _A_in['mem0'], 'A_Wq': _A_in['Wq'], 'A_Wk': _A_in['Wk'], 'A_Wv': _A_in['Wv'], 'A_Wo': _A_in['Wo'], 'A_seg_len': _A_in['seg_len'], 'B_x': _B_in['x'], 'B_W_gate': _B_in['W_gate'], 'B_W_up': _B_in['W_up'], 'B_W_down': _B_in['W_down']}

def reference(A_x, A_mem0, A_Wq, A_Wk, A_Wv, A_Wo, A_seg_len, B_x, B_W_gate, B_W_up, B_W_down):

    def _A_ref(x, mem0, Wq, Wk, Wv, Wo, seg_len):
        B, S, Dm = x.shape
        H, Dh = (Wq.shape[1], Wq.shape[2])
        M = mem0.shape[1]
        scale = Dh ** (-0.5)
        n_seg = S // seg_len
        L = M + seg_len
        idx = torch.arange(L)
        mask = (idx[:, None] < M) | (idx[:, None] >= idx[None, :])
        mem = mem0
        outs = []
        for s in range(n_seg):
            xs = x[:, s * seg_len:(s + 1) * seg_len, :].clone()
            h = torch.concatenate([mem, xs], axis=1)
            q = torch.einsum('btd,dhe->bhte', h, Wq)
            k = torch.einsum('btd,dhe->bhte', h, Wk)
            v = torch.einsum('btd,dhe->bhte', h, Wv)
            scores = torch.einsum('bhqe,bhke->bhqk', q, k) * scale
            scores = torch.where(mask[None, None], scores, -1000000000.0)
            p = _softmax(scores, axis=-1)
            o = torch.einsum('bhqk,bhke->bhqe', p, v)
            o = torch.einsum('bhte,hed->btd', o, Wo)
            mem = o[:, :M, :].clone()
            outs.append(o[:, M:, :])
        return torch.concatenate(outs, axis=1)

    def _B_ref(x, W_gate, W_up, W_down):
        gate = torch.einsum('bsd,df->bsf', x, W_gate)
        up = torch.einsum('bsd,df->bsf', x, W_up)
        gate = gate * (lambda x, dt: x.to(dt))(gate > 0, gate.dtype)
        h = gate * up
        return torch.einsum('bsf,fd->bsd', h, W_down)
    x = A_x
    h = x + _A_ref(_layernorm(x, axis=-1), A_mem0, A_Wq, A_Wk, A_Wv, A_Wo, A_seg_len)
    h2 = h + _B_ref(_layernorm(h, axis=-1), B_W_gate, B_W_up, B_W_down)
    return h2
```

```asm
; @launch kernel=prep_kernel grid=(443,1,1) block=(256,1,1) lds=36864
; @launch kernel=qkv_kernel grid=(256,1,1) block=(256,1,1) lds=61440
; @launch kernel=chain_kernel grid=(256,1,1) block=(256,1,1) lds=157696
; @launch kernel=awl_kernel grid=(64,1,1) block=(256,1,1) lds=65536
; @launch kernel=ffn1_kernel grid=(108,1,1) block=(256,1,1) lds=65536
; @launch kernel=ffn2_kernel grid=(60,1,1) block=(256,1,1) lds=65536
.amdgcn_target "amdgcn-amd-amdhsa--gfx950"
.text
.globl prep_kernel
.p2align 8
.type prep_kernel,@function
prep_kernel:
  s_load_dwordx2 s[4:5], s[0:1], 0
  s_load_dwordx2 s[6:7], s[0:1], 104
  s_load_dwordx4 s[8:11], s[0:1], 16
  s_load_dwordx4 s[12:15], s[0:1], 32
  s_load_dwordx4 s[16:19], s[0:1], 64
  s_load_dwordx2 s[20:21], s[0:1], 80
  v_lshrrev_b32 v1, 6, v0
  v_and_b32 v2, 63, v0
  s_nop 0
  v_readfirstlane_b32 s22, v1
  s_lshl_b32 s23, s2, 2
  s_nop 2
  s_add_u32 s23, s23, s22
  s_waitcnt lgkmcnt(0)
  s_cmp_ge_u32 s23, 1771
  s_cbranch_scc1 prep_done
  s_cmp_lt_u32 s23, 128
  s_cbranch_scc1 prep_ln
  s_cmp_ge_u32 s23, 1362
  s_cbranch_scc1 prep_clr
  s_cmp_lt_u32 s23, 896
  s_cbranch_scc1 prep_qkv
  s_cmp_lt_u32 s23, 1056
  s_cbranch_scc1 prep_wo
  s_cmp_lt_u32 s23, 1272
  s_cbranch_scc1 prep_gu
  s_sub_u32 s24, s23, 1272
  s_mov_b32 s25, 0x1c71c71d
  s_mul_hi_u32 s26, s24, s25
  s_mul_i32 s27, s26, 9
  s_sub_u32 s27, s24, s27
  s_mul_i32 s27, s27, 6
  s_mov_b32 s28, s20
  s_mov_b32 s29, s21
  s_mov_b32 s30, 1280
  s_lshl_b32 s31, s26, 6
  s_mov_b32 s32, 6
  s_mul_i32 s33, s26, 216
  s_add_u32 s33, s33, s27
  s_lshl_b32 s33, s33, 10
  s_add_u32 s33, s33, 0x1b40000
  s_mov_b32 s44, 55296
  s_mov_b32 s45, 110592
  s_mov_b32 s46, 165888
  s_mov_b32 s34, 4
  s_mov_b32 s35, 16
  s_branch prep_rl
prep_gu:
  s_sub_u32 s24, s23, 1056
  s_and_b32 s27, s24, 3
  s_mul_i32 s27, s27, 5
  s_lshr_b32 s26, s24, 3
  s_bitcmp1_b32 s24, 2
  s_cselect_b32 s28, s18, s16
  s_cselect_b32 s29, s19, s17
  s_cselect_b32 s25, 2, 0
  s_mov_b32 s30, 3456
  s_lshl_b32 s31, s26, 6
  s_mov_b32 s32, 5
  s_lshl_b32 s33, s26, 3
  s_add_u32 s33, s33, s25
  s_mul_i32 s33, s33, 20
  s_add_u32 s33, s33, s27
  s_lshl_b32 s33, s33, 10
  s_add_u32 s33, s33, 0x1700000
  s_mov_b32 s44, 20480
  s_mov_b32 s45, 81920
  s_mov_b32 s46, 102400
  s_mov_b32 s34, 8
  s_mov_b32 s35, 4
  s_branch prep_rl
prep_wo:
  s_sub_u32 s24, s23, 896
  s_lshr_b32 s26, s24, 4
  s_and_b32 s27, s24, 15
  s_lshl_b32 s27, s27, 3
  s_mov_b32 s28, s14
  s_mov_b32 s29, s15
  s_mov_b32 s30, 1280
  s_lshl_b32 s31, s26, 6
  s_mov_b32 s32, 8
  s_mul_i32 s33, s26, 516
  s_add_u32 s33, s33, s27
  s_lshl_b32 s33, s33, 10
  s_add_u32 s33, s33, 0x1180000
  s_mov_b32 s44, 132096
  s_mov_b32 s45, 264192
  s_mov_b32 s46, 396288
  s_mov_b32 s34, 4
  s_mov_b32 s35, 16
  s_branch prep_rl
prep_qkv:
  s_sub_u32 s24, s23, 128
  s_and_b32 s27, s24, 3
  s_mul_i32 s27, s27, 5
  s_lshr_b32 s24, s24, 2
  s_lshr_b32 s26, s24, 6
  s_and_b32 s25, s24, 63
  s_mov_b32 s28, s8
  s_mov_b32 s29, s9
  s_cmp_eq_u32 s26, 1
  s_cselect_b32 s28, s10, s28
  s_cselect_b32 s29, s11, s29
  s_cmp_eq_u32 s26, 2
  s_cselect_b32 s28, s12, s28
  s_cselect_b32 s29, s13, s29
  s_mov_b32 s30, 8192
  s_lshl_b32 s31, s25, 6
  s_mov_b32 s32, 5
  s_mul_i32 s33, s24, 80
  s_add_u32 s33, s33, s27
  s_lshl_b32 s33, s33, 10
  s_add_u32 s33, s33, 0x280000
  s_mov_b32 s44, 20480
  s_mov_b32 s45, 40960
  s_mov_b32 s46, 61440
  s_mov_b32 s34, 8
  s_mov_b32 s35, 4
prep_rl:
  v_lshrrev_b32 v4, 3, v2
  v_and_b32 v5, 7, v2
  s_lshl_b32 s36, s27, 5
  v_add_u32 v6, s36, v4
  v_mul_lo_u32 v6, v6, s30
  s_lshl_b32 s37, s31, 1
  v_lshl_add_u32 v6, v5, 4, v6
  v_add_u32 v8, s37, v6
  s_lshl_b32 s38, s30, 3
  v_add_u32 v9, s38, v8
  v_add_u32 v10, s38, v9
  v_add_u32 v11, s38, v10
  s_lshl_b32 s38, s30, 5
  s_mul_i32 s39, s22, 9216
  v_mul_u32_u24 v12, 144, v4
  v_lshl_add_u32 v12, v5, 4, v12
  v_add_u32 v12, s39, v12
  v_lshrrev_b32 v13, 4, v2
  v_mul_lo_u32 v13, v13, s34
  v_bfe_u32 v14, v2, 2, 2
  v_add_u32 v13, v13, v14
  v_mul_u32_u24 v13, 144, v13
  v_and_b32 v14, 3, v2
  v_lshl_add_u32 v13, v14, 3, v13
  v_add_u32 v13, s39, v13
  s_mul_i32 s40, s35, 144
  v_add_u32 v14, s40, v13
  v_lshlrev_b32 v16, 4, v2
  v_add_u32 v17, s44, v16
  v_add_u32 v18, s45, v16
  v_add_u32 v19, s46, v16
  s_add_u32 s40, s6, s33
  s_addc_u32 s41, s7, 0
  global_load_dwordx4 v[20:23], v8, s[28:29]
  global_load_dwordx4 v[24:27], v9, s[28:29]
  global_load_dwordx4 v[28:31], v10, s[28:29]
  global_load_dwordx4 v[32:35], v11, s[28:29]
  s_mov_b32 s42, 0
prep_rl_loop:
  s_add_u32 s28, s28, s38
  s_addc_u32 s29, s29, 0
  s_waitcnt vmcnt(0)
  ds_write_b128 v12, v[20:23]
  ds_write_b128 v12, v[24:27] offset:1152
  ds_write_b128 v12, v[28:31] offset:2304
  ds_write_b128 v12, v[32:35] offset:3456
  s_add_u32 s43, s42, 1
  s_cmp_ge_u32 s43, s32
  s_cbranch_scc1 prep_rl_nold
  global_load_dwordx4 v[20:23], v8, s[28:29]
  global_load_dwordx4 v[24:27], v9, s[28:29]
  global_load_dwordx4 v[28:31], v10, s[28:29]
  global_load_dwordx4 v[32:35], v11, s[28:29]
prep_rl_nold:
  s_waitcnt lgkmcnt(0)
  ds_read_b64_tr_b16 v[40:41], v13 offset:0
  ds_read_b64_tr_b16 v[42:43], v14 offset:0
  ds_read_b64_tr_b16 v[44:45], v13 offset:32
  ds_read_b64_tr_b16 v[46:47], v14 offset:32
  ds_read_b64_tr_b16 v[48:49], v13 offset:64
  ds_read_b64_tr_b16 v[50:51], v14 offset:64
  ds_read_b64_tr_b16 v[52:53], v13 offset:96
  ds_read_b64_tr_b16 v[54:55], v14 offset:96
  s_waitcnt lgkmcnt(6)
  global_store_dwordx4 v16, v[40:43], s[40:41]
  s_waitcnt lgkmcnt(4)
  global_store_dwordx4 v17, v[44:47], s[40:41]
  s_waitcnt lgkmcnt(2)
  global_store_dwordx4 v18, v[48:51], s[40:41]
  s_waitcnt lgkmcnt(0)
  global_store_dwordx4 v19, v[52:55], s[40:41]
  s_add_u32 s40, s40, 0x400
  s_addc_u32 s41, s41, 0
  s_add_u32 s42, s42, 1
  s_cmp_lt_u32 s42, s32
  s_cbranch_scc1 prep_rl_loop
  s_branch prep_done
prep_clr:
  s_sub_u32 s24, s23, 1362
  s_cmp_lg_u32 s24, 0
  s_cbranch_scc1 prep_clr2
  v_lshlrev_b32 v16, 4, v2
  v_mov_b32 v20, 0
  v_mov_b32 v21, 0
  v_mov_b32 v22, 0
  v_mov_b32 v23, 0
  s_add_u32 s40, s6, 0x8c00000
  s_addc_u32 s41, s7, 0
  global_store_dwordx4 v16, v[20:23], s[40:41]
  global_store_dwordx4 v16, v[20:23], s[40:41] offset:1024
  s_nop 1
prep_clr2:
  s_lshl_b32 s24, s24, 14
  v_lshlrev_b32 v16, 4, v2
  v_mov_b32 v20, -1
  v_mov_b32 v21, -1
  v_mov_b32 v22, -1
  v_mov_b32 v23, -1
  s_mov_b32 s39, 0
prep_clr_loop:
  s_add_u32 s25, s24, s39
  s_cmp_ge_u32 s25, 6701056
  s_cbranch_scc1 prep_done
  s_mov_b32 s27, 0x8000000
  s_cmp_lt_u32 s25, 1310720
  s_cselect_b32 s26, s27, 0x82c0000
  s_add_u32 s25, s25, s26
  s_add_u32 s40, s6, s25
  s_addc_u32 s41, s7, 0
  global_store_dwordx4 v16, v[20:23], s[40:41]
  s_add_u32 s39, s39, 1024
  s_cmp_lt_u32 s39, 16384
  s_cbranch_scc1 prep_clr_loop
  s_branch prep_done
prep_ln:
  v_and_b32 v4, 15, v2
  v_lshrrev_b32 v5, 4, v2
  s_lshl_b32 s40, s23, 4
  v_add_u32 v4, s40, v4
  v_mul_u32_u24 v4, 0x500, v4
  v_lshl_add_u32 v4, v5, 4, v4
  global_load_dwordx4 v[16:19], v4, s[4:5] offset:0
  global_load_dwordx4 v[20:23], v4, s[4:5] offset:64
  global_load_dwordx4 v[24:27], v4, s[4:5] offset:128
  global_load_dwordx4 v[28:31], v4, s[4:5] offset:192
  global_load_dwordx4 v[32:35], v4, s[4:5] offset:256
  global_load_dwordx4 v[36:39], v4, s[4:5] offset:320
  global_load_dwordx4 v[40:43], v4, s[4:5] offset:384
  global_load_dwordx4 v[44:47], v4, s[4:5] offset:448
  global_load_dwordx4 v[48:51], v4, s[4:5] offset:512
  global_load_dwordx4 v[52:55], v4, s[4:5] offset:576
  global_load_dwordx4 v[56:59], v4, s[4:5] offset:640
  global_load_dwordx4 v[60:63], v4, s[4:5] offset:704
  global_load_dwordx4 v[64:67], v4, s[4:5] offset:768
  global_load_dwordx4 v[68:71], v4, s[4:5] offset:832
  global_load_dwordx4 v[72:75], v4, s[4:5] offset:896
  global_load_dwordx4 v[76:79], v4, s[4:5] offset:960
  global_load_dwordx4 v[80:83], v4, s[4:5] offset:1024
  global_load_dwordx4 v[84:87], v4, s[4:5] offset:1088
  global_load_dwordx4 v[88:91], v4, s[4:5] offset:1152
  global_load_dwordx4 v[92:95], v4, s[4:5] offset:1216
  v_mov_b32 v6, 0
  v_mov_b32 v7, 0
  s_mov_b32 s41, 0xffff0000
  s_waitcnt vmcnt(19)
  v_lshlrev_b32 v8, 16, v16
  v_and_b32 v9, s41, v16
  v_add_f32 v6, v6, v8
  v_add_f32 v7, v7, v9
  v_lshlrev_b32 v8, 16, v17
  v_and_b32 v9, s41, v17
  v_add_f32 v6, v6, v8
  v_add_f32 v7, v7, v9
  v_lshlrev_b32 v8, 16, v18
  v_and_b32 v9, s41, v18
  v_add_f32 v6, v6, v8
  v_add_f32 v7, v7, v9
  v_lshlrev_b32 v8, 16, v19
  v_and_b32 v9, s41, v19
  v_add_f32 v6, v6, v8
  v_add_f32 v7, v7, v9
  s_waitcnt vmcnt(18)
  v_lshlrev_b32 v8, 16, v20
  v_and_b32 v9, s41, v20
  v_add_f32 v6, v6, v8
  v_add_f32 v7, v7, v9
  v_lshlrev_b32 v8, 16, v21
  v_and_b32 v9, s41, v21
  v_add_f32 v6, v6, v8
  v_add_f32 v7, v7, v9
  v_lshlrev_b32 v8, 16, v22
  v_and_b32 v9, s41, v22
  v_add_f32 v6, v6, v8
  v_add_f32 v7, v7, v9
  v_lshlrev_b32 v8, 16, v23
  v_and_b32 v9, s41, v23
  v_add_f32 v6, v6, v8
  v_add_f32 v7, v7, v9
  s_waitcnt vmcnt(17)
  v_lshlrev_b32 v8, 16, v24
  v_and_b32 v9, s41, v24
  v_add_f32 v6, v6, v8
  v_add_f32 v7, v7, v9
  v_lshlrev_b32 v8, 16, v25
  v_and_b32 v9, s41, v25
  v_add_f32 v6, v6, v8
  v_add_f32 v7, v7, v9
  v_lshlrev_b32 v8, 16, v26
  v_and_b32 v9, s41, v26
  v_add_f32 v6, v6, v8
  v_add_f32 v7, v7, v9
  v_lshlrev_b32 v8, 16, v27
  v_and_b32 v9, s41, v27
  v_add_f32 v6, v6, v8
  v_add_f32 v7, v7, v9
  s_waitcnt vmcnt(16)
  v_lshlrev_b32 v8, 16, v28
  v_and_b32 v9, s41, v28
  v_add_f32 v6, v6, v8
  v_add_f32 v7, v7, v9
  v_lshlrev_b32 v8, 16, v29
  v_and_b32 v9, s41, v29
  v_add_f32 v6, v6, v8
  v_add_f32 v7, v7, v9
  v_lshlrev_b32 v8, 16, v30
  v_and_b32 v9, s41, v30
  v_add_f32 v6, v6, v8
  v_add_f32 v7, v7, v9
  v_lshlrev_b32 v8, 16, v31
  v_and_b32 v9, s41, v31
  v_add_f32 v6, v6, v8
  v_add_f32 v7, v7, v9
  s_waitcnt vmcnt(15)
  v_lshlrev_b32 v8, 16, v32
  v_and_b32 v9, s41, v32
  v_add_f32 v6, v6, v8
  v_add_f32 v7, v7, v9
  v_lshlrev_b32 v8, 16, v33
  v_and_b32 v9, s41, v33
  v_add_f32 v6, v6, v8
  v_add_f32 v7, v7, v9
  v_lshlrev_b32 v8, 16, v34
  v_and_b32 v9, s41, v34
  v_add_f32 v6, v6, v8
  v_add_f32 v7, v7, v9
  v_lshlrev_b32 v8, 16, v35
  v_and_b32 v9, s41, v35
  v_add_f32 v6, v6, v8
  v_add_f32 v7, v7, v9
  s_waitcnt vmcnt(14)
  v_lshlrev_b32 v8, 16, v36
  v_and_b32 v9, s41, v36
  v_add_f32 v6, v6, v8
  v_add_f32 v7, v7, v9
  v_lshlrev_b32 v8, 16, v37
  v_and_b32 v9, s41, v37
  v_add_f32 v6, v6, v8
  v_add_f32 v7, v7, v9
  v_lshlrev_b32 v8, 16, v38
  v_and_b32 v9, s41, v38
  v_add_f32 v6, v6, v8
  v_add_f32 v7, v7, v9
  v_lshlrev_b32 v8, 16, v39
  v_and_b32 v9, s41, v39
  v_add_f32 v6, v6, v8
  v_add_f32 v7, v7, v9
  s_waitcnt vmcnt(13)
  v_lshlrev_b32 v8, 16, v40
  v_and_b32 v9, s41, v40
  v_add_f32 v6, v6, v8
  v_add_f32 v7, v7, v9
  v_lshlrev_b32 v8, 16, v41
  v_and_b32 v9, s41, v41
  v_add_f32 v6, v6, v8
  v_add_f32 v7, v7, v9
  v_lshlrev_b32 v8, 16, v42
  v_and_b32 v9, s41, v42
  v_add_f32 v6, v6, v8
  v_add_f32 v7, v7, v9
  v_lshlrev_b32 v8, 16, v43
  v_and_b32 v9, s41, v43
  v_add_f32 v6, v6, v8
  v_add_f32 v7, v7, v9
  s_waitcnt vmcnt(12)
  v_lshlrev_b32 v8, 16, v44
  v_and_b32 v9, s41, v44
  v_add_f32 v6, v6, v8
  v_add_f32 v7, v7, v9
  v_lshlrev_b32 v8, 16, v45
  v_and_b32 v9, s41, v45
  v_add_f32 v6, v6, v8
  v_add_f32 v7, v7, v9
  v_lshlrev_b32 v8, 16, v46
  v_and_b32 v9, s41, v46
  v_add_f32 v6, v6, v8
  v_add_f32 v7, v7, v9
  v_lshlrev_b32 v8, 16, v47
  v_and_b32 v9, s41, v47
  v_add_f32 v6, v6, v8
  v_add_f32 v7, v7, v9
  s_waitcnt vmcnt(11)
  v_lshlrev_b32 v8, 16, v48
  v_and_b32 v9, s41, v48
  v_add_f32 v6, v6, v8
  v_add_f32 v7, v7, v9
  v_lshlrev_b32 v8, 16, v49
  v_and_b32 v9, s41, v49
  v_add_f32 v6, v6, v8
  v_add_f32 v7, v7, v9
  v_lshlrev_b32 v8, 16, v50
  v_and_b32 v9, s41, v50
  v_add_f32 v6, v6, v8
  v_add_f32 v7, v7, v9
  v_lshlrev_b32 v8, 16, v51
  v_and_b32 v9, s41, v51
  v_add_f32 v6, v6, v8
  v_add_f32 v7, v7, v9
  s_waitcnt vmcnt(10)
  v_lshlrev_b32 v8, 16, v52
  v_and_b32 v9, s41, v52
  v_add_f32 v6, v6, v8
  v_add_f32 v7, v7, v9
  v_lshlrev_b32 v8, 16, v53
  v_and_b32 v9, s41, v53
  v_add_f32 v6, v6, v8
  v_add_f32 v7, v7, v9
  v_lshlrev_b32 v8, 16, v54
  v_and_b32 v9, s41, v54
  v_add_f32 v6, v6, v8
  v_add_f32 v7, v7, v9
  v_lshlrev_b32 v8, 16, v55
  v_and_b32 v9, s41, v55
  v_add_f32 v6, v6, v8
  v_add_f32 v7, v7, v9
  s_waitcnt vmcnt(9)
  v_lshlrev_b32 v8, 16, v56
  v_and_b32 v9, s41, v56
  v_add_f32 v6, v6, v8
  v_add_f32 v7, v7, v9
  v_lshlrev_b32 v8, 16, v57
  v_and_b32 v9, s41, v57
  v_add_f32 v6, v6, v8
  v_add_f32 v7, v7, v9
  v_lshlrev_b32 v8, 16, v58
  v_and_b32 v9, s41, v58
  v_add_f32 v6, v6, v8
  v_add_f32 v7, v7, v9
  v_lshlrev_b32 v8, 16, v59
  v_and_b32 v9, s41, v59
  v_add_f32 v6, v6, v8
  v_add_f32 v7, v7, v9
  s_waitcnt vmcnt(8)
  v_lshlrev_b32 v8, 16, v60
  v_and_b32 v9, s41, v60
  v_add_f32 v6, v6, v8
  v_add_f32 v7, v7, v9
  v_lshlrev_b32 v8, 16, v61
  v_and_b32 v9, s41, v61
  v_add_f32 v6, v6, v8
  v_add_f32 v7, v7, v9
  v_lshlrev_b32 v8, 16, v62
  v_and_b32 v9, s41, v62
  v_add_f32 v6, v6, v8
  v_add_f32 v7, v7, v9
  v_lshlrev_b32 v8, 16, v63
  v_and_b32 v9, s41, v63
  v_add_f32 v6, v6, v8
  v_add_f32 v7, v7, v9
  s_waitcnt vmcnt(7)
  v_lshlrev_b32 v8, 16, v64
  v_and_b32 v9, s41, v64
  v_add_f32 v6, v6, v8
  v_add_f32 v7, v7, v9
  v_lshlrev_b32 v8, 16, v65
  v_and_b32 v9, s41, v65
  v_add_f32 v6, v6, v8
  v_add_f32 v7, v7, v9
  v_lshlrev_b32 v8, 16, v66
  v_and_b32 v9, s41, v66
  v_add_f32 v6, v6, v8
  v_add_f32 v7, v7, v9
  v_lshlrev_b32 v8, 16, v67
  v_and_b32 v9, s41, v67
  v_add_f32 v6, v6, v8
  v_add_f32 v7, v7, v9
  s_waitcnt vmcnt(6)
  v_lshlrev_b32 v8, 16, v68
  v_and_b32 v9, s41, v68
  v_add_f32 v6, v6, v8
  v_add_f32 v7, v7, v9
  v_lshlrev_b32 v8, 16, v69
  v_and_b32 v9, s41, v69
  v_add_f32 v6, v6, v8
  v_add_f32 v7, v7, v9
  v_lshlrev_b32 v8, 16, v70
  v_and_b32 v9, s41, v70
  v_add_f32 v6, v6, v8
  v_add_f32 v7, v7, v9
  v_lshlrev_b32 v8, 16, v71
  v_and_b32 v9, s41, v71
  v_add_f32 v6, v6, v8
  v_add_f32 v7, v7, v9
  s_waitcnt vmcnt(5)
  v_lshlrev_b32 v8, 16, v72
  v_and_b32 v9, s41, v72
  v_add_f32 v6, v6, v8
  v_add_f32 v7, v7, v9
  v_lshlrev_b32 v8, 16, v73
  v_and_b32 v9, s41, v73
  v_add_f32 v6, v6, v8
  v_add_f32 v7, v7, v9
  v_lshlrev_b32 v8, 16, v74
  v_and_b32 v9, s41, v74
  v_add_f32 v6, v6, v8
  v_add_f32 v7, v7, v9
  v_lshlrev_b32 v8, 16, v75
  v_and_b32 v9, s41, v75
  v_add_f32 v6, v6, v8
  v_add_f32 v7, v7, v9
  s_waitcnt vmcnt(4)
  v_lshlrev_b32 v8, 16, v76
  v_and_b32 v9, s41, v76
  v_add_f32 v6, v6, v8
  v_add_f32 v7, v7, v9
  v_lshlrev_b32 v8, 16, v77
  v_and_b32 v9, s41, v77
  v_add_f32 v6, v6, v8
  v_add_f32 v7, v7, v9
  v_lshlrev_b32 v8, 16, v78
  v_and_b32 v9, s41, v78
  v_add_f32 v6, v6, v8
  v_add_f32 v7, v7, v9
  v_lshlrev_b32 v8, 16, v79
  v_and_b32 v9, s41, v79
  v_add_f32 v6, v6, v8
  v_add_f32 v7, v7, v9
  s_waitcnt vmcnt(3)
  v_lshlrev_b32 v8, 16, v80
  v_and_b32 v9, s41, v80
  v_add_f32 v6, v6, v8
  v_add_f32 v7, v7, v9
  v_lshlrev_b32 v8, 16, v81
  v_and_b32 v9, s41, v81
  v_add_f32 v6, v6, v8
  v_add_f32 v7, v7, v9
  v_lshlrev_b32 v8, 16, v82
  v_and_b32 v9, s41, v82
  v_add_f32 v6, v6, v8
  v_add_f32 v7, v7, v9
  v_lshlrev_b32 v8, 16, v83
  v_and_b32 v9, s41, v83
  v_add_f32 v6, v6, v8
  v_add_f32 v7, v7, v9
  s_waitcnt vmcnt(2)
  v_lshlrev_b32 v8, 16, v84
  v_and_b32 v9, s41, v84
  v_add_f32 v6, v6, v8
  v_add_f32 v7, v7, v9
  v_lshlrev_b32 v8, 16, v85
  v_and_b32 v9, s41, v85
  v_add_f32 v6, v6, v8
  v_add_f32 v7, v7, v9
  v_lshlrev_b32 v8, 16, v86
  v_and_b32 v9, s41, v86
  v_add_f32 v6, v6, v8
  v_add_f32 v7, v7, v9
  v_lshlrev_b32 v8, 16, v87
  v_and_b32 v9, s41, v87
  v_add_f32 v6, v6, v8
  v_add_f32 v7, v7, v9
  s_waitcnt vmcnt(1)
  v_lshlrev_b32 v8, 16, v88
  v_and_b32 v9, s41, v88
  v_add_f32 v6, v6, v8
  v_add_f32 v7, v7, v9
  v_lshlrev_b32 v8, 16, v89
  v_and_b32 v9, s41, v89
  v_add_f32 v6, v6, v8
  v_add_f32 v7, v7, v9
  v_lshlrev_b32 v8, 16, v90
  v_and_b32 v9, s41, v90
  v_add_f32 v6, v6, v8
  v_add_f32 v7, v7, v9
  v_lshlrev_b32 v8, 16, v91
  v_and_b32 v9, s41, v91
  v_add_f32 v6, v6, v8
  v_add_f32 v7, v7, v9
  s_waitcnt vmcnt(0)
  v_lshlrev_b32 v8, 16, v92
  v_and_b32 v9, s41, v92
  v_add_f32 v6, v6, v8
  v_add_f32 v7, v7, v9
  v_lshlrev_b32 v8, 16, v93
  v_and_b32 v9, s41, v93
  v_add_f32 v6, v6, v8
  v_add_f32 v7, v7, v9
  v_lshlrev_b32 v8, 16, v94
  v_and_b32 v9, s41, v94
  v_add_f32 v6, v6, v8
  v_add_f32 v7, v7, v9
  v_lshlrev_b32 v8, 16, v95
  v_and_b32 v9, s41, v95
  v_add_f32 v6, v6, v8
  v_add_f32 v7, v7, v9
  v_add_f32 v6, v6, v7
  s_nop 1
  v_mov_b32 v7, v6
  s_nop 1
  v_permlane16_swap_b32 v6, v7
  v_add_f32 v6, v6, v7
  s_nop 1
  v_mov_b32 v7, v6
  s_nop 1
  v_permlane32_swap_b32 v6, v7
  v_add_f32 v6, v6, v7
  v_mul_f32 v6, 0x3acccccd, v6
  v_mov_b32 v10, 0
  v_mov_b32 v11, 0
  v_lshlrev_b32 v8, 16, v16
  v_and_b32 v9, s41, v16
  v_sub_f32 v8, v8, v6
  v_sub_f32 v9, v9, v6
  v_fmac_f32 v10, v8, v8
  v_fmac_f32 v11, v9, v9
  v_lshlrev_b32 v8, 16, v17
  v_and_b32 v9, s41, v17
  v_sub_f32 v8, v8, v6
  v_sub_f32 v9, v9, v6
  v_fmac_f32 v10, v8, v8
  v_fmac_f32 v11, v9, v9
  v_lshlrev_b32 v8, 16, v18
  v_and_b32 v9, s41, v18
  v_sub_f32 v8, v8, v6
  v_sub_f32 v9, v9, v6
  v_fmac_f32 v10, v8, v8
  v_fmac_f32 v11, v9, v9
  v_lshlrev_b32 v8, 16, v19
  v_and_b32 v9, s41, v19
  v_sub_f32 v8, v8, v6
  v_sub_f32 v9, v9, v6
  v_fmac_f32 v10, v8, v8
  v_fmac_f32 v11, v9, v9
  v_lshlrev_b32 v8, 16, v20
  v_and_b32 v9, s41, v20
  v_sub_f32 v8, v8, v6
  v_sub_f32 v9, v9, v6
  v_fmac_f32 v10, v8, v8
  v_fmac_f32 v11, v9, v9
  v_lshlrev_b32 v8, 16, v21
  v_and_b32 v9, s41, v21
  v_sub_f32 v8, v8, v6
  v_sub_f32 v9, v9, v6
  v_fmac_f32 v10, v8, v8
  v_fmac_f32 v11, v9, v9
  v_lshlrev_b32 v8, 16, v22
  v_and_b32 v9, s41, v22
  v_sub_f32 v8, v8, v6
  v_sub_f32 v9, v9, v6
  v_fmac_f32 v10, v8, v8
  v_fmac_f32 v11, v9, v9
  v_lshlrev_b32 v8, 16, v23
  v_and_b32 v9, s41, v23
  v_sub_f32 v8, v8, v6
  v_sub_f32 v9, v9, v6
  v_fmac_f32 v10, v8, v8
  v_fmac_f32 v11, v9, v9
  v_lshlrev_b32 v8, 16, v24
  v_and_b32 v9, s41, v24
  v_sub_f32 v8, v8, v6
  v_sub_f32 v9, v9, v6
  v_fmac_f32 v10, v8, v8
  v_fmac_f32 v11, v9, v9
  v_lshlrev_b32 v8, 16, v25
  v_and_b32 v9, s41, v25
  v_sub_f32 v8, v8, v6
  v_sub_f32 v9, v9, v6
  v_fmac_f32 v10, v8, v8
  v_fmac_f32 v11, v9, v9
  v_lshlrev_b32 v8, 16, v26
  v_and_b32 v9, s41, v26
  v_sub_f32 v8, v8, v6
  v_sub_f32 v9, v9, v6
  v_fmac_f32 v10, v8, v8
  v_fmac_f32 v11, v9, v9
  v_lshlrev_b32 v8, 16, v27
  v_and_b32 v9, s41, v27
  v_sub_f32 v8, v8, v6
  v_sub_f32 v9, v9, v6
  v_fmac_f32 v10, v8, v8
  v_fmac_f32 v11, v9, v9
  v_lshlrev_b32 v8, 16, v28
  v_and_b32 v9, s41, v28
  v_sub_f32 v8, v8, v6
  v_sub_f32 v9, v9, v6
  v_fmac_f32 v10, v8, v8
  v_fmac_f32 v11, v9, v9
  v_lshlrev_b32 v8, 16, v29
  v_and_b32 v9, s41, v29
  v_sub_f32 v8, v8, v6
  v_sub_f32 v9, v9, v6
  v_fmac_f32 v10, v8, v8
  v_fmac_f32 v11, v9, v9
  v_lshlrev_b32 v8, 16, v30
  v_and_b32 v9, s41, v30
  v_sub_f32 v8, v8, v6
  v_sub_f32 v9, v9, v6
  v_fmac_f32 v10, v8, v8
  v_fmac_f32 v11, v9, v9
  v_lshlrev_b32 v8, 16, v31
  v_and_b32 v9, s41, v31
  v_sub_f32 v8, v8, v6
  v_sub_f32 v9, v9, v6
  v_fmac_f32 v10, v8, v8
  v_fmac_f32 v11, v9, v9
  v_lshlrev_b32 v8, 16, v32
  v_and_b32 v9, s41, v32
  v_sub_f32 v8, v8, v6
  v_sub_f32 v9, v9, v6
  v_fmac_f32 v10, v8, v8
  v_fmac_f32 v11, v9, v9
  v_lshlrev_b32 v8, 16, v33
  v_and_b32 v9, s41, v33
  v_sub_f32 v8, v8, v6
  v_sub_f32 v9, v9, v6
  v_fmac_f32 v10, v8, v8
  v_fmac_f32 v11, v9, v9
  v_lshlrev_b32 v8, 16, v34
  v_and_b32 v9, s41, v34
  v_sub_f32 v8, v8, v6
  v_sub_f32 v9, v9, v6
  v_fmac_f32 v10, v8, v8
  v_fmac_f32 v11, v9, v9
  v_lshlrev_b32 v8, 16, v35
  v_and_b32 v9, s41, v35
  v_sub_f32 v8, v8, v6
  v_sub_f32 v9, v9, v6
  v_fmac_f32 v10, v8, v8
  v_fmac_f32 v11, v9, v9
  v_lshlrev_b32 v8, 16, v36
  v_and_b32 v9, s41, v36
  v_sub_f32 v8, v8, v6
  v_sub_f32 v9, v9, v6
  v_fmac_f32 v10, v8, v8
  v_fmac_f32 v11, v9, v9
  v_lshlrev_b32 v8, 16, v37
  v_and_b32 v9, s41, v37
  v_sub_f32 v8, v8, v6
  v_sub_f32 v9, v9, v6
  v_fmac_f32 v10, v8, v8
  v_fmac_f32 v11, v9, v9
  v_lshlrev_b32 v8, 16, v38
  v_and_b32 v9, s41, v38
  v_sub_f32 v8, v8, v6
  v_sub_f32 v9, v9, v6
  v_fmac_f32 v10, v8, v8
  v_fmac_f32 v11, v9, v9
  v_lshlrev_b32 v8, 16, v39
  v_and_b32 v9, s41, v39
  v_sub_f32 v8, v8, v6
  v_sub_f32 v9, v9, v6
  v_fmac_f32 v10, v8, v8
  v_fmac_f32 v11, v9, v9
  v_lshlrev_b32 v8, 16, v40
  v_and_b32 v9, s41, v40
  v_sub_f32 v8, v8, v6
  v_sub_f32 v9, v9, v6
  v_fmac_f32 v10, v8, v8
  v_fmac_f32 v11, v9, v9
  v_lshlrev_b32 v8, 16, v41
  v_and_b32 v9, s41, v41
  v_sub_f32 v8, v8, v6
  v_sub_f32 v9, v9, v6
  v_fmac_f32 v10, v8, v8
  v_fmac_f32 v11, v9, v9
  v_lshlrev_b32 v8, 16, v42
  v_and_b32 v9, s41, v42
  v_sub_f32 v8, v8, v6
  v_sub_f32 v9, v9, v6
  v_fmac_f32 v10, v8, v8
  v_fmac_f32 v11, v9, v9
  v_lshlrev_b32 v8, 16, v43
  v_and_b32 v9, s41, v43
  v_sub_f32 v8, v8, v6
  v_sub_f32 v9, v9, v6
  v_fmac_f32 v10, v8, v8
  v_fmac_f32 v11, v9, v9
  v_lshlrev_b32 v8, 16, v44
  v_and_b32 v9, s41, v44
  v_sub_f32 v8, v8, v6
  v_sub_f32 v9, v9, v6
  v_fmac_f32 v10, v8, v8
  v_fmac_f32 v11, v9, v9
  v_lshlrev_b32 v8, 16, v45
  v_and_b32 v9, s41, v45
  v_sub_f32 v8, v8, v6
  v_sub_f32 v9, v9, v6
  v_fmac_f32 v10, v8, v8
  v_fmac_f32 v11, v9, v9
  v_lshlrev_b32 v8, 16, v46
  v_and_b32 v9, s41, v46
  v_sub_f32 v8, v8, v6
  v_sub_f32 v9, v9, v6
  v_fmac_f32 v10, v8, v8
  v_fmac_f32 v11, v9, v9
  v_lshlrev_b32 v8, 16, v47
  v_and_b32 v9, s41, v47
  v_sub_f32 v8, v8, v6
  v_sub_f32 v9, v9, v6
  v_fmac_f32 v10, v8, v8
  v_fmac_f32 v11, v9, v9
  v_lshlrev_b32 v8, 16, v48
  v_and_b32 v9, s41, v48
  v_sub_f32 v8, v8, v6
  v_sub_f32 v9, v9, v6
  v_fmac_f32 v10, v8, v8
  v_fmac_f32 v11, v9, v9
  v_lshlrev_b32 v8, 16, v49
  v_and_b32 v9, s41, v49
  v_sub_f32 v8, v8, v6
  v_sub_f32 v9, v9, v6
  v_fmac_f32 v10, v8, v8
  v_fmac_f32 v11, v9, v9
  v_lshlrev_b32 v8, 16, v50
  v_and_b32 v9, s41, v50
  v_sub_f32 v8, v8, v6
  v_sub_f32 v9, v9, v6
  v_fmac_f32 v10, v8, v8
  v_fmac_f32 v11, v9, v9
  v_lshlrev_b32 v8, 16, v51
  v_and_b32 v9, s41, v51
  v_sub_f32 v8, v8, v6
  v_sub_f32 v9, v9, v6
  v_fmac_f32 v10, v8, v8
  v_fmac_f32 v11, v9, v9
  v_lshlrev_b32 v8, 16, v52
  v_and_b32 v9, s41, v52
  v_sub_f32 v8, v8, v6
  v_sub_f32 v9, v9, v6
  v_fmac_f32 v10, v8, v8
  v_fmac_f32 v11, v9, v9
  v_lshlrev_b32 v8, 16, v53
  v_and_b32 v9, s41, v53
  v_sub_f32 v8, v8, v6
  v_sub_f32 v9, v9, v6
  v_fmac_f32 v10, v8, v8
  v_fmac_f32 v11, v9, v9
  v_lshlrev_b32 v8, 16, v54
  v_and_b32 v9, s41, v54
  v_sub_f32 v8, v8, v6
  v_sub_f32 v9, v9, v6
  v_fmac_f32 v10, v8, v8
  v_fmac_f32 v11, v9, v9
  v_lshlrev_b32 v8, 16, v55
  v_and_b32 v9, s41, v55
  v_sub_f32 v8, v8, v6
  v_sub_f32 v9, v9, v6
  v_fmac_f32 v10, v8, v8
  v_fmac_f32 v11, v9, v9
  v_lshlrev_b32 v8, 16, v56
  v_and_b32 v9, s41, v56
  v_sub_f32 v8, v8, v6
  v_sub_f32 v9, v9, v6
  v_fmac_f32 v10, v8, v8
  v_fmac_f32 v11, v9, v9
  v_lshlrev_b32 v8, 16, v57
  v_and_b32 v9, s41, v57
  v_sub_f32 v8, v8, v6
  v_sub_f32 v9, v9, v6
  v_fmac_f32 v10, v8, v8
  v_fmac_f32 v11, v9, v9
  v_lshlrev_b32 v8, 16, v58
  v_and_b32 v9, s41, v58
  v_sub_f32 v8, v8, v6
  v_sub_f32 v9, v9, v6
  v_fmac_f32 v10, v8, v8
  v_fmac_f32 v11, v9, v9
  v_lshlrev_b32 v8, 16, v59
  v_and_b32 v9, s41, v59
  v_sub_f32 v8, v8, v6
  v_sub_f32 v9, v9, v6
  v_fmac_f32 v10, v8, v8
  v_fmac_f32 v11, v9, v9
  v_lshlrev_b32 v8, 16, v60
  v_and_b32 v9, s41, v60
  v_sub_f32 v8, v8, v6
  v_sub_f32 v9, v9, v6
  v_fmac_f32 v10, v8, v8
  v_fmac_f32 v11, v9, v9
  v_lshlrev_b32 v8, 16, v61
  v_and_b32 v9, s41, v61
  v_sub_f32 v8, v8, v6
  v_sub_f32 v9, v9, v6
  v_fmac_f32 v10, v8, v8
  v_fmac_f32 v11, v9, v9
  v_lshlrev_b32 v8, 16, v62
  v_and_b32 v9, s41, v62
  v_sub_f32 v8, v8, v6
  v_sub_f32 v9, v9, v6
  v_fmac_f32 v10, v8, v8
  v_fmac_f32 v11, v9, v9
  v_lshlrev_b32 v8, 16, v63
  v_and_b32 v9, s41, v63
  v_sub_f32 v8, v8, v6
  v_sub_f32 v9, v9, v6
  v_fmac_f32 v10, v8, v8
  v_fmac_f32 v11, v9, v9
  v_lshlrev_b32 v8, 16, v64
  v_and_b32 v9, s41, v64
  v_sub_f32 v8, v8, v6
  v_sub_f32 v9, v9, v6
  v_fmac_f32 v10, v8, v8
  v_fmac_f32 v11, v9, v9
  v_lshlrev_b32 v8, 16, v65
  v_and_b32 v9, s41, v65
  v_sub_f32 v8, v8, v6
  v_sub_f32 v9, v9, v6
  v_fmac_f32 v10, v8, v8
  v_fmac_f32 v11, v9, v9
  v_lshlrev_b32 v8, 16, v66
  v_and_b32 v9, s41, v66
  v_sub_f32 v8, v8, v6
  v_sub_f32 v9, v9, v6
  v_fmac_f32 v10, v8, v8
  v_fmac_f32 v11, v9, v9
  v_lshlrev_b32 v8, 16, v67
  v_and_b32 v9, s41, v67
  v_sub_f32 v8, v8, v6
  v_sub_f32 v9, v9, v6
  v_fmac_f32 v10, v8, v8
  v_fmac_f32 v11, v9, v9
  v_lshlrev_b32 v8, 16, v68
  v_and_b32 v9, s41, v68
  v_sub_f32 v8, v8, v6
  v_sub_f32 v9, v9, v6
  v_fmac_f32 v10, v8, v8
  v_fmac_f32 v11, v9, v9
  v_lshlrev_b32 v8, 16, v69
  v_and_b32 v9, s41, v69
  v_sub_f32 v8, v8, v6
  v_sub_f32 v9, v9, v6
  v_fmac_f32 v10, v8, v8
  v_fmac_f32 v11, v9, v9
  v_lshlrev_b32 v8, 16, v70
  v_and_b32 v9, s41, v70
  v_sub_f32 v8, v8, v6
  v_sub_f32 v9, v9, v6
  v_fmac_f32 v10, v8, v8
  v_fmac_f32 v11, v9, v9
  v_lshlrev_b32 v8, 16, v71
  v_and_b32 v9, s41, v71
  v_sub_f32 v8, v8, v6
  v_sub_f32 v9, v9, v6
  v_fmac_f32 v10, v8, v8
  v_fmac_f32 v11, v9, v9
  v_lshlrev_b32 v8, 16, v72
  v_and_b32 v9, s41, v72
  v_sub_f32 v8, v8, v6
  v_sub_f32 v9, v9, v6
  v_fmac_f32 v10, v8, v8
  v_fmac_f32 v11, v9, v9
  v_lshlrev_b32 v8, 16, v73
  v_and_b32 v9, s41, v73
  v_sub_f32 v8, v8, v6
  v_sub_f32 v9, v9, v6
  v_fmac_f32 v10, v8, v8
  v_fmac_f32 v11, v9, v9
  v_lshlrev_b32 v8, 16, v74
  v_and_b32 v9, s41, v74
  v_sub_f32 v8, v8, v6
  v_sub_f32 v9, v9, v6
  v_fmac_f32 v10, v8, v8
  v_fmac_f32 v11, v9, v9
  v_lshlrev_b32 v8, 16, v75
  v_and_b32 v9, s41, v75
  v_sub_f32 v8, v8, v6
  v_sub_f32 v9, v9, v6
  v_fmac_f32 v10, v8, v8
  v_fmac_f32 v11, v9, v9
  v_lshlrev_b32 v8, 16, v76
  v_and_b32 v9, s41, v76
  v_sub_f32 v8, v8, v6
  v_sub_f32 v9, v9, v6
  v_fmac_f32 v10, v8, v8
  v_fmac_f32 v11, v9, v9
  v_lshlrev_b32 v8, 16, v77
  v_and_b32 v9, s41, v77
  v_sub_f32 v8, v8, v6
  v_sub_f32 v9, v9, v6
  v_fmac_f32 v10, v8, v8
  v_fmac_f32 v11, v9, v9
  v_lshlrev_b32 v8, 16, v78
  v_and_b32 v9, s41, v78
  v_sub_f32 v8, v8, v6
  v_sub_f32 v9, v9, v6
  v_fmac_f32 v10, v8, v8
  v_fmac_f32 v11, v9, v9
  v_lshlrev_b32 v8, 16, v79
  v_and_b32 v9, s41, v79
  v_sub_f32 v8, v8, v6
  v_sub_f32 v9, v9, v6
  v_fmac_f32 v10, v8, v8
  v_fmac_f32 v11, v9, v9
  v_lshlrev_b32 v8, 16, v80
  v_and_b32 v9, s41, v80
  v_sub_f32 v8, v8, v6
  v_sub_f32 v9, v9, v6
  v_fmac_f32 v10, v8, v8
  v_fmac_f32 v11, v9, v9
  v_lshlrev_b32 v8, 16, v81
  v_and_b32 v9, s41, v81
  v_sub_f32 v8, v8, v6
  v_sub_f32 v9, v9, v6
  v_fmac_f32 v10, v8, v8
  v_fmac_f32 v11, v9, v9
  v_lshlrev_b32 v8, 16, v82
  v_and_b32 v9, s41, v82
  v_sub_f32 v8, v8, v6
  v_sub_f32 v9, v9, v6
  v_fmac_f32 v10, v8, v8
  v_fmac_f32 v11, v9, v9
  v_lshlrev_b32 v8, 16, v83
  v_and_b32 v9, s41, v83
  v_sub_f32 v8, v8, v6
  v_sub_f32 v9, v9, v6
  v_fmac_f32 v10, v8, v8
  v_fmac_f32 v11, v9, v9
  v_lshlrev_b32 v8, 16, v84
  v_and_b32 v9, s41, v84
  v_sub_f32 v8, v8, v6
  v_sub_f32 v9, v9, v6
  v_fmac_f32 v10, v8, v8
  v_fmac_f32 v11, v9, v9
  v_lshlrev_b32 v8, 16, v85
  v_and_b32 v9, s41, v85
  v_sub_f32 v8, v8, v6
  v_sub_f32 v9, v9, v6
  v_fmac_f32 v10, v8, v8
  v_fmac_f32 v11, v9, v9
  v_lshlrev_b32 v8, 16, v86
  v_and_b32 v9, s41, v86
  v_sub_f32 v8, v8, v6
  v_sub_f32 v9, v9, v6
  v_fmac_f32 v10, v8, v8
  v_fmac_f32 v11, v9, v9
  v_lshlrev_b32 v8, 16, v87
  v_and_b32 v9, s41, v87
  v_sub_f32 v8, v8, v6
  v_sub_f32 v9, v9, v6
  v_fmac_f32 v10, v8, v8
  v_fmac_f32 v11, v9, v9
  v_lshlrev_b32 v8, 16, v88
  v_and_b32 v9, s41, v88
  v_sub_f32 v8, v8, v6
  v_sub_f32 v9, v9, v6
  v_fmac_f32 v10, v8, v8
  v_fmac_f32 v11, v9, v9
  v_lshlrev_b32 v8, 16, v89
  v_and_b32 v9, s41, v89
  v_sub_f32 v8, v8, v6
  v_sub_f32 v9, v9, v6
  v_fmac_f32 v10, v8, v8
  v_fmac_f32 v11, v9, v9
  v_lshlrev_b32 v8, 16, v90
  v_and_b32 v9, s41, v90
  v_sub_f32 v8, v8, v6
  v_sub_f32 v9, v9, v6
  v_fmac_f32 v10, v8, v8
  v_fmac_f32 v11, v9, v9
  v_lshlrev_b32 v8, 16, v91
  v_and_b32 v9, s41, v91
  v_sub_f32 v8, v8, v6
  v_sub_f32 v9, v9, v6
  v_fmac_f32 v10, v8, v8
  v_fmac_f32 v11, v9, v9
  v_lshlrev_b32 v8, 16, v92
  v_and_b32 v9, s41, v92
  v_sub_f32 v8, v8, v6
  v_sub_f32 v9, v9, v6
  v_fmac_f32 v10, v8, v8
  v_fmac_f32 v11, v9, v9
  v_lshlrev_b32 v8, 16, v93
  v_and_b32 v9, s41, v93
  v_sub_f32 v8, v8, v6
  v_sub_f32 v9, v9, v6
  v_fmac_f32 v10, v8, v8
  v_fmac_f32 v11, v9, v9
  v_lshlrev_b32 v8, 16, v94
  v_and_b32 v9, s41, v94
  v_sub_f32 v8, v8, v6
  v_sub_f32 v9, v9, v6
  v_fmac_f32 v10, v8, v8
  v_fmac_f32 v11, v9, v9
  v_lshlrev_b32 v8, 16, v95
  v_and_b32 v9, s41, v95
  v_sub_f32 v8, v8, v6
  v_sub_f32 v9, v9, v6
  v_fmac_f32 v10, v8, v8
  v_fmac_f32 v11, v9, v9
  v_add_f32 v10, v10, v11
  s_nop 1
  v_mov_b32 v11, v10
  s_nop 1
  v_permlane16_swap_b32 v10, v11
  v_add_f32 v10, v10, v11
  s_nop 1
  v_mov_b32 v11, v10
  s_nop 1
  v_permlane32_swap_b32 v10, v11
  v_add_f32 v10, v10, v11
  v_mul_f32 v10, 0x3acccccd, v10
  v_cvt_pk_bf16_f32 v12, v6, v10
  v_lshlrev_b32 v6, 16, v12
  v_and_b32 v10, s41, v12
  v_add_f32 v10, 0x3727c5ac, v10
  v_cvt_pk_bf16_f32 v12, v10, v10
  v_lshlrev_b32 v10, 16, v12
  v_sqrt_f32 v10, v10
  s_nop 0
  v_cvt_pk_bf16_f32 v12, v10, v10
  v_lshlrev_b32 v10, 16, v12
  v_rcp_f32 v11, v10
  s_nop 0
  v_fma_f32 v12, -v10, v11, 1.0
  v_fma_f32 v11, v12, v11, v11
  s_mul_i32 s42, s23, 20480
  s_add_u32 s42, s42, 0x0
  s_add_u32 s44, s6, s42
  s_addc_u32 s45, s7, 0
  v_lshlrev_b32 v13, 4, v2
  v_lshlrev_b32 v8, 16, v16
  v_and_b32 v9, s41, v16
  v_sub_f32 v8, v8, v6
  v_sub_f32 v9, v9, v6
  v_cvt_pk_bf16_f32 v14, v8, v9
  v_lshlrev_b32 v8, 16, v14
  v_and_b32 v9, s41, v14
  v_mul_f32 v8, v8, v11
  v_mul_f32 v9, v9, v11
  v_cvt_pk_bf16_f32 v16, v8, v9
  v_lshlrev_b32 v8, 16, v17
  v_and_b32 v9, s41, v17
  v_sub_f32 v8, v8, v6
  v_sub_f32 v9, v9, v6
  v_cvt_pk_bf16_f32 v14, v8, v9
  v_lshlrev_b32 v8, 16, v14
  v_and_b32 v9, s41, v14
  v_mul_f32 v8, v8, v11
  v_mul_f32 v9, v9, v11
  v_cvt_pk_bf16_f32 v17, v8, v9
  v_lshlrev_b32 v8, 16, v18
  v_and_b32 v9, s41, v18
  v_sub_f32 v8, v8, v6
  v_sub_f32 v9, v9, v6
  v_cvt_pk_bf16_f32 v14, v8, v9
  v_lshlrev_b32 v8, 16, v14
  v_and_b32 v9, s41, v14
  v_mul_f32 v8, v8, v11
  v_mul_f32 v9, v9, v11
  v_cvt_pk_bf16_f32 v18, v8, v9
  v_lshlrev_b32 v8, 16, v19
  v_and_b32 v9, s41, v19
  v_sub_f32 v8, v8, v6
  v_sub_f32 v9, v9, v6
  v_cvt_pk_bf16_f32 v14, v8, v9
  v_lshlrev_b32 v8, 16, v14
  v_and_b32 v9, s41, v14
  v_mul_f32 v8, v8, v11
  v_mul_f32 v9, v9, v11
  v_cvt_pk_bf16_f32 v19, v8, v9
  global_store_dwordx4 v13, v[16:19], s[44:45] offset:0
  v_lshlrev_b32 v8, 16, v20
  v_and_b32 v9, s41, v20
  v_sub_f32 v8, v8, v6
  v_sub_f32 v9, v9, v6
  v_cvt_pk_bf16_f32 v14, v8, v9
  v_lshlrev_b32 v8, 16, v14
  v_and_b32 v9, s41, v14
  v_mul_f32 v8, v8, v11
  v_mul_f32 v9, v9, v11
  v_cvt_pk_bf16_f32 v20, v8, v9
  v_lshlrev_b32 v8, 16, v21
  v_and_b32 v9, s41, v21
  v_sub_f32 v8, v8, v6
  v_sub_f32 v9, v9, v6
  v_cvt_pk_bf16_f32 v14, v8, v9
  v_lshlrev_b32 v8, 16, v14
  v_and_b32 v9, s41, v14
  v_mul_f32 v8, v8, v11
  v_mul_f32 v9, v9, v11
  v_cvt_pk_bf16_f32 v21, v8, v9
  v_lshlrev_b32 v8, 16, v22
  v_and_b32 v9, s41, v22
  v_sub_f32 v8, v8, v6
  v_sub_f32 v9, v9, v6
  v_cvt_pk_bf16_f32 v14, v8, v9
  v_lshlrev_b32 v8, 16, v14
  v_and_b32 v9, s41, v14
  v_mul_f32 v8, v8, v11
  v_mul_f32 v9, v9, v11
  v_cvt_pk_bf16_f32 v22, v8, v9
  v_lshlrev_b32 v8, 16, v23
  v_and_b32 v9, s41, v23
  v_sub_f32 v8, v8, v6
  v_sub_f32 v9, v9, v6
  v_cvt_pk_bf16_f32 v14, v8, v9
  v_lshlrev_b32 v8, 16, v14
  v_and_b32 v9, s41, v14
  v_mul_f32 v8, v8, v11
  v_mul_f32 v9, v9, v11
  v_cvt_pk_bf16_f32 v23, v8, v9
  global_store_dwordx4 v13, v[20:23], s[44:45] offset:1024
  v_lshlrev_b32 v8, 16, v24
  v_and_b32 v9, s41, v24
  v_sub_f32 v8, v8, v6
  v_sub_f32 v9, v9, v6
  v_cvt_pk_bf16_f32 v14, v8, v9
  v_lshlrev_b32 v8, 16, v14
  v_and_b32 v9, s41, v14
  v_mul_f32 v8, v8, v11
  v_mul_f32 v9, v9, v11
  v_cvt_pk_bf16_f32 v24, v8, v9
  v_lshlrev_b32 v8, 16, v25
  v_and_b32 v9, s41, v25
  v_sub_f32 v8, v8, v6
  v_sub_f32 v9, v9, v6
  v_cvt_pk_bf16_f32 v14, v8, v9
  v_lshlrev_b32 v8, 16, v14
  v_and_b32 v9, s41, v14
  v_mul_f32 v8, v8, v11
  v_mul_f32 v9, v9, v11
  v_cvt_pk_bf16_f32 v25, v8, v9
  v_lshlrev_b32 v8, 16, v26
  v_and_b32 v9, s41, v26
  v_sub_f32 v8, v8, v6
  v_sub_f32 v9, v9, v6
  v_cvt_pk_bf16_f32 v14, v8, v9
  v_lshlrev_b32 v8, 16, v14
  v_and_b32 v9, s41, v14
  v_mul_f32 v8, v8, v11
  v_mul_f32 v9, v9, v11
  v_cvt_pk_bf16_f32 v26, v8, v9
  v_lshlrev_b32 v8, 16, v27
  v_and_b32 v9, s41, v27
  v_sub_f32 v8, v8, v6
  v_sub_f32 v9, v9, v6
  v_cvt_pk_bf16_f32 v14, v8, v9
  v_lshlrev_b32 v8, 16, v14
  v_and_b32 v9, s41, v14
  v_mul_f32 v8, v8, v11
  v_mul_f32 v9, v9, v11
  v_cvt_pk_bf16_f32 v27, v8, v9
  global_store_dwordx4 v13, v[24:27], s[44:45] offset:2048
  v_lshlrev_b32 v8, 16, v28
  v_and_b32 v9, s41, v28
  v_sub_f32 v8, v8, v6
  v_sub_f32 v9, v9, v6
  v_cvt_pk_bf16_f32 v14, v8, v9
  v_lshlrev_b32 v8, 16, v14
  v_and_b32 v9, s41, v14
  v_mul_f32 v8, v8, v11
  v_mul_f32 v9, v9, v11
  v_cvt_pk_bf16_f32 v28, v8, v9
  v_lshlrev_b32 v8, 16, v29
  v_and_b32 v9, s41, v29
  v_sub_f32 v8, v8, v6
  v_sub_f32 v9, v9, v6
  v_cvt_pk_bf16_f32 v14, v8, v9
  v_lshlrev_b32 v8, 16, v14
  v_and_b32 v9, s41, v14
  v_mul_f32 v8, v8, v11
  v_mul_f32 v9, v9, v11
  v_cvt_pk_bf16_f32 v29, v8, v9
  v_lshlrev_b32 v8, 16, v30
  v_and_b32 v9, s41, v30
  v_sub_f32 v8, v8, v6
  v_sub_f32 v9, v9, v6
  v_cvt_pk_bf16_f32 v14, v8, v9
  v_lshlrev_b32 v8, 16, v14
  v_and_b32 v9, s41, v14
  v_mul_f32 v8, v8, v11
  v_mul_f32 v9, v9, v11
  v_cvt_pk_bf16_f32 v30, v8, v9
  v_lshlrev_b32 v8, 16, v31
  v_and_b32 v9, s41, v31
  v_sub_f32 v8, v8, v6
  v_sub_f32 v9, v9, v6
  v_cvt_pk_bf16_f32 v14, v8, v9
  v_lshlrev_b32 v8, 16, v14
  v_and_b32 v9, s41, v14
  v_mul_f32 v8, v8, v11
  v_mul_f32 v9, v9, v11
  v_cvt_pk_bf16_f32 v31, v8, v9
  global_store_dwordx4 v13, v[28:31], s[44:45] offset:3072
  v_lshlrev_b32 v8, 16, v32
  v_and_b32 v9, s41, v32
  v_sub_f32 v8, v8, v6
  v_sub_f32 v9, v9, v6
  v_cvt_pk_bf16_f32 v14, v8, v9
  v_lshlrev_b32 v8, 16, v14
  v_and_b32 v9, s41, v14
  v_mul_f32 v8, v8, v11
  v_mul_f32 v9, v9, v11
  v_cvt_pk_bf16_f32 v32, v8, v9
  v_lshlrev_b32 v8, 16, v33
  v_and_b32 v9, s41, v33
  v_sub_f32 v8, v8, v6
  v_sub_f32 v9, v9, v6
  v_cvt_pk_bf16_f32 v14, v8, v9
  v_lshlrev_b32 v8, 16, v14
  v_and_b32 v9, s41, v14
  v_mul_f32 v8, v8, v11
  v_mul_f32 v9, v9, v11
  v_cvt_pk_bf16_f32 v33, v8, v9
  v_lshlrev_b32 v8, 16, v34
  v_and_b32 v9, s41, v34
  v_sub_f32 v8, v8, v6
  v_sub_f32 v9, v9, v6
  v_cvt_pk_bf16_f32 v14, v8, v9
  v_lshlrev_b32 v8, 16, v14
  v_and_b32 v9, s41, v14
  v_mul_f32 v8, v8, v11
  v_mul_f32 v9, v9, v11
  v_cvt_pk_bf16_f32 v34, v8, v9
  v_lshlrev_b32 v8, 16, v35
  v_and_b32 v9, s41, v35
  v_sub_f32 v8, v8, v6
  v_sub_f32 v9, v9, v6
  v_cvt_pk_bf16_f32 v14, v8, v9
  v_lshlrev_b32 v8, 16, v14
  v_and_b32 v9, s41, v14
  v_mul_f32 v8, v8, v11
  v_mul_f32 v9, v9, v11
  v_cvt_pk_bf16_f32 v35, v8, v9
  s_add_u32 s44, s44, 0x1000
  s_addc_u32 s45, s45, 0
  global_store_dwordx4 v13, v[32:35], s[44:45] offset:0
  v_lshlrev_b32 v8, 16, v36
  v_and_b32 v9, s41, v36
  v_sub_f32 v8, v8, v6
  v_sub_f32 v9, v9, v6
  v_cvt_pk_bf16_f32 v14, v8, v9
  v_lshlrev_b32 v8, 16, v14
  v_and_b32 v9, s41, v14
  v_mul_f32 v8, v8, v11
  v_mul_f32 v9, v9, v11
  v_cvt_pk_bf16_f32 v36, v8, v9
  v_lshlrev_b32 v8, 16, v37
  v_and_b32 v9, s41, v37
  v_sub_f32 v8, v8, v6
  v_sub_f32 v9, v9, v6
  v_cvt_pk_bf16_f32 v14, v8, v9
  v_lshlrev_b32 v8, 16, v14
  v_and_b32 v9, s41, v14
  v_mul_f32 v8, v8, v11
  v_mul_f32 v9, v9, v11
  v_cvt_pk_bf16_f32 v37, v8, v9
  v_lshlrev_b32 v8, 16, v38
  v_and_b32 v9, s41, v38
  v_sub_f32 v8, v8, v6
  v_sub_f32 v9, v9, v6
  v_cvt_pk_bf16_f32 v14, v8, v9
  v_lshlrev_b32 v8, 16, v14
  v_and_b32 v9, s41, v14
  v_mul_f32 v8, v8, v11
  v_mul_f32 v9, v9, v11
  v_cvt_pk_bf16_f32 v38, v8, v9
  v_lshlrev_b32 v8, 16, v39
  v_and_b32 v9, s41, v39
  v_sub_f32 v8, v8, v6
  v_sub_f32 v9, v9, v6
  v_cvt_pk_bf16_f32 v14, v8, v9
  v_lshlrev_b32 v8, 16, v14
  v_and_b32 v9, s41, v14
  v_mul_f32 v8, v8, v11
  v_mul_f32 v9, v9, v11
  v_cvt_pk_bf16_f32 v39, v8, v9
  global_store_dwordx4 v13, v[36:39], s[44:45] offset:1024
  v_lshlrev_b32 v8, 16, v40
  v_and_b32 v9, s41, v40
  v_sub_f32 v8, v8, v6
  v_sub_f32 v9, v9, v6
  v_cvt_pk_bf16_f32 v14, v8, v9
  v_lshlrev_b32 v8, 16, v14
  v_and_b32 v9, s41, v14
  v_mul_f32 v8, v8, v11
  v_mul_f32 v9, v9, v11
  v_cvt_pk_bf16_f32 v40, v8, v9
  v_lshlrev_b32 v8, 16, v41
  v_and_b32 v9, s41, v41
  v_sub_f32 v8, v8, v6
  v_sub_f32 v9, v9, v6
  v_cvt_pk_bf16_f32 v14, v8, v9
  v_lshlrev_b32 v8, 16, v14
  v_and_b32 v9, s41, v14
  v_mul_f32 v8, v8, v11
  v_mul_f32 v9, v9, v11
  v_cvt_pk_bf16_f32 v41, v8, v9
  v_lshlrev_b32 v8, 16, v42
  v_and_b32 v9, s41, v42
  v_sub_f32 v8, v8, v6
  v_sub_f32 v9, v9, v6
  v_cvt_pk_bf16_f32 v14, v8, v9
  v_lshlrev_b32 v8, 16, v14
  v_and_b32 v9, s41, v14
  v_mul_f32 v8, v8, v11
  v_mul_f32 v9, v9, v11
  v_cvt_pk_bf16_f32 v42, v8, v9
  v_lshlrev_b32 v8, 16, v43
  v_and_b32 v9, s41, v43
  v_sub_f32 v8, v8, v6
  v_sub_f32 v9, v9, v6
  v_cvt_pk_bf16_f32 v14, v8, v9
  v_lshlrev_b32 v8, 16, v14
  v_and_b32 v9, s41, v14
  v_mul_f32 v8, v8, v11
  v_mul_f32 v9, v9, v11
  v_cvt_pk_bf16_f32 v43, v8, v9
  global_store_dwordx4 v13, v[40:43], s[44:45] offset:2048
  v_lshlrev_b32 v8, 16, v44
  v_and_b32 v9, s41, v44
  v_sub_f32 v8, v8, v6
  v_sub_f32 v9, v9, v6
  v_cvt_pk_bf16_f32 v14, v8, v9
  v_lshlrev_b32 v8, 16, v14
  v_and_b32 v9, s41, v14
  v_mul_f32 v8, v8, v11
  v_mul_f32 v9, v9, v11
  v_cvt_pk_bf16_f32 v44, v8, v9
  v_lshlrev_b32 v8, 16, v45
  v_and_b32 v9, s41, v45
  v_sub_f32 v8, v8, v6
  v_sub_f32 v9, v9, v6
  v_cvt_pk_bf16_f32 v14, v8, v9
  v_lshlrev_b32 v8, 16, v14
  v_and_b32 v9, s41, v14
  v_mul_f32 v8, v8, v11
  v_mul_f32 v9, v9, v11
  v_cvt_pk_bf16_f32 v45, v8, v9
  v_lshlrev_b32 v8, 16, v46
  v_and_b32 v9, s41, v46
  v_sub_f32 v8, v8, v6
  v_sub_f32 v9, v9, v6
  v_cvt_pk_bf16_f32 v14, v8, v9
  v_lshlrev_b32 v8, 16, v14
  v_and_b32 v9, s41, v14
  v_mul_f32 v8, v8, v11
  v_mul_f32 v9, v9, v11
  v_cvt_pk_bf16_f32 v46, v8, v9
  v_lshlrev_b32 v8, 16, v47
  v_and_b32 v9, s41, v47
  v_sub_f32 v8, v8, v6
  v_sub_f32 v9, v9, v6
  v_cvt_pk_bf16_f32 v14, v8, v9
  v_lshlrev_b32 v8, 16, v14
  v_and_b32 v9, s41, v14
  v_mul_f32 v8, v8, v11
  v_mul_f32 v9, v9, v11
  v_cvt_pk_bf16_f32 v47, v8, v9
  global_store_dwordx4 v13, v[44:47], s[44:45] offset:3072
  v_lshlrev_b32 v8, 16, v48
  v_and_b32 v9, s41, v48
  v_sub_f32 v8, v8, v6
  v_sub_f32 v9, v9, v6
  v_cvt_pk_bf16_f32 v14, v8, v9
  v_lshlrev_b32 v8, 16, v14
  v_and_b32 v9, s41, v14
  v_mul_f32 v8, v8, v11
  v_mul_f32 v9, v9, v11
  v_cvt_pk_bf16_f32 v48, v8, v9
  v_lshlrev_b32 v8, 16, v49
  v_and_b32 v9, s41, v49
  v_sub_f32 v8, v8, v6
  v_sub_f32 v9, v9, v6
  v_cvt_pk_bf16_f32 v14, v8, v9
  v_lshlrev_b32 v8, 16, v14
  v_and_b32 v9, s41, v14
  v_mul_f32 v8, v8, v11
  v_mul_f32 v9, v9, v11
  v_cvt_pk_bf16_f32 v49, v8, v9
  v_lshlrev_b32 v8, 16, v50
  v_and_b32 v9, s41, v50
  v_sub_f32 v8, v8, v6
  v_sub_f32 v9, v9, v6
  v_cvt_pk_bf16_f32 v14, v8, v9
  v_lshlrev_b32 v8, 16, v14
  v_and_b32 v9, s41, v14
  v_mul_f32 v8, v8, v11
  v_mul_f32 v9, v9, v11
  v_cvt_pk_bf16_f32 v50, v8, v9
  v_lshlrev_b32 v8, 16, v51
  v_and_b32 v9, s41, v51
  v_sub_f32 v8, v8, v6
  v_sub_f32 v9, v9, v6
  v_cvt_pk_bf16_f32 v14, v8, v9
  v_lshlrev_b32 v8, 16, v14
  v_and_b32 v9, s41, v14
  v_mul_f32 v8, v8, v11
  v_mul_f32 v9, v9, v11
  v_cvt_pk_bf16_f32 v51, v8, v9
  s_add_u32 s44, s44, 0x1000
  s_addc_u32 s45, s45, 0
  global_store_dwordx4 v13, v[48:51], s[44:45] offset:0
  v_lshlrev_b32 v8, 16, v52
  v_and_b32 v9, s41, v52
  v_sub_f32 v8, v8, v6
  v_sub_f32 v9, v9, v6
  v_cvt_pk_bf16_f32 v14, v8, v9
  v_lshlrev_b32 v8, 16, v14
  v_and_b32 v9, s41, v14
  v_mul_f32 v8, v8, v11
  v_mul_f32 v9, v9, v11
  v_cvt_pk_bf16_f32 v52, v8, v9
  v_lshlrev_b32 v8, 16, v53
  v_and_b32 v9, s41, v53
  v_sub_f32 v8, v8, v6
  v_sub_f32 v9, v9, v6
  v_cvt_pk_bf16_f32 v14, v8, v9
  v_lshlrev_b32 v8, 16, v14
  v_and_b32 v9, s41, v14
  v_mul_f32 v8, v8, v11
  v_mul_f32 v9, v9, v11
  v_cvt_pk_bf16_f32 v53, v8, v9
  v_lshlrev_b32 v8, 16, v54
  v_and_b32 v9, s41, v54
  v_sub_f32 v8, v8, v6
  v_sub_f32 v9, v9, v6
  v_cvt_pk_bf16_f32 v14, v8, v9
  v_lshlrev_b32 v8, 16, v14
  v_and_b32 v9, s41, v14
  v_mul_f32 v8, v8, v11
  v_mul_f32 v9, v9, v11
  v_cvt_pk_bf16_f32 v54, v8, v9
  v_lshlrev_b32 v8, 16, v55
  v_and_b32 v9, s41, v55
  v_sub_f32 v8, v8, v6
  v_sub_f32 v9, v9, v6
  v_cvt_pk_bf16_f32 v14, v8, v9
  v_lshlrev_b32 v8, 16, v14
  v_and_b32 v9, s41, v14
  v_mul_f32 v8, v8, v11
  v_mul_f32 v9, v9, v11
  v_cvt_pk_bf16_f32 v55, v8, v9
  global_store_dwordx4 v13, v[52:55], s[44:45] offset:1024
  v_lshlrev_b32 v8, 16, v56
  v_and_b32 v9, s41, v56
  v_sub_f32 v8, v8, v6
  v_sub_f32 v9, v9, v6
  v_cvt_pk_bf16_f32 v14, v8, v9
  v_lshlrev_b32 v8, 16, v14
  v_and_b32 v9, s41, v14
  v_mul_f32 v8, v8, v11
  v_mul_f32 v9, v9, v11
  v_cvt_pk_bf16_f32 v56, v8, v9
  v_lshlrev_b32 v8, 16, v57
  v_and_b32 v9, s41, v57
  v_sub_f32 v8, v8, v6
  v_sub_f32 v9, v9, v6
  v_cvt_pk_bf16_f32 v14, v8, v9
  v_lshlrev_b32 v8, 16, v14
  v_and_b32 v9, s41, v14
  v_mul_f32 v8, v8, v11
  v_mul_f32 v9, v9, v11
  v_cvt_pk_bf16_f32 v57, v8, v9
  v_lshlrev_b32 v8, 16, v58
  v_and_b32 v9, s41, v58
  v_sub_f32 v8, v8, v6
  v_sub_f32 v9, v9, v6
  v_cvt_pk_bf16_f32 v14, v8, v9
  v_lshlrev_b32 v8, 16, v14
  v_and_b32 v9, s41, v14
  v_mul_f32 v8, v8, v11
  v_mul_f32 v9, v9, v11
  v_cvt_pk_bf16_f32 v58, v8, v9
  v_lshlrev_b32 v8, 16, v59
  v_and_b32 v9, s41, v59
  v_sub_f32 v8, v8, v6
  v_sub_f32 v9, v9, v6
  v_cvt_pk_bf16_f32 v14, v8, v9
  v_lshlrev_b32 v8, 16, v14
  v_and_b32 v9, s41, v14
  v_mul_f32 v8, v8, v11
  v_mul_f32 v9, v9, v11
  v_cvt_pk_bf16_f32 v59, v8, v9
  global_store_dwordx4 v13, v[56:59], s[44:45] offset:2048
  v_lshlrev_b32 v8, 16, v60
  v_and_b32 v9, s41, v60
  v_sub_f32 v8, v8, v6
  v_sub_f32 v9, v9, v6
  v_cvt_pk_bf16_f32 v14, v8, v9
  v_lshlrev_b32 v8, 16, v14
  v_and_b32 v9, s41, v14
  v_mul_f32 v8, v8, v11
  v_mul_f32 v9, v9, v11
  v_cvt_pk_bf16_f32 v60, v8, v9
  v_lshlrev_b32 v8, 16, v61
  v_and_b32 v9, s41, v61
  v_sub_f32 v8, v8, v6
  v_sub_f32 v9, v9, v6
  v_cvt_pk_bf16_f32 v14, v8, v9
  v_lshlrev_b32 v8, 16, v14
  v_and_b32 v9, s41, v14
  v_mul_f32 v8, v8, v11
  v_mul_f32 v9, v9, v11
  v_cvt_pk_bf16_f32 v61, v8, v9
  v_lshlrev_b32 v8, 16, v62
  v_and_b32 v9, s41, v62
  v_sub_f32 v8, v8, v6
  v_sub_f32 v9, v9, v6
  v_cvt_pk_bf16_f32 v14, v8, v9
  v_lshlrev_b32 v8, 16, v14
  v_and_b32 v9, s41, v14
  v_mul_f32 v8, v8, v11
  v_mul_f32 v9, v9, v11
  v_cvt_pk_bf16_f32 v62, v8, v9
  v_lshlrev_b32 v8, 16, v63
  v_and_b32 v9, s41, v63
  v_sub_f32 v8, v8, v6
  v_sub_f32 v9, v9, v6
  v_cvt_pk_bf16_f32 v14, v8, v9
  v_lshlrev_b32 v8, 16, v14
  v_and_b32 v9, s41, v14
  v_mul_f32 v8, v8, v11
  v_mul_f32 v9, v9, v11
  v_cvt_pk_bf16_f32 v63, v8, v9
  global_store_dwordx4 v13, v[60:63], s[44:45] offset:3072
  v_lshlrev_b32 v8, 16, v64
  v_and_b32 v9, s41, v64
  v_sub_f32 v8, v8, v6
  v_sub_f32 v9, v9, v6
  v_cvt_pk_bf16_f32 v14, v8, v9
  v_lshlrev_b32 v8, 16, v14
  v_and_b32 v9, s41, v14
  v_mul_f32 v8, v8, v11
  v_mul_f32 v9, v9, v11
  v_cvt_pk_bf16_f32 v64, v8, v9
  v_lshlrev_b32 v8, 16, v65
  v_and_b32 v9, s41, v65
  v_sub_f32 v8, v8, v6
  v_sub_f32 v9, v9, v6
  v_cvt_pk_bf16_f32 v14, v8, v9
  v_lshlrev_b32 v8, 16, v14
  v_and_b32 v9, s41, v14
  v_mul_f32 v8, v8, v11
  v_mul_f32 v9, v9, v11
  v_cvt_pk_bf16_f32 v65, v8, v9
  v_lshlrev_b32 v8, 16, v66
  v_and_b32 v9, s41, v66
  v_sub_f32 v8, v8, v6
  v_sub_f32 v9, v9, v6
  v_cvt_pk_bf16_f32 v14, v8, v9
  v_lshlrev_b32 v8, 16, v14
  v_and_b32 v9, s41, v14
  v_mul_f32 v8, v8, v11
  v_mul_f32 v9, v9, v11
  v_cvt_pk_bf16_f32 v66, v8, v9
  v_lshlrev_b32 v8, 16, v67
  v_and_b32 v9, s41, v67
  v_sub_f32 v8, v8, v6
  v_sub_f32 v9, v9, v6
  v_cvt_pk_bf16_f32 v14, v8, v9
  v_lshlrev_b32 v8, 16, v14
  v_and_b32 v9, s41, v14
  v_mul_f32 v8, v8, v11
  v_mul_f32 v9, v9, v11
  v_cvt_pk_bf16_f32 v67, v8, v9
  s_add_u32 s44, s44, 0x1000
  s_addc_u32 s45, s45, 0
  global_store_dwordx4 v13, v[64:67], s[44:45] offset:0
  v_lshlrev_b32 v8, 16, v68
  v_and_b32 v9, s41, v68
  v_sub_f32 v8, v8, v6
  v_sub_f32 v9, v9, v6
  v_cvt_pk_bf16_f32 v14, v8, v9
  v_lshlrev_b32 v8, 16, v14
  v_and_b32 v9, s41, v14
  v_mul_f32 v8, v8, v11
  v_mul_f32 v9, v9, v11
  v_cvt_pk_bf16_f32 v68, v8, v9
  v_lshlrev_b32 v8, 16, v69
  v_and_b32 v9, s41, v69
  v_sub_f32 v8, v8, v6
  v_sub_f32 v9, v9, v6
  v_cvt_pk_bf16_f32 v14, v8, v9
  v_lshlrev_b32 v8, 16, v14
  v_and_b32 v9, s41, v14
  v_mul_f32 v8, v8, v11
  v_mul_f32 v9, v9, v11
  v_cvt_pk_bf16_f32 v69, v8, v9
  v_lshlrev_b32 v8, 16, v70
  v_and_b32 v9, s41, v70
  v_sub_f32 v8, v8, v6
  v_sub_f32 v9, v9, v6
  v_cvt_pk_bf16_f32 v14, v8, v9
  v_lshlrev_b32 v8, 16, v14
  v_and_b32 v9, s41, v14
  v_mul_f32 v8, v8, v11
  v_mul_f32 v9, v9, v11
  v_cvt_pk_bf16_f32 v70, v8, v9
  v_lshlrev_b32 v8, 16, v71
  v_and_b32 v9, s41, v71
  v_sub_f32 v8, v8, v6
  v_sub_f32 v9, v9, v6
  v_cvt_pk_bf16_f32 v14, v8, v9
  v_lshlrev_b32 v8, 16, v14
  v_and_b32 v9, s41, v14
  v_mul_f32 v8, v8, v11
  v_mul_f32 v9, v9, v11
  v_cvt_pk_bf16_f32 v71, v8, v9
  global_store_dwordx4 v13, v[68:71], s[44:45] offset:1024
  v_lshlrev_b32 v8, 16, v72
  v_and_b32 v9, s41, v72
  v_sub_f32 v8, v8, v6
  v_sub_f32 v9, v9, v6
  v_cvt_pk_bf16_f32 v14, v8, v9
  v_lshlrev_b32 v8, 16, v14
  v_and_b32 v9, s41, v14
  v_mul_f32 v8, v8, v11
  v_mul_f32 v9, v9, v11
  v_cvt_pk_bf16_f32 v72, v8, v9
  v_lshlrev_b32 v8, 16, v73
  v_and_b32 v9, s41, v73
  v_sub_f32 v8, v8, v6
  v_sub_f32 v9, v9, v6
  v_cvt_pk_bf16_f32 v14, v8, v9
  v_lshlrev_b32 v8, 16, v14
  v_and_b32 v9, s41, v14
  v_mul_f32 v8, v8, v11
  v_mul_f32 v9, v9, v11
  v_cvt_pk_bf16_f32 v73, v8, v9
  v_lshlrev_b32 v8, 16, v74
  v_and_b32 v9, s41, v74
  v_sub_f32 v8, v8, v6
  v_sub_f32 v9, v9, v6
  v_cvt_pk_bf16_f32 v14, v8, v9
  v_lshlrev_b32 v8, 16, v14
  v_and_b32 v9, s41, v14
  v_mul_f32 v8, v8, v11
  v_mul_f32 v9, v9, v11
  v_cvt_pk_bf16_f32 v74, v8, v9
  v_lshlrev_b32 v8, 16, v75
  v_and_b32 v9, s41, v75
  v_sub_f32 v8, v8, v6
  v_sub_f32 v9, v9, v6
  v_cvt_pk_bf16_f32 v14, v8, v9
  v_lshlrev_b32 v8, 16, v14
  v_and_b32 v9, s41, v14
  v_mul_f32 v8, v8, v11
  v_mul_f32 v9, v9, v11
  v_cvt_pk_bf16_f32 v75, v8, v9
  global_store_dwordx4 v13, v[72:75], s[44:45] offset:2048
  v_lshlrev_b32 v8, 16, v76
  v_and_b32 v9, s41, v76
  v_sub_f32 v8, v8, v6
  v_sub_f32 v9, v9, v6
  v_cvt_pk_bf16_f32 v14, v8, v9
  v_lshlrev_b32 v8, 16, v14
  v_and_b32 v9, s41, v14
  v_mul_f32 v8, v8, v11
  v_mul_f32 v9, v9, v11
  v_cvt_pk_bf16_f32 v76, v8, v9
  v_lshlrev_b32 v8, 16, v77
  v_and_b32 v9, s41, v77
  v_sub_f32 v8, v8, v6
  v_sub_f32 v9, v9, v6
  v_cvt_pk_bf16_f32 v14, v8, v9
  v_lshlrev_b32 v8, 16, v14
  v_and_b32 v9, s41, v14
  v_mul_f32 v8, v8, v11
  v_mul_f32 v9, v9, v11
  v_cvt_pk_bf16_f32 v77, v8, v9
  v_lshlrev_b32 v8, 16, v78
  v_and_b32 v9, s41, v78
  v_sub_f32 v8, v8, v6
  v_sub_f32 v9, v9, v6
  v_cvt_pk_bf16_f32 v14, v8, v9
  v_lshlrev_b32 v8, 16, v14
  v_and_b32 v9, s41, v14
  v_mul_f32 v8, v8, v11
  v_mul_f32 v9, v9, v11
  v_cvt_pk_bf16_f32 v78, v8, v9
  v_lshlrev_b32 v8, 16, v79
  v_and_b32 v9, s41, v79
  v_sub_f32 v8, v8, v6
  v_sub_f32 v9, v9, v6
  v_cvt_pk_bf16_f32 v14, v8, v9
  v_lshlrev_b32 v8, 16, v14
  v_and_b32 v9, s41, v14
  v_mul_f32 v8, v8, v11
  v_mul_f32 v9, v9, v11
  v_cvt_pk_bf16_f32 v79, v8, v9
  global_store_dwordx4 v13, v[76:79], s[44:45] offset:3072
  v_lshlrev_b32 v8, 16, v80
  v_and_b32 v9, s41, v80
  v_sub_f32 v8, v8, v6
  v_sub_f32 v9, v9, v6
  v_cvt_pk_bf16_f32 v14, v8, v9
  v_lshlrev_b32 v8, 16, v14
  v_and_b32 v9, s41, v14
  v_mul_f32 v8, v8, v11
  v_mul_f32 v9, v9, v11
  v_cvt_pk_bf16_f32 v80, v8, v9
  v_lshlrev_b32 v8, 16, v81
  v_and_b32 v9, s41, v81
  v_sub_f32 v8, v8, v6
  v_sub_f32 v9, v9, v6
  v_cvt_pk_bf16_f32 v14, v8, v9
  v_lshlrev_b32 v8, 16, v14
  v_and_b32 v9, s41, v14
  v_mul_f32 v8, v8, v11
  v_mul_f32 v9, v9, v11
  v_cvt_pk_bf16_f32 v81, v8, v9
  v_lshlrev_b32 v8, 16, v82
  v_and_b32 v9, s41, v82
  v_sub_f32 v8, v8, v6
  v_sub_f32 v9, v9, v6
  v_cvt_pk_bf16_f32 v14, v8, v9
  v_lshlrev_b32 v8, 16, v14
  v_and_b32 v9, s41, v14
  v_mul_f32 v8, v8, v11
  v_mul_f32 v9, v9, v11
  v_cvt_pk_bf16_f32 v82, v8, v9
  v_lshlrev_b32 v8, 16, v83
  v_and_b32 v9, s41, v83
  v_sub_f32 v8, v8, v6
  v_sub_f32 v9, v9, v6
  v_cvt_pk_bf16_f32 v14, v8, v9
  v_lshlrev_b32 v8, 16, v14
  v_and_b32 v9, s41, v14
  v_mul_f32 v8, v8, v11
  v_mul_f32 v9, v9, v11
  v_cvt_pk_bf16_f32 v83, v8, v9
  s_add_u32 s44, s44, 0x1000
  s_addc_u32 s45, s45, 0
  global_store_dwordx4 v13, v[80:83], s[44:45] offset:0
  v_lshlrev_b32 v8, 16, v84
  v_and_b32 v9, s41, v84
  v_sub_f32 v8, v8, v6
  v_sub_f32 v9, v9, v6
  v_cvt_pk_bf16_f32 v14, v8, v9
  v_lshlrev_b32 v8, 16, v14
  v_and_b32 v9, s41, v14
  v_mul_f32 v8, v8, v11
  v_mul_f32 v9, v9, v11
  v_cvt_pk_bf16_f32 v84, v8, v9
  v_lshlrev_b32 v8, 16, v85
  v_and_b32 v9, s41, v85
  v_sub_f32 v8, v8, v6
  v_sub_f32 v9, v9, v6
  v_cvt_pk_bf16_f32 v14, v8, v9
  v_lshlrev_b32 v8, 16, v14
  v_and_b32 v9, s41, v14
  v_mul_f32 v8, v8, v11
  v_mul_f32 v9, v9, v11
  v_cvt_pk_bf16_f32 v85, v8, v9
  v_lshlrev_b32 v8, 16, v86
  v_and_b32 v9, s41, v86
  v_sub_f32 v8, v8, v6
  v_sub_f32 v9, v9, v6
  v_cvt_pk_bf16_f32 v14, v8, v9
  v_lshlrev_b32 v8, 16, v14
  v_and_b32 v9, s41, v14
  v_mul_f32 v8, v8, v11
  v_mul_f32 v9, v9, v11
  v_cvt_pk_bf16_f32 v86, v8, v9
  v_lshlrev_b32 v8, 16, v87
  v_and_b32 v9, s41, v87
  v_sub_f32 v8, v8, v6
  v_sub_f32 v9, v9, v6
  v_cvt_pk_bf16_f32 v14, v8, v9
  v_lshlrev_b32 v8, 16, v14
  v_and_b32 v9, s41, v14
  v_mul_f32 v8, v8, v11
  v_mul_f32 v9, v9, v11
  v_cvt_pk_bf16_f32 v87, v8, v9
  global_store_dwordx4 v13, v[84:87], s[44:45] offset:1024
  v_lshlrev_b32 v8, 16, v88
  v_and_b32 v9, s41, v88
  v_sub_f32 v8, v8, v6
  v_sub_f32 v9, v9, v6
  v_cvt_pk_bf16_f32 v14, v8, v9
  v_lshlrev_b32 v8, 16, v14
  v_and_b32 v9, s41, v14
  v_mul_f32 v8, v8, v11
  v_mul_f32 v9, v9, v11
  v_cvt_pk_bf16_f32 v88, v8, v9
  v_lshlrev_b32 v8, 16, v89
  v_and_b32 v9, s41, v89
  v_sub_f32 v8, v8, v6
  v_sub_f32 v9, v9, v6
  v_cvt_pk_bf16_f32 v14, v8, v9
  v_lshlrev_b32 v8, 16, v14
  v_and_b32 v9, s41, v14
  v_mul_f32 v8, v8, v11
  v_mul_f32 v9, v9, v11
  v_cvt_pk_bf16_f32 v89, v8, v9
  v_lshlrev_b32 v8, 16, v90
  v_and_b32 v9, s41, v90
  v_sub_f32 v8, v8, v6
  v_sub_f32 v9, v9, v6
  v_cvt_pk_bf16_f32 v14, v8, v9
  v_lshlrev_b32 v8, 16, v14
  v_and_b32 v9, s41, v14
  v_mul_f32 v8, v8, v11
  v_mul_f32 v9, v9, v11
  v_cvt_pk_bf16_f32 v90, v8, v9
  v_lshlrev_b32 v8, 16, v91
  v_and_b32 v9, s41, v91
  v_sub_f32 v8, v8, v6
  v_sub_f32 v9, v9, v6
  v_cvt_pk_bf16_f32 v14, v8, v9
  v_lshlrev_b32 v8, 16, v14
  v_and_b32 v9, s41, v14
  v_mul_f32 v8, v8, v11
  v_mul_f32 v9, v9, v11
  v_cvt_pk_bf16_f32 v91, v8, v9
  global_store_dwordx4 v13, v[88:91], s[44:45] offset:2048
  v_lshlrev_b32 v8, 16, v92
  v_and_b32 v9, s41, v92
  v_sub_f32 v8, v8, v6
  v_sub_f32 v9, v9, v6
  v_cvt_pk_bf16_f32 v14, v8, v9
  v_lshlrev_b32 v8, 16, v14
  v_and_b32 v9, s41, v14
  v_mul_f32 v8, v8, v11
  v_mul_f32 v9, v9, v11
  v_cvt_pk_bf16_f32 v92, v8, v9
  v_lshlrev_b32 v8, 16, v93
  v_and_b32 v9, s41, v93
  v_sub_f32 v8, v8, v6
  v_sub_f32 v9, v9, v6
  v_cvt_pk_bf16_f32 v14, v8, v9
  v_lshlrev_b32 v8, 16, v14
  v_and_b32 v9, s41, v14
  v_mul_f32 v8, v8, v11
  v_mul_f32 v9, v9, v11
  v_cvt_pk_bf16_f32 v93, v8, v9
  v_lshlrev_b32 v8, 16, v94
  v_and_b32 v9, s41, v94
  v_sub_f32 v8, v8, v6
  v_sub_f32 v9, v9, v6
  v_cvt_pk_bf16_f32 v14, v8, v9
  v_lshlrev_b32 v8, 16, v14
  v_and_b32 v9, s41, v14
  v_mul_f32 v8, v8, v11
  v_mul_f32 v9, v9, v11
  v_cvt_pk_bf16_f32 v94, v8, v9
  v_lshlrev_b32 v8, 16, v95
  v_and_b32 v9, s41, v95
  v_sub_f32 v8, v8, v6
  v_sub_f32 v9, v9, v6
  v_cvt_pk_bf16_f32 v14, v8, v9
  v_lshlrev_b32 v8, 16, v14
  v_and_b32 v9, s41, v14
  v_mul_f32 v8, v8, v11
  v_mul_f32 v9, v9, v11
  v_cvt_pk_bf16_f32 v95, v8, v9
  global_store_dwordx4 v13, v[92:95], s[44:45] offset:3072
prep_done:
  s_endpgm
.globl qkv_kernel
.p2align 8
.type qkv_kernel,@function
qkv_kernel:
  s_cmp_ge_u32 s2, 256
  s_cbranch_scc1 qkv_kernel_done
  s_load_dwordx2 s[6:7], s[0:1], 104
  s_load_dwordx2 s[4:5], s[0:1], 0
  s_load_dwordx2 s[8:9], s[0:1], 88
  v_lshrrev_b32 v5, 6, v0
  v_and_b32 v6, 63, v0
  s_nop 0
  v_readfirstlane_b32 s22, v5
  v_lshlrev_b32 v1, 4, v6
  s_and_b32 s10, s2, 7
  s_lshr_b32 s11, s2, 3
  s_lshr_b32 s20, s11, 3
  s_and_b32 s13, s11, 7
  s_lshl_b32 s21, s10, 3
  s_add_u32 s21, s21, s13
  s_add_u32 s21, s21, 32
  s_mov_b32 s19, 0
  s_waitcnt lgkmcnt(0)
  s_lshr_b32 s23, s22, 1
  s_and_b32 s24, s22, 1
  s_add_u32 s25, s22, 0
  s_mul_i32 s26, s20, 4
  s_add_u32 s26, s26, s25
  s_mul_i32 s26, s26, 20480
  s_add_u32 s26, s26, 0x0
  s_mul_i32 s27, s21, 8
  s_add_u32 s27, s27, s25
  s_sub_u32 s27, s27, 4
  s_mul_i32 s27, s27, 20480
  s_add_u32 s27, s27, 0x280000
  s_cmp_lt_u32 s25, 4
  s_cselect_b32 s26, s26, s27
  s_add_u32 s40, s6, s26
  s_addc_u32 s41, s7, 0
  s_add_u32 s25, s22, 4
  s_mul_i32 s26, s20, 4
  s_add_u32 s26, s26, s25
  s_mul_i32 s26, s26, 20480
  s_add_u32 s26, s26, 0x0
  s_mul_i32 s27, s21, 8
  s_add_u32 s27, s27, s25
  s_sub_u32 s27, s27, 4
  s_mul_i32 s27, s27, 20480
  s_add_u32 s27, s27, 0x280000
  s_cmp_lt_u32 s25, 4
  s_cselect_b32 s26, s26, s27
  s_add_u32 s42, s6, s26
  s_addc_u32 s43, s7, 0
  s_add_u32 s25, s22, 8
  s_mul_i32 s26, s20, 4
  s_add_u32 s26, s26, s25
  s_mul_i32 s26, s26, 20480
  s_add_u32 s26, s26, 0x0
  s_mul_i32 s27, s21, 8
  s_add_u32 s27, s27, s25
  s_sub_u32 s27, s27, 4
  s_mul_i32 s27, s27, 20480
  s_add_u32 s27, s27, 0x280000
  s_cmp_lt_u32 s25, 4
  s_cselect_b32 s26, s26, s27
  s_add_u32 s44, s6, s26
  s_addc_u32 s45, s7, 0
  s_mul_i32 s28, s22, 1024
  s_mul_i32 s25, s19, 0
  v_add_u32 v2, s25, v1
  s_mul_i32 s29, s23, 2048
  s_mul_i32 s30, s24, 4096
  s_add_u32 s30, s30, 4096
  s_mov_b32 s31, 0
  s_mov_b32 s32, 0
  s_add_u32 s33, s32, s28
  s_add_u32 m0, s33, 0
  s_nop 0
  global_load_lds_dwordx4 v2, s[40:41]
  s_add_u32 m0, s33, 4096
  s_nop 0
  global_load_lds_dwordx4 v2, s[42:43]
  s_add_u32 m0, s33, 8192
  s_nop 0
  global_load_lds_dwordx4 v2, s[44:45]
  v_add_u32 v2, 1024, v2
  s_add_u32 s32, s32, 12288
  s_cmp_ge_u32 s32, 61440
  s_cselect_b32 s32, 0, s32
  s_add_u32 s33, s32, s28
  s_add_u32 m0, s33, 0
  s_nop 0
  global_load_lds_dwordx4 v2, s[40:41]
  s_add_u32 m0, s33, 4096
  s_nop 0
  global_load_lds_dwordx4 v2, s[42:43]
  s_add_u32 m0, s33, 8192
  s_nop 0
  global_load_lds_dwordx4 v2, s[44:45]
  v_add_u32 v2, 1024, v2
  s_add_u32 s32, s32, 12288
  s_cmp_ge_u32 s32, 61440
  s_cselect_b32 s32, 0, s32
  s_add_u32 s33, s32, s28
  s_add_u32 m0, s33, 0
  s_nop 0
  global_load_lds_dwordx4 v2, s[40:41]
  s_add_u32 m0, s33, 4096
  s_nop 0
  global_load_lds_dwordx4 v2, s[42:43]
  s_add_u32 m0, s33, 8192
  s_nop 0
  global_load_lds_dwordx4 v2, s[44:45]
  v_add_u32 v2, 1024, v2
  s_add_u32 s32, s32, 12288
  s_cmp_ge_u32 s32, 61440
  s_cselect_b32 s32, 0, s32
  s_add_u32 s33, s32, s28
  s_add_u32 m0, s33, 0
  s_nop 0
  global_load_lds_dwordx4 v2, s[40:41]
  s_add_u32 m0, s33, 4096
  s_nop 0
  global_load_lds_dwordx4 v2, s[42:43]
  s_add_u32 m0, s33, 8192
  s_nop 0
  global_load_lds_dwordx4 v2, s[44:45]
  v_add_u32 v2, 1024, v2
  s_add_u32 s32, s32, 12288
  s_cmp_ge_u32 s32, 61440
  s_cselect_b32 s32, 0, s32
  s_add_u32 s33, s32, s28
  s_add_u32 m0, s33, 0
  s_nop 0
  global_load_lds_dwordx4 v2, s[40:41]
  s_add_u32 m0, s33, 4096
  s_nop 0
  global_load_lds_dwordx4 v2, s[42:43]
  s_add_u32 m0, s33, 8192
  s_nop 0
  global_load_lds_dwordx4 v2, s[44:45]
  v_add_u32 v2, 1024, v2
  s_add_u32 s32, s32, 12288
  s_cmp_ge_u32 s32, 61440
  s_cselect_b32 s32, 0, s32
  v_accvgpr_write_b32 a0, 0
  v_accvgpr_write_b32 a1, 0
  v_accvgpr_write_b32 a2, 0
  v_accvgpr_write_b32 a3, 0
  v_accvgpr_write_b32 a4, 0
  v_accvgpr_write_b32 a5, 0
  v_accvgpr_write_b32 a6, 0
  v_accvgpr_write_b32 a7, 0
  v_accvgpr_write_b32 a8, 0
  v_accvgpr_write_b32 a9, 0
  v_accvgpr_write_b32 a10, 0
  v_accvgpr_write_b32 a11, 0
  v_accvgpr_write_b32 a12, 0
  v_accvgpr_write_b32 a13, 0
  v_accvgpr_write_b32 a14, 0
  v_accvgpr_write_b32 a15, 0
  v_accvgpr_write_b32 a16, 0
  v_accvgpr_write_b32 a17, 0
  v_accvgpr_write_b32 a18, 0
  v_accvgpr_write_b32 a19, 0
  v_accvgpr_write_b32 a20, 0
  v_accvgpr_write_b32 a21, 0
  v_accvgpr_write_b32 a22, 0
  v_accvgpr_write_b32 a23, 0
  v_accvgpr_write_b32 a24, 0
  v_accvgpr_write_b32 a25, 0
  v_accvgpr_write_b32 a26, 0
  v_accvgpr_write_b32 a27, 0
  v_accvgpr_write_b32 a28, 0
  v_accvgpr_write_b32 a29, 0
  v_accvgpr_write_b32 a30, 0
  v_accvgpr_write_b32 a31, 0
  s_lshr_b32 s37, s21, 5
  s_and_b32 s38, s21, 31
  s_cmp_eq_u32 s37, 2
  s_cbranch_scc1 qkv_v
  s_waitcnt vmcnt(12)
  s_barrier
  s_add_u32 s34, s31, s29
  s_add_u32 s35, s31, s30
  v_add_u32 v3, s34, v1
  v_add_u32 v4, s35, v1
  ds_read_b128 v[8:11], v4 offset:0
  ds_read_b128 v[12:15], v4 offset:1024
  ds_read_b128 v[16:19], v4 offset:2048
  ds_read_b128 v[20:23], v4 offset:3072
  ds_read_b128 v[24:27], v3 offset:0
  ds_read_b128 v[28:31], v3 offset:1024
  s_add_u32 s31, s31, 12288
  s_cmp_ge_u32 s31, 61440
  s_cselect_b32 s31, 0, s31
  s_waitcnt vmcnt(9) lgkmcnt(0)
  s_barrier
  v_mfma_f32_16x16x32_bf16 a[0:3], v[8:11], v[24:27], a[0:3]
  s_add_u32 s34, s31, s29
  s_add_u32 s35, s31, s30
  v_add_u32 v3, s34, v1
  v_add_u32 v4, s35, v1
  ds_read_b128 v[32:35], v4 offset:0
  v_mfma_f32_16x16x32_bf16 a[4:7], v[12:15], v[24:27], a[4:7]
  ds_read_b128 v[36:39], v4 offset:1024
  ds_read_b128 v[40:43], v4 offset:2048
  v_mfma_f32_16x16x32_bf16 a[8:11], v[16:19], v[24:27], a[8:11]
  ds_read_b128 v[44:47], v4 offset:3072
  v_mfma_f32_16x16x32_bf16 a[12:15], v[20:23], v[24:27], a[12:15]
  ds_read_b128 v[48:51], v3 offset:0
  ds_read_b128 v[52:55], v3 offset:1024
  v_mfma_f32_16x16x32_bf16 a[16:19], v[8:11], v[28:31], a[16:19]
  s_add_u32 s31, s31, 12288
  s_cmp_ge_u32 s31, 61440
  s_cselect_b32 s31, 0, s31
  s_add_u32 s33, s32, s28
  v_mfma_f32_16x16x32_bf16 a[20:23], v[12:15], v[28:31], a[20:23]
  s_add_u32 m0, s33, 0
  s_nop 0
  global_load_lds_dwordx4 v2, s[40:41]
  v_mfma_f32_16x16x32_bf16 a[24:27], v[16:19], v[28:31], a[24:27]
  s_add_u32 m0, s33, 4096
  s_nop 0
  global_load_lds_dwordx4 v2, s[42:43]
  s_add_u32 m0, s33, 8192
  s_nop 0
  global_load_lds_dwordx4 v2, s[44:45]
  v_mfma_f32_16x16x32_bf16 a[28:31], v[20:23], v[28:31], a[28:31]
  v_add_u32 v2, 1024, v2
  s_add_u32 s32, s32, 12288
  s_cmp_ge_u32 s32, 61440
  s_cselect_b32 s32, 0, s32
  s_mov_b32 s36, 0
qkv_kernel_t_loop:
  s_waitcnt vmcnt(9) lgkmcnt(0)
  s_barrier
  v_mfma_f32_16x16x32_bf16 a[0:3], v[32:35], v[48:51], a[0:3]
  s_add_u32 s34, s31, s29
  s_add_u32 s35, s31, s30
  v_add_u32 v3, s34, v1
  v_add_u32 v4, s35, v1
  ds_read_b128 v[8:11], v4 offset:0
  v_mfma_f32_16x16x32_bf16 a[4:7], v[36:39], v[48:51], a[4:7]
  ds_read_b128 v[12:15], v4 offset:1024
  ds_read_b128 v[16:19], v4 offset:2048
  v_mfma_f32_16x16x32_bf16 a[8:11], v[40:43], v[48:51], a[8:11]
  ds_read_b128 v[20:23], v4 offset:3072
  v_mfma_f32_16x16x32_bf16 a[12:15], v[44:47], v[48:51], a[12:15]
  ds_read_b128 v[24:27], v3 offset:0
  ds_read_b128 v[28:31], v3 offset:1024
  v_mfma_f32_16x16x32_bf16 a[16:19], v[32:35], v[52:55], a[16:19]
  s_add_u32 s31, s31, 12288
  s_cmp_ge_u32 s31, 61440
  s_cselect_b32 s31, 0, s31
  s_add_u32 s33, s32, s28
  v_mfma_f32_16x16x32_bf16 a[20:23], v[36:39], v[52:55], a[20:23]
  s_add_u32 m0, s33, 0
  s_nop 0
  global_load_lds_dwordx4 v2, s[40:41]
  v_mfma_f32_16x16x32_bf16 a[24:27], v[40:43], v[52:55], a[24:27]
  s_add_u32 m0, s33, 4096
  s_nop 0
  global_load_lds_dwordx4 v2, s[42:43]
  s_add_u32 m0, s33, 8192
  s_nop 0
  global_load_lds_dwordx4 v2, s[44:45]
  v_mfma_f32_16x16x32_bf16 a[28:31], v[44:47], v[52:55], a[28:31]
  v_add_u32 v2, 1024, v2
  s_add_u32 s32, s32, 12288
  s_cmp_ge_u32 s32, 61440
  s_cselect_b32 s32, 0, s32
  s_waitcnt vmcnt(9) lgkmcnt(0)
  s_barrier
  v_mfma_f32_16x16x32_bf16 a[0:3], v[8:11], v[24:27], a[0:3]
  s_add_u32 s34, s31, s29
  s_add_u32 s35, s31, s30
  v_add_u32 v3, s34, v1
  v_add_u32 v4, s35, v1
  ds_read_b128 v[32:35], v4 offset:0
  v_mfma_f32_16x16x32_bf16 a[4:7], v[12:15], v[24:27], a[4:7]
  ds_read_b128 v[36:39], v4 offset:1024
  ds_read_b128 v[40:43], v4 offset:2048
  v_mfma_f32_16x16x32_bf16 a[8:11], v[16:19], v[24:27], a[8:11]
  ds_read_b128 v[44:47], v4 offset:3072
  v_mfma_f32_16x16x32_bf16 a[12:15], v[20:23], v[24:27], a[12:15]
  ds_read_b128 v[48:51], v3 offset:0
  ds_read_b128 v[52:55], v3 offset:1024
  v_mfma_f32_16x16x32_bf16 a[16:19], v[8:11], v[28:31], a[16:19]
  s_add_u32 s31, s31, 12288
  s_cmp_ge_u32 s31, 61440
  s_cselect_b32 s31, 0, s31
  s_add_u32 s33, s32, s28
  v_mfma_f32_16x16x32_bf16 a[20:23], v[12:15], v[28:31], a[20:23]
  s_add_u32 m0, s33, 0
  s_nop 0
  global_load_lds_dwordx4 v2, s[40:41]
  v_mfma_f32_16x16x32_bf16 a[24:27], v[16:19], v[28:31], a[24:27]
  s_add_u32 m0, s33, 4096
  s_nop 0
  global_load_lds_dwordx4 v2, s[42:43]
  s_add_u32 m0, s33, 8192
  s_nop 0
  global_load_lds_dwordx4 v2, s[44:45]
  v_mfma_f32_16x16x32_bf16 a[28:31], v[20:23], v[28:31], a[28:31]
  v_add_u32 v2, 1024, v2
  s_add_u32 s32, s32, 12288
  s_cmp_ge_u32 s32, 61440
  s_cselect_b32 s32, 0, s32
  s_add_u32 s36, s36, 2
  s_cmp_lt_u32 s36, 14
  s_cbranch_scc1 qkv_kernel_t_loop
  s_waitcnt vmcnt(9) lgkmcnt(0)
  s_barrier
  v_mfma_f32_16x16x32_bf16 a[0:3], v[32:35], v[48:51], a[0:3]
  s_add_u32 s34, s31, s29
  s_add_u32 s35, s31, s30
  v_add_u32 v3, s34, v1
  v_add_u32 v4, s35, v1
  v_mfma_f32_16x16x32_bf16 a[4:7], v[36:39], v[48:51], a[4:7]
  ds_read_b128 v[8:11], v4 offset:0
  v_mfma_f32_16x16x32_bf16 a[8:11], v[40:43], v[48:51], a[8:11]
  ds_read_b128 v[12:15], v4 offset:1024
  v_mfma_f32_16x16x32_bf16 a[12:15], v[44:47], v[48:51], a[12:15]
  ds_read_b128 v[16:19], v4 offset:2048
  v_mfma_f32_16x16x32_bf16 a[16:19], v[32:35], v[52:55], a[16:19]
  ds_read_b128 v[20:23], v4 offset:3072
  v_mfma_f32_16x16x32_bf16 a[20:23], v[36:39], v[52:55], a[20:23]
  ds_read_b128 v[24:27], v3 offset:0
  v_mfma_f32_16x16x32_bf16 a[24:27], v[40:43], v[52:55], a[24:27]
  ds_read_b128 v[28:31], v3 offset:1024
  v_mfma_f32_16x16x32_bf16 a[28:31], v[44:47], v[52:55], a[28:31]
  s_add_u32 s31, s31, 12288
  s_cmp_ge_u32 s31, 61440
  s_cselect_b32 s31, 0, s31
  s_waitcnt vmcnt(6) lgkmcnt(0)
  s_barrier
  v_mfma_f32_16x16x32_bf16 a[0:3], v[8:11], v[24:27], a[0:3]
  s_add_u32 s34, s31, s29
  s_add_u32 s35, s31, s30
  v_add_u32 v3, s34, v1
  v_add_u32 v4, s35, v1
  v_mfma_f32_16x16x32_bf16 a[4:7], v[12:15], v[24:27], a[4:7]
  ds_read_b128 v[32:35], v4 offset:0
  v_mfma_f32_16x16x32_bf16 a[8:11], v[16:19], v[24:27], a[8:11]
  ds_read_b128 v[36:39], v4 offset:1024
  v_mfma_f32_16x16x32_bf16 a[12:15], v[20:23], v[24:27], a[12:15]
  ds_read_b128 v[40:43], v4 offset:2048
  v_mfma_f32_16x16x32_bf16 a[16:19], v[8:11], v[28:31], a[16:19]
  ds_read_b128 v[44:47], v4 offset:3072
  v_mfma_f32_16x16x32_bf16 a[20:23], v[12:15], v[28:31], a[20:23]
  ds_read_b128 v[48:51], v3 offset:0
  v_mfma_f32_16x16x32_bf16 a[24:27], v[16:19], v[28:31], a[24:27]
  ds_read_b128 v[52:55], v3 offset:1024
  v_mfma_f32_16x16x32_bf16 a[28:31], v[20:23], v[28:31], a[28:31]
  s_add_u32 s31, s31, 12288
  s_cmp_ge_u32 s31, 61440
  s_cselect_b32 s31, 0, s31
  s_waitcnt vmcnt(3) lgkmcnt(0)
  s_barrier
  v_mfma_f32_16x16x32_bf16 a[0:3], v[32:35], v[48:51], a[0:3]
  s_add_u32 s34, s31, s29
  s_add_u32 s35, s31, s30
  v_add_u32 v3, s34, v1
  v_add_u32 v4, s35, v1
  v_mfma_f32_16x16x32_bf16 a[4:7], v[36:39], v[48:51], a[4:7]
  ds_read_b128 v[8:11], v4 offset:0
  v_mfma_f32_16x16x32_bf16 a[8:11], v[40:43], v[48:51], a[8:11]
  ds_read_b128 v[12:15], v4 offset:1024
  v_mfma_f32_16x16x32_bf16 a[12:15], v[44:47], v[48:51], a[12:15]
  ds_read_b128 v[16:19], v4 offset:2048
  v_mfma_f32_16x16x32_bf16 a[16:19], v[32:35], v[52:55], a[16:19]
  ds_read_b128 v[20:23], v4 offset:3072
  v_mfma_f32_16x16x32_bf16 a[20:23], v[36:39], v[52:55], a[20:23]
  ds_read_b128 v[24:27], v3 offset:0
  v_mfma_f32_16x16x32_bf16 a[24:27], v[40:43], v[52:55], a[24:27]
  ds_read_b128 v[28:31], v3 offset:1024
  v_mfma_f32_16x16x32_bf16 a[28:31], v[44:47], v[52:55], a[28:31]
  s_add_u32 s31, s31, 12288
  s_cmp_ge_u32 s31, 61440
  s_cselect_b32 s31, 0, s31
  s_waitcnt vmcnt(0) lgkmcnt(0)
  s_barrier
  v_mfma_f32_16x16x32_bf16 a[0:3], v[8:11], v[24:27], a[0:3]
  s_add_u32 s34, s31, s29
  s_add_u32 s35, s31, s30
  v_add_u32 v3, s34, v1
  v_add_u32 v4, s35, v1
  v_mfma_f32_16x16x32_bf16 a[4:7], v[12:15], v[24:27], a[4:7]
  ds_read_b128 v[32:35], v4 offset:0
  v_mfma_f32_16x16x32_bf16 a[8:11], v[16:19], v[24:27], a[8:11]
  ds_read_b128 v[36:39], v4 offset:1024
  v_mfma_f32_16x16x32_bf16 a[12:15], v[20:23], v[24:27], a[12:15]
  ds_read_b128 v[40:43], v4 offset:2048
  v_mfma_f32_16x16x32_bf16 a[16:19], v[8:11], v[28:31], a[16:19]
  ds_read_b128 v[44:47], v4 offset:3072
  v_mfma_f32_16x16x32_bf16 a[20:23], v[12:15], v[28:31], a[20:23]
  ds_read_b128 v[48:51], v3 offset:0
  v_mfma_f32_16x16x32_bf16 a[24:27], v[16:19], v[28:31], a[24:27]
  ds_read_b128 v[52:55], v3 offset:1024
  v_mfma_f32_16x16x32_bf16 a[28:31], v[20:23], v[28:31], a[28:31]
  s_add_u32 s31, s31, 12288
  s_cmp_ge_u32 s31, 61440
  s_cselect_b32 s31, 0, s31
  s_waitcnt lgkmcnt(0)
  v_mfma_f32_16x16x32_bf16 a[0:3], v[32:35], v[48:51], a[0:3]
  v_mfma_f32_16x16x32_bf16 a[4:7], v[36:39], v[48:51], a[4:7]
  v_mfma_f32_16x16x32_bf16 a[8:11], v[40:43], v[48:51], a[8:11]
  v_mfma_f32_16x16x32_bf16 a[12:15], v[44:47], v[48:51], a[12:15]
  v_mfma_f32_16x16x32_bf16 a[16:19], v[32:35], v[52:55], a[16:19]
  v_mfma_f32_16x16x32_bf16 a[20:23], v[36:39], v[52:55], a[20:23]
  v_mfma_f32_16x16x32_bf16 a[24:27], v[40:43], v[52:55], a[24:27]
  v_mfma_f32_16x16x32_bf16 a[28:31], v[44:47], v[52:55], a[28:31]
  s_nop 7
  s_nop 3
  s_lshl_b32 s10, s37, 24
  s_add_u32 s10, s10, 0x2000000
  s_mul_i32 s11, s20, 2
  s_mul_i32 s12, s23, 1
  s_add_u32 s11, s11, s12
  s_lshl_b32 s11, s11, 5
  s_add_u32 s11, s11, s38
  s_lshl_b32 s11, s11, 13
  s_add_u32 s10, s10, s11
  s_lshl_b32 s12, s24, 12
  s_add_u32 s10, s10, s12
  s_add_u32 s14, s6, s10
  s_addc_u32 s15, s7, 0
  v_accvgpr_read_b32 v8, a0
  v_accvgpr_read_b32 v12, a4
  v_accvgpr_read_b32 v9, a1
  v_accvgpr_read_b32 v13, a5
  v_accvgpr_read_b32 v10, a2
  v_accvgpr_read_b32 v14, a6
  v_accvgpr_read_b32 v11, a3
  v_accvgpr_read_b32 v15, a7
  v_cvt_pk_bf16_f32 v16, v8, v9
  v_cvt_pk_bf16_f32 v17, v10, v11
  v_cvt_pk_bf16_f32 v18, v12, v13
  v_cvt_pk_bf16_f32 v19, v14, v15
  global_store_dwordx4 v1, v[16:19], s[14:15] offset:0
  s_nop 1
  v_accvgpr_read_b32 v8, a8
  v_accvgpr_read_b32 v12, a12
  v_accvgpr_read_b32 v9, a9
  v_accvgpr_read_b32 v13, a13
  v_accvgpr_read_b32 v10, a10
  v_accvgpr_read_b32 v14, a14
  v_accvgpr_read_b32 v11, a11
  v_accvgpr_read_b32 v15, a15
  v_cvt_pk_bf16_f32 v16, v8, v9
  v_cvt_pk_bf16_f32 v17, v10, v11
  v_cvt_pk_bf16_f32 v18, v12, v13
  v_cvt_pk_bf16_f32 v19, v14, v15
  global_store_dwordx4 v1, v[16:19], s[14:15] offset:2048
  s_nop 1
  v_accvgpr_read_b32 v8, a16
  v_accvgpr_read_b32 v12, a20
  v_accvgpr_read_b32 v9, a17
  v_accvgpr_read_b32 v13, a21
  v_accvgpr_read_b32 v10, a18
  v_accvgpr_read_b32 v14, a22
  v_accvgpr_read_b32 v11, a19
  v_accvgpr_read_b32 v15, a23
  v_cvt_pk_bf16_f32 v16, v8, v9
  v_cvt_pk_bf16_f32 v17, v10, v11
  v_cvt_pk_bf16_f32 v18, v12, v13
  v_cvt_pk_bf16_f32 v19, v14, v15
  global_store_dwordx4 v1, v[16:19], s[14:15] offset:1024
  s_nop 1
  v_accvgpr_read_b32 v8, a24
  v_accvgpr_read_b32 v12, a28
  v_accvgpr_read_b32 v9, a25
  v_accvgpr_read_b32 v13, a29
  v_accvgpr_read_b32 v10, a26
  v_accvgpr_read_b32 v14, a30
  v_accvgpr_read_b32 v11, a27
  v_accvgpr_read_b32 v15, a31
  v_cvt_pk_bf16_f32 v16, v8, v9
  v_cvt_pk_bf16_f32 v17, v10, v11
  v_cvt_pk_bf16_f32 v18, v12, v13
  v_cvt_pk_bf16_f32 v19, v14, v15
  global_store_dwordx4 v1, v[16:19], s[14:15] offset:3072
  s_nop 1
  s_add_u32 s14, s14, 0x40000
  s_addc_u32 s15, s15, 0
  s_branch qkv_kernel_done
qkv_v:
  s_waitcnt vmcnt(12)
  s_barrier
  s_add_u32 s34, s31, s29
  s_add_u32 s35, s31, s30
  v_add_u32 v3, s34, v1
  v_add_u32 v4, s35, v1
  ds_read_b128 v[8:11], v4 offset:0
  ds_read_b128 v[12:15], v4 offset:1024
  ds_read_b128 v[16:19], v4 offset:2048
  ds_read_b128 v[20:23], v4 offset:3072
  ds_read_b128 v[24:27], v3 offset:0
  ds_read_b128 v[28:31], v3 offset:1024
  s_add_u32 s31, s31, 12288
  s_cmp_ge_u32 s31, 61440
  s_cselect_b32 s31, 0, s31
  s_waitcnt vmcnt(9) lgkmcnt(0)
  s_barrier
  v_mfma_f32_16x16x32_bf16 a[0:3], v[24:27], v[8:11], a[0:3]
  s_add_u32 s34, s31, s29
  s_add_u32 s35, s31, s30
  v_add_u32 v3, s34, v1
  v_add_u32 v4, s35, v1
  ds_read_b128 v[32:35], v4 offset:0
  v_mfma_f32_16x16x32_bf16 a[4:7], v[24:27], v[12:15], a[4:7]
  ds_read_b128 v[36:39], v4 offset:1024
  ds_read_b128 v[40:43], v4 offset:2048
  v_mfma_f32_16x16x32_bf16 a[8:11], v[24:27], v[16:19], a[8:11]
  ds_read_b128 v[44:47], v4 offset:3072
  v_mfma_f32_16x16x32_bf16 a[12:15], v[24:27], v[20:23], a[12:15]
  ds_read_b128 v[48:51], v3 offset:0
  ds_read_b128 v[52:55], v3 offset:1024
  v_mfma_f32_16x16x32_bf16 a[16:19], v[28:31], v[8:11], a[16:19]
  s_add_u32 s31, s31, 12288
  s_cmp_ge_u32 s31, 61440
  s_cselect_b32 s31, 0, s31
  s_add_u32 s33, s32, s28
  v_mfma_f32_16x16x32_bf16 a[20:23], v[28:31], v[12:15], a[20:23]
  s_add_u32 m0, s33, 0
  s_nop 0
  global_load_lds_dwordx4 v2, s[40:41]
  v_mfma_f32_16x16x32_bf16 a[24:27], v[28:31], v[16:19], a[24:27]
  s_add_u32 m0, s33, 4096
  s_nop 0
  global_load_lds_dwordx4 v2, s[42:43]
  s_add_u32 m0, s33, 8192
  s_nop 0
  global_load_lds_dwordx4 v2, s[44:45]
  v_mfma_f32_16x16x32_bf16 a[28:31], v[28:31], v[20:23], a[28:31]
  v_add_u32 v2, 1024, v2
  s_add_u32 s32, s32, 12288
  s_cmp_ge_u32 s32, 61440
  s_cselect_b32 s32, 0, s32
  s_mov_b32 s36, 0
qkv_kernel_n_loop:
  s_waitcnt vmcnt(9) lgkmcnt(0)
  s_barrier
  v_mfma_f32_16x16x32_bf16 a[0:3], v[48:51], v[32:35], a[0:3]
  s_add_u32 s34, s31, s29
  s_add_u32 s35, s31, s30
  v_add_u32 v3, s34, v1
  v_add_u32 v4, s35, v1
  ds_read_b128 v[8:11], v4 offset:0
  v_mfma_f32_16x16x32_bf16 a[4:7], v[48:51], v[36:39], a[4:7]
  ds_read_b128 v[12:15], v4 offset:1024
  ds_read_b128 v[16:19], v4 offset:2048
  v_mfma_f32_16x16x32_bf16 a[8:11], v[48:51], v[40:43], a[8:11]
  ds_read_b128 v[20:23], v4 offset:3072
  v_mfma_f32_16x16x32_bf16 a[12:15], v[48:51], v[44:47], a[12:15]
  ds_read_b128 v[24:27], v3 offset:0
  ds_read_b128 v[28:31], v3 offset:1024
  v_mfma_f32_16x16x32_bf16 a[16:19], v[52:55], v[32:35], a[16:19]
  s_add_u32 s31, s31, 12288
  s_cmp_ge_u32 s31, 61440
  s_cselect_b32 s31, 0, s31
  s_add_u32 s33, s32, s28
  v_mfma_f32_16x16x32_bf16 a[20:23], v[52:55], v[36:39], a[20:23]
  s_add_u32 m0, s33, 0
  s_nop 0
  global_load_lds_dwordx4 v2, s[40:41]
  v_mfma_f32_16x16x32_bf16 a[24:27], v[52:55], v[40:43], a[24:27]
  s_add_u32 m0, s33, 4096
  s_nop 0
  global_load_lds_dwordx4 v2, s[42:43]
  s_add_u32 m0, s33, 8192
  s_nop 0
  global_load_lds_dwordx4 v2, s[44:45]
  v_mfma_f32_16x16x32_bf16 a[28:31], v[52:55], v[44:47], a[28:31]
  v_add_u32 v2, 1024, v2
  s_add_u32 s32, s32, 12288
  s_cmp_ge_u32 s32, 61440
  s_cselect_b32 s32, 0, s32
  s_waitcnt vmcnt(9) lgkmcnt(0)
  s_barrier
  v_mfma_f32_16x16x32_bf16 a[0:3], v[24:27], v[8:11], a[0:3]
  s_add_u32 s34, s31, s29
  s_add_u32 s35, s31, s30
  v_add_u32 v3, s34, v1
  v_add_u32 v4, s35, v1
  ds_read_b128 v[32:35], v4 offset:0
  v_mfma_f32_16x16x32_bf16 a[4:7], v[24:27], v[12:15], a[4:7]
  ds_read_b128 v[36:39], v4 offset:1024
  ds_read_b128 v[40:43], v4 offset:2048
  v_mfma_f32_16x16x32_bf16 a[8:11], v[24:27], v[16:19], a[8:11]
  ds_read_b128 v[44:47], v4 offset:3072
  v_mfma_f32_16x16x32_bf16 a[12:15], v[24:27], v[20:23], a[12:15]
  ds_read_b128 v[48:51], v3 offset:0
  ds_read_b128 v[52:55], v3 offset:1024
  v_mfma_f32_16x16x32_bf16 a[16:19], v[28:31], v[8:11], a[16:19]
  s_add_u32 s31, s31, 12288
  s_cmp_ge_u32 s31, 61440
  s_cselect_b32 s31, 0, s31
  s_add_u32 s33, s32, s28
  v_mfma_f32_16x16x32_bf16 a[20:23], v[28:31], v[12:15], a[20:23]
  s_add_u32 m0, s33, 0
  s_nop 0
  global_load_lds_dwordx4 v2, s[40:41]
  v_mfma_f32_16x16x32_bf16 a[24:27], v[28:31], v[16:19], a[24:27]
  s_add_u32 m0, s33, 4096
  s_nop 0
  global_load_lds_dwordx4 v2, s[42:43]
  s_add_u32 m0, s33, 8192
  s_nop 0
  global_load_lds_dwordx4 v2, s[44:45]
  v_mfma_f32_16x16x32_bf16 a[28:31], v[28:31], v[20:23], a[28:31]
  v_add_u32 v2, 1024, v2
  s_add_u32 s32, s32, 12288
  s_cmp_ge_u32 s32, 61440
  s_cselect_b32 s32, 0, s32
  s_add_u32 s36, s36, 2
  s_cmp_lt_u32 s36, 14
  s_cbranch_scc1 qkv_kernel_n_loop
  s_waitcnt vmcnt(9) lgkmcnt(0)
  s_barrier
  v_mfma_f32_16x16x32_bf16 a[0:3], v[48:51], v[32:35], a[0:3]
  s_add_u32 s34, s31, s29
  s_add_u32 s35, s31, s30
  v_add_u32 v3, s34, v1
  v_add_u32 v4, s35, v1
  v_mfma_f32_16x16x32_bf16 a[4:7], v[48:51], v[36:39], a[4:7]
  ds_read_b128 v[8:11], v4 offset:0
  v_mfma_f32_16x16x32_bf16 a[8:11], v[48:51], v[40:43], a[8:11]
  ds_read_b128 v[12:15], v4 offset:1024
  v_mfma_f32_16x16x32_bf16 a[12:15], v[48:51], v[44:47], a[12:15]
  ds_read_b128 v[16:19], v4 offset:2048
  v_mfma_f32_16x16x32_bf16 a[16:19], v[52:55], v[32:35], a[16:19]
  ds_read_b128 v[20:23], v4 offset:3072
  v_mfma_f32_16x16x32_bf16 a[20:23], v[52:55], v[36:39], a[20:23]
  ds_read_b128 v[24:27], v3 offset:0
  v_mfma_f32_16x16x32_bf16 a[24:27], v[52:55], v[40:43], a[24:27]
  ds_read_b128 v[28:31], v3 offset:1024
  v_mfma_f32_16x16x32_bf16 a[28:31], v[52:55], v[44:47], a[28:31]
  s_add_u32 s31, s31, 12288
  s_cmp_ge_u32 s31, 61440
  s_cselect_b32 s31, 0, s31
  s_waitcnt vmcnt(6) lgkmcnt(0)
  s_barrier
  v_mfma_f32_16x16x32_bf16 a[0:3], v[24:27], v[8:11], a[0:3]
  s_add_u32 s34, s31, s29
  s_add_u32 s35, s31, s30
  v_add_u32 v3, s34, v1
  v_add_u32 v4, s35, v1
  v_mfma_f32_16x16x32_bf16 a[4:7], v[24:27], v[12:15], a[4:7]
  ds_read_b128 v[32:35], v4 offset:0
  v_mfma_f32_16x16x32_bf16 a[8:11], v[24:27], v[16:19], a[8:11]
  ds_read_b128 v[36:39], v4 offset:1024
  v_mfma_f32_16x16x32_bf16 a[12:15], v[24:27], v[20:23], a[12:15]
  ds_read_b128 v[40:43], v4 offset:2048
  v_mfma_f32_16x16x32_bf16 a[16:19], v[28:31], v[8:11], a[16:19]
  ds_read_b128 v[44:47], v4 offset:3072
  v_mfma_f32_16x16x32_bf16 a[20:23], v[28:31], v[12:15], a[20:23]
  ds_read_b128 v[48:51], v3 offset:0
  v_mfma_f32_16x16x32_bf16 a[24:27], v[28:31], v[16:19], a[24:27]
  ds_read_b128 v[52:55], v3 offset:1024
  v_mfma_f32_16x16x32_bf16 a[28:31], v[28:31], v[20:23], a[28:31]
  s_add_u32 s31, s31, 12288
  s_cmp_ge_u32 s31, 61440
  s_cselect_b32 s31, 0, s31
  s_waitcnt vmcnt(3) lgkmcnt(0)
  s_barrier
  v_mfma_f32_16x16x32_bf16 a[0:3], v[48:51], v[32:35], a[0:3]
  s_add_u32 s34, s31, s29
  s_add_u32 s35, s31, s30
  v_add_u32 v3, s34, v1
  v_add_u32 v4, s35, v1
  v_mfma_f32_16x16x32_bf16 a[4:7], v[48:51], v[36:39], a[4:7]
  ds_read_b128 v[8:11], v4 offset:0
  v_mfma_f32_16x16x32_bf16 a[8:11], v[48:51], v[40:43], a[8:11]
  ds_read_b128 v[12:15], v4 offset:1024
  v_mfma_f32_16x16x32_bf16 a[12:15], v[48:51], v[44:47], a[12:15]
  ds_read_b128 v[16:19], v4 offset:2048
  v_mfma_f32_16x16x32_bf16 a[16:19], v[52:55], v[32:35], a[16:19]
  ds_read_b128 v[20:23], v4 offset:3072
  v_mfma_f32_16x16x32_bf16 a[20:23], v[52:55], v[36:39], a[20:23]
  ds_read_b128 v[24:27], v3 offset:0
  v_mfma_f32_16x16x32_bf16 a[24:27], v[52:55], v[40:43], a[24:27]
  ds_read_b128 v[28:31], v3 offset:1024
  v_mfma_f32_16x16x32_bf16 a[28:31], v[52:55], v[44:47], a[28:31]
  s_add_u32 s31, s31, 12288
  s_cmp_ge_u32 s31, 61440
  s_cselect_b32 s31, 0, s31
  s_waitcnt vmcnt(0) lgkmcnt(0)
  s_barrier
  v_mfma_f32_16x16x32_bf16 a[0:3], v[24:27], v[8:11], a[0:3]
  s_add_u32 s34, s31, s29
  s_add_u32 s35, s31, s30
  v_add_u32 v3, s34, v1
  v_add_u32 v4, s35, v1
  v_mfma_f32_16x16x32_bf16 a[4:7], v[24:27], v[12:15], a[4:7]
  ds_read_b128 v[32:35], v4 offset:0
  v_mfma_f32_16x16x32_bf16 a[8:11], v[24:27], v[16:19], a[8:11]
  ds_read_b128 v[36:39], v4 offset:1024
  v_mfma_f32_16x16x32_bf16 a[12:15], v[24:27], v[20:23], a[12:15]
  ds_read_b128 v[40:43], v4 offset:2048
  v_mfma_f32_16x16x32_bf16 a[16:19], v[28:31], v[8:11], a[16:19]
  ds_read_b128 v[44:47], v4 offset:3072
  v_mfma_f32_16x16x32_bf16 a[20:23], v[28:31], v[12:15], a[20:23]
  ds_read_b128 v[48:51], v3 offset:0
  v_mfma_f32_16x16x32_bf16 a[24:27], v[28:31], v[16:19], a[24:27]
  ds_read_b128 v[52:55], v3 offset:1024
  v_mfma_f32_16x16x32_bf16 a[28:31], v[28:31], v[20:23], a[28:31]
  s_add_u32 s31, s31, 12288
  s_cmp_ge_u32 s31, 61440
  s_cselect_b32 s31, 0, s31
  s_waitcnt lgkmcnt(0)
  v_mfma_f32_16x16x32_bf16 a[0:3], v[48:51], v[32:35], a[0:3]
  v_mfma_f32_16x16x32_bf16 a[4:7], v[48:51], v[36:39], a[4:7]
  v_mfma_f32_16x16x32_bf16 a[8:11], v[48:51], v[40:43], a[8:11]
  v_mfma_f32_16x16x32_bf16 a[12:15], v[48:51], v[44:47], a[12:15]
  v_mfma_f32_16x16x32_bf16 a[16:19], v[52:55], v[32:35], a[16:19]
  v_mfma_f32_16x16x32_bf16 a[20:23], v[52:55], v[36:39], a[20:23]
  v_mfma_f32_16x16x32_bf16 a[24:27], v[52:55], v[40:43], a[24:27]
  v_mfma_f32_16x16x32_bf16 a[28:31], v[52:55], v[44:47], a[28:31]
  s_nop 7
  s_nop 3
  s_mul_i32 s11, s20, 2
  s_mul_i32 s12, s23, 1
  s_add_u32 s11, s11, s12
  s_lshl_b32 s11, s11, 5
  s_add_u32 s11, s11, s38
  s_lshl_b32 s11, s11, 13
  s_add_u32 s10, s11, 0x4000000
  s_lshl_b32 s12, s24, 12
  s_add_u32 s10, s10, s12
  s_add_u32 s14, s6, s10
  s_addc_u32 s15, s7, 0
  v_accvgpr_read_b32 v8, a0
  v_accvgpr_read_b32 v12, a16
  v_accvgpr_read_b32 v9, a1
  v_accvgpr_read_b32 v13, a17
  v_accvgpr_read_b32 v10, a2
  v_accvgpr_read_b32 v14, a18
  v_accvgpr_read_b32 v11, a3
  v_accvgpr_read_b32 v15, a19
  v_cvt_pk_bf16_f32 v16, v8, v9
  v_cvt_pk_bf16_f32 v17, v10, v11
  v_cvt_pk_bf16_f32 v18, v12, v13
  v_cvt_pk_bf16_f32 v19, v14, v15
  global_store_dwordx4 v1, v[16:19], s[14:15] offset:0
  s_nop 1
  v_accvgpr_read_b32 v8, a4
  v_accvgpr_read_b32 v12, a20
  v_accvgpr_read_b32 v9, a5
  v_accvgpr_read_b32 v13, a21
  v_accvgpr_read_b32 v10, a6
  v_accvgpr_read_b32 v14, a22
  v_accvgpr_read_b32 v11, a7
  v_accvgpr_read_b32 v15, a23
  v_cvt_pk_bf16_f32 v16, v8, v9
  v_cvt_pk_bf16_f32 v17, v10, v11
  v_cvt_pk_bf16_f32 v18, v12, v13
  v_cvt_pk_bf16_f32 v19, v14, v15
  global_store_dwordx4 v1, v[16:19], s[14:15] offset:1024
  s_nop 1
  v_accvgpr_read_b32 v8, a8
  v_accvgpr_read_b32 v12, a24
  v_accvgpr_read_b32 v9, a9
  v_accvgpr_read_b32 v13, a25
  v_accvgpr_read_b32 v10, a10
  v_accvgpr_read_b32 v14, a26
  v_accvgpr_read_b32 v11, a11
  v_accvgpr_read_b32 v15, a27
  v_cvt_pk_bf16_f32 v16, v8, v9
  v_cvt_pk_bf16_f32 v17, v10, v11
  v_cvt_pk_bf16_f32 v18, v12, v13
  v_cvt_pk_bf16_f32 v19, v14, v15
  global_store_dwordx4 v1, v[16:19], s[14:15] offset:2048
  s_nop 1
  v_accvgpr_read_b32 v8, a12
  v_accvgpr_read_b32 v12, a28
  v_accvgpr_read_b32 v9, a13
  v_accvgpr_read_b32 v13, a29
  v_accvgpr_read_b32 v10, a14
  v_accvgpr_read_b32 v14, a30
  v_accvgpr_read_b32 v11, a15
  v_accvgpr_read_b32 v15, a31
  v_cvt_pk_bf16_f32 v16, v8, v9
  v_cvt_pk_bf16_f32 v17, v10, v11
  v_cvt_pk_bf16_f32 v18, v12, v13
  v_cvt_pk_bf16_f32 v19, v14, v15
  global_store_dwordx4 v1, v[16:19], s[14:15] offset:3072
  s_nop 1
  s_add_u32 s14, s14, 0x40000
  s_addc_u32 s15, s15, 0
qkv_kernel_done:
  s_endpgm
.globl chain_kernel
.p2align 8
.type chain_kernel,@function
chain_kernel:
  s_cmp_ge_u32 s2, 256
  s_cbranch_scc1 chain_done
  s_load_dwordx2 s[4:5], s[0:1], 8
  s_load_dwordx2 s[6:7], s[0:1], 104
  v_lshrrev_b32 v2, 6, v0
  v_and_b32 v3, 63, v0
  s_nop 0
  v_readfirstlane_b32 s8, v2
  v_lshlrev_b32 v1, 4, v3
  v_and_b32 v4, 15, v3
  v_lshrrev_b32 v5, 4, v3
  s_load_dwordx2 s[70:71], s[0:1], 96
  s_getreg_b32 s61, hwreg(HW_REG_XCC_ID)
  s_and_b32 s61, s61, 15
  s_mov_b32 s94, 0
  s_mov_b32 s95, 0
  s_waitcnt lgkmcnt(0)
  s_mov_b64 s[12:13], s[6:7]
  s_mov_b64 s[14:15], s[6:7]
  s_mov_b64 s[16:17], s[6:7]
  s_mov_b64 s[18:19], s[6:7]
  s_mov_b64 s[20:21], s[6:7]
  s_mov_b64 s[22:23], s[6:7]
  s_mov_b64 s[24:25], s[6:7]
  s_mov_b64 s[26:27], s[6:7]
  s_mov_b64 s[28:29], s[6:7]
  s_mov_b64 s[30:31], s[6:7]
  s_mov_b64 s[32:33], s[6:7]
  s_mov_b64 s[34:35], s[6:7]
  s_mov_b64 s[36:37], s[6:7]
  s_mov_b64 s[38:39], s[6:7]
  s_mov_b64 s[40:41], s[6:7]
  s_mov_b64 s[42:43], s[6:7]
  s_mov_b64 s[44:45], s[6:7]
  s_mov_b64 s[58:59], s[6:7]
  s_mov_b64 s[92:93], s[6:7]
  s_mov_b64 s[96:97], s[6:7]
  v_mov_b32 v2, 0
  v_mov_b32 v6, 0
  v_mov_b32 v7, 0
  v_mov_b32 v8, 0
  v_mov_b32 v9, 0
  v_mov_b32 v10, 0
  v_mov_b32 v11, 0
  v_mov_b32 v12, 0
  v_mov_b32 v13, 0
  v_mov_b32 v14, 0
  v_mov_b32 v15, 0
  s_cmp_lg_u32 s8, 0
  s_cbranch_scc1 chain_tk_wait
  s_min_u32 s11, s61, 8
  s_lshl_b32 s11, s11, 2
  v_mov_b32 v16, s11
  v_mov_b32 v17, 1
  v_mov_b32 v19, 64
  s_mov_b64 s[56:57], exec
  s_mov_b64 exec, 1
  global_atomic_add v18, v16, v17, s[70:71] sc0
  s_waitcnt vmcnt(0)
  global_atomic_add v19, v17, s[70:71]
  v_mov_b32 v16, 137216
  ds_write_b32 v16, v18
  s_waitcnt vmcnt(0) lgkmcnt(0)
  s_mov_b64 exec, s[56:57]
chain_tk_wait:
  s_barrier
  v_mov_b32 v16, 137216
  ds_read_b32 v18, v16
  s_waitcnt lgkmcnt(0)
  s_nop 0
  v_readfirstlane_b32 s9, v18
  s_mov_b32 s10, s61
  s_mov_b32 s65, 0
  s_mov_b32 s51, 1
  s_cmp_lt_u32 s9, 32
  s_cselect_b32 s11, 1, 0
  s_cmp_lt_u32 s10, 8
  s_cselect_b32 s11, s11, 0
  s_cmp_eq_u32 s11, 1
  s_cbranch_scc1 chain_setup
chain_slow:
  s_mov_b32 s11, 0x33333334
  s_mul_hi_u32 s9, s2, s11
  s_mul_i32 s11, s9, 5
  s_sub_u32 s10, s2, s11
  s_mov_b32 s51, 0
  s_cmp_lt_u32 s2, 160
  s_cbranch_scc1 chain_setup
  s_sub_u32 s11, s2, 160
  s_lshr_b32 s10, s11, 5
  s_add_u32 s10, s10, 5
  s_and_b32 s9, s11, 31
chain_setup:
  s_cmp_ge_u32 s10, 5
  s_cbranch_scc1 chain_verify
  s_lshl_b32 s11, s9, 3
  s_lshl_b32 s12, s8, 1
  s_add_u32 s11, s11, s12
  s_mul_i32 s11, s11, 20480
  s_add_u32 s11, s11, 0x280000
  s_add_u32 s14, s6, s11
  s_addc_u32 s15, s7, 0
  s_add_u32 s16, s14, 20480
  s_addc_u32 s17, s15, 0
  s_add_u32 s18, s14, 5242880
  s_addc_u32 s19, s15, 0
  s_add_u32 s20, s18, 20480
  s_addc_u32 s21, s19, 0
  s_add_u32 s22, s18, 5242880
  s_addc_u32 s23, s19, 0
  s_add_u32 s24, s22, 20480
  s_addc_u32 s25, s23, 0
  v_mov_b32 v6, v1
  global_load_dwordx4 a[0:3], v6, s[14:15]
  global_load_dwordx4 a[4:7], v6, s[16:17]
  global_load_dwordx4 a[8:11], v6, s[18:19]
  global_load_dwordx4 a[12:15], v6, s[20:21]
  global_load_dwordx4 v[176:179], v6, s[22:23]
  global_load_dwordx4 v[180:183], v6, s[24:25]
  v_add_u32 v6, 0x400, v6
  global_load_dwordx4 a[16:19], v6, s[14:15]
  global_load_dwordx4 a[20:23], v6, s[16:17]
  global_load_dwordx4 a[24:27], v6, s[18:19]
  global_load_dwordx4 a[28:31], v6, s[20:21]
  global_load_dwordx4 v[184:187], v6, s[22:23]
  global_load_dwordx4 v[188:191], v6, s[24:25]
  v_add_u32 v6, 0x400, v6
  global_load_dwordx4 a[32:35], v6, s[14:15]
  global_load_dwordx4 a[36:39], v6, s[16:17]
  global_load_dwordx4 a[40:43], v6, s[18:19]
  global_load_dwordx4 a[44:47], v6, s[20:21]
  global_load_dwordx4 v[192:195], v6, s[22:23]
  global_load_dwordx4 v[196:199], v6, s[24:25]
  v_add_u32 v6, 0x400, v6
  global_load_dwordx4 a[48:51], v6, s[14:15]
  global_load_dwordx4 a[52:55], v6, s[16:17]
  global_load_dwordx4 a[56:59], v6, s[18:19]
  global_load_dwordx4 a[60:63], v6, s[20:21]
  global_load_dwordx4 v[200:203], v6, s[22:23]
  global_load_dwordx4 v[204:207], v6, s[24:25]
  v_add_u32 v6, 0x400, v6
  global_load_dwordx4 a[64:67], v6, s[14:15]
  global_load_dwordx4 a[68:71], v6, s[16:17]
  global_load_dwordx4 a[72:75], v6, s[18:19]
  global_load_dwordx4 a[76:79], v6, s[20:21]
  global_load_dwordx4 v[208:211], v6, s[22:23]
  global_load_dwordx4 v[212:215], v6, s[24:25]
  v_add_u32 v6, 0x400, v6
  global_load_dwordx4 a[80:83], v6, s[14:15]
  global_load_dwordx4 a[84:87], v6, s[16:17]
  global_load_dwordx4 a[88:91], v6, s[18:19]
  global_load_dwordx4 a[92:95], v6, s[20:21]
  global_load_dwordx4 v[216:219], v6, s[22:23]
  global_load_dwordx4 v[220:223], v6, s[24:25]
  v_add_u32 v6, 0x400, v6
  global_load_dwordx4 a[96:99], v6, s[14:15]
  global_load_dwordx4 a[100:103], v6, s[16:17]
  global_load_dwordx4 a[104:107], v6, s[18:19]
  global_load_dwordx4 a[108:111], v6, s[20:21]
  global_load_dwordx4 v[224:227], v6, s[22:23]
  global_load_dwordx4 v[228:231], v6, s[24:25]
  v_add_u32 v6, 0x400, v6
  global_load_dwordx4 a[112:115], v6, s[14:15]
  global_load_dwordx4 a[116:119], v6, s[16:17]
  global_load_dwordx4 a[120:123], v6, s[18:19]
  global_load_dwordx4 a[124:127], v6, s[20:21]
  global_load_dwordx4 v[232:235], v6, s[22:23]
  global_load_dwordx4 v[236:239], v6, s[24:25]
  v_add_u32 v6, 0x400, v6
  global_load_dwordx4 a[128:131], v6, s[14:15]
  global_load_dwordx4 a[132:135], v6, s[16:17]
  global_load_dwordx4 a[136:139], v6, s[18:19]
  global_load_dwordx4 a[140:143], v6, s[20:21]
  global_load_dwordx4 v[240:243], v6, s[22:23]
  global_load_dwordx4 v[244:247], v6, s[24:25]
  v_add_u32 v6, 0x400, v6
  global_load_dwordx4 a[144:147], v6, s[14:15]
  global_load_dwordx4 a[148:151], v6, s[16:17]
  global_load_dwordx4 a[152:155], v6, s[18:19]
  global_load_dwordx4 a[156:159], v6, s[20:21]
  global_load_dwordx4 v[248:251], v6, s[22:23]
  global_load_dwordx4 v[252:255], v6, s[24:25]
  v_add_u32 v6, 0x400, v6
  global_load_dwordx4 a[160:163], v6, s[14:15]
  global_load_dwordx4 a[164:167], v6, s[16:17]
  global_load_dwordx4 a[168:171], v6, s[18:19]
  global_load_dwordx4 a[172:175], v6, s[20:21]
  s_mul_i32 s26, s8, 20480
  s_add_u32 m0, s26, 0
  s_nop 0
  global_load_lds_dwordx4 v6, s[22:23]
  s_mul_i32 s26, s8, 20480
  s_add_u32 m0, s26, 1024
  s_nop 0
  global_load_lds_dwordx4 v6, s[24:25]
  v_add_u32 v6, 0x400, v6
  global_load_dwordx4 a[176:179], v6, s[14:15]
  global_load_dwordx4 a[180:183], v6, s[16:17]
  global_load_dwordx4 a[184:187], v6, s[18:19]
  global_load_dwordx4 a[188:191], v6, s[20:21]
  s_mul_i32 s26, s8, 20480
  s_add_u32 m0, s26, 2048
  s_nop 0
  global_load_lds_dwordx4 v6, s[22:23]
  s_mul_i32 s26, s8, 20480
  s_add_u32 m0, s26, 3072
  s_nop 0
  global_load_lds_dwordx4 v6, s[24:25]
  v_add_u32 v6, 0x400, v6
  global_load_dwordx4 a[192:195], v6, s[14:15]
  global_load_dwordx4 a[196:199], v6, s[16:17]
  global_load_dwordx4 a[200:203], v6, s[18:19]
  global_load_dwordx4 a[204:207], v6, s[20:21]
  s_mul_i32 s26, s8, 20480
  s_add_u32 m0, s26, 4096
  s_nop 0
  global_load_lds_dwordx4 v6, s[22:23]
  s_mul_i32 s26, s8, 20480
  s_add_u32 m0, s26, 5120
  s_nop 0
  global_load_lds_dwordx4 v6, s[24:25]
  v_add_u32 v6, 0x400, v6
  global_load_dwordx4 a[208:211], v6, s[14:15]
  global_load_dwordx4 a[212:215], v6, s[16:17]
  global_load_dwordx4 a[216:219], v6, s[18:19]
  global_load_dwordx4 a[220:223], v6, s[20:21]
  s_mul_i32 s26, s8, 20480
  s_add_u32 m0, s26, 6144
  s_nop 0
  global_load_lds_dwordx4 v6, s[22:23]
  s_mul_i32 s26, s8, 20480
  s_add_u32 m0, s26, 7168
  s_nop 0
  global_load_lds_dwordx4 v6, s[24:25]
  v_add_u32 v6, 0x400, v6
  global_load_dwordx4 a[224:227], v6, s[14:15]
  global_load_dwordx4 a[228:231], v6, s[16:17]
  global_load_dwordx4 a[232:235], v6, s[18:19]
  global_load_dwordx4 a[236:239], v6, s[20:21]
  s_mul_i32 s26, s8, 20480
  s_add_u32 m0, s26, 8192
  s_nop 0
  global_load_lds_dwordx4 v6, s[22:23]
  s_mul_i32 s26, s8, 20480
  s_add_u32 m0, s26, 9216
  s_nop 0
  global_load_lds_dwordx4 v6, s[24:25]
  v_add_u32 v6, 0x400, v6
  global_load_dwordx4 a[240:243], v6, s[14:15]
  global_load_dwordx4 a[244:247], v6, s[16:17]
  global_load_dwordx4 a[248:251], v6, s[18:19]
  global_load_dwordx4 a[252:255], v6, s[20:21]
  s_mul_i32 s26, s8, 20480
  s_add_u32 m0, s26, 10240
  s_nop 0
  global_load_lds_dwordx4 v6, s[22:23]
  s_mul_i32 s26, s8, 20480
  s_add_u32 m0, s26, 11264
  s_nop 0
  global_load_lds_dwordx4 v6, s[24:25]
  v_add_u32 v6, 0x400, v6
  global_load_dwordx4 v[112:115], v6, s[14:15]
  global_load_dwordx4 v[116:119], v6, s[16:17]
  global_load_dwordx4 v[120:123], v6, s[18:19]
  global_load_dwordx4 v[124:127], v6, s[20:21]
  s_mul_i32 s26, s8, 20480
  s_add_u32 m0, s26, 12288
  s_nop 0
  global_load_lds_dwordx4 v6, s[22:23]
  s_mul_i32 s26, s8, 20480
  s_add_u32 m0, s26, 13312
  s_nop 0
  global_load_lds_dwordx4 v6, s[24:25]
  v_add_u32 v6, 0x400, v6
  global_load_dwordx4 v[128:131], v6, s[14:15]
  global_load_dwordx4 v[132:135], v6, s[16:17]
  global_load_dwordx4 v[136:139], v6, s[18:19]
  global_load_dwordx4 v[140:143], v6, s[20:21]
  s_mul_i32 s26, s8, 20480
  s_add_u32 m0, s26, 14336
  s_nop 0
  global_load_lds_dwordx4 v6, s[22:23]
  s_mul_i32 s26, s8, 20480
  s_add_u32 m0, s26, 15360
  s_nop 0
  global_load_lds_dwordx4 v6, s[24:25]
  v_add_u32 v6, 0x400, v6
  global_load_dwordx4 v[144:147], v6, s[14:15]
  global_load_dwordx4 v[148:151], v6, s[16:17]
  global_load_dwordx4 v[152:155], v6, s[18:19]
  global_load_dwordx4 v[156:159], v6, s[20:21]
  s_mul_i32 s26, s8, 20480
  s_add_u32 m0, s26, 16384
  s_nop 0
  global_load_lds_dwordx4 v6, s[22:23]
  s_mul_i32 s26, s8, 20480
  s_add_u32 m0, s26, 17408
  s_nop 0
  global_load_lds_dwordx4 v6, s[24:25]
  v_add_u32 v6, 0x400, v6
  global_load_dwordx4 v[160:163], v6, s[14:15]
  global_load_dwordx4 v[164:167], v6, s[16:17]
  global_load_dwordx4 v[168:171], v6, s[18:19]
  global_load_dwordx4 v[172:175], v6, s[20:21]
  s_mul_i32 s26, s8, 20480
  s_add_u32 m0, s26, 18432
  s_nop 0
  global_load_lds_dwordx4 v6, s[22:23]
  s_mul_i32 s26, s8, 20480
  s_add_u32 m0, s26, 19456
  s_nop 0
  global_load_lds_dwordx4 v6, s[24:25]
  v_add_u32 v6, 0x400, v6
  s_mul_i32 s11, s10, 1032
  s_lshl_b32 s12, s9, 2
  s_add_u32 s11, s11, s12
  s_add_u32 s11, s11, s8
  s_lshl_b32 s11, s11, 10
  s_add_u32 s11, s11, 0x1180000
  s_add_u32 s26, s6, s11
  s_addc_u32 s27, s7, 0
  s_lshl_b32 s12, s8, 10
  s_add_u32 m0, s12, 81920
  s_nop 0
  global_load_lds_dwordx4 v1, s[26:27]
  s_add_u32 s26, s26, 132096
  s_addc_u32 s27, s27, 0
  s_add_u32 m0, s12, 86016
  s_nop 0
  global_load_lds_dwordx4 v1, s[26:27]
  s_add_u32 s26, s26, 132096
  s_addc_u32 s27, s27, 0
  s_add_u32 m0, s12, 90112
  s_nop 0
  global_load_lds_dwordx4 v1, s[26:27]
  s_add_u32 s26, s26, 132096
  s_addc_u32 s27, s27, 0
  s_add_u32 m0, s12, 94208
  s_nop 0
  global_load_lds_dwordx4 v1, s[26:27]
  s_add_u32 s26, s26, 132096
  s_addc_u32 s27, s27, 0
  s_add_u32 m0, s12, 98304
  s_nop 0
  global_load_lds_dwordx4 v1, s[26:27]
  s_add_u32 s26, s26, 132096
  s_addc_u32 s27, s27, 0
  s_add_u32 m0, s12, 102400
  s_nop 0
  global_load_lds_dwordx4 v1, s[26:27]
  s_add_u32 s26, s26, 132096
  s_addc_u32 s27, s27, 0
  s_add_u32 m0, s12, 106496
  s_nop 0
  global_load_lds_dwordx4 v1, s[26:27]
  s_add_u32 s26, s26, 132096
  s_addc_u32 s27, s27, 0
  s_add_u32 m0, s12, 110592
  s_nop 0
  global_load_lds_dwordx4 v1, s[26:27]
  s_add_u32 s26, s26, 132096
  s_addc_u32 s27, s27, 0
  s_mul_i32 s11, s8, 160
  v_add_u32 v8, s11, v3
  v_lshlrev_b32 v9, 4, v8
  v_add_u32 v10, 114688, v9
  v_and_b32 v11, 7, v8
  v_mul_u32_u24 v11, 0x500, v11
  v_lshrrev_b32 v12, 5, v8
  v_lshl_add_u32 v11, v12, 6, v11
  v_bfe_u32 v12, v8, 3, 2
  v_lshl_add_u32 v11, v12, 4, v11
  v_lshrrev_b32 v12, 1, v5
  v_lshlrev_b32 v12, 13, v12
  v_lshrrev_b32 v13, 2, v4
  v_lshl_add_u32 v12, v13, 12, v12
  v_and_b32 v13, 3, v4
  v_lshl_add_u32 v12, v13, 5, v12
  v_and_b32 v13, 1, v5
  v_lshl_add_u32 v12, v13, 4, v12
  v_lshlrev_b32 v13, 3, v3
  s_lshl_b32 s11, s10, 17
  s_lshl_b32 s12, s9, 7
  s_add_u32 s11, s11, s12
  s_lshl_b32 s12, s8, 15
  s_add_u32 s11, s11, s12
  s_add_u32 s11, s11, 0x8000000
  s_add_u32 s28, s6, s11
  s_addc_u32 s29, s7, 0
  s_lshl_b32 s11, s10, 5
  s_add_u32 s11, s11, s9
  s_lshl_b32 s12, s11, 12
  s_add_u32 s12, s12, 0x8000000
  s_add_u32 s30, s6, s12
  s_addc_u32 s31, s7, 0
  s_lshl_b32 s12, s11, 6
  s_add_u32 s12, s12, 0x8402800
  s_add_u32 s32, s6, s12
  s_addc_u32 s33, s7, 0
  s_mul_i32 s12, s10, 665600
  s_add_u32 s12, s12, 0x8402800
  s_add_u32 s34, s6, s12
  s_addc_u32 s35, s7, 0
  v_lshrrev_b32 v2, 3, v3
  v_mul_u32_u24 v2, 665600, v2
  v_and_b32 v7, 7, v3
  v_lshl_add_u32 v2, v7, 3, v2
  s_lshl_b32 s12, s10, 7
  s_add_u32 s12, s12, 0x8914000
  s_add_u32 s92, s6, s12
  s_addc_u32 s93, s7, 0
  s_lshl_b32 s94, s9, 2
  s_mov_b32 s36, 1
  s_cmp_eq_u32 s8, 3
  s_cselect_b32 s36, s36, 0
  s_lshl_b32 s11, s9, 13
  s_lshl_b32 s12, s8, 11
  s_add_u32 s11, s11, s12
  s_add_u32 s12, s11, 0x3000000
  s_add_u32 s38, s6, s12
  s_addc_u32 s39, s7, 0
  s_add_u32 s12, s11, 0x4000000
  s_add_u32 s40, s6, s12
  s_addc_u32 s41, s7, 0
  s_lshl_b32 s11, s9, 12
  s_lshl_b32 s12, s8, 10
  s_add_u32 s11, s11, s12
  s_add_u32 s12, s11, 0xc000000
  s_add_u32 s42, s6, s12
  s_addc_u32 s43, s7, 0
  s_add_u32 s12, s11, 0xc800000
  s_add_u32 s44, s6, s12
  s_addc_u32 s45, s7, 0
  v_lshrrev_b32 v7, 3, v4
  v_mul_u32_u24 v7, 6144, v7
  v_and_b32 v14, 7, v4
  v_lshl_add_u32 v7, v14, 4, v7
  v_lshl_add_u32 v7, v5, 8, v7
  v_add_u32 v7, 124928, v7
  v_and_b32 v14, 7, v4
  v_lshlrev_b32 v14, 4, v14
  v_lshl_add_u32 v14, v5, 7, v14
  v_add_u32 v14, 114688, v14
  s_mul_i32 s11, s8, 20480
  v_add_u32 v15, s11, v1
  s_mul_i32 s46, s8, 3072
  s_add_u32 s46, s46, 124928
  s_lshl_b32 s47, s8, 10
  s_add_u32 s47, s47, 137216
  s_lshl_b32 s48, s8, 13
  s_add_u32 s48, s48, 81920
  s_mov_b32 s49, 0
  s_mov_b32 s50, 0
  s_mov_b32 s52, 0x3db504f3
  s_mov_b32 s53, 1040356334
  s_mov_b32 s54, 0xffff0000
  s_lshl_b32 s95, s8, 12
  s_add_u32 s95, s95, 141312
  v_add_u32 v6, s95, v1
  s_mov_b32 m0, s95
  s_nop 0
  global_load_lds_dwordx4 v1, s[38:39]
  global_load_lds_dwordx4 v1, s[38:39] offset:1024
  s_add_u32 m0, s95, 2048
  s_nop 0
  global_load_lds_dwordx4 v1, s[40:41]
  global_load_lds_dwordx4 v1, s[40:41] offset:1024
  v_mov_b32 v24, 0
  v_mov_b32 v25, 0
  v_mov_b32 v26, 0
  v_mov_b32 v27, 0
  global_load_dwordx4 v[16:19], v11, s[4:5]
  global_load_dwordx4 v[20:23], v11, s[4:5] offset:128
  v_cmp_gt_u32 vcc, 32, v3
  s_and_saveexec_b64 s[56:57], vcc
  global_load_dwordx4 v[24:27], v11, s[4:5] offset:256
  s_mov_b64 exec, s[56:57]
chain_verify:
  s_waitcnt vmcnt(0) lgkmcnt(0)
  s_cmp_eq_u32 s65, 1
  s_cbranch_scc1 chain_verified
  s_mov_b32 s60, 0
  v_lshlrev_b32 v28, 2, v3
  s_cmp_lg_u32 s8, 0
  s_cbranch_scc1 chain_vwait
chain_vpoll:
  s_sleep 4
  v_mov_b32 v29, 32
  v_cmp_gt_u32 vcc, 17, v3
  s_and_saveexec_b64 s[56:57], vcc
  global_load_dword v29, v28, s[70:71] sc1
  s_mov_b64 exec, s[56:57]
  s_waitcnt vmcnt(0)
  v_readlane_b32 s11, v29, 16
  s_add_u32 s60, s60, 1
  s_cmp_gt_u32 s60, 30000
  s_cbranch_scc1 chain_vdone
  s_cmp_lt_u32 s11, 256
  s_cbranch_scc1 chain_vpoll
chain_vdone:
  v_mov_b32 v29, 32
  v_cmp_gt_u32 vcc, 8, v3
  s_and_saveexec_b64 s[56:57], vcc
  global_load_dword v29, v28, s[70:71] sc1
  s_mov_b64 exec, s[56:57]
  s_waitcnt vmcnt(0)
  v_cmp_ne_u32 vcc, 32, v29
  s_mov_b32 s11, 0
  s_cbranch_vccz chain_vok
  s_mov_b32 s11, 1
chain_vok:
  v_mov_b32 v29, s11
  v_mov_b32 v30, 137280
  ds_write_b32 v30, v29
  s_waitcnt lgkmcnt(0)
chain_vwait:
  s_barrier
  v_mov_b32 v30, 137280
  ds_read_b32 v29, v30
  s_waitcnt lgkmcnt(0)
  s_nop 0
  v_readfirstlane_b32 s11, v29
  s_mov_b32 s65, 1
  s_nop 2
  s_cmp_eq_u32 s11, 0
  s_cbranch_scc1 chain_verified
  s_barrier
  s_branch chain_slow
chain_verified:
  s_barrier
  s_cmp_ge_u32 s10, 5
  s_cbranch_scc1 chain_bulk
chain_step:
  ds_read_b128 v[72:75], v6
  ds_read_b128 v[76:79], v6 offset:1024
  ds_read_b128 v[80:83], v6 offset:2048
  ds_read_b128 v[84:87], v6 offset:3072
  ds_write_b128 v10, v[16:19]
  ds_write_b128 v10, v[20:23] offset:1024
  v_cmp_gt_u32 vcc, 32, v3
  s_and_saveexec_b64 s[56:57], vcc
  ds_write_b128 v10, v[24:27] offset:2048
  s_mov_b64 exec, s[56:57]
  s_add_u32 s38, s38, 0x40000
  s_addc_u32 s39, s39, 0
  s_add_u32 s40, s40, 0x40000
  s_addc_u32 s41, s41, 0
  s_waitcnt lgkmcnt(0)
  s_barrier
  s_cmp_eq_u32 s49, 63
  s_cbranch_scc1 chain_nokv
  s_mov_b32 m0, s95
  s_nop 0
  global_load_lds_dwordx4 v1, s[38:39]
  global_load_lds_dwordx4 v1, s[38:39] offset:1024
  s_add_u32 m0, s95, 2048
  s_nop 0
  global_load_lds_dwordx4 v1, s[40:41]
  global_load_lds_dwordx4 v1, s[40:41] offset:1024
chain_nokv:
  ds_read_b128 v[16:19], v14 offset:0
  ds_read_b128 v[20:23], v14 offset:512
  ds_read_b128 v[24:27], v14 offset:1024
  ds_read_b128 v[28:31], v14 offset:1536
  s_waitcnt lgkmcnt(3)
  v_mfma_f32_16x16x32_bf16 v[48:51], a[0:3], v[16:19], 0
  v_mfma_f32_16x16x32_bf16 v[52:55], a[4:7], v[16:19], 0
  v_mfma_f32_16x16x32_bf16 v[56:59], a[8:11], v[16:19], 0
  v_mfma_f32_16x16x32_bf16 v[60:63], a[12:15], v[16:19], 0
  ds_read_b128 v[16:19], v14 offset:2048
  s_waitcnt lgkmcnt(3)
  v_mfma_f32_16x16x32_bf16 v[48:51], a[16:19], v[20:23], v[48:51]
  v_mfma_f32_16x16x32_bf16 v[52:55], a[20:23], v[20:23], v[52:55]
  v_mfma_f32_16x16x32_bf16 v[56:59], a[24:27], v[20:23], v[56:59]
  v_mfma_f32_16x16x32_bf16 v[60:63], a[28:31], v[20:23], v[60:63]
  ds_read_b128 v[20:23], v14 offset:2560
  s_waitcnt lgkmcnt(3)
  v_mfma_f32_16x16x32_bf16 v[48:51], a[32:35], v[24:27], v[48:51]
  v_mfma_f32_16x16x32_bf16 v[52:55], a[36:39], v[24:27], v[52:55]
  v_mfma_f32_16x16x32_bf16 v[56:59], a[40:43], v[24:27], v[56:59]
  v_mfma_f32_16x16x32_bf16 v[60:63], a[44:47], v[24:27], v[60:63]
  ds_read_b128 v[24:27], v14 offset:3072
  s_waitcnt lgkmcnt(3)
  v_mfma_f32_16x16x32_bf16 v[48:51], a[48:51], v[28:31], v[48:51]
  v_mfma_f32_16x16x32_bf16 v[52:55], a[52:55], v[28:31], v[52:55]
  v_mfma_f32_16x16x32_bf16 v[56:59], a[56:59], v[28:31], v[56:59]
  v_mfma_f32_16x16x32_bf16 v[60:63], a[60:63], v[28:31], v[60:63]
  ds_read_b128 v[28:31], v14 offset:3584
  s_waitcnt lgkmcnt(3)
  v_mfma_f32_16x16x32_bf16 v[48:51], a[64:67], v[16:19], v[48:51]
  v_mfma_f32_16x16x32_bf16 v[52:55], a[68:71], v[16:19], v[52:55]
  v_mfma_f32_16x16x32_bf16 v[56:59], a[72:75], v[16:19], v[56:59]
  v_mfma_f32_16x16x32_bf16 v[60:63], a[76:79], v[16:19], v[60:63]
  ds_read_b128 v[16:19], v14 offset:4096
  s_waitcnt lgkmcnt(3)
  v_mfma_f32_16x16x32_bf16 v[48:51], a[80:83], v[20:23], v[48:51]
  v_mfma_f32_16x16x32_bf16 v[52:55], a[84:87], v[20:23], v[52:55]
  v_mfma_f32_16x16x32_bf16 v[56:59], a[88:91], v[20:23], v[56:59]
  v_mfma_f32_16x16x32_bf16 v[60:63], a[92:95], v[20:23], v[60:63]
  ds_read_b128 v[20:23], v14 offset:4608
  s_waitcnt lgkmcnt(3)
  v_mfma_f32_16x16x32_bf16 v[48:51], a[96:99], v[24:27], v[48:51]
  v_mfma_f32_16x16x32_bf16 v[52:55], a[100:103], v[24:27], v[52:55]
  v_mfma_f32_16x16x32_bf16 v[56:59], a[104:107], v[24:27], v[56:59]
  v_mfma_f32_16x16x32_bf16 v[60:63], a[108:111], v[24:27], v[60:63]
  ds_read_b128 v[24:27], v14 offset:5120
  s_waitcnt lgkmcnt(3)
  v_mfma_f32_16x16x32_bf16 v[48:51], a[112:115], v[28:31], v[48:51]
  v_mfma_f32_16x16x32_bf16 v[52:55], a[116:119], v[28:31], v[52:55]
  v_mfma_f32_16x16x32_bf16 v[56:59], a[120:123], v[28:31], v[56:59]
  v_mfma_f32_16x16x32_bf16 v[60:63], a[124:127], v[28:31], v[60:63]
  ds_read_b128 v[28:31], v14 offset:5632
  ds_read_b128 v[32:35], v15 offset:0
  ds_read_b128 v[36:39], v15 offset:1024
  s_waitcnt lgkmcnt(5)
  v_mfma_f32_16x16x32_bf16 v[48:51], a[128:131], v[16:19], v[48:51]
  v_mfma_f32_16x16x32_bf16 v[52:55], a[132:135], v[16:19], v[52:55]
  v_mfma_f32_16x16x32_bf16 v[56:59], a[136:139], v[16:19], v[56:59]
  v_mfma_f32_16x16x32_bf16 v[60:63], a[140:143], v[16:19], v[60:63]
  ds_read_b128 v[16:19], v14 offset:6144
  ds_read_b128 v[40:43], v15 offset:2048
  ds_read_b128 v[44:47], v15 offset:3072
  s_waitcnt lgkmcnt(7)
  v_mfma_f32_16x16x32_bf16 v[48:51], a[144:147], v[20:23], v[48:51]
  v_mfma_f32_16x16x32_bf16 v[52:55], a[148:151], v[20:23], v[52:55]
  v_mfma_f32_16x16x32_bf16 v[56:59], a[152:155], v[20:23], v[56:59]
  v_mfma_f32_16x16x32_bf16 v[60:63], a[156:159], v[20:23], v[60:63]
  ds_read_b128 v[20:23], v14 offset:6656
  s_waitcnt lgkmcnt(7)
  v_mfma_f32_16x16x32_bf16 v[48:51], a[160:163], v[24:27], v[48:51]
  v_mfma_f32_16x16x32_bf16 v[52:55], a[164:167], v[24:27], v[52:55]
  v_mfma_f32_16x16x32_bf16 v[56:59], a[168:171], v[24:27], v[56:59]
  v_mfma_f32_16x16x32_bf16 v[60:63], a[172:175], v[24:27], v[60:63]
  s_waitcnt lgkmcnt(4)
  v_mfma_f32_16x16x32_bf16 v[64:67], v[24:27], v[32:35], 0
  v_mfma_f32_16x16x32_bf16 v[68:71], v[24:27], v[36:39], 0
  ds_read_b128 v[32:35], v15 offset:4096
  ds_read_b128 v[36:39], v15 offset:5120
  ds_read_b128 v[24:27], v14 offset:7168
  v_mfma_f32_16x16x32_bf16 v[48:51], a[176:179], v[28:31], v[48:51]
  v_mfma_f32_16x16x32_bf16 v[52:55], a[180:183], v[28:31], v[52:55]
  v_mfma_f32_16x16x32_bf16 v[56:59], a[184:187], v[28:31], v[56:59]
  v_mfma_f32_16x16x32_bf16 v[60:63], a[188:191], v[28:31], v[60:63]
  s_waitcnt lgkmcnt(4)
  v_mfma_f32_16x16x32_bf16 v[64:67], v[28:31], v[40:43], v[64:67]
  v_mfma_f32_16x16x32_bf16 v[68:71], v[28:31], v[44:47], v[68:71]
  ds_read_b128 v[40:43], v15 offset:6144
  ds_read_b128 v[44:47], v15 offset:7168
  ds_read_b128 v[28:31], v14 offset:7680
  v_mfma_f32_16x16x32_bf16 v[48:51], a[192:195], v[16:19], v[48:51]
  v_mfma_f32_16x16x32_bf16 v[52:55], a[196:199], v[16:19], v[52:55]
  v_mfma_f32_16x16x32_bf16 v[56:59], a[200:203], v[16:19], v[56:59]
  v_mfma_f32_16x16x32_bf16 v[60:63], a[204:207], v[16:19], v[60:63]
  s_waitcnt lgkmcnt(4)
  v_mfma_f32_16x16x32_bf16 v[64:67], v[16:19], v[32:35], v[64:67]
  v_mfma_f32_16x16x32_bf16 v[68:71], v[16:19], v[36:39], v[68:71]
  ds_read_b128 v[32:35], v15 offset:8192
  ds_read_b128 v[36:39], v15 offset:9216
  ds_read_b128 v[16:19], v14 offset:8192
  v_mfma_f32_16x16x32_bf16 v[48:51], a[208:211], v[20:23], v[48:51]
  v_mfma_f32_16x16x32_bf16 v[52:55], a[212:215], v[20:23], v[52:55]
  v_mfma_f32_16x16x32_bf16 v[56:59], a[216:219], v[20:23], v[56:59]
  v_mfma_f32_16x16x32_bf16 v[60:63], a[220:223], v[20:23], v[60:63]
  s_waitcnt lgkmcnt(4)
  v_mfma_f32_16x16x32_bf16 v[64:67], v[20:23], v[40:43], v[64:67]
  v_mfma_f32_16x16x32_bf16 v[68:71], v[20:23], v[44:47], v[68:71]
  ds_read_b128 v[40:43], v15 offset:10240
  ds_read_b128 v[44:47], v15 offset:11264
  ds_read_b128 v[20:23], v14 offset:8704
  v_mfma_f32_16x16x32_bf16 v[48:51], a[224:227], v[24:27], v[48:51]
  v_mfma_f32_16x16x32_bf16 v[52:55], a[228:231], v[24:27], v[52:55]
  v_mfma_f32_16x16x32_bf16 v[56:59], a[232:235], v[24:27], v[56:59]
  v_mfma_f32_16x16x32_bf16 v[60:63], a[236:239], v[24:27], v[60:63]
  s_waitcnt lgkmcnt(4)
  v_mfma_f32_16x16x32_bf16 v[64:67], v[24:27], v[32:35], v[64:67]
  v_mfma_f32_16x16x32_bf16 v[68:71], v[24:27], v[36:39], v[68:71]
  ds_read_b128 v[32:35], v15 offset:12288
  ds_read_b128 v[36:39], v15 offset:13312
  ds_read_b128 v[24:27], v14 offset:9216
  v_mfma_f32_16x16x32_bf16 v[48:51], a[240:243], v[28:31], v[48:51]
  v_mfma_f32_16x16x32_bf16 v[52:55], a[244:247], v[28:31], v[52:55]
  v_mfma_f32_16x16x32_bf16 v[56:59], a[248:251], v[28:31], v[56:59]
  v_mfma_f32_16x16x32_bf16 v[60:63], a[252:255], v[28:31], v[60:63]
  s_waitcnt lgkmcnt(4)
  v_mfma_f32_16x16x32_bf16 v[64:67], v[28:31], v[40:43], v[64:67]
  v_mfma_f32_16x16x32_bf16 v[68:71], v[28:31], v[44:47], v[68:71]
  ds_read_b128 v[40:43], v15 offset:14336
  ds_read_b128 v[44:47], v15 offset:15360
  ds_read_b128 v[28:31], v14 offset:9728
  v_mfma_f32_16x16x32_bf16 v[48:51], v[112:115], v[16:19], v[48:51]
  v_mfma_f32_16x16x32_bf16 v[52:55], v[116:119], v[16:19], v[52:55]
  v_mfma_f32_16x16x32_bf16 v[56:59], v[120:123], v[16:19], v[56:59]
  v_mfma_f32_16x16x32_bf16 v[60:63], v[124:127], v[16:19], v[60:63]
  s_waitcnt lgkmcnt(4)
  v_mfma_f32_16x16x32_bf16 v[64:67], v[16:19], v[32:35], v[64:67]
  v_mfma_f32_16x16x32_bf16 v[68:71], v[16:19], v[36:39], v[68:71]
  ds_read_b128 v[32:35], v15 offset:16384
  ds_read_b128 v[36:39], v15 offset:17408
  v_mfma_f32_16x16x32_bf16 v[48:51], v[128:131], v[20:23], v[48:51]
  v_mfma_f32_16x16x32_bf16 v[52:55], v[132:135], v[20:23], v[52:55]
  v_mfma_f32_16x16x32_bf16 v[56:59], v[136:139], v[20:23], v[56:59]
  v_mfma_f32_16x16x32_bf16 v[60:63], v[140:143], v[20:23], v[60:63]
  s_waitcnt lgkmcnt(3)
  v_mfma_f32_16x16x32_bf16 v[64:67], v[20:23], v[40:43], v[64:67]
  v_mfma_f32_16x16x32_bf16 v[68:71], v[20:23], v[44:47], v[68:71]
  ds_read_b128 v[40:43], v15 offset:18432
  ds_read_b128 v[44:47], v15 offset:19456
  v_mfma_f32_16x16x32_bf16 v[48:51], v[144:147], v[24:27], v[48:51]
  v_mfma_f32_16x16x32_bf16 v[52:55], v[148:151], v[24:27], v[52:55]
  v_mfma_f32_16x16x32_bf16 v[56:59], v[152:155], v[24:27], v[56:59]
  v_mfma_f32_16x16x32_bf16 v[60:63], v[156:159], v[24:27], v[60:63]
  s_waitcnt lgkmcnt(2)
  v_mfma_f32_16x16x32_bf16 v[64:67], v[24:27], v[32:35], v[64:67]
  v_mfma_f32_16x16x32_bf16 v[68:71], v[24:27], v[36:39], v[68:71]
  v_mfma_f32_16x16x32_bf16 v[48:51], v[160:163], v[28:31], v[48:51]
  v_mfma_f32_16x16x32_bf16 v[52:55], v[164:167], v[28:31], v[52:55]
  v_mfma_f32_16x16x32_bf16 v[56:59], v[168:171], v[28:31], v[56:59]
  v_mfma_f32_16x16x32_bf16 v[60:63], v[172:175], v[28:31], v[60:63]
  s_waitcnt lgkmcnt(0)
  v_mfma_f32_16x16x32_bf16 v[64:67], v[28:31], v[40:43], v[64:67]
  v_mfma_f32_16x16x32_bf16 v[68:71], v[28:31], v[44:47], v[68:71]
  ds_read_b128 v[32:35], v14 offset:0
  ds_read_b128 v[36:39], v14 offset:512
  ds_read_b128 v[40:43], v14 offset:1024
  s_nop 4
  v_cvt_pk_bf16_f32 v88, v48, v49
  v_cvt_pk_bf16_f32 v89, v50, v51
  v_cvt_pk_bf16_f32 v90, v52, v53
  v_cvt_pk_bf16_f32 v91, v54, v55
  v_cvt_pk_bf16_f32 v92, v56, v57
  v_cvt_pk_bf16_f32 v93, v58, v59
  v_cvt_pk_bf16_f32 v94, v60, v61
  v_cvt_pk_bf16_f32 v95, v62, v63
  s_cmp_eq_u32 s49, 63
  s_cbranch_scc1 chain_last
  v_mfma_f32_16x16x32_bf16 v[48:51], v[92:95], v[88:91], 0
  v_mfma_f32_16x16x32_bf16 v[52:55], v[72:75], v[88:91], 0
  v_mfma_f32_16x16x32_bf16 v[56:59], v[76:79], v[88:91], 0
  s_waitcnt lgkmcnt(2)
  v_mfma_f32_16x16x32_bf16 v[64:67], v[32:35], v[176:179], v[64:67]
  v_mfma_f32_16x16x32_bf16 v[68:71], v[32:35], v[180:183], v[68:71]
  ds_read_b128 v[44:47], v14 offset:1536
  v_add_u32 v96, s46, v1
  v_add_u32 v97, 124928, v1
  v_mov_b32 v98, s52
  v_mov_b32 v99, s52
  s_nop 1
  ds_write_b128 v96, v[48:51]
  ds_write_b128 v96, v[52:55] offset:1024
  ds_write_b128 v96, v[56:59] offset:2048
  s_waitcnt lgkmcnt(5)
  v_mfma_f32_16x16x32_bf16 v[64:67], v[36:39], v[184:187], v[64:67]
  v_mfma_f32_16x16x32_bf16 v[68:71], v[36:39], v[188:191], v[68:71]
  ds_read_b128 v[32:35], v14 offset:2048
  s_waitcnt lgkmcnt(0)
  s_barrier
  ds_read_b128 v[48:51], v7 offset:0
  ds_read_b128 v[52:55], v7 offset:1024
  ds_read_b128 v[56:59], v7 offset:2048
  ds_read_b128 v[100:103], v7 offset:3072
  ds_read_b128 v[104:107], v7 offset:4096
  ds_read_b128 v[108:111], v7 offset:5120
  v_mfma_f32_16x16x32_bf16 v[64:67], v[40:43], v[192:195], v[64:67]
  v_mfma_f32_16x16x32_bf16 v[68:71], v[40:43], v[196:199], v[68:71]
  ds_read_b128 v[36:39], v14 offset:2560
  v_mfma_f32_16x16x32_bf16 v[64:67], v[44:47], v[200:203], v[64:67]
  s_waitcnt lgkmcnt(1)
  v_pk_add_f32 v[48:49], v[48:49], v[100:101]
  v_pk_add_f32 v[50:51], v[50:51], v[102:103]
  v_pk_add_f32 v[52:53], v[52:53], v[104:105]
  v_mfma_f32_16x16x32_bf16 v[68:71], v[44:47], v[204:207], v[68:71]
  ds_read_b128 v[40:43], v14 offset:3072
  v_pk_add_f32 v[54:55], v[54:55], v[106:107]
  v_pk_add_f32 v[56:57], v[56:57], v[108:109]
  v_pk_add_f32 v[58:59], v[58:59], v[110:111]
  v_mfma_f32_16x16x32_bf16 v[64:67], v[32:35], v[208:211], v[64:67]
  v_add_f32_dpp v48, v48, v48 row_ror:8 row_mask:0xf bank_mask:0xf
  v_add_f32_dpp v49, v49, v49 row_ror:8 row_mask:0xf bank_mask:0xf
  v_add_f32_dpp v50, v50, v50 row_ror:8 row_mask:0xf bank_mask:0xf
  v_add_f32_dpp v51, v51, v51 row_ror:8 row_mask:0xf bank_mask:0xf
  v_mfma_f32_16x16x32_bf16 v[68:71], v[32:35], v[212:215], v[68:71]
  ds_read_b128 v[44:47], v14 offset:3584
  v_add_f32_dpp v52, v52, v52 row_ror:8 row_mask:0xf bank_mask:0xf
  v_add_f32_dpp v53, v53, v53 row_ror:8 row_mask:0xf bank_mask:0xf
  v_add_f32_dpp v54, v54, v54 row_ror:8 row_mask:0xf bank_mask:0xf
  v_add_f32_dpp v55, v55, v55 row_ror:8 row_mask:0xf bank_mask:0xf
  s_waitcnt lgkmcnt(2)
  v_mfma_f32_16x16x32_bf16 v[64:67], v[36:39], v[216:219], v[64:67]
  v_add_f32_dpp v56, v56, v56 row_ror:8 row_mask:0xf bank_mask:0xf
  v_add_f32_dpp v57, v57, v57 row_ror:8 row_mask:0xf bank_mask:0xf
  v_add_f32_dpp v58, v58, v58 row_ror:8 row_mask:0xf bank_mask:0xf
  v_add_f32_dpp v59, v59, v59 row_ror:8 row_mask:0xf bank_mask:0xf
  v_mfma_f32_16x16x32_bf16 v[68:71], v[36:39], v[220:223], v[68:71]
  ds_read_b128 v[32:35], v14 offset:4096
  v_mov_b32 v101, 0xff800000
  v_cmp_lt_u32 vcc, 31, v3
  v_max3_f32 v100, v52, v53, v54
  v_max3_f32 v102, v55, v56, v57
  s_waitcnt lgkmcnt(2)
  v_mfma_f32_16x16x32_bf16 v[64:67], v[40:43], v[224:227], v[64:67]
  v_cndmask_b32 v48, v48, v101, vcc
  v_cndmask_b32 v49, v49, v101, vcc
  v_cndmask_b32 v50, v50, v101, vcc
  v_cndmask_b32 v51, v51, v101, vcc
  v_mfma_f32_16x16x32_bf16 v[68:71], v[40:43], v[228:231], v[68:71]
  ds_read_b128 v[36:39], v14 offset:4608
  v_max3_f32 v100, v100, v58, v59
  v_max3_f32 v102, v102, v48, v49
  v_max3_f32 v100, v100, v50, v51
  v_max_f32 v100, v100, v102
  s_waitcnt lgkmcnt(2)
  v_mfma_f32_16x16x32_bf16 v[64:67], v[44:47], v[232:235], v[64:67]
  s_nop 0
  v_mov_b32 v101, v100
  s_nop 1
  v_permlane16_swap_b32 v100, v101
  v_mfma_f32_16x16x32_bf16 v[68:71], v[44:47], v[236:239], v[68:71]
  v_max_f32 v100, v100, v101
  s_nop 0
  v_mov_b32 v101, v100
  s_nop 1
  s_waitcnt lgkmcnt(1)
  v_mfma_f32_16x16x32_bf16 v[64:67], v[32:35], v[240:243], v[64:67]
  v_permlane32_swap_b32 v100, v101
  v_max_f32 v100, v100, v101
  v_mul_f32 v100, s53, v100
  v_mov_b32 v102, s53
  v_mfma_f32_16x16x32_bf16 v[68:71], v[32:35], v[244:247], v[68:71]
  v_fma_f32 v48, v48, v102, -v100
  v_fma_f32 v49, v49, v102, -v100
  v_fma_f32 v50, v50, v102, -v100
  v_fma_f32 v51, v51, v102, -v100
  s_waitcnt lgkmcnt(0)
  v_mfma_f32_16x16x32_bf16 v[64:67], v[36:39], v[248:251], v[64:67]
  v_fma_f32 v52, v52, v102, -v100
  v_fma_f32 v53, v53, v102, -v100
  v_fma_f32 v54, v54, v102, -v100
  v_fma_f32 v55, v55, v102, -v100
  v_mfma_f32_16x16x32_bf16 v[68:71], v[36:39], v[252:255], v[68:71]
  v_fma_f32 v56, v56, v102, -v100
  v_fma_f32 v57, v57, v102, -v100
  v_fma_f32 v58, v58, v102, -v100
  v_fma_f32 v59, v59, v102, -v100
  v_exp_f32 v48, v48
  v_exp_f32 v49, v49
  v_exp_f32 v50, v50
  v_exp_f32 v51, v51
  v_exp_f32 v52, v52
  v_exp_f32 v53, v53
  v_exp_f32 v54, v54
  v_exp_f32 v55, v55
  v_exp_f32 v56, v56
  v_exp_f32 v57, v57
  v_exp_f32 v58, v58
  v_exp_f32 v59, v59
  v_pk_add_f32 v[100:101], v[48:49], v[50:51]
  v_pk_add_f32 v[102:103], v[52:53], v[54:55]
  v_pk_add_f32 v[104:105], v[56:57], v[58:59]
  v_pk_add_f32 v[100:101], v[100:101], v[102:103]
  v_pk_add_f32 v[100:101], v[100:101], v[104:105]
  v_add_f32 v100, v100, v101
  s_nop 0
  v_mov_b32 v101, v100
  s_nop 1
  v_permlane16_swap_b32 v100, v101
  v_add_f32 v100, v100, v101
  s_nop 0
  v_mov_b32 v101, v100
  s_nop 1
  v_permlane32_swap_b32 v100, v101
  v_add_f32 v100, v100, v101
  v_rcp_f32 v102, v100
  s_nop 0
  v_fma_f32 v103, -v100, v102, 1.0
  v_fma_f32 v102, v103, v102, v102
  v_mov_b32 v103, v102
  v_pk_mul_f32 v[48:49], v[48:49], v[102:103]
  v_pk_mul_f32 v[50:51], v[50:51], v[102:103]
  v_pk_mul_f32 v[52:53], v[52:53], v[102:103]
  v_pk_mul_f32 v[54:55], v[54:55], v[102:103]
  v_pk_mul_f32 v[56:57], v[56:57], v[102:103]
  v_pk_mul_f32 v[58:59], v[58:59], v[102:103]
  v_cvt_pk_bf16_f32 v100, v48, v49
  v_cvt_pk_bf16_f32 v101, v50, v51
  v_cvt_pk_bf16_f32 v104, v52, v53
  v_cvt_pk_bf16_f32 v105, v54, v55
  v_cvt_pk_bf16_f32 v106, v56, v57
  v_cvt_pk_bf16_f32 v107, v58, v59
  v_add_u32 v108, s47, v1
  v_add_u32 v109, s48, v1
  ds_read_b128 v[16:19], v109
  ds_read_b128 v[20:23], v109 offset:1024
  v_mfma_f32_16x16x32_bf16 v[48:51], v[80:83], v[104:107], 0
  v_mfma_f32_16x16x32_bf16 v[52:55], v[84:87], v[104:107], 0
  ds_read_b128 v[24:27], v109 offset:2048
  ds_read_b128 v[28:31], v109 offset:3072
  v_cvt_pk_bf16_f32 v96, v64, v65
  v_cvt_pk_bf16_f32 v97, v66, v67
  v_cvt_pk_bf16_f32 v98, v68, v69
  v_cvt_pk_bf16_f32 v99, v70, v71
  s_nop 3
  v_mfma_f32_16x16x16_bf16 v[48:51], v[96:97], v[100:101], v[48:51]
  v_mfma_f32_16x16x16_bf16 v[52:55], v[98:99], v[100:101], v[52:55]
  s_nop 7
  v_cvt_pk_bf16_f32 v56, v48, v49
  v_cvt_pk_bf16_f32 v57, v50, v51
  v_cvt_pk_bf16_f32 v58, v52, v53
  v_cvt_pk_bf16_f32 v59, v54, v55
  ds_write_b128 v108, v[56:59]
  s_waitcnt lgkmcnt(0)
  s_barrier
  v_add_u32 v108, 137216, v1
  ds_read_b128 v[32:35], v108
  ds_read_b128 v[36:39], v108 offset:1024
  ds_read_b128 v[40:43], v108 offset:2048
  ds_read_b128 v[44:47], v108 offset:3072
  ds_read_b128 v[48:51], v109 offset:4096
  ds_read_b128 v[52:55], v109 offset:5120
  ds_read_b128 v[56:59], v109 offset:6144
  ds_read_b128 v[60:63], v109 offset:7168
  s_waitcnt lgkmcnt(4)
  v_mfma_f32_16x16x32_bf16 v[100:103], v[16:19], v[32:35], 0
  v_mfma_f32_16x16x32_bf16 v[100:103], v[20:23], v[36:39], v[100:103]
  v_mfma_f32_16x16x32_bf16 v[100:103], v[24:27], v[40:43], v[100:103]
  v_mfma_f32_16x16x32_bf16 v[100:103], v[28:31], v[44:47], v[100:103]
  s_waitcnt lgkmcnt(0)
  v_mfma_f32_16x16x32_bf16 v[104:107], v[48:51], v[32:35], 0
  v_mfma_f32_16x16x32_bf16 v[104:107], v[52:55], v[36:39], v[104:107]
  v_mfma_f32_16x16x32_bf16 v[104:107], v[56:59], v[40:43], v[104:107]
  v_mfma_f32_16x16x32_bf16 v[104:107], v[60:63], v[44:47], v[104:107]
chain_wo1:
  s_add_u32 s58, s28, s50
  s_addc_u32 s59, s29, 0
  v_cmp_gt_u32 vcc, 8, v4
  s_and_saveexec_b64 s[56:57], vcc
  s_nop 7
  s_add_u32 s96, s58, 16384
  s_addc_u32 s97, s59, 0
  s_cmp_eq_u32 s51, 0
  s_cbranch_scc1 chain_st_slow
  global_store_dwordx4 v12, v[100:103], s[58:59]
  global_store_dwordx4 v12, v[104:107], s[96:97]
  s_branch chain_st1
chain_st_slow:
  global_store_dwordx4 v12, v[100:103], s[58:59] sc1
  global_store_dwordx4 v12, v[104:107], s[96:97] sc1
chain_st1:
  s_mov_b64 exec, s[56:57]
  s_add_u32 s11, s49, 2
  s_and_b32 s12, s11, 7
  s_cmp_lg_u32 s12, 0
  s_cbranch_scc1 chain_kvok
  s_cmp_ge_u32 s11, 64
  s_cbranch_scc1 chain_kvok
  s_lshr_b32 s11, s11, 3
  s_lshl_b32 s11, s11, 2
  s_add_u32 s11, s11, 128
  v_mov_b32 v28, s11
  s_mov_b32 s60, 0
chain_kvpoll:
  global_load_dword v29, v28, s[70:71] sc1
  s_waitcnt vmcnt(0)
  v_readfirstlane_b32 s12, v29
  s_add_u32 s60, s60, 1
  s_cmp_gt_u32 s60, 30000
  s_cbranch_scc1 chain_kvok
  s_cmp_ge_u32 s12, 64
  s_cbranch_scc1 chain_kvok
  s_sleep 8
  s_branch chain_kvpoll
chain_kvok:
  s_cmp_eq_u32 s36, 0
  s_cbranch_scc1 chain_cons
  s_add_u32 s58, s30, s50
  s_addc_u32 s59, s31, 0
  s_mov_b32 s60, 0
  s_cmp_eq_u32 s51, 1
  s_cbranch_scc1 chain_rpoll
  s_sleep 16
chain_rpoll:
  s_sleep 2
  global_load_dwordx4 v[16:19], v1, s[58:59] sc1
  global_load_dwordx4 v[20:23], v1, s[58:59] offset:1024 sc1
  global_load_dwordx4 v[24:27], v1, s[58:59] offset:2048 sc1
  global_load_dwordx4 v[28:31], v1, s[58:59] offset:3072 sc1
  s_waitcnt vmcnt(0)
  v_max3_u32 v32, v16, v17, v18
  v_max3_u32 v33, v19, v20, v21
  v_max3_u32 v34, v22, v23, v24
  v_max3_u32 v35, v25, v26, v27
  v_max3_u32 v32, v32, v28, v29
  v_max3_u32 v33, v33, v30, v31
  v_max3_u32 v32, v32, v34, v35
  v_max_u32 v32, v32, v33
  v_cmp_eq_u32 vcc, -1, v32
  s_add_u32 s60, s60, 1
  s_cmp_gt_u32 s60, 30000
  s_cbranch_scc1 chain_rdone
  s_cbranch_vccnz chain_rpoll
chain_rdone:
  v_add_f32 v16, v16, v20
  v_add_f32 v17, v17, v21
  v_add_f32 v18, v18, v22
  v_add_f32 v19, v19, v23
  v_add_f32 v24, v24, v28
  v_add_f32 v25, v25, v29
  v_add_f32 v26, v26, v30
  v_add_f32 v27, v27, v31
  v_add_f32 v16, v16, v24
  v_add_f32 v17, v17, v25
  v_add_f32 v18, v18, v26
  v_add_f32 v19, v19, v27
  s_nop 1
  v_add_f32_dpp v16, v16, v16 row_ror:8 row_mask:0xf bank_mask:0xf
  v_add_f32_dpp v17, v17, v17 row_ror:8 row_mask:0xf bank_mask:0xf
  v_add_f32_dpp v18, v18, v18 row_ror:8 row_mask:0xf bank_mask:0xf
  v_add_f32_dpp v19, v19, v19 row_ror:8 row_mask:0xf bank_mask:0xf
  v_mov_b32 v20, v16
  v_mov_b32 v21, v17
  v_mov_b32 v22, v18
  v_mov_b32 v23, v19
  s_nop 1
  v_permlane16_swap_b32 v16, v20
  v_permlane16_swap_b32 v17, v21
  v_permlane16_swap_b32 v18, v22
  v_permlane16_swap_b32 v19, v23
  v_add_f32 v16, v16, v20
  v_add_f32 v17, v17, v21
  v_add_f32 v18, v18, v22
  v_add_f32 v19, v19, v23
  v_mov_b32 v20, v16
  v_mov_b32 v21, v17
  v_mov_b32 v22, v18
  v_mov_b32 v23, v19
  s_nop 1
  v_permlane32_swap_b32 v16, v20
  v_permlane32_swap_b32 v17, v21
  v_permlane32_swap_b32 v18, v22
  v_permlane32_swap_b32 v19, v23
  v_add_f32 v16, v16, v20
  v_add_f32 v17, v17, v21
  v_add_f32 v18, v18, v22
  v_add_f32 v19, v19, v23
  v_cvt_pk_bf16_f32 v20, v16, v17
  v_cvt_pk_bf16_f32 v21, v18, v19
  global_store_dwordx2 v2, v[20:21], s[32:33] sc1
  v_mov_b32 v24, -1
  v_mov_b32 v25, -1
  v_mov_b32 v26, -1
  v_mov_b32 v27, -1
  s_cmp_eq_u32 s51, 0
  s_cbranch_scc1 chain_rc_slow
  v_mov_b32 v28, s94
  v_mov_b32 v29, 1
  s_mov_b64 s[56:57], exec
  s_mov_b64 exec, 1
  global_store_dword v28, v29, s[92:93]
  s_mov_b64 exec, s[56:57]
  global_store_dwordx4 v1, v[24:27], s[58:59]
  global_store_dwordx4 v1, v[24:27], s[58:59] offset:1024
  global_store_dwordx4 v1, v[24:27], s[58:59] offset:2048
  global_store_dwordx4 v1, v[24:27], s[58:59] offset:3072
  s_branch chain_rc_done
chain_rc_slow:
  global_store_dwordx4 v1, v[24:27], s[58:59] sc1
  global_store_dwordx4 v1, v[24:27], s[58:59] offset:1024 sc1
  global_store_dwordx4 v1, v[24:27], s[58:59] offset:2048 sc1
  global_store_dwordx4 v1, v[24:27], s[58:59] offset:3072 sc1
chain_rc_done:
  s_add_u32 s32, s32, 10240
  s_addc_u32 s33, s33, 0
  s_mov_b32 s60, 0
  s_cmp_eq_u32 s51, 1
  s_cbranch_scc1 chain_lf
  s_sleep 22
  s_branch chain_cpoll2
chain_cons:
  s_mov_b32 s60, 0
  s_cmp_eq_u32 s51, 1
  s_cbranch_scc1 chain_lf0
  s_sleep 58
  s_branch chain_cpoll2
chain_lf0:
  s_sleep 6
chain_lf:
  v_lshlrev_b32 v28, 2, v3
chain_lfpoll:
  s_sleep 1
  v_mov_b32 v29, 0
  v_cmp_gt_u32 vcc, 32, v3
  s_and_saveexec_b64 s[56:57], vcc
  global_load_dword v29, v28, s[92:93] sc1
  s_mov_b64 exec, s[56:57]
  s_waitcnt vmcnt(0)
  v_cmp_eq_u32 vcc, -1, v29
  s_add_u32 s60, s60, 1
  s_cmp_gt_u32 s60, 30000
  s_cbranch_scc1 chain_lfdone
  s_cbranch_vccnz chain_lfpoll
chain_lfdone:
  s_mov_b32 s60, 0
  s_sleep 1
chain_cpoll2:
  v_mov_b32 v24, 0
  v_mov_b32 v25, 0
  v_mov_b32 v26, 0
  v_mov_b32 v27, 0
chain_cpoll:
  s_sleep 2
  global_load_dwordx4 v[16:19], v9, s[34:35] sc1
  global_load_dwordx4 v[20:23], v9, s[34:35] offset:1024 sc1
  v_cmp_gt_u32 vcc, 32, v3
  s_and_saveexec_b64 s[56:57], vcc
  global_load_dwordx4 v[24:27], v9, s[34:35] offset:2048 sc1
  s_mov_b64 exec, s[56:57]
  s_waitcnt vmcnt(0)
  v_max3_u32 v32, v16, v17, v18
  v_max3_u32 v33, v19, v20, v21
  v_max3_u32 v34, v22, v23, v24
  v_max3_u32 v32, v32, v25, v26
  v_max3_u32 v33, v33, v27, v34
  v_max_u32 v32, v32, v33
  v_cmp_eq_u32 vcc, -1, v32
  s_add_u32 s60, s60, 1
  s_cmp_gt_u32 s60, 30000
  s_cbranch_scc1 chain_cdone
  s_cbranch_vccnz chain_cpoll
chain_cdone:
  s_cmp_lg_u32 s10, 0
  s_cbranch_scc1 chain_nosig
  s_cmp_eq_u32 s49, 0
  s_cbranch_scc1 chain_nosig0
  s_sub_u32 s11, s49, 1
  s_lshr_b32 s11, s11, 1
  s_lshl_b32 s11, s11, 2
  s_add_u32 s12, s6, 0x8c00400
  s_addc_u32 s13, s7, 0
  v_mov_b32 v28, s11
  v_mov_b32 v29, 1
  s_mov_b64 s[56:57], exec
  s_mov_b64 exec, 1
  global_atomic_add v28, v29, s[12:13]
  s_mov_b64 exec, s[56:57]
chain_nosig0:
  global_store_dwordx4 v1, v[92:95], s[42:43] sc1
  global_store_dwordx2 v13, v[96:97], s[44:45] sc1
  global_store_dwordx2 v13, v[98:99], s[44:45] offset:512 sc1
chain_nosig:
  s_add_u32 s42, s42, 0x20000
  s_addc_u32 s43, s43, 0
  s_add_u32 s44, s44, 0x20000
  s_addc_u32 s45, s45, 0
  s_add_u32 s34, s34, 10240
  s_addc_u32 s35, s35, 0
  s_add_u32 s92, s92, 1024
  s_addc_u32 s93, s93, 0
  s_xor_b32 s50, s50, 655360
  s_add_u32 s49, s49, 1
  s_branch chain_step
chain_last:
  s_waitcnt lgkmcnt(0)
  ds_read_b128 v[16:19], v14 offset:0
  s_waitcnt lgkmcnt(0)
  v_mfma_f32_16x16x32_bf16 v[64:67], v[16:19], v[176:179], v[64:67]
  v_mfma_f32_16x16x32_bf16 v[68:71], v[16:19], v[180:183], v[68:71]
  s_nop 7
  ds_read_b128 v[16:19], v14 offset:512
  s_waitcnt lgkmcnt(0)
  v_mfma_f32_16x16x32_bf16 v[64:67], v[16:19], v[184:187], v[64:67]
  v_mfma_f32_16x16x32_bf16 v[68:71], v[16:19], v[188:191], v[68:71]
  s_nop 7
  ds_read_b128 v[16:19], v14 offset:1024
  s_waitcnt lgkmcnt(0)
  v_mfma_f32_16x16x32_bf16 v[64:67], v[16:19], v[192:195], v[64:67]
  v_mfma_f32_16x16x32_bf16 v[68:71], v[16:19], v[196:199], v[68:71]
  s_nop 7
  ds_read_b128 v[16:19], v14 offset:1536
  s_waitcnt lgkmcnt(0)
  v_mfma_f32_16x16x32_bf16 v[64:67], v[16:19], v[200:203], v[64:67]
  v_mfma_f32_16x16x32_bf16 v[68:71], v[16:19], v[204:207], v[68:71]
  s_nop 7
  ds_read_b128 v[16:19], v14 offset:2048
  s_waitcnt lgkmcnt(0)
  v_mfma_f32_16x16x32_bf16 v[64:67], v[16:19], v[208:211], v[64:67]
  v_mfma_f32_16x16x32_bf16 v[68:71], v[16:19], v[212:215], v[68:71]
  s_nop 7
  ds_read_b128 v[16:19], v14 offset:2560
  s_waitcnt lgkmcnt(0)
  v_mfma_f32_16x16x32_bf16 v[64:67], v[16:19], v[216:219], v[64:67]
  v_mfma_f32_16x16x32_bf16 v[68:71], v[16:19], v[220:223], v[68:71]
  s_nop 7
  ds_read_b128 v[16:19], v14 offset:3072
  s_waitcnt lgkmcnt(0)
  v_mfma_f32_16x16x32_bf16 v[64:67], v[16:19], v[224:227], v[64:67]
  v_mfma_f32_16x16x32_bf16 v[68:71], v[16:19], v[228:231], v[68:71]
  s_nop 7
  ds_read_b128 v[16:19], v14 offset:3584
  s_waitcnt lgkmcnt(0)
  v_mfma_f32_16x16x32_bf16 v[64:67], v[16:19], v[232:235], v[64:67]
  v_mfma_f32_16x16x32_bf16 v[68:71], v[16:19], v[236:239], v[68:71]
  s_nop 7
  ds_read_b128 v[16:19], v14 offset:4096
  s_waitcnt lgkmcnt(0)
  v_mfma_f32_16x16x32_bf16 v[64:67], v[16:19], v[240:243], v[64:67]
  v_mfma_f32_16x16x32_bf16 v[68:71], v[16:19], v[244:247], v[68:71]
  s_nop 7
  ds_read_b128 v[16:19], v14 offset:4608
  s_waitcnt lgkmcnt(0)
  v_mfma_f32_16x16x32_bf16 v[64:67], v[16:19], v[248:251], v[64:67]
  v_mfma_f32_16x16x32_bf16 v[68:71], v[16:19], v[252:255], v[68:71]
  s_nop 7
  s_nop 7
  v_cvt_pk_bf16_f32 v96, v64, v65
  v_cvt_pk_bf16_f32 v97, v66, v67
  v_cvt_pk_bf16_f32 v98, v68, v69
  v_cvt_pk_bf16_f32 v99, v70, v71
  s_cmp_lg_u32 s10, 0
  s_cbranch_scc1 chain_done
  global_store_dwordx4 v1, v[92:95], s[42:43]
  global_store_dwordx2 v13, v[96:97], s[44:45]
  global_store_dwordx2 v13, v[98:99], s[44:45] offset:512
  s_branch chain_done
chain_bulk:
  s_sub_u32 s98, s10, 5
  s_lshl_b32 s98, s98, 5
  s_add_u32 s98, s98, s9
qbulk_tile:
  s_load_dwordx2 s[6:7], s[0:1], 104
  s_load_dwordx2 s[4:5], s[0:1], 0
  s_load_dwordx2 s[8:9], s[0:1], 88
  v_lshrrev_b32 v5, 6, v0
  v_and_b32 v6, 63, v0
  s_nop 0
  v_readfirstlane_b32 s22, v5
  v_lshlrev_b32 v1, 4, v6
  s_lshr_b32 s20, s98, 6
  s_add_u32 s20, s20, 1
  s_and_b32 s21, s98, 63
  s_add_u32 s21, s21, 32
  s_sub_u32 s10, s98, 448
  s_and_b32 s11, s10, 7
  s_lshr_b32 s12, s10, 3
  s_cmp_ge_u32 s98, 448
  s_cselect_b32 s20, s11, s20
  s_cselect_b32 s21, s12, s21
  s_mov_b32 s19, 0
  s_waitcnt lgkmcnt(0)
  s_lshr_b32 s23, s22, 1
  s_and_b32 s24, s22, 1
  s_add_u32 s25, s22, 0
  s_mul_i32 s26, s20, 16
  s_add_u32 s26, s26, s25
  s_mul_i32 s26, s26, 20480
  s_add_u32 s26, s26, 0x0
  s_mul_i32 s27, s21, 8
  s_add_u32 s27, s27, s25
  s_sub_u32 s27, s27, 16
  s_mul_i32 s27, s27, 20480
  s_add_u32 s27, s27, 0x280000
  s_cmp_lt_u32 s25, 16
  s_cselect_b32 s26, s26, s27
  s_add_u32 s40, s6, s26
  s_addc_u32 s41, s7, 0
  s_add_u32 s25, s22, 4
  s_mul_i32 s26, s20, 16
  s_add_u32 s26, s26, s25
  s_mul_i32 s26, s26, 20480
  s_add_u32 s26, s26, 0x0
  s_mul_i32 s27, s21, 8
  s_add_u32 s27, s27, s25
  s_sub_u32 s27, s27, 16
  s_mul_i32 s27, s27, 20480
  s_add_u32 s27, s27, 0x280000
  s_cmp_lt_u32 s25, 16
  s_cselect_b32 s26, s26, s27
  s_add_u32 s42, s6, s26
  s_addc_u32 s43, s7, 0
  s_add_u32 s25, s22, 8
  s_mul_i32 s26, s20, 16
  s_add_u32 s26, s26, s25
  s_mul_i32 s26, s26, 20480
  s_add_u32 s26, s26, 0x0
  s_mul_i32 s27, s21, 8
  s_add_u32 s27, s27, s25
  s_sub_u32 s27, s27, 16
  s_mul_i32 s27, s27, 20480
  s_add_u32 s27, s27, 0x280000
  s_cmp_lt_u32 s25, 16
  s_cselect_b32 s26, s26, s27
  s_add_u32 s44, s6, s26
  s_addc_u32 s45, s7, 0
  s_add_u32 s25, s22, 12
  s_mul_i32 s26, s20, 16
  s_add_u32 s26, s26, s25
  s_mul_i32 s26, s26, 20480
  s_add_u32 s26, s26, 0x0
  s_mul_i32 s27, s21, 8
  s_add_u32 s27, s27, s25
  s_sub_u32 s27, s27, 16
  s_mul_i32 s27, s27, 20480
  s_add_u32 s27, s27, 0x280000
  s_cmp_lt_u32 s25, 16
  s_cselect_b32 s26, s26, s27
  s_add_u32 s46, s6, s26
  s_addc_u32 s47, s7, 0
  s_add_u32 s25, s22, 16
  s_mul_i32 s26, s20, 16
  s_add_u32 s26, s26, s25
  s_mul_i32 s26, s26, 20480
  s_add_u32 s26, s26, 0x0
  s_mul_i32 s27, s21, 8
  s_add_u32 s27, s27, s25
  s_sub_u32 s27, s27, 16
  s_mul_i32 s27, s27, 20480
  s_add_u32 s27, s27, 0x280000
  s_cmp_lt_u32 s25, 16
  s_cselect_b32 s26, s26, s27
  s_add_u32 s48, s6, s26
  s_addc_u32 s49, s7, 0
  s_add_u32 s25, s22, 20
  s_mul_i32 s26, s20, 16
  s_add_u32 s26, s26, s25
  s_mul_i32 s26, s26, 20480
  s_add_u32 s26, s26, 0x0
  s_mul_i32 s27, s21, 8
  s_add_u32 s27, s27, s25
  s_sub_u32 s27, s27, 16
  s_mul_i32 s27, s27, 20480
  s_add_u32 s27, s27, 0x280000
  s_cmp_lt_u32 s25, 16
  s_cselect_b32 s26, s26, s27
  s_add_u32 s50, s6, s26
  s_addc_u32 s51, s7, 0
  s_mul_i32 s28, s22, 1024
  s_mul_i32 s25, s19, 0
  v_add_u32 v2, s25, v1
  s_mul_i32 s29, s23, 8192
  s_mul_i32 s30, s24, 4096
  s_add_u32 s30, s30, 16384
  s_mov_b32 s31, 0
  s_mov_b32 s32, 0
  s_add_u32 s33, s32, s28
  s_add_u32 m0, s33, 0
  s_nop 0
  global_load_lds_dwordx4 v2, s[40:41]
  s_add_u32 m0, s33, 4096
  s_nop 0
  global_load_lds_dwordx4 v2, s[42:43]
  s_add_u32 m0, s33, 8192
  s_nop 0
  global_load_lds_dwordx4 v2, s[44:45]
  s_add_u32 m0, s33, 12288
  s_nop 0
  global_load_lds_dwordx4 v2, s[46:47]
  s_add_u32 m0, s33, 16384
  s_nop 0
  global_load_lds_dwordx4 v2, s[48:49]
  s_add_u32 m0, s33, 20480
  s_nop 0
  global_load_lds_dwordx4 v2, s[50:51]
  v_add_u32 v2, 1024, v2
  s_add_u32 s32, s32, 24576
  s_cmp_ge_u32 s32, 122880
  s_cselect_b32 s32, 0, s32
  s_add_u32 s33, s32, s28
  s_add_u32 m0, s33, 0
  s_nop 0
  global_load_lds_dwordx4 v2, s[40:41]
  s_add_u32 m0, s33, 4096
  s_nop 0
  global_load_lds_dwordx4 v2, s[42:43]
  s_add_u32 m0, s33, 8192
  s_nop 0
  global_load_lds_dwordx4 v2, s[44:45]
  s_add_u32 m0, s33, 12288
  s_nop 0
  global_load_lds_dwordx4 v2, s[46:47]
  s_add_u32 m0, s33, 16384
  s_nop 0
  global_load_lds_dwordx4 v2, s[48:49]
  s_add_u32 m0, s33, 20480
  s_nop 0
  global_load_lds_dwordx4 v2, s[50:51]
  v_add_u32 v2, 1024, v2
  s_add_u32 s32, s32, 24576
  s_cmp_ge_u32 s32, 122880
  s_cselect_b32 s32, 0, s32
  s_add_u32 s33, s32, s28
  s_add_u32 m0, s33, 0
  s_nop 0
  global_load_lds_dwordx4 v2, s[40:41]
  s_add_u32 m0, s33, 4096
  s_nop 0
  global_load_lds_dwordx4 v2, s[42:43]
  s_add_u32 m0, s33, 8192
  s_nop 0
  global_load_lds_dwordx4 v2, s[44:45]
  s_add_u32 m0, s33, 12288
  s_nop 0
  global_load_lds_dwordx4 v2, s[46:47]
  s_add_u32 m0, s33, 16384
  s_nop 0
  global_load_lds_dwordx4 v2, s[48:49]
  s_add_u32 m0, s33, 20480
  s_nop 0
  global_load_lds_dwordx4 v2, s[50:51]
  v_add_u32 v2, 1024, v2
  s_add_u32 s32, s32, 24576
  s_cmp_ge_u32 s32, 122880
  s_cselect_b32 s32, 0, s32
  s_add_u32 s33, s32, s28
  s_add_u32 m0, s33, 0
  s_nop 0
  global_load_lds_dwordx4 v2, s[40:41]
  s_add_u32 m0, s33, 4096
  s_nop 0
  global_load_lds_dwordx4 v2, s[42:43]
  s_add_u32 m0, s33, 8192
  s_nop 0
  global_load_lds_dwordx4 v2, s[44:45]
  s_add_u32 m0, s33, 12288
  s_nop 0
  global_load_lds_dwordx4 v2, s[46:47]
  s_add_u32 m0, s33, 16384
  s_nop 0
  global_load_lds_dwordx4 v2, s[48:49]
  s_add_u32 m0, s33, 20480
  s_nop 0
  global_load_lds_dwordx4 v2, s[50:51]
  v_add_u32 v2, 1024, v2
  s_add_u32 s32, s32, 24576
  s_cmp_ge_u32 s32, 122880
  s_cselect_b32 s32, 0, s32
  s_add_u32 s33, s32, s28
  s_add_u32 m0, s33, 0
  s_nop 0
  global_load_lds_dwordx4 v2, s[40:41]
  s_add_u32 m0, s33, 4096
  s_nop 0
  global_load_lds_dwordx4 v2, s[42:43]
  s_add_u32 m0, s33, 8192
  s_nop 0
  global_load_lds_dwordx4 v2, s[44:45]
  s_add_u32 m0, s33, 12288
  s_nop 0
  global_load_lds_dwordx4 v2, s[46:47]
  s_add_u32 m0, s33, 16384
  s_nop 0
  global_load_lds_dwordx4 v2, s[48:49]
  s_add_u32 m0, s33, 20480
  s_nop 0
  global_load_lds_dwordx4 v2, s[50:51]
  v_add_u32 v2, 1024, v2
  s_add_u32 s32, s32, 24576
  s_cmp_ge_u32 s32, 122880
  s_cselect_b32 s32, 0, s32
  v_accvgpr_write_b32 a0, 0
  v_accvgpr_write_b32 a1, 0
  v_accvgpr_write_b32 a2, 0
  v_accvgpr_write_b32 a3, 0
  v_accvgpr_write_b32 a4, 0
  v_accvgpr_write_b32 a5, 0
  v_accvgpr_write_b32 a6, 0
  v_accvgpr_write_b32 a7, 0
  v_accvgpr_write_b32 a8, 0
  v_accvgpr_write_b32 a9, 0
  v_accvgpr_write_b32 a10, 0
  v_accvgpr_write_b32 a11, 0
  v_accvgpr_write_b32 a12, 0
  v_accvgpr_write_b32 a13, 0
  v_accvgpr_write_b32 a14, 0
  v_accvgpr_write_b32 a15, 0
  v_accvgpr_write_b32 a16, 0
  v_accvgpr_write_b32 a17, 0
  v_accvgpr_write_b32 a18, 0
  v_accvgpr_write_b32 a19, 0
  v_accvgpr_write_b32 a20, 0
  v_accvgpr_write_b32 a21, 0
  v_accvgpr_write_b32 a22, 0
  v_accvgpr_write_b32 a23, 0
  v_accvgpr_write_b32 a24, 0
  v_accvgpr_write_b32 a25, 0
  v_accvgpr_write_b32 a26, 0
  v_accvgpr_write_b32 a27, 0
  v_accvgpr_write_b32 a28, 0
  v_accvgpr_write_b32 a29, 0
  v_accvgpr_write_b32 a30, 0
  v_accvgpr_write_b32 a31, 0
  v_accvgpr_write_b32 a32, 0
  v_accvgpr_write_b32 a33, 0
  v_accvgpr_write_b32 a34, 0
  v_accvgpr_write_b32 a35, 0
  v_accvgpr_write_b32 a36, 0
  v_accvgpr_write_b32 a37, 0
  v_accvgpr_write_b32 a38, 0
  v_accvgpr_write_b32 a39, 0
  v_accvgpr_write_b32 a40, 0
  v_accvgpr_write_b32 a41, 0
  v_accvgpr_write_b32 a42, 0
  v_accvgpr_write_b32 a43, 0
  v_accvgpr_write_b32 a44, 0
  v_accvgpr_write_b32 a45, 0
  v_accvgpr_write_b32 a46, 0
  v_accvgpr_write_b32 a47, 0
  v_accvgpr_write_b32 a48, 0
  v_accvgpr_write_b32 a49, 0
  v_accvgpr_write_b32 a50, 0
  v_accvgpr_write_b32 a51, 0
  v_accvgpr_write_b32 a52, 0
  v_accvgpr_write_b32 a53, 0
  v_accvgpr_write_b32 a54, 0
  v_accvgpr_write_b32 a55, 0
  v_accvgpr_write_b32 a56, 0
  v_accvgpr_write_b32 a57, 0
  v_accvgpr_write_b32 a58, 0
  v_accvgpr_write_b32 a59, 0
  v_accvgpr_write_b32 a60, 0
  v_accvgpr_write_b32 a61, 0
  v_accvgpr_write_b32 a62, 0
  v_accvgpr_write_b32 a63, 0
  v_accvgpr_write_b32 a64, 0
  v_accvgpr_write_b32 a65, 0
  v_accvgpr_write_b32 a66, 0
  v_accvgpr_write_b32 a67, 0
  v_accvgpr_write_b32 a68, 0
  v_accvgpr_write_b32 a69, 0
  v_accvgpr_write_b32 a70, 0
  v_accvgpr_write_b32 a71, 0
  v_accvgpr_write_b32 a72, 0
  v_accvgpr_write_b32 a73, 0
  v_accvgpr_write_b32 a74, 0
  v_accvgpr_write_b32 a75, 0
  v_accvgpr_write_b32 a76, 0
  v_accvgpr_write_b32 a77, 0
  v_accvgpr_write_b32 a78, 0
  v_accvgpr_write_b32 a79, 0
  v_accvgpr_write_b32 a80, 0
  v_accvgpr_write_b32 a81, 0
  v_accvgpr_write_b32 a82, 0
  v_accvgpr_write_b32 a83, 0
  v_accvgpr_write_b32 a84, 0
  v_accvgpr_write_b32 a85, 0
  v_accvgpr_write_b32 a86, 0
  v_accvgpr_write_b32 a87, 0
  v_accvgpr_write_b32 a88, 0
  v_accvgpr_write_b32 a89, 0
  v_accvgpr_write_b32 a90, 0
  v_accvgpr_write_b32 a91, 0
  v_accvgpr_write_b32 a92, 0
  v_accvgpr_write_b32 a93, 0
  v_accvgpr_write_b32 a94, 0
  v_accvgpr_write_b32 a95, 0
  v_accvgpr_write_b32 a96, 0
  v_accvgpr_write_b32 a97, 0
  v_accvgpr_write_b32 a98, 0
  v_accvgpr_write_b32 a99, 0
  v_accvgpr_write_b32 a100, 0
  v_accvgpr_write_b32 a101, 0
  v_accvgpr_write_b32 a102, 0
  v_accvgpr_write_b32 a103, 0
  v_accvgpr_write_b32 a104, 0
  v_accvgpr_write_b32 a105, 0
  v_accvgpr_write_b32 a106, 0
  v_accvgpr_write_b32 a107, 0
  v_accvgpr_write_b32 a108, 0
  v_accvgpr_write_b32 a109, 0
  v_accvgpr_write_b32 a110, 0
  v_accvgpr_write_b32 a111, 0
  v_accvgpr_write_b32 a112, 0
  v_accvgpr_write_b32 a113, 0
  v_accvgpr_write_b32 a114, 0
  v_accvgpr_write_b32 a115, 0
  v_accvgpr_write_b32 a116, 0
  v_accvgpr_write_b32 a117, 0
  v_accvgpr_write_b32 a118, 0
  v_accvgpr_write_b32 a119, 0
  v_accvgpr_write_b32 a120, 0
  v_accvgpr_write_b32 a121, 0
  v_accvgpr_write_b32 a122, 0
  v_accvgpr_write_b32 a123, 0
  v_accvgpr_write_b32 a124, 0
  v_accvgpr_write_b32 a125, 0
  v_accvgpr_write_b32 a126, 0
  v_accvgpr_write_b32 a127, 0
  s_lshr_b32 s37, s21, 5
  s_and_b32 s38, s21, 31
  s_cmp_eq_u32 s37, 2
  s_cbranch_scc1 qbulk_v
  s_waitcnt vmcnt(24)
  s_barrier
  s_add_u32 s34, s31, s29
  s_add_u32 s35, s31, s30
  v_add_u32 v3, s34, v1
  v_add_u32 v4, s35, v1
  ds_read_b128 v[8:11], v4 offset:0
  ds_read_b128 v[12:15], v4 offset:1024
  ds_read_b128 v[16:19], v4 offset:2048
  ds_read_b128 v[20:23], v4 offset:3072
  ds_read_b128 v[24:27], v3 offset:0
  ds_read_b128 v[28:31], v3 offset:1024
  ds_read_b128 v[32:35], v3 offset:2048
  ds_read_b128 v[36:39], v3 offset:3072
  ds_read_b128 v[40:43], v3 offset:4096
  ds_read_b128 v[44:47], v3 offset:5120
  ds_read_b128 v[48:51], v3 offset:6144
  ds_read_b128 v[52:55], v3 offset:7168
  s_add_u32 s31, s31, 24576
  s_cmp_ge_u32 s31, 122880
  s_cselect_b32 s31, 0, s31
  s_waitcnt vmcnt(18) lgkmcnt(0)
  s_barrier
  v_mfma_f32_16x16x32_bf16 a[0:3], v[8:11], v[24:27], a[0:3]
  s_add_u32 s34, s31, s29
  s_add_u32 s35, s31, s30
  v_add_u32 v3, s34, v1
  v_add_u32 v4, s35, v1
  v_mfma_f32_16x16x32_bf16 a[4:7], v[12:15], v[24:27], a[4:7]
  ds_read_b128 v[56:59], v4 offset:0
  v_mfma_f32_16x16x32_bf16 a[8:11], v[16:19], v[24:27], a[8:11]
  ds_read_b128 v[60:63], v4 offset:1024
  v_mfma_f32_16x16x32_bf16 a[12:15], v[20:23], v[24:27], a[12:15]
  v_mfma_f32_16x16x32_bf16 a[16:19], v[8:11], v[28:31], a[16:19]
  ds_read_b128 v[64:67], v4 offset:2048
  v_mfma_f32_16x16x32_bf16 a[20:23], v[12:15], v[28:31], a[20:23]
  ds_read_b128 v[68:71], v4 offset:3072
  v_mfma_f32_16x16x32_bf16 a[24:27], v[16:19], v[28:31], a[24:27]
  v_mfma_f32_16x16x32_bf16 a[28:31], v[20:23], v[28:31], a[28:31]
  ds_read_b128 v[72:75], v3 offset:0
  v_mfma_f32_16x16x32_bf16 a[32:35], v[8:11], v[32:35], a[32:35]
  ds_read_b128 v[76:79], v3 offset:1024
  v_mfma_f32_16x16x32_bf16 a[36:39], v[12:15], v[32:35], a[36:39]
  v_mfma_f32_16x16x32_bf16 a[40:43], v[16:19], v[32:35], a[40:43]
  ds_read_b128 v[80:83], v3 offset:2048
  v_mfma_f32_16x16x32_bf16 a[44:47], v[20:23], v[32:35], a[44:47]
  ds_read_b128 v[84:87], v3 offset:3072
  v_mfma_f32_16x16x32_bf16 a[48:51], v[8:11], v[36:39], a[48:51]
  v_mfma_f32_16x16x32_bf16 a[52:55], v[12:15], v[36:39], a[52:55]
  ds_read_b128 v[88:91], v3 offset:4096
  v_mfma_f32_16x16x32_bf16 a[56:59], v[16:19], v[36:39], a[56:59]
  ds_read_b128 v[92:95], v3 offset:5120
  v_mfma_f32_16x16x32_bf16 a[60:63], v[20:23], v[36:39], a[60:63]
  v_mfma_f32_16x16x32_bf16 a[64:67], v[8:11], v[40:43], a[64:67]
  ds_read_b128 v[96:99], v3 offset:6144
  v_mfma_f32_16x16x32_bf16 a[68:71], v[12:15], v[40:43], a[68:71]
  ds_read_b128 v[100:103], v3 offset:7168
  v_mfma_f32_16x16x32_bf16 a[72:75], v[16:19], v[40:43], a[72:75]
  s_add_u32 s31, s31, 24576
  s_cmp_ge_u32 s31, 122880
  s_cselect_b32 s31, 0, s31
  v_mfma_f32_16x16x32_bf16 a[76:79], v[20:23], v[40:43], a[76:79]
  v_mfma_f32_16x16x32_bf16 a[80:83], v[8:11], v[44:47], a[80:83]
  s_add_u32 s33, s32, s28
  v_mfma_f32_16x16x32_bf16 a[84:87], v[12:15], v[44:47], a[84:87]
  s_add_u32 m0, s33, 0
  s_nop 0
  global_load_lds_dwordx4 v2, s[40:41]
  v_mfma_f32_16x16x32_bf16 a[88:91], v[16:19], v[44:47], a[88:91]
  v_mfma_f32_16x16x32_bf16 a[92:95], v[20:23], v[44:47], a[92:95]
  s_add_u32 m0, s33, 4096
  s_nop 0
  global_load_lds_dwordx4 v2, s[42:43]
  v_mfma_f32_16x16x32_bf16 a[96:99], v[8:11], v[48:51], a[96:99]
  s_add_u32 m0, s33, 8192
  s_nop 0
  global_load_lds_dwordx4 v2, s[44:45]
  v_mfma_f32_16x16x32_bf16 a[100:103], v[12:15], v[48:51], a[100:103]
  v_mfma_f32_16x16x32_bf16 a[104:107], v[16:19], v[48:51], a[104:107]
  s_add_u32 m0, s33, 12288
  s_nop 0
  global_load_lds_dwordx4 v2, s[46:47]
  v_mfma_f32_16x16x32_bf16 a[108:111], v[20:23], v[48:51], a[108:111]
  s_add_u32 m0, s33, 16384
  s_nop 0
  global_load_lds_dwordx4 v2, s[48:49]
  v_mfma_f32_16x16x32_bf16 a[112:115], v[8:11], v[52:55], a[112:115]
  v_mfma_f32_16x16x32_bf16 a[116:119], v[12:15], v[52:55], a[116:119]
  s_add_u32 m0, s33, 20480
  s_nop 0
  global_load_lds_dwordx4 v2, s[50:51]
  v_mfma_f32_16x16x32_bf16 a[120:123], v[16:19], v[52:55], a[120:123]
  v_add_u32 v2, 1024, v2
  s_add_u32 s32, s32, 24576
  s_cmp_ge_u32 s32, 122880
  s_cselect_b32 s32, 0, s32
  v_mfma_f32_16x16x32_bf16 a[124:127], v[20:23], v[52:55], a[124:127]
  s_mov_b32 s36, 0
qbulk_bt_loop:
  s_waitcnt vmcnt(18) lgkmcnt(0)
  s_barrier
  v_mfma_f32_16x16x32_bf16 a[0:3], v[56:59], v[72:75], a[0:3]
  s_add_u32 s34, s31, s29
  s_add_u32 s35, s31, s30
  v_add_u32 v3, s34, v1
  v_add_u32 v4, s35, v1
  v_mfma_f32_16x16x32_bf16 a[4:7], v[60:63], v[72:75], a[4:7]
  ds_read_b128 v[8:11], v4 offset:0
  v_mfma_f32_16x16x32_bf16 a[8:11], v[64:67], v[72:75], a[8:11]
  ds_read_b128 v[12:15], v4 offset:1024
  v_mfma_f32_16x16x32_bf16 a[12:15], v[68:71], v[72:75], a[12:15]
  v_mfma_f32_16x16x32_bf16 a[16:19], v[56:59], v[76:79], a[16:19]
  ds_read_b128 v[16:19], v4 offset:2048
  v_mfma_f32_16x16x32_bf16 a[20:23], v[60:63], v[76:79], a[20:23]
  ds_read_b128 v[20:23], v4 offset:3072
  v_mfma_f32_16x16x32_bf16 a[24:27], v[64:67], v[76:79], a[24:27]
  v_mfma_f32_16x16x32_bf16 a[28:31], v[68:71], v[76:79], a[28:31]
  ds_read_b128 v[24:27], v3 offset:0
  v_mfma_f32_16x16x32_bf16 a[32:35], v[56:59], v[80:83], a[32:35]
  ds_read_b128 v[28:31], v3 offset:1024
  v_mfma_f32_16x16x32_bf16 a[36:39], v[60:63], v[80:83], a[36:39]
  v_mfma_f32_16x16x32_bf16 a[40:43], v[64:67], v[80:83], a[40:43]
  ds_read_b128 v[32:35], v3 offset:2048
  v_mfma_f32_16x16x32_bf16 a[44:47], v[68:71], v[80:83], a[44:47]
  ds_read_b128 v[36:39], v3 offset:3072
  v_mfma_f32_16x16x32_bf16 a[48:51], v[56:59], v[84:87], a[48:51]
  v_mfma_f32_16x16x32_bf16 a[52:55], v[60:63], v[84:87], a[52:55]
  ds_read_b128 v[40:43], v3 offset:4096
  v_mfma_f32_16x16x32_bf16 a[56:59], v[64:67], v[84:87], a[56:59]
  ds_read_b128 v[44:47], v3 offset:5120
  v_mfma_f32_16x16x32_bf16 a[60:63], v[68:71], v[84:87], a[60:63]
  v_mfma_f32_16x16x32_bf16 a[64:67], v[56:59], v[88:91], a[64:67]
  ds_read_b128 v[48:51], v3 offset:6144
  v_mfma_f32_16x16x32_bf16 a[68:71], v[60:63], v[88:91], a[68:71]
  ds_read_b128 v[52:55], v3 offset:7168
  v_mfma_f32_16x16x32_bf16 a[72:75], v[64:67], v[88:91], a[72:75]
  s_add_u32 s31, s31, 24576
  s_cmp_ge_u32 s31, 122880
  s_cselect_b32 s31, 0, s31
  v_mfma_f32_16x16x32_bf16 a[76:79], v[68:71], v[88:91], a[76:79]
  v_mfma_f32_16x16x32_bf16 a[80:83], v[56:59], v[92:95], a[80:83]
  s_add_u32 s33, s32, s28
  v_mfma_f32_16x16x32_bf16 a[84:87], v[60:63], v[92:95], a[84:87]
  s_add_u32 m0, s33, 0
  s_nop 0
  global_load_lds_dwordx4 v2, s[40:41]
  v_mfma_f32_16x16x32_bf16 a[88:91], v[64:67], v[92:95], a[88:91]
  v_mfma_f32_16x16x32_bf16 a[92:95], v[68:71], v[92:95], a[92:95]
  s_add_u32 m0, s33, 4096
  s_nop 0
  global_load_lds_dwordx4 v2, s[42:43]
  v_mfma_f32_16x16x32_bf16 a[96:99], v[56:59], v[96:99], a[96:99]
  s_add_u32 m0, s33, 8192
  s_nop 0
  global_load_lds_dwordx4 v2, s[44:45]
  v_mfma_f32_16x16x32_bf16 a[100:103], v[60:63], v[96:99], a[100:103]
  v_mfma_f32_16x16x32_bf16 a[104:107], v[64:67], v[96:99], a[104:107]
  s_add_u32 m0, s33, 12288
  s_nop 0
  global_load_lds_dwordx4 v2, s[46:47]
  v_mfma_f32_16x16x32_bf16 a[108:111], v[68:71], v[96:99], a[108:111]
  s_add_u32 m0, s33, 16384
  s_nop 0
  global_load_lds_dwordx4 v2, s[48:49]
  v_mfma_f32_16x16x32_bf16 a[112:115], v[56:59], v[100:103], a[112:115]
  v_mfma_f32_16x16x32_bf16 a[116:119], v[60:63], v[100:103], a[116:119]
  s_add_u32 m0, s33, 20480
  s_nop 0
  global_load_lds_dwordx4 v2, s[50:51]
  v_mfma_f32_16x16x32_bf16 a[120:123], v[64:67], v[100:103], a[120:123]
  v_add_u32 v2, 1024, v2
  s_add_u32 s32, s32, 24576
  s_cmp_ge_u32 s32, 122880
  s_cselect_b32 s32, 0, s32
  v_mfma_f32_16x16x32_bf16 a[124:127], v[68:71], v[100:103], a[124:127]
  s_waitcnt vmcnt(18) lgkmcnt(0)
  s_barrier
  v_mfma_f32_16x16x32_bf16 a[0:3], v[8:11], v[24:27], a[0:3]
  s_add_u32 s34, s31, s29
  s_add_u32 s35, s31, s30
  v_add_u32 v3, s34, v1
  v_add_u32 v4, s35, v1
  v_mfma_f32_16x16x32_bf16 a[4:7], v[12:15], v[24:27], a[4:7]
  ds_read_b128 v[56:59], v4 offset:0
  v_mfma_f32_16x16x32_bf16 a[8:11], v[16:19], v[24:27], a[8:11]
  ds_read_b128 v[60:63], v4 offset:1024
  v_mfma_f32_16x16x32_bf16 a[12:15], v[20:23], v[24:27], a[12:15]
  v_mfma_f32_16x16x32_bf16 a[16:19], v[8:11], v[28:31], a[16:19]
  ds_read_b128 v[64:67], v4 offset:2048
  v_mfma_f32_16x16x32_bf16 a[20:23], v[12:15], v[28:31], a[20:23]
  ds_read_b128 v[68:71], v4 offset:3072
  v_mfma_f32_16x16x32_bf16 a[24:27], v[16:19], v[28:31], a[24:27]
  v_mfma_f32_16x16x32_bf16 a[28:31], v[20:23], v[28:31], a[28:31]
  ds_read_b128 v[72:75], v3 offset:0
  v_mfma_f32_16x16x32_bf16 a[32:35], v[8:11], v[32:35], a[32:35]
  ds_read_b128 v[76:79], v3 offset:1024
  v_mfma_f32_16x16x32_bf16 a[36:39], v[12:15], v[32:35], a[36:39]
  v_mfma_f32_16x16x32_bf16 a[40:43], v[16:19], v[32:35], a[40:43]
  ds_read_b128 v[80:83], v3 offset:2048
  v_mfma_f32_16x16x32_bf16 a[44:47], v[20:23], v[32:35], a[44:47]
  ds_read_b128 v[84:87], v3 offset:3072
  v_mfma_f32_16x16x32_bf16 a[48:51], v[8:11], v[36:39], a[48:51]
  v_mfma_f32_16x16x32_bf16 a[52:55], v[12:15], v[36:39], a[52:55]
  ds_read_b128 v[88:91], v3 offset:4096
  v_mfma_f32_16x16x32_bf16 a[56:59], v[16:19], v[36:39], a[56:59]
  ds_read_b128 v[92:95], v3 offset:5120
  v_mfma_f32_16x16x32_bf16 a[60:63], v[20:23], v[36:39], a[60:63]
  v_mfma_f32_16x16x32_bf16 a[64:67], v[8:11], v[40:43], a[64:67]
  ds_read_b128 v[96:99], v3 offset:6144
  v_mfma_f32_16x16x32_bf16 a[68:71], v[12:15], v[40:43], a[68:71]
  ds_read_b128 v[100:103], v3 offset:7168
  v_mfma_f32_16x16x32_bf16 a[72:75], v[16:19], v[40:43], a[72:75]
  s_add_u32 s31, s31, 24576
  s_cmp_ge_u32 s31, 122880
  s_cselect_b32 s31, 0, s31
  v_mfma_f32_16x16x32_bf16 a[76:79], v[20:23], v[40:43], a[76:79]
  v_mfma_f32_16x16x32_bf16 a[80:83], v[8:11], v[44:47], a[80:83]
  s_add_u32 s33, s32, s28
  v_mfma_f32_16x16x32_bf16 a[84:87], v[12:15], v[44:47], a[84:87]
  s_add_u32 m0, s33, 0
  s_nop 0
  global_load_lds_dwordx4 v2, s[40:41]
  v_mfma_f32_16x16x32_bf16 a[88:91], v[16:19], v[44:47], a[88:91]
  v_mfma_f32_16x16x32_bf16 a[92:95], v[20:23], v[44:47], a[92:95]
  s_add_u32 m0, s33, 4096
  s_nop 0
  global_load_lds_dwordx4 v2, s[42:43]
  v_mfma_f32_16x16x32_bf16 a[96:99], v[8:11], v[48:51], a[96:99]
  s_add_u32 m0, s33, 8192
  s_nop 0
  global_load_lds_dwordx4 v2, s[44:45]
  v_mfma_f32_16x16x32_bf16 a[100:103], v[12:15], v[48:51], a[100:103]
  v_mfma_f32_16x16x32_bf16 a[104:107], v[16:19], v[48:51], a[104:107]
  s_add_u32 m0, s33, 12288
  s_nop 0
  global_load_lds_dwordx4 v2, s[46:47]
  v_mfma_f32_16x16x32_bf16 a[108:111], v[20:23], v[48:51], a[108:111]
  s_add_u32 m0, s33, 16384
  s_nop 0
  global_load_lds_dwordx4 v2, s[48:49]
  v_mfma_f32_16x16x32_bf16 a[112:115], v[8:11], v[52:55], a[112:115]
  v_mfma_f32_16x16x32_bf16 a[116:119], v[12:15], v[52:55], a[116:119]
  s_add_u32 m0, s33, 20480
  s_nop 0
  global_load_lds_dwordx4 v2, s[50:51]
  v_mfma_f32_16x16x32_bf16 a[120:123], v[16:19], v[52:55], a[120:123]
  v_add_u32 v2, 1024, v2
  s_add_u32 s32, s32, 24576
  s_cmp_ge_u32 s32, 122880
  s_cselect_b32 s32, 0, s32
  v_mfma_f32_16x16x32_bf16 a[124:127], v[20:23], v[52:55], a[124:127]
  s_add_u32 s36, s36, 2
  s_cmp_lt_u32 s36, 14
  s_cbranch_scc1 qbulk_bt_loop
  s_waitcnt vmcnt(18) lgkmcnt(0)
  s_barrier
  v_mfma_f32_16x16x32_bf16 a[0:3], v[56:59], v[72:75], a[0:3]
  s_add_u32 s34, s31, s29
  s_add_u32 s35, s31, s30
  v_add_u32 v3, s34, v1
  v_add_u32 v4, s35, v1
  v_mfma_f32_16x16x32_bf16 a[4:7], v[60:63], v[72:75], a[4:7]
  v_mfma_f32_16x16x32_bf16 a[8:11], v[64:67], v[72:75], a[8:11]
  ds_read_b128 v[8:11], v4 offset:0
  v_mfma_f32_16x16x32_bf16 a[12:15], v[68:71], v[72:75], a[12:15]
  v_mfma_f32_16x16x32_bf16 a[16:19], v[56:59], v[76:79], a[16:19]
  ds_read_b128 v[12:15], v4 offset:1024
  v_mfma_f32_16x16x32_bf16 a[20:23], v[60:63], v[76:79], a[20:23]
  v_mfma_f32_16x16x32_bf16 a[24:27], v[64:67], v[76:79], a[24:27]
  ds_read_b128 v[16:19], v4 offset:2048
  v_mfma_f32_16x16x32_bf16 a[28:31], v[68:71], v[76:79], a[28:31]
  v_mfma_f32_16x16x32_bf16 a[32:35], v[56:59], v[80:83], a[32:35]
  v_mfma_f32_16x16x32_bf16 a[36:39], v[60:63], v[80:83], a[36:39]
  ds_read_b128 v[20:23], v4 offset:3072
  v_mfma_f32_16x16x32_bf16 a[40:43], v[64:67], v[80:83], a[40:43]
  v_mfma_f32_16x16x32_bf16 a[44:47], v[68:71], v[80:83], a[44:47]
  ds_read_b128 v[24:27], v3 offset:0
  v_mfma_f32_16x16x32_bf16 a[48:51], v[56:59], v[84:87], a[48:51]
  v_mfma_f32_16x16x32_bf16 a[52:55], v[60:63], v[84:87], a[52:55]
  ds_read_b128 v[28:31], v3 offset:1024
  v_mfma_f32_16x16x32_bf16 a[56:59], v[64:67], v[84:87], a[56:59]
  v_mfma_f32_16x16x32_bf16 a[60:63], v[68:71], v[84:87], a[60:63]
  v_mfma_f32_16x16x32_bf16 a[64:67], v[56:59], v[88:91], a[64:67]
  ds_read_b128 v[32:35], v3 offset:2048
  v_mfma_f32_16x16x32_bf16 a[68:71], v[60:63], v[88:91], a[68:71]
  v_mfma_f32_16x16x32_bf16 a[72:75], v[64:67], v[88:91], a[72:75]
  ds_read_b128 v[36:39], v3 offset:3072
  v_mfma_f32_16x16x32_bf16 a[76:79], v[68:71], v[88:91], a[76:79]
  v_mfma_f32_16x16x32_bf16 a[80:83], v[56:59], v[92:95], a[80:83]
  ds_read_b128 v[40:43], v3 offset:4096
  v_mfma_f32_16x16x32_bf16 a[84:87], v[60:63], v[92:95], a[84:87]
  v_mfma_f32_16x16x32_bf16 a[88:91], v[64:67], v[92:95], a[88:91]
  ds_read_b128 v[44:47], v3 offset:5120
  v_mfma_f32_16x16x32_bf16 a[92:95], v[68:71], v[92:95], a[92:95]
  v_mfma_f32_16x16x32_bf16 a[96:99], v[56:59], v[96:99], a[96:99]
  v_mfma_f32_16x16x32_bf16 a[100:103], v[60:63], v[96:99], a[100:103]
  ds_read_b128 v[48:51], v3 offset:6144
  v_mfma_f32_16x16x32_bf16 a[104:107], v[64:67], v[96:99], a[104:107]
  v_mfma_f32_16x16x32_bf16 a[108:111], v[68:71], v[96:99], a[108:111]
  ds_read_b128 v[52:55], v3 offset:7168
  v_mfma_f32_16x16x32_bf16 a[112:115], v[56:59], v[100:103], a[112:115]
  v_mfma_f32_16x16x32_bf16 a[116:119], v[60:63], v[100:103], a[116:119]
  s_add_u32 s31, s31, 24576
  s_cmp_ge_u32 s31, 122880
  s_cselect_b32 s31, 0, s31
  v_mfma_f32_16x16x32_bf16 a[120:123], v[64:67], v[100:103], a[120:123]
  v_mfma_f32_16x16x32_bf16 a[124:127], v[68:71], v[100:103], a[124:127]
  s_waitcnt vmcnt(12) lgkmcnt(0)
  s_barrier
  v_mfma_f32_16x16x32_bf16 a[0:3], v[8:11], v[24:27], a[0:3]
  s_add_u32 s34, s31, s29
  s_add_u32 s35, s31, s30
  v_add_u32 v3, s34, v1
  v_add_u32 v4, s35, v1
  v_mfma_f32_16x16x32_bf16 a[4:7], v[12:15], v[24:27], a[4:7]
  v_mfma_f32_16x16x32_bf16 a[8:11], v[16:19], v[24:27], a[8:11]
  ds_read_b128 v[56:59], v4 offset:0
  v_mfma_f32_16x16x32_bf16 a[12:15], v[20:23], v[24:27], a[12:15]
  v_mfma_f32_16x16x32_bf16 a[16:19], v[8:11], v[28:31], a[16:19]
  ds_read_b128 v[60:63], v4 offset:1024
  v_mfma_f32_16x16x32_bf16 a[20:23], v[12:15], v[28:31], a[20:23]
  v_mfma_f32_16x16x32_bf16 a[24:27], v[16:19], v[28:31], a[24:27]
  ds_read_b128 v[64:67], v4 offset:2048
  v_mfma_f32_16x16x32_bf16 a[28:31], v[20:23], v[28:31], a[28:31]
  v_mfma_f32_16x16x32_bf16 a[32:35], v[8:11], v[32:35], a[32:35]
  v_mfma_f32_16x16x32_bf16 a[36:39], v[12:15], v[32:35], a[36:39]
  ds_read_b128 v[68:71], v4 offset:3072
  v_mfma_f32_16x16x32_bf16 a[40:43], v[16:19], v[32:35], a[40:43]
  v_mfma_f32_16x16x32_bf16 a[44:47], v[20:23], v[32:35], a[44:47]
  ds_read_b128 v[72:75], v3 offset:0
  v_mfma_f32_16x16x32_bf16 a[48:51], v[8:11], v[36:39], a[48:51]
  v_mfma_f32_16x16x32_bf16 a[52:55], v[12:15], v[36:39], a[52:55]
  ds_read_b128 v[76:79], v3 offset:1024
  v_mfma_f32_16x16x32_bf16 a[56:59], v[16:19], v[36:39], a[56:59]
  v_mfma_f32_16x16x32_bf16 a[60:63], v[20:23], v[36:39], a[60:63]
  v_mfma_f32_16x16x32_bf16 a[64:67], v[8:11], v[40:43], a[64:67]
  ds_read_b128 v[80:83], v3 offset:2048
  v_mfma_f32_16x16x32_bf16 a[68:71], v[12:15], v[40:43], a[68:71]
  v_mfma_f32_16x16x32_bf16 a[72:75], v[16:19], v[40:43], a[72:75]
  ds_read_b128 v[84:87], v3 offset:3072
  v_mfma_f32_16x16x32_bf16 a[76:79], v[20:23], v[40:43], a[76:79]
  v_mfma_f32_16x16x32_bf16 a[80:83], v[8:11], v[44:47], a[80:83]
  ds_read_b128 v[88:91], v3 offset:4096
  v_mfma_f32_16x16x32_bf16 a[84:87], v[12:15], v[44:47], a[84:87]
  v_mfma_f32_16x16x32_bf16 a[88:91], v[16:19], v[44:47], a[88:91]
  ds_read_b128 v[92:95], v3 offset:5120
  v_mfma_f32_16x16x32_bf16 a[92:95], v[20:23], v[44:47], a[92:95]
  v_mfma_f32_16x16x32_bf16 a[96:99], v[8:11], v[48:51], a[96:99]
  v_mfma_f32_16x16x32_bf16 a[100:103], v[12:15], v[48:51], a[100:103]
  ds_read_b128 v[96:99], v3 offset:6144
  v_mfma_f32_16x16x32_bf16 a[104:107], v[16:19], v[48:51], a[104:107]
  v_mfma_f32_16x16x32_bf16 a[108:111], v[20:23], v[48:51], a[108:111]
  ds_read_b128 v[100:103], v3 offset:7168
  v_mfma_f32_16x16x32_bf16 a[112:115], v[8:11], v[52:55], a[112:115]
  v_mfma_f32_16x16x32_bf16 a[116:119], v[12:15], v[52:55], a[116:119]
  s_add_u32 s31, s31, 24576
  s_cmp_ge_u32 s31, 122880
  s_cselect_b32 s31, 0, s31
  v_mfma_f32_16x16x32_bf16 a[120:123], v[16:19], v[52:55], a[120:123]
  v_mfma_f32_16x16x32_bf16 a[124:127], v[20:23], v[52:55], a[124:127]
  s_waitcnt vmcnt(6) lgkmcnt(0)
  s_barrier
  v_mfma_f32_16x16x32_bf16 a[0:3], v[56:59], v[72:75], a[0:3]
  s_add_u32 s34, s31, s29
  s_add_u32 s35, s31, s30
  v_add_u32 v3, s34, v1
  v_add_u32 v4, s35, v1
  v_mfma_f32_16x16x32_bf16 a[4:7], v[60:63], v[72:75], a[4:7]
  v_mfma_f32_16x16x32_bf16 a[8:11], v[64:67], v[72:75], a[8:11]
  ds_read_b128 v[8:11], v4 offset:0
  v_mfma_f32_16x16x32_bf16 a[12:15], v[68:71], v[72:75], a[12:15]
  v_mfma_f32_16x16x32_bf16 a[16:19], v[56:59], v[76:79], a[16:19]
  ds_read_b128 v[12:15], v4 offset:1024
  v_mfma_f32_16x16x32_bf16 a[20:23], v[60:63], v[76:79], a[20:23]
  v_mfma_f32_16x16x32_bf16 a[24:27], v[64:67], v[76:79], a[24:27]
  ds_read_b128 v[16:19], v4 offset:2048
  v_mfma_f32_16x16x32_bf16 a[28:31], v[68:71], v[76:79], a[28:31]
  v_mfma_f32_16x16x32_bf16 a[32:35], v[56:59], v[80:83], a[32:35]
  v_mfma_f32_16x16x32_bf16 a[36:39], v[60:63], v[80:83], a[36:39]
  ds_read_b128 v[20:23], v4 offset:3072
  v_mfma_f32_16x16x32_bf16 a[40:43], v[64:67], v[80:83], a[40:43]
  v_mfma_f32_16x16x32_bf16 a[44:47], v[68:71], v[80:83], a[44:47]
  ds_read_b128 v[24:27], v3 offset:0
  v_mfma_f32_16x16x32_bf16 a[48:51], v[56:59], v[84:87], a[48:51]
  v_mfma_f32_16x16x32_bf16 a[52:55], v[60:63], v[84:87], a[52:55]
  ds_read_b128 v[28:31], v3 offset:1024
  v_mfma_f32_16x16x32_bf16 a[56:59], v[64:67], v[84:87], a[56:59]
  v_mfma_f32_16x16x32_bf16 a[60:63], v[68:71], v[84:87], a[60:63]
  v_mfma_f32_16x16x32_bf16 a[64:67], v[56:59], v[88:91], a[64:67]
  ds_read_b128 v[32:35], v3 offset:2048
  v_mfma_f32_16x16x32_bf16 a[68:71], v[60:63], v[88:91], a[68:71]
  v_mfma_f32_16x16x32_bf16 a[72:75], v[64:67], v[88:91], a[72:75]
  ds_read_b128 v[36:39], v3 offset:3072
  v_mfma_f32_16x16x32_bf16 a[76:79], v[68:71], v[88:91], a[76:79]
  v_mfma_f32_16x16x32_bf16 a[80:83], v[56:59], v[92:95], a[80:83]
  ds_read_b128 v[40:43], v3 offset:4096
  v_mfma_f32_16x16x32_bf16 a[84:87], v[60:63], v[92:95], a[84:87]
  v_mfma_f32_16x16x32_bf16 a[88:91], v[64:67], v[92:95], a[88:91]
  ds_read_b128 v[44:47], v3 offset:5120
  v_mfma_f32_16x16x32_bf16 a[92:95], v[68:71], v[92:95], a[92:95]
  v_mfma_f32_16x16x32_bf16 a[96:99], v[56:59], v[96:99], a[96:99]
  v_mfma_f32_16x16x32_bf16 a[100:103], v[60:63], v[96:99], a[100:103]
  ds_read_b128 v[48:51], v3 offset:6144
  v_mfma_f32_16x16x32_bf16 a[104:107], v[64:67], v[96:99], a[104:107]
  v_mfma_f32_16x16x32_bf16 a[108:111], v[68:71], v[96:99], a[108:111]
  ds_read_b128 v[52:55], v3 offset:7168
  v_mfma_f32_16x16x32_bf16 a[112:115], v[56:59], v[100:103], a[112:115]
  v_mfma_f32_16x16x32_bf16 a[116:119], v[60:63], v[100:103], a[116:119]
  s_add_u32 s31, s31, 24576
  s_cmp_ge_u32 s31, 122880
  s_cselect_b32 s31, 0, s31
  v_mfma_f32_16x16x32_bf16 a[120:123], v[64:67], v[100:103], a[120:123]
  v_mfma_f32_16x16x32_bf16 a[124:127], v[68:71], v[100:103], a[124:127]
  s_waitcnt vmcnt(0) lgkmcnt(0)
  s_barrier
  v_mfma_f32_16x16x32_bf16 a[0:3], v[8:11], v[24:27], a[0:3]
  s_add_u32 s34, s31, s29
  s_add_u32 s35, s31, s30
  v_add_u32 v3, s34, v1
  v_add_u32 v4, s35, v1
  v_mfma_f32_16x16x32_bf16 a[4:7], v[12:15], v[24:27], a[4:7]
  v_mfma_f32_16x16x32_bf16 a[8:11], v[16:19], v[24:27], a[8:11]
  ds_read_b128 v[56:59], v4 offset:0
  v_mfma_f32_16x16x32_bf16 a[12:15], v[20:23], v[24:27], a[12:15]
  v_mfma_f32_16x16x32_bf16 a[16:19], v[8:11], v[28:31], a[16:19]
  ds_read_b128 v[60:63], v4 offset:1024
  v_mfma_f32_16x16x32_bf16 a[20:23], v[12:15], v[28:31], a[20:23]
  v_mfma_f32_16x16x32_bf16 a[24:27], v[16:19], v[28:31], a[24:27]
  ds_read_b128 v[64:67], v4 offset:2048
  v_mfma_f32_16x16x32_bf16 a[28:31], v[20:23], v[28:31], a[28:31]
  v_mfma_f32_16x16x32_bf16 a[32:35], v[8:11], v[32:35], a[32:35]
  v_mfma_f32_16x16x32_bf16 a[36:39], v[12:15], v[32:35], a[36:39]
  ds_read_b128 v[68:71], v4 offset:3072
  v_mfma_f32_16x16x32_bf16 a[40:43], v[16:19], v[32:35], a[40:43]
  v_mfma_f32_16x16x32_bf16 a[44:47], v[20:23], v[32:35], a[44:47]
  ds_read_b128 v[72:75], v3 offset:0
  v_mfma_f32_16x16x32_bf16 a[48:51], v[8:11], v[36:39], a[48:51]
  v_mfma_f32_16x16x32_bf16 a[52:55], v[12:15], v[36:39], a[52:55]
  ds_read_b128 v[76:79], v3 offset:1024
  v_mfma_f32_16x16x32_bf16 a[56:59], v[16:19], v[36:39], a[56:59]
  v_mfma_f32_16x16x32_bf16 a[60:63], v[20:23], v[36:39], a[60:63]
  v_mfma_f32_16x16x32_bf16 a[64:67], v[8:11], v[40:43], a[64:67]
  ds_read_b128 v[80:83], v3 offset:2048
  v_mfma_f32_16x16x32_bf16 a[68:71], v[12:15], v[40:43], a[68:71]
  v_mfma_f32_16x16x32_bf16 a[72:75], v[16:19], v[40:43], a[72:75]
  ds_read_b128 v[84:87], v3 offset:3072
  v_mfma_f32_16x16x32_bf16 a[76:79], v[20:23], v[40:43], a[76:79]
  v_mfma_f32_16x16x32_bf16 a[80:83], v[8:11], v[44:47], a[80:83]
  ds_read_b128 v[88:91], v3 offset:4096
  v_mfma_f32_16x16x32_bf16 a[84:87], v[12:15], v[44:47], a[84:87]
  v_mfma_f32_16x16x32_bf16 a[88:91], v[16:19], v[44:47], a[88:91]
  ds_read_b128 v[92:95], v3 offset:5120
  v_mfma_f32_16x16x32_bf16 a[92:95], v[20:23], v[44:47], a[92:95]
  v_mfma_f32_16x16x32_bf16 a[96:99], v[8:11], v[48:51], a[96:99]
  v_mfma_f32_16x16x32_bf16 a[100:103], v[12:15], v[48:51], a[100:103]
  ds_read_b128 v[96:99], v3 offset:6144
  v_mfma_f32_16x16x32_bf16 a[104:107], v[16:19], v[48:51], a[104:107]
  v_mfma_f32_16x16x32_bf16 a[108:111], v[20:23], v[48:51], a[108:111]
  ds_read_b128 v[100:103], v3 offset:7168
  v_mfma_f32_16x16x32_bf16 a[112:115], v[8:11], v[52:55], a[112:115]
  v_mfma_f32_16x16x32_bf16 a[116:119], v[12:15], v[52:55], a[116:119]
  s_add_u32 s31, s31, 24576
  s_cmp_ge_u32 s31, 122880
  s_cselect_b32 s31, 0, s31
  v_mfma_f32_16x16x32_bf16 a[120:123], v[16:19], v[52:55], a[120:123]
  v_mfma_f32_16x16x32_bf16 a[124:127], v[20:23], v[52:55], a[124:127]
  s_waitcnt lgkmcnt(0)
  v_mfma_f32_16x16x32_bf16 a[0:3], v[56:59], v[72:75], a[0:3]
  v_mfma_f32_16x16x32_bf16 a[4:7], v[60:63], v[72:75], a[4:7]
  v_mfma_f32_16x16x32_bf16 a[8:11], v[64:67], v[72:75], a[8:11]
  v_mfma_f32_16x16x32_bf16 a[12:15], v[68:71], v[72:75], a[12:15]
  v_mfma_f32_16x16x32_bf16 a[16:19], v[56:59], v[76:79], a[16:19]
  v_mfma_f32_16x16x32_bf16 a[20:23], v[60:63], v[76:79], a[20:23]
  v_mfma_f32_16x16x32_bf16 a[24:27], v[64:67], v[76:79], a[24:27]
  v_mfma_f32_16x16x32_bf16 a[28:31], v[68:71], v[76:79], a[28:31]
  v_mfma_f32_16x16x32_bf16 a[32:35], v[56:59], v[80:83], a[32:35]
  v_mfma_f32_16x16x32_bf16 a[36:39], v[60:63], v[80:83], a[36:39]
  v_mfma_f32_16x16x32_bf16 a[40:43], v[64:67], v[80:83], a[40:43]
  v_mfma_f32_16x16x32_bf16 a[44:47], v[68:71], v[80:83], a[44:47]
  v_mfma_f32_16x16x32_bf16 a[48:51], v[56:59], v[84:87], a[48:51]
  v_mfma_f32_16x16x32_bf16 a[52:55], v[60:63], v[84:87], a[52:55]
  v_mfma_f32_16x16x32_bf16 a[56:59], v[64:67], v[84:87], a[56:59]
  v_mfma_f32_16x16x32_bf16 a[60:63], v[68:71], v[84:87], a[60:63]
  v_mfma_f32_16x16x32_bf16 a[64:67], v[56:59], v[88:91], a[64:67]
  v_mfma_f32_16x16x32_bf16 a[68:71], v[60:63], v[88:91], a[68:71]
  v_mfma_f32_16x16x32_bf16 a[72:75], v[64:67], v[88:91], a[72:75]
  v_mfma_f32_16x16x32_bf16 a[76:79], v[68:71], v[88:91], a[76:79]
  v_mfma_f32_16x16x32_bf16 a[80:83], v[56:59], v[92:95], a[80:83]
  v_mfma_f32_16x16x32_bf16 a[84:87], v[60:63], v[92:95], a[84:87]
  v_mfma_f32_16x16x32_bf16 a[88:91], v[64:67], v[92:95], a[88:91]
  v_mfma_f32_16x16x32_bf16 a[92:95], v[68:71], v[92:95], a[92:95]
  v_mfma_f32_16x16x32_bf16 a[96:99], v[56:59], v[96:99], a[96:99]
  v_mfma_f32_16x16x32_bf16 a[100:103], v[60:63], v[96:99], a[100:103]
  v_mfma_f32_16x16x32_bf16 a[104:107], v[64:67], v[96:99], a[104:107]
  v_mfma_f32_16x16x32_bf16 a[108:111], v[68:71], v[96:99], a[108:111]
  v_mfma_f32_16x16x32_bf16 a[112:115], v[56:59], v[100:103], a[112:115]
  v_mfma_f32_16x16x32_bf16 a[116:119], v[60:63], v[100:103], a[116:119]
  v_mfma_f32_16x16x32_bf16 a[120:123], v[64:67], v[100:103], a[120:123]
  v_mfma_f32_16x16x32_bf16 a[124:127], v[68:71], v[100:103], a[124:127]
  s_nop 7
  s_nop 3
  s_lshl_b32 s10, s37, 24
  s_add_u32 s10, s10, 0x2000000
  s_mul_i32 s11, s20, 8
  s_mul_i32 s12, s23, 4
  s_add_u32 s11, s11, s12
  s_lshl_b32 s11, s11, 5
  s_add_u32 s11, s11, s38
  s_lshl_b32 s11, s11, 13
  s_add_u32 s10, s10, s11
  s_lshl_b32 s12, s24, 12
  s_add_u32 s10, s10, s12
  s_add_u32 s14, s6, s10
  s_addc_u32 s15, s7, 0
  v_accvgpr_read_b32 v8, a0
  v_accvgpr_read_b32 v12, a4
  v_accvgpr_read_b32 v9, a1
  v_accvgpr_read_b32 v13, a5
  v_accvgpr_read_b32 v10, a2
  v_accvgpr_read_b32 v14, a6
  v_accvgpr_read_b32 v11, a3
  v_accvgpr_read_b32 v15, a7
  v_cvt_pk_bf16_f32 v16, v8, v9
  v_cvt_pk_bf16_f32 v17, v10, v11
  v_cvt_pk_bf16_f32 v18, v12, v13
  v_cvt_pk_bf16_f32 v19, v14, v15
  global_store_dwordx4 v1, v[16:19], s[14:15] offset:0 sc1
  s_nop 1
  v_accvgpr_read_b32 v8, a8
  v_accvgpr_read_b32 v12, a12
  v_accvgpr_read_b32 v9, a9
  v_accvgpr_read_b32 v13, a13
  v_accvgpr_read_b32 v10, a10
  v_accvgpr_read_b32 v14, a14
  v_accvgpr_read_b32 v11, a11
  v_accvgpr_read_b32 v15, a15
  v_cvt_pk_bf16_f32 v16, v8, v9
  v_cvt_pk_bf16_f32 v17, v10, v11
  v_cvt_pk_bf16_f32 v18, v12, v13
  v_cvt_pk_bf16_f32 v19, v14, v15
  global_store_dwordx4 v1, v[16:19], s[14:15] offset:2048 sc1
  s_nop 1
  v_accvgpr_read_b32 v8, a16
  v_accvgpr_read_b32 v12, a20
  v_accvgpr_read_b32 v9, a17
  v_accvgpr_read_b32 v13, a21
  v_accvgpr_read_b32 v10, a18
  v_accvgpr_read_b32 v14, a22
  v_accvgpr_read_b32 v11, a19
  v_accvgpr_read_b32 v15, a23
  v_cvt_pk_bf16_f32 v16, v8, v9
  v_cvt_pk_bf16_f32 v17, v10, v11
  v_cvt_pk_bf16_f32 v18, v12, v13
  v_cvt_pk_bf16_f32 v19, v14, v15
  global_store_dwordx4 v1, v[16:19], s[14:15] offset:1024 sc1
  s_nop 1
  v_accvgpr_read_b32 v8, a24
  v_accvgpr_read_b32 v12, a28
  v_accvgpr_read_b32 v9, a25
  v_accvgpr_read_b32 v13, a29
  v_accvgpr_read_b32 v10, a26
  v_accvgpr_read_b32 v14, a30
  v_accvgpr_read_b32 v11, a27
  v_accvgpr_read_b32 v15, a31
  v_cvt_pk_bf16_f32 v16, v8, v9
  v_cvt_pk_bf16_f32 v17, v10, v11
  v_cvt_pk_bf16_f32 v18, v12, v13
  v_cvt_pk_bf16_f32 v19, v14, v15
  global_store_dwordx4 v1, v[16:19], s[14:15] offset:3072 sc1
  s_nop 1
  s_add_u32 s14, s14, 0x40000
  s_addc_u32 s15, s15, 0
  v_accvgpr_read_b32 v8, a32
  v_accvgpr_read_b32 v12, a36
  v_accvgpr_read_b32 v9, a33
  v_accvgpr_read_b32 v13, a37
  v_accvgpr_read_b32 v10, a34
  v_accvgpr_read_b32 v14, a38
  v_accvgpr_read_b32 v11, a35
  v_accvgpr_read_b32 v15, a39
  v_cvt_pk_bf16_f32 v16, v8, v9
  v_cvt_pk_bf16_f32 v17, v10, v11
  v_cvt_pk_bf16_f32 v18, v12, v13
  v_cvt_pk_bf16_f32 v19, v14, v15
  global_store_dwordx4 v1, v[16:19], s[14:15] offset:0 sc1
  s_nop 1
  v_accvgpr_read_b32 v8, a40
  v_accvgpr_read_b32 v12, a44
  v_accvgpr_read_b32 v9, a41
  v_accvgpr_read_b32 v13, a45
  v_accvgpr_read_b32 v10, a42
  v_accvgpr_read_b32 v14, a46
  v_accvgpr_read_b32 v11, a43
  v_accvgpr_read_b32 v15, a47
  v_cvt_pk_bf16_f32 v16, v8, v9
  v_cvt_pk_bf16_f32 v17, v10, v11
  v_cvt_pk_bf16_f32 v18, v12, v13
  v_cvt_pk_bf16_f32 v19, v14, v15
  global_store_dwordx4 v1, v[16:19], s[14:15] offset:2048 sc1
  s_nop 1
  v_accvgpr_read_b32 v8, a48
  v_accvgpr_read_b32 v12, a52
  v_accvgpr_read_b32 v9, a49
  v_accvgpr_read_b32 v13, a53
  v_accvgpr_read_b32 v10, a50
  v_accvgpr_read_b32 v14, a54
  v_accvgpr_read_b32 v11, a51
  v_accvgpr_read_b32 v15, a55
  v_cvt_pk_bf16_f32 v16, v8, v9
  v_cvt_pk_bf16_f32 v17, v10, v11
  v_cvt_pk_bf16_f32 v18, v12, v13
  v_cvt_pk_bf16_f32 v19, v14, v15
  global_store_dwordx4 v1, v[16:19], s[14:15] offset:1024 sc1
  s_nop 1
  v_accvgpr_read_b32 v8, a56
  v_accvgpr_read_b32 v12, a60
  v_accvgpr_read_b32 v9, a57
  v_accvgpr_read_b32 v13, a61
  v_accvgpr_read_b32 v10, a58
  v_accvgpr_read_b32 v14, a62
  v_accvgpr_read_b32 v11, a59
  v_accvgpr_read_b32 v15, a63
  v_cvt_pk_bf16_f32 v16, v8, v9
  v_cvt_pk_bf16_f32 v17, v10, v11
  v_cvt_pk_bf16_f32 v18, v12, v13
  v_cvt_pk_bf16_f32 v19, v14, v15
  global_store_dwordx4 v1, v[16:19], s[14:15] offset:3072 sc1
  s_nop 1
  s_add_u32 s14, s14, 0x40000
  s_addc_u32 s15, s15, 0
  v_accvgpr_read_b32 v8, a64
  v_accvgpr_read_b32 v12, a68
  v_accvgpr_read_b32 v9, a65
  v_accvgpr_read_b32 v13, a69
  v_accvgpr_read_b32 v10, a66
  v_accvgpr_read_b32 v14, a70
  v_accvgpr_read_b32 v11, a67
  v_accvgpr_read_b32 v15, a71
  v_cvt_pk_bf16_f32 v16, v8, v9
  v_cvt_pk_bf16_f32 v17, v10, v11
  v_cvt_pk_bf16_f32 v18, v12, v13
  v_cvt_pk_bf16_f32 v19, v14, v15
  global_store_dwordx4 v1, v[16:19], s[14:15] offset:0 sc1
  s_nop 1
  v_accvgpr_read_b32 v8, a72
  v_accvgpr_read_b32 v12, a76
  v_accvgpr_read_b32 v9, a73
  v_accvgpr_read_b32 v13, a77
  v_accvgpr_read_b32 v10, a74
  v_accvgpr_read_b32 v14, a78
  v_accvgpr_read_b32 v11, a75
  v_accvgpr_read_b32 v15, a79
  v_cvt_pk_bf16_f32 v16, v8, v9
  v_cvt_pk_bf16_f32 v17, v10, v11
  v_cvt_pk_bf16_f32 v18, v12, v13
  v_cvt_pk_bf16_f32 v19, v14, v15
  global_store_dwordx4 v1, v[16:19], s[14:15] offset:2048 sc1
  s_nop 1
  v_accvgpr_read_b32 v8, a80
  v_accvgpr_read_b32 v12, a84
  v_accvgpr_read_b32 v9, a81
  v_accvgpr_read_b32 v13, a85
  v_accvgpr_read_b32 v10, a82
  v_accvgpr_read_b32 v14, a86
  v_accvgpr_read_b32 v11, a83
  v_accvgpr_read_b32 v15, a87
  v_cvt_pk_bf16_f32 v16, v8, v9
  v_cvt_pk_bf16_f32 v17, v10, v11
  v_cvt_pk_bf16_f32 v18, v12, v13
  v_cvt_pk_bf16_f32 v19, v14, v15
  global_store_dwordx4 v1, v[16:19], s[14:15] offset:1024 sc1
  s_nop 1
  v_accvgpr_read_b32 v8, a88
  v_accvgpr_read_b32 v12, a92
  v_accvgpr_read_b32 v9, a89
  v_accvgpr_read_b32 v13, a93
  v_accvgpr_read_b32 v10, a90
  v_accvgpr_read_b32 v14, a94
  v_accvgpr_read_b32 v11, a91
  v_accvgpr_read_b32 v15, a95
  v_cvt_pk_bf16_f32 v16, v8, v9
  v_cvt_pk_bf16_f32 v17, v10, v11
  v_cvt_pk_bf16_f32 v18, v12, v13
  v_cvt_pk_bf16_f32 v19, v14, v15
  global_store_dwordx4 v1, v[16:19], s[14:15] offset:3072 sc1
  s_nop 1
  s_add_u32 s14, s14, 0x40000
  s_addc_u32 s15, s15, 0
  v_accvgpr_read_b32 v8, a96
  v_accvgpr_read_b32 v12, a100
  v_accvgpr_read_b32 v9, a97
  v_accvgpr_read_b32 v13, a101
  v_accvgpr_read_b32 v10, a98
  v_accvgpr_read_b32 v14, a102
  v_accvgpr_read_b32 v11, a99
  v_accvgpr_read_b32 v15, a103
  v_cvt_pk_bf16_f32 v16, v8, v9
  v_cvt_pk_bf16_f32 v17, v10, v11
  v_cvt_pk_bf16_f32 v18, v12, v13
  v_cvt_pk_bf16_f32 v19, v14, v15
  global_store_dwordx4 v1, v[16:19], s[14:15] offset:0 sc1
  s_nop 1
  v_accvgpr_read_b32 v8, a104
  v_accvgpr_read_b32 v12, a108
  v_accvgpr_read_b32 v9, a105
  v_accvgpr_read_b32 v13, a109
  v_accvgpr_read_b32 v10, a106
  v_accvgpr_read_b32 v14, a110
  v_accvgpr_read_b32 v11, a107
  v_accvgpr_read_b32 v15, a111
  v_cvt_pk_bf16_f32 v16, v8, v9
  v_cvt_pk_bf16_f32 v17, v10, v11
  v_cvt_pk_bf16_f32 v18, v12, v13
  v_cvt_pk_bf16_f32 v19, v14, v15
  global_store_dwordx4 v1, v[16:19], s[14:15] offset:2048 sc1
  s_nop 1
  v_accvgpr_read_b32 v8, a112
  v_accvgpr_read_b32 v12, a116
  v_accvgpr_read_b32 v9, a113
  v_accvgpr_read_b32 v13, a117
  v_accvgpr_read_b32 v10, a114
  v_accvgpr_read_b32 v14, a118
  v_accvgpr_read_b32 v11, a115
  v_accvgpr_read_b32 v15, a119
  v_cvt_pk_bf16_f32 v16, v8, v9
  v_cvt_pk_bf16_f32 v17, v10, v11
  v_cvt_pk_bf16_f32 v18, v12, v13
  v_cvt_pk_bf16_f32 v19, v14, v15
  global_store_dwordx4 v1, v[16:19], s[14:15] offset:1024 sc1
  s_nop 1
  v_accvgpr_read_b32 v8, a120
  v_accvgpr_read_b32 v12, a124
  v_accvgpr_read_b32 v9, a121
  v_accvgpr_read_b32 v13, a125
  v_accvgpr_read_b32 v10, a122
  v_accvgpr_read_b32 v14, a126
  v_accvgpr_read_b32 v11, a123
  v_accvgpr_read_b32 v15, a127
  v_cvt_pk_bf16_f32 v16, v8, v9
  v_cvt_pk_bf16_f32 v17, v10, v11
  v_cvt_pk_bf16_f32 v18, v12, v13
  v_cvt_pk_bf16_f32 v19, v14, v15
  global_store_dwordx4 v1, v[16:19], s[14:15] offset:3072 sc1
  s_nop 1
  s_add_u32 s14, s14, 0x40000
  s_addc_u32 s15, s15, 0
  s_branch qbulk_sig
qbulk_v:
  s_waitcnt vmcnt(24)
  s_barrier
  s_add_u32 s34, s31, s29
  s_add_u32 s35, s31, s30
  v_add_u32 v3, s34, v1
  v_add_u32 v4, s35, v1
  ds_read_b128 v[8:11], v4 offset:0
  ds_read_b128 v[12:15], v4 offset:1024
  ds_read_b128 v[16:19], v4 offset:2048
  ds_read_b128 v[20:23], v4 offset:3072
  ds_read_b128 v[24:27], v3 offset:0
  ds_read_b128 v[28:31], v3 offset:1024
  ds_read_b128 v[32:35], v3 offset:2048
  ds_read_b128 v[36:39], v3 offset:3072
  ds_read_b128 v[40:43], v3 offset:4096
  ds_read_b128 v[44:47], v3 offset:5120
  ds_read_b128 v[48:51], v3 offset:6144
  ds_read_b128 v[52:55], v3 offset:7168
  s_add_u32 s31, s31, 24576
  s_cmp_ge_u32 s31, 122880
  s_cselect_b32 s31, 0, s31
  s_waitcnt vmcnt(18) lgkmcnt(0)
  s_barrier
  v_mfma_f32_16x16x32_bf16 a[0:3], v[24:27], v[8:11], a[0:3]
  s_add_u32 s34, s31, s29
  s_add_u32 s35, s31, s30
  v_add_u32 v3, s34, v1
  v_add_u32 v4, s35, v1
  v_mfma_f32_16x16x32_bf16 a[4:7], v[24:27], v[12:15], a[4:7]
  ds_read_b128 v[56:59], v4 offset:0
  v_mfma_f32_16x16x32_bf16 a[8:11], v[24:27], v[16:19], a[8:11]
  ds_read_b128 v[60:63], v4 offset:1024
  v_mfma_f32_16x16x32_bf16 a[12:15], v[24:27], v[20:23], a[12:15]
  v_mfma_f32_16x16x32_bf16 a[16:19], v[28:31], v[8:11], a[16:19]
  ds_read_b128 v[64:67], v4 offset:2048
  v_mfma_f32_16x16x32_bf16 a[20:23], v[28:31], v[12:15], a[20:23]
  ds_read_b128 v[68:71], v4 offset:3072
  v_mfma_f32_16x16x32_bf16 a[24:27], v[28:31], v[16:19], a[24:27]
  v_mfma_f32_16x16x32_bf16 a[28:31], v[28:31], v[20:23], a[28:31]
  ds_read_b128 v[72:75], v3 offset:0
  v_mfma_f32_16x16x32_bf16 a[32:35], v[32:35], v[8:11], a[32:35]
  ds_read_b128 v[76:79], v3 offset:1024
  v_mfma_f32_16x16x32_bf16 a[36:39], v[32:35], v[12:15], a[36:39]
  v_mfma_f32_16x16x32_bf16 a[40:43], v[32:35], v[16:19], a[40:43]
  ds_read_b128 v[80:83], v3 offset:2048
  v_mfma_f32_16x16x32_bf16 a[44:47], v[32:35], v[20:23], a[44:47]
  ds_read_b128 v[84:87], v3 offset:3072
  v_mfma_f32_16x16x32_bf16 a[48:51], v[36:39], v[8:11], a[48:51]
  v_mfma_f32_16x16x32_bf16 a[52:55], v[36:39], v[12:15], a[52:55]
  ds_read_b128 v[88:91], v3 offset:4096
  v_mfma_f32_16x16x32_bf16 a[56:59], v[36:39], v[16:19], a[56:59]
  ds_read_b128 v[92:95], v3 offset:5120
  v_mfma_f32_16x16x32_bf16 a[60:63], v[36:39], v[20:23], a[60:63]
  v_mfma_f32_16x16x32_bf16 a[64:67], v[40:43], v[8:11], a[64:67]
  ds_read_b128 v[96:99], v3 offset:6144
  v_mfma_f32_16x16x32_bf16 a[68:71], v[40:43], v[12:15], a[68:71]
  ds_read_b128 v[100:103], v3 offset:7168
  v_mfma_f32_16x16x32_bf16 a[72:75], v[40:43], v[16:19], a[72:75]
  s_add_u32 s31, s31, 24576
  s_cmp_ge_u32 s31, 122880
  s_cselect_b32 s31, 0, s31
  v_mfma_f32_16x16x32_bf16 a[76:79], v[40:43], v[20:23], a[76:79]
  v_mfma_f32_16x16x32_bf16 a[80:83], v[44:47], v[8:11], a[80:83]
  s_add_u32 s33, s32, s28
  v_mfma_f32_16x16x32_bf16 a[84:87], v[44:47], v[12:15], a[84:87]
  s_add_u32 m0, s33, 0
  s_nop 0
  global_load_lds_dwordx4 v2, s[40:41]
  v_mfma_f32_16x16x32_bf16 a[88:91], v[44:47], v[16:19], a[88:91]
  v_mfma_f32_16x16x32_bf16 a[92:95], v[44:47], v[20:23], a[92:95]
  s_add_u32 m0, s33, 4096
  s_nop 0
  global_load_lds_dwordx4 v2, s[42:43]
  v_mfma_f32_16x16x32_bf16 a[96:99], v[48:51], v[8:11], a[96:99]
  s_add_u32 m0, s33, 8192
  s_nop 0
  global_load_lds_dwordx4 v2, s[44:45]
  v_mfma_f32_16x16x32_bf16 a[100:103], v[48:51], v[12:15], a[100:103]
  v_mfma_f32_16x16x32_bf16 a[104:107], v[48:51], v[16:19], a[104:107]
  s_add_u32 m0, s33, 12288
  s_nop 0
  global_load_lds_dwordx4 v2, s[46:47]
  v_mfma_f32_16x16x32_bf16 a[108:111], v[48:51], v[20:23], a[108:111]
  s_add_u32 m0, s33, 16384
  s_nop 0
  global_load_lds_dwordx4 v2, s[48:49]
  v_mfma_f32_16x16x32_bf16 a[112:115], v[52:55], v[8:11], a[112:115]
  v_mfma_f32_16x16x32_bf16 a[116:119], v[52:55], v[12:15], a[116:119]
  s_add_u32 m0, s33, 20480
  s_nop 0
  global_load_lds_dwordx4 v2, s[50:51]
  v_mfma_f32_16x16x32_bf16 a[120:123], v[52:55], v[16:19], a[120:123]
  v_add_u32 v2, 1024, v2
  s_add_u32 s32, s32, 24576
  s_cmp_ge_u32 s32, 122880
  s_cselect_b32 s32, 0, s32
  v_mfma_f32_16x16x32_bf16 a[124:127], v[52:55], v[20:23], a[124:127]
  s_mov_b32 s36, 0
qbulk_bn_loop:
  s_waitcnt vmcnt(18) lgkmcnt(0)
  s_barrier
  v_mfma_f32_16x16x32_bf16 a[0:3], v[72:75], v[56:59], a[0:3]
  s_add_u32 s34, s31, s29
  s_add_u32 s35, s31, s30
  v_add_u32 v3, s34, v1
  v_add_u32 v4, s35, v1
  v_mfma_f32_16x16x32_bf16 a[4:7], v[72:75], v[60:63], a[4:7]
  ds_read_b128 v[8:11], v4 offset:0
  v_mfma_f32_16x16x32_bf16 a[8:11], v[72:75], v[64:67], a[8:11]
  ds_read_b128 v[12:15], v4 offset:1024
  v_mfma_f32_16x16x32_bf16 a[12:15], v[72:75], v[68:71], a[12:15]
  v_mfma_f32_16x16x32_bf16 a[16:19], v[76:79], v[56:59], a[16:19]
  ds_read_b128 v[16:19], v4 offset:2048
  v_mfma_f32_16x16x32_bf16 a[20:23], v[76:79], v[60:63], a[20:23]
  ds_read_b128 v[20:23], v4 offset:3072
  v_mfma_f32_16x16x32_bf16 a[24:27], v[76:79], v[64:67], a[24:27]
  v_mfma_f32_16x16x32_bf16 a[28:31], v[76:79], v[68:71], a[28:31]
  ds_read_b128 v[24:27], v3 offset:0
  v_mfma_f32_16x16x32_bf16 a[32:35], v[80:83], v[56:59], a[32:35]
  ds_read_b128 v[28:31], v3 offset:1024
  v_mfma_f32_16x16x32_bf16 a[36:39], v[80:83], v[60:63], a[36:39]
  v_mfma_f32_16x16x32_bf16 a[40:43], v[80:83], v[64:67], a[40:43]
  ds_read_b128 v[32:35], v3 offset:2048
  v_mfma_f32_16x16x32_bf16 a[44:47], v[80:83], v[68:71], a[44:47]
  ds_read_b128 v[36:39], v3 offset:3072
  v_mfma_f32_16x16x32_bf16 a[48:51], v[84:87], v[56:59], a[48:51]
  v_mfma_f32_16x16x32_bf16 a[52:55], v[84:87], v[60:63], a[52:55]
  ds_read_b128 v[40:43], v3 offset:4096
  v_mfma_f32_16x16x32_bf16 a[56:59], v[84:87], v[64:67], a[56:59]
  ds_read_b128 v[44:47], v3 offset:5120
  v_mfma_f32_16x16x32_bf16 a[60:63], v[84:87], v[68:71], a[60:63]
  v_mfma_f32_16x16x32_bf16 a[64:67], v[88:91], v[56:59], a[64:67]
  ds_read_b128 v[48:51], v3 offset:6144
  v_mfma_f32_16x16x32_bf16 a[68:71], v[88:91], v[60:63], a[68:71]
  ds_read_b128 v[52:55], v3 offset:7168
  v_mfma_f32_16x16x32_bf16 a[72:75], v[88:91], v[64:67], a[72:75]
  s_add_u32 s31, s31, 24576
  s_cmp_ge_u32 s31, 122880
  s_cselect_b32 s31, 0, s31
  v_mfma_f32_16x16x32_bf16 a[76:79], v[88:91], v[68:71], a[76:79]
  v_mfma_f32_16x16x32_bf16 a[80:83], v[92:95], v[56:59], a[80:83]
  s_add_u32 s33, s32, s28
  v_mfma_f32_16x16x32_bf16 a[84:87], v[92:95], v[60:63], a[84:87]
  s_add_u32 m0, s33, 0
  s_nop 0
  global_load_lds_dwordx4 v2, s[40:41]
  v_mfma_f32_16x16x32_bf16 a[88:91], v[92:95], v[64:67], a[88:91]
  v_mfma_f32_16x16x32_bf16 a[92:95], v[92:95], v[68:71], a[92:95]
  s_add_u32 m0, s33, 4096
  s_nop 0
  global_load_lds_dwordx4 v2, s[42:43]
  v_mfma_f32_16x16x32_bf16 a[96:99], v[96:99], v[56:59], a[96:99]
  s_add_u32 m0, s33, 8192
  s_nop 0
  global_load_lds_dwordx4 v2, s[44:45]
  v_mfma_f32_16x16x32_bf16 a[100:103], v[96:99], v[60:63], a[100:103]
  v_mfma_f32_16x16x32_bf16 a[104:107], v[96:99], v[64:67], a[104:107]
  s_add_u32 m0, s33, 12288
  s_nop 0
  global_load_lds_dwordx4 v2, s[46:47]
  v_mfma_f32_16x16x32_bf16 a[108:111], v[96:99], v[68:71], a[108:111]
  s_add_u32 m0, s33, 16384
  s_nop 0
  global_load_lds_dwordx4 v2, s[48:49]
  v_mfma_f32_16x16x32_bf16 a[112:115], v[100:103], v[56:59], a[112:115]
  v_mfma_f32_16x16x32_bf16 a[116:119], v[100:103], v[60:63], a[116:119]
  s_add_u32 m0, s33, 20480
  s_nop 0
  global_load_lds_dwordx4 v2, s[50:51]
  v_mfma_f32_16x16x32_bf16 a[120:123], v[100:103], v[64:67], a[120:123]
  v_add_u32 v2, 1024, v2
  s_add_u32 s32, s32, 24576
  s_cmp_ge_u32 s32, 122880
  s_cselect_b32 s32, 0, s32
  v_mfma_f32_16x16x32_bf16 a[124:127], v[100:103], v[68:71], a[124:127]
  s_waitcnt vmcnt(18) lgkmcnt(0)
  s_barrier
  v_mfma_f32_16x16x32_bf16 a[0:3], v[24:27], v[8:11], a[0:3]
  s_add_u32 s34, s31, s29
  s_add_u32 s35, s31, s30
  v_add_u32 v3, s34, v1
  v_add_u32 v4, s35, v1
  v_mfma_f32_16x16x32_bf16 a[4:7], v[24:27], v[12:15], a[4:7]
  ds_read_b128 v[56:59], v4 offset:0
  v_mfma_f32_16x16x32_bf16 a[8:11], v[24:27], v[16:19], a[8:11]
  ds_read_b128 v[60:63], v4 offset:1024
  v_mfma_f32_16x16x32_bf16 a[12:15], v[24:27], v[20:23], a[12:15]
  v_mfma_f32_16x16x32_bf16 a[16:19], v[28:31], v[8:11], a[16:19]
  ds_read_b128 v[64:67], v4 offset:2048
  v_mfma_f32_16x16x32_bf16 a[20:23], v[28:31], v[12:15], a[20:23]
  ds_read_b128 v[68:71], v4 offset:3072
  v_mfma_f32_16x16x32_bf16 a[24:27], v[28:31], v[16:19], a[24:27]
  v_mfma_f32_16x16x32_bf16 a[28:31], v[28:31], v[20:23], a[28:31]
  ds_read_b128 v[72:75], v3 offset:0
  v_mfma_f32_16x16x32_bf16 a[32:35], v[32:35], v[8:11], a[32:35]
  ds_read_b128 v[76:79], v3 offset:1024
  v_mfma_f32_16x16x32_bf16 a[36:39], v[32:35], v[12:15], a[36:39]
  v_mfma_f32_16x16x32_bf16 a[40:43], v[32:35], v[16:19], a[40:43]
  ds_read_b128 v[80:83], v3 offset:2048
  v_mfma_f32_16x16x32_bf16 a[44:47], v[32:35], v[20:23], a[44:47]
  ds_read_b128 v[84:87], v3 offset:3072
  v_mfma_f32_16x16x32_bf16 a[48:51], v[36:39], v[8:11], a[48:51]
  v_mfma_f32_16x16x32_bf16 a[52:55], v[36:39], v[12:15], a[52:55]
  ds_read_b128 v[88:91], v3 offset:4096
  v_mfma_f32_16x16x32_bf16 a[56:59], v[36:39], v[16:19], a[56:59]
  ds_read_b128 v[92:95], v3 offset:5120
  v_mfma_f32_16x16x32_bf16 a[60:63], v[36:39], v[20:23], a[60:63]
  v_mfma_f32_16x16x32_bf16 a[64:67], v[40:43], v[8:11], a[64:67]
  ds_read_b128 v[96:99], v3 offset:6144
  v_mfma_f32_16x16x32_bf16 a[68:71], v[40:43], v[12:15], a[68:71]
  ds_read_b128 v[100:103], v3 offset:7168
  v_mfma_f32_16x16x32_bf16 a[72:75], v[40:43], v[16:19], a[72:75]
  s_add_u32 s31, s31, 24576
  s_cmp_ge_u32 s31, 122880
  s_cselect_b32 s31, 0, s31
  v_mfma_f32_16x16x32_bf16 a[76:79], v[40:43], v[20:23], a[76:79]
  v_mfma_f32_16x16x32_bf16 a[80:83], v[44:47], v[8:11], a[80:83]
  s_add_u32 s33, s32, s28
  v_mfma_f32_16x16x32_bf16 a[84:87], v[44:47], v[12:15], a[84:87]
  s_add_u32 m0, s33, 0
  s_nop 0
  global_load_lds_dwordx4 v2, s[40:41]
  v_mfma_f32_16x16x32_bf16 a[88:91], v[44:47], v[16:19], a[88:91]
  v_mfma_f32_16x16x32_bf16 a[92:95], v[44:47], v[20:23], a[92:95]
  s_add_u32 m0, s33, 4096
  s_nop 0
  global_load_lds_dwordx4 v2, s[42:43]
  v_mfma_f32_16x16x32_bf16 a[96:99], v[48:51], v[8:11], a[96:99]
  s_add_u32 m0, s33, 8192
  s_nop 0
  global_load_lds_dwordx4 v2, s[44:45]
  v_mfma_f32_16x16x32_bf16 a[100:103], v[48:51], v[12:15], a[100:103]
  v_mfma_f32_16x16x32_bf16 a[104:107], v[48:51], v[16:19], a[104:107]
  s_add_u32 m0, s33, 12288
  s_nop 0
  global_load_lds_dwordx4 v2, s[46:47]
  v_mfma_f32_16x16x32_bf16 a[108:111], v[48:51], v[20:23], a[108:111]
  s_add_u32 m0, s33, 16384
  s_nop 0
  global_load_lds_dwordx4 v2, s[48:49]
  v_mfma_f32_16x16x32_bf16 a[112:115], v[52:55], v[8:11], a[112:115]
  v_mfma_f32_16x16x32_bf16 a[116:119], v[52:55], v[12:15], a[116:119]
  s_add_u32 m0, s33, 20480
  s_nop 0
  global_load_lds_dwordx4 v2, s[50:51]
  v_mfma_f32_16x16x32_bf16 a[120:123], v[52:55], v[16:19], a[120:123]
  v_add_u32 v2, 1024, v2
  s_add_u32 s32, s32, 24576
  s_cmp_ge_u32 s32, 122880
  s_cselect_b32 s32, 0, s32
  v_mfma_f32_16x16x32_bf16 a[124:127], v[52:55], v[20:23], a[124:127]
  s_add_u32 s36, s36, 2
  s_cmp_lt_u32 s36, 14
  s_cbranch_scc1 qbulk_bn_loop
  s_waitcnt vmcnt(18) lgkmcnt(0)
  s_barrier
  v_mfma_f32_16x16x32_bf16 a[0:3], v[72:75], v[56:59], a[0:3]
  s_add_u32 s34, s31, s29
  s_add_u32 s35, s31, s30
  v_add_u32 v3, s34, v1
  v_add_u32 v4, s35, v1
  v_mfma_f32_16x16x32_bf16 a[4:7], v[72:75], v[60:63], a[4:7]
  v_mfma_f32_16x16x32_bf16 a[8:11], v[72:75], v[64:67], a[8:11]
  ds_read_b128 v[8:11], v4 offset:0
  v_mfma_f32_16x16x32_bf16 a[12:15], v[72:75], v[68:71], a[12:15]
  v_mfma_f32_16x16x32_bf16 a[16:19], v[76:79], v[56:59], a[16:19]
  ds_read_b128 v[12:15], v4 offset:1024
  v_mfma_f32_16x16x32_bf16 a[20:23], v[76:79], v[60:63], a[20:23]
  v_mfma_f32_16x16x32_bf16 a[24:27], v[76:79], v[64:67], a[24:27]
  ds_read_b128 v[16:19], v4 offset:2048
  v_mfma_f32_16x16x32_bf16 a[28:31], v[76:79], v[68:71], a[28:31]
  v_mfma_f32_16x16x32_bf16 a[32:35], v[80:83], v[56:59], a[32:35]
  v_mfma_f32_16x16x32_bf16 a[36:39], v[80:83], v[60:63], a[36:39]
  ds_read_b128 v[20:23], v4 offset:3072
  v_mfma_f32_16x16x32_bf16 a[40:43], v[80:83], v[64:67], a[40:43]
  v_mfma_f32_16x16x32_bf16 a[44:47], v[80:83], v[68:71], a[44:47]
  ds_read_b128 v[24:27], v3 offset:0
  v_mfma_f32_16x16x32_bf16 a[48:51], v[84:87], v[56:59], a[48:51]
  v_mfma_f32_16x16x32_bf16 a[52:55], v[84:87], v[60:63], a[52:55]
  ds_read_b128 v[28:31], v3 offset:1024
  v_mfma_f32_16x16x32_bf16 a[56:59], v[84:87], v[64:67], a[56:59]
  v_mfma_f32_16x16x32_bf16 a[60:63], v[84:87], v[68:71], a[60:63]
  v_mfma_f32_16x16x32_bf16 a[64:67], v[88:91], v[56:59], a[64:67]
  ds_read_b128 v[32:35], v3 offset:2048
  v_mfma_f32_16x16x32_bf16 a[68:71], v[88:91], v[60:63], a[68:71]
  v_mfma_f32_16x16x32_bf16 a[72:75], v[88:91], v[64:67], a[72:75]
  ds_read_b128 v[36:39], v3 offset:3072
  v_mfma_f32_16x16x32_bf16 a[76:79], v[88:91], v[68:71], a[76:79]
  v_mfma_f32_16x16x32_bf16 a[80:83], v[92:95], v[56:59], a[80:83]
  ds_read_b128 v[40:43], v3 offset:4096
  v_mfma_f32_16x16x32_bf16 a[84:87], v[92:95], v[60:63], a[84:87]
  v_mfma_f32_16x16x32_bf16 a[88:91], v[92:95], v[64:67], a[88:91]
  ds_read_b128 v[44:47], v3 offset:5120
  v_mfma_f32_16x16x32_bf16 a[92:95], v[92:95], v[68:71], a[92:95]
  v_mfma_f32_16x16x32_bf16 a[96:99], v[96:99], v[56:59], a[96:99]
  v_mfma_f32_16x16x32_bf16 a[100:103], v[96:99], v[60:63], a[100:103]
  ds_read_b128 v[48:51], v3 offset:6144
  v_mfma_f32_16x16x32_bf16 a[104:107], v[96:99], v[64:67], a[104:107]
  v_mfma_f32_16x16x32_bf16 a[108:111], v[96:99], v[68:71], a[108:111]
  ds_read_b128 v[52:55], v3 offset:7168
  v_mfma_f32_16x16x32_bf16 a[112:115], v[100:103], v[56:59], a[112:115]
  v_mfma_f32_16x16x32_bf16 a[116:119], v[100:103], v[60:63], a[116:119]
  s_add_u32 s31, s31, 24576
  s_cmp_ge_u32 s31, 122880
  s_cselect_b32 s31, 0, s31
  v_mfma_f32_16x16x32_bf16 a[120:123], v[100:103], v[64:67], a[120:123]
  v_mfma_f32_16x16x32_bf16 a[124:127], v[100:103], v[68:71], a[124:127]
  s_waitcnt vmcnt(12) lgkmcnt(0)
  s_barrier
  v_mfma_f32_16x16x32_bf16 a[0:3], v[24:27], v[8:11], a[0:3]
  s_add_u32 s34, s31, s29
  s_add_u32 s35, s31, s30
  v_add_u32 v3, s34, v1
  v_add_u32 v4, s35, v1
  v_mfma_f32_16x16x32_bf16 a[4:7], v[24:27], v[12:15], a[4:7]
  v_mfma_f32_16x16x32_bf16 a[8:11], v[24:27], v[16:19], a[8:11]
  ds_read_b128 v[56:59], v4 offset:0
  v_mfma_f32_16x16x32_bf16 a[12:15], v[24:27], v[20:23], a[12:15]
  v_mfma_f32_16x16x32_bf16 a[16:19], v[28:31], v[8:11], a[16:19]
  ds_read_b128 v[60:63], v4 offset:1024
  v_mfma_f32_16x16x32_bf16 a[20:23], v[28:31], v[12:15], a[20:23]
  v_mfma_f32_16x16x32_bf16 a[24:27], v[28:31], v[16:19], a[24:27]
  ds_read_b128 v[64:67], v4 offset:2048
  v_mfma_f32_16x16x32_bf16 a[28:31], v[28:31], v[20:23], a[28:31]
  v_mfma_f32_16x16x32_bf16 a[32:35], v[32:35], v[8:11], a[32:35]
  v_mfma_f32_16x16x32_bf16 a[36:39], v[32:35], v[12:15], a[36:39]
  ds_read_b128 v[68:71], v4 offset:3072
  v_mfma_f32_16x16x32_bf16 a[40:43], v[32:35], v[16:19], a[40:43]
  v_mfma_f32_16x16x32_bf16 a[44:47], v[32:35], v[20:23], a[44:47]
  ds_read_b128 v[72:75], v3 offset:0
  v_mfma_f32_16x16x32_bf16 a[48:51], v[36:39], v[8:11], a[48:51]
  v_mfma_f32_16x16x32_bf16 a[52:55], v[36:39], v[12:15], a[52:55]
  ds_read_b128 v[76:79], v3 offset:1024
  v_mfma_f32_16x16x32_bf16 a[56:59], v[36:39], v[16:19], a[56:59]
  v_mfma_f32_16x16x32_bf16 a[60:63], v[36:39], v[20:23], a[60:63]
  v_mfma_f32_16x16x32_bf16 a[64:67], v[40:43], v[8:11], a[64:67]
  ds_read_b128 v[80:83], v3 offset:2048
  v_mfma_f32_16x16x32_bf16 a[68:71], v[40:43], v[12:15], a[68:71]
  v_mfma_f32_16x16x32_bf16 a[72:75], v[40:43], v[16:19], a[72:75]
  ds_read_b128 v[84:87], v3 offset:3072
  v_mfma_f32_16x16x32_bf16 a[76:79], v[40:43], v[20:23], a[76:79]
  v_mfma_f32_16x16x32_bf16 a[80:83], v[44:47], v[8:11], a[80:83]
  ds_read_b128 v[88:91], v3 offset:4096
  v_mfma_f32_16x16x32_bf16 a[84:87], v[44:47], v[12:15], a[84:87]
  v_mfma_f32_16x16x32_bf16 a[88:91], v[44:47], v[16:19], a[88:91]
  ds_read_b128 v[92:95], v3 offset:5120
  v_mfma_f32_16x16x32_bf16 a[92:95], v[44:47], v[20:23], a[92:95]
  v_mfma_f32_16x16x32_bf16 a[96:99], v[48:51], v[8:11], a[96:99]
  v_mfma_f32_16x16x32_bf16 a[100:103], v[48:51], v[12:15], a[100:103]
  ds_read_b128 v[96:99], v3 offset:6144
  v_mfma_f32_16x16x32_bf16 a[104:107], v[48:51], v[16:19], a[104:107]
  v_mfma_f32_16x16x32_bf16 a[108:111], v[48:51], v[20:23], a[108:111]
  ds_read_b128 v[100:103], v3 offset:7168
  v_mfma_f32_16x16x32_bf16 a[112:115], v[52:55], v[8:11], a[112:115]
  v_mfma_f32_16x16x32_bf16 a[116:119], v[52:55], v[12:15], a[116:119]
  s_add_u32 s31, s31, 24576
  s_cmp_ge_u32 s31, 122880
  s_cselect_b32 s31, 0, s31
  v_mfma_f32_16x16x32_bf16 a[120:123], v[52:55], v[16:19], a[120:123]
  v_mfma_f32_16x16x32_bf16 a[124:127], v[52:55], v[20:23], a[124:127]
  s_waitcnt vmcnt(6) lgkmcnt(0)
  s_barrier
  v_mfma_f32_16x16x32_bf16 a[0:3], v[72:75], v[56:59], a[0:3]
  s_add_u32 s34, s31, s29
  s_add_u32 s35, s31, s30
  v_add_u32 v3, s34, v1
  v_add_u32 v4, s35, v1
  v_mfma_f32_16x16x32_bf16 a[4:7], v[72:75], v[60:63], a[4:7]
  v_mfma_f32_16x16x32_bf16 a[8:11], v[72:75], v[64:67], a[8:11]
  ds_read_b128 v[8:11], v4 offset:0
  v_mfma_f32_16x16x32_bf16 a[12:15], v[72:75], v[68:71], a[12:15]
  v_mfma_f32_16x16x32_bf16 a[16:19], v[76:79], v[56:59], a[16:19]
  ds_read_b128 v[12:15], v4 offset:1024
  v_mfma_f32_16x16x32_bf16 a[20:23], v[76:79], v[60:63], a[20:23]
  v_mfma_f32_16x16x32_bf16 a[24:27], v[76:79], v[64:67], a[24:27]
  ds_read_b128 v[16:19], v4 offset:2048
  v_mfma_f32_16x16x32_bf16 a[28:31], v[76:79], v[68:71], a[28:31]
  v_mfma_f32_16x16x32_bf16 a[32:35], v[80:83], v[56:59], a[32:35]
  v_mfma_f32_16x16x32_bf16 a[36:39], v[80:83], v[60:63], a[36:39]
  ds_read_b128 v[20:23], v4 offset:3072
  v_mfma_f32_16x16x32_bf16 a[40:43], v[80:83], v[64:67], a[40:43]
  v_mfma_f32_16x16x32_bf16 a[44:47], v[80:83], v[68:71], a[44:47]
  ds_read_b128 v[24:27], v3 offset:0
  v_mfma_f32_16x16x32_bf16 a[48:51], v[84:87], v[56:59], a[48:51]
  v_mfma_f32_16x16x32_bf16 a[52:55], v[84:87], v[60:63], a[52:55]
  ds_read_b128 v[28:31], v3 offset:1024
  v_mfma_f32_16x16x32_bf16 a[56:59], v[84:87], v[64:67], a[56:59]
  v_mfma_f32_16x16x32_bf16 a[60:63], v[84:87], v[68:71], a[60:63]
  v_mfma_f32_16x16x32_bf16 a[64:67], v[88:91], v[56:59], a[64:67]
  ds_read_b128 v[32:35], v3 offset:2048
  v_mfma_f32_16x16x32_bf16 a[68:71], v[88:91], v[60:63], a[68:71]
  v_mfma_f32_16x16x32_bf16 a[72:75], v[88:91], v[64:67], a[72:75]
  ds_read_b128 v[36:39], v3 offset:3072
  v_mfma_f32_16x16x32_bf16 a[76:79], v[88:91], v[68:71], a[76:79]
  v_mfma_f32_16x16x32_bf16 a[80:83], v[92:95], v[56:59], a[80:83]
  ds_read_b128 v[40:43], v3 offset:4096
  v_mfma_f32_16x16x32_bf16 a[84:87], v[92:95], v[60:63], a[84:87]
  v_mfma_f32_16x16x32_bf16 a[88:91], v[92:95], v[64:67], a[88:91]
  ds_read_b128 v[44:47], v3 offset:5120
  v_mfma_f32_16x16x32_bf16 a[92:95], v[92:95], v[68:71], a[92:95]
  v_mfma_f32_16x16x32_bf16 a[96:99], v[96:99], v[56:59], a[96:99]
  v_mfma_f32_16x16x32_bf16 a[100:103], v[96:99], v[60:63], a[100:103]
  ds_read_b128 v[48:51], v3 offset:6144
  v_mfma_f32_16x16x32_bf16 a[104:107], v[96:99], v[64:67], a[104:107]
  v_mfma_f32_16x16x32_bf16 a[108:111], v[96:99], v[68:71], a[108:111]
  ds_read_b128 v[52:55], v3 offset:7168
  v_mfma_f32_16x16x32_bf16 a[112:115], v[100:103], v[56:59], a[112:115]
  v_mfma_f32_16x16x32_bf16 a[116:119], v[100:103], v[60:63], a[116:119]
  s_add_u32 s31, s31, 24576
  s_cmp_ge_u32 s31, 122880
  s_cselect_b32 s31, 0, s31
  v_mfma_f32_16x16x32_bf16 a[120:123], v[100:103], v[64:67], a[120:123]
  v_mfma_f32_16x16x32_bf16 a[124:127], v[100:103], v[68:71], a[124:127]
  s_waitcnt vmcnt(0) lgkmcnt(0)
  s_barrier
  v_mfma_f32_16x16x32_bf16 a[0:3], v[24:27], v[8:11], a[0:3]
  s_add_u32 s34, s31, s29
  s_add_u32 s35, s31, s30
  v_add_u32 v3, s34, v1
  v_add_u32 v4, s35, v1
  v_mfma_f32_16x16x32_bf16 a[4:7], v[24:27], v[12:15], a[4:7]
  v_mfma_f32_16x16x32_bf16 a[8:11], v[24:27], v[16:19], a[8:11]
  ds_read_b128 v[56:59], v4 offset:0
  v_mfma_f32_16x16x32_bf16 a[12:15], v[24:27], v[20:23], a[12:15]
  v_mfma_f32_16x16x32_bf16 a[16:19], v[28:31], v[8:11], a[16:19]
  ds_read_b128 v[60:63], v4 offset:1024
  v_mfma_f32_16x16x32_bf16 a[20:23], v[28:31], v[12:15], a[20:23]
  v_mfma_f32_16x16x32_bf16 a[24:27], v[28:31], v[16:19], a[24:27]
  ds_read_b128 v[64:67], v4 offset:2048
  v_mfma_f32_16x16x32_bf16 a[28:31], v[28:31], v[20:23], a[28:31]
  v_mfma_f32_16x16x32_bf16 a[32:35], v[32:35], v[8:11], a[32:35]
  v_mfma_f32_16x16x32_bf16 a[36:39], v[32:35], v[12:15], a[36:39]
  ds_read_b128 v[68:71], v4 offset:3072
  v_mfma_f32_16x16x32_bf16 a[40:43], v[32:35], v[16:19], a[40:43]
  v_mfma_f32_16x16x32_bf16 a[44:47], v[32:35], v[20:23], a[44:47]
  ds_read_b128 v[72:75], v3 offset:0
  v_mfma_f32_16x16x32_bf16 a[48:51], v[36:39], v[8:11], a[48:51]
  v_mfma_f32_16x16x32_bf16 a[52:55], v[36:39], v[12:15], a[52:55]
  ds_read_b128 v[76:79], v3 offset:1024
  v_mfma_f32_16x16x32_bf16 a[56:59], v[36:39], v[16:19], a[56:59]
  v_mfma_f32_16x16x32_bf16 a[60:63], v[36:39], v[20:23], a[60:63]
  v_mfma_f32_16x16x32_bf16 a[64:67], v[40:43], v[8:11], a[64:67]
  ds_read_b128 v[80:83], v3 offset:2048
  v_mfma_f32_16x16x32_bf16 a[68:71], v[40:43], v[12:15], a[68:71]
  v_mfma_f32_16x16x32_bf16 a[72:75], v[40:43], v[16:19], a[72:75]
  ds_read_b128 v[84:87], v3 offset:3072
  v_mfma_f32_16x16x32_bf16 a[76:79], v[40:43], v[20:23], a[76:79]
  v_mfma_f32_16x16x32_bf16 a[80:83], v[44:47], v[8:11], a[80:83]
  ds_read_b128 v[88:91], v3 offset:4096
  v_mfma_f32_16x16x32_bf16 a[84:87], v[44:47], v[12:15], a[84:87]
  v_mfma_f32_16x16x32_bf16 a[88:91], v[44:47], v[16:19], a[88:91]
  ds_read_b128 v[92:95], v3 offset:5120
  v_mfma_f32_16x16x32_bf16 a[92:95], v[44:47], v[20:23], a[92:95]
  v_mfma_f32_16x16x32_bf16 a[96:99], v[48:51], v[8:11], a[96:99]
  v_mfma_f32_16x16x32_bf16 a[100:103], v[48:51], v[12:15], a[100:103]
  ds_read_b128 v[96:99], v3 offset:6144
  v_mfma_f32_16x16x32_bf16 a[104:107], v[48:51], v[16:19], a[104:107]
  v_mfma_f32_16x16x32_bf16 a[108:111], v[48:51], v[20:23], a[108:111]
  ds_read_b128 v[100:103], v3 offset:7168
  v_mfma_f32_16x16x32_bf16 a[112:115], v[52:55], v[8:11], a[112:115]
  v_mfma_f32_16x16x32_bf16 a[116:119], v[52:55], v[12:15], a[116:119]
  s_add_u32 s31, s31, 24576
  s_cmp_ge_u32 s31, 122880
  s_cselect_b32 s31, 0, s31
  v_mfma_f32_16x16x32_bf16 a[120:123], v[52:55], v[16:19], a[120:123]
  v_mfma_f32_16x16x32_bf16 a[124:127], v[52:55], v[20:23], a[124:127]
  s_waitcnt lgkmcnt(0)
  v_mfma_f32_16x16x32_bf16 a[0:3], v[72:75], v[56:59], a[0:3]
  v_mfma_f32_16x16x32_bf16 a[4:7], v[72:75], v[60:63], a[4:7]
  v_mfma_f32_16x16x32_bf16 a[8:11], v[72:75], v[64:67], a[8:11]
  v_mfma_f32_16x16x32_bf16 a[12:15], v[72:75], v[68:71], a[12:15]
  v_mfma_f32_16x16x32_bf16 a[16:19], v[76:79], v[56:59], a[16:19]
  v_mfma_f32_16x16x32_bf16 a[20:23], v[76:79], v[60:63], a[20:23]
  v_mfma_f32_16x16x32_bf16 a[24:27], v[76:79], v[64:67], a[24:27]
  v_mfma_f32_16x16x32_bf16 a[28:31], v[76:79], v[68:71], a[28:31]
  v_mfma_f32_16x16x32_bf16 a[32:35], v[80:83], v[56:59], a[32:35]
  v_mfma_f32_16x16x32_bf16 a[36:39], v[80:83], v[60:63], a[36:39]
  v_mfma_f32_16x16x32_bf16 a[40:43], v[80:83], v[64:67], a[40:43]
  v_mfma_f32_16x16x32_bf16 a[44:47], v[80:83], v[68:71], a[44:47]
  v_mfma_f32_16x16x32_bf16 a[48:51], v[84:87], v[56:59], a[48:51]
  v_mfma_f32_16x16x32_bf16 a[52:55], v[84:87], v[60:63], a[52:55]
  v_mfma_f32_16x16x32_bf16 a[56:59], v[84:87], v[64:67], a[56:59]
  v_mfma_f32_16x16x32_bf16 a[60:63], v[84:87], v[68:71], a[60:63]
  v_mfma_f32_16x16x32_bf16 a[64:67], v[88:91], v[56:59], a[64:67]
  v_mfma_f32_16x16x32_bf16 a[68:71], v[88:91], v[60:63], a[68:71]
  v_mfma_f32_16x16x32_bf16 a[72:75], v[88:91], v[64:67], a[72:75]
  v_mfma_f32_16x16x32_bf16 a[76:79], v[88:91], v[68:71], a[76:79]
  v_mfma_f32_16x16x32_bf16 a[80:83], v[92:95], v[56:59], a[80:83]
  v_mfma_f32_16x16x32_bf16 a[84:87], v[92:95], v[60:63], a[84:87]
  v_mfma_f32_16x16x32_bf16 a[88:91], v[92:95], v[64:67], a[88:91]
  v_mfma_f32_16x16x32_bf16 a[92:95], v[92:95], v[68:71], a[92:95]
  v_mfma_f32_16x16x32_bf16 a[96:99], v[96:99], v[56:59], a[96:99]
  v_mfma_f32_16x16x32_bf16 a[100:103], v[96:99], v[60:63], a[100:103]
  v_mfma_f32_16x16x32_bf16 a[104:107], v[96:99], v[64:67], a[104:107]
  v_mfma_f32_16x16x32_bf16 a[108:111], v[96:99], v[68:71], a[108:111]
  v_mfma_f32_16x16x32_bf16 a[112:115], v[100:103], v[56:59], a[112:115]
  v_mfma_f32_16x16x32_bf16 a[116:119], v[100:103], v[60:63], a[116:119]
  v_mfma_f32_16x16x32_bf16 a[120:123], v[100:103], v[64:67], a[120:123]
  v_mfma_f32_16x16x32_bf16 a[124:127], v[100:103], v[68:71], a[124:127]
  s_nop 7
  s_nop 3
  s_mul_i32 s11, s20, 8
  s_mul_i32 s12, s23, 4
  s_add_u32 s11, s11, s12
  s_lshl_b32 s11, s11, 5
  s_add_u32 s11, s11, s38
  s_lshl_b32 s11, s11, 13
  s_add_u32 s10, s11, 0x4000000
  s_lshl_b32 s12, s24, 12
  s_add_u32 s10, s10, s12
  s_add_u32 s14, s6, s10
  s_addc_u32 s15, s7, 0
  v_accvgpr_read_b32 v8, a0
  v_accvgpr_read_b32 v12, a16
  v_accvgpr_read_b32 v9, a1
  v_accvgpr_read_b32 v13, a17
  v_accvgpr_read_b32 v10, a2
  v_accvgpr_read_b32 v14, a18
  v_accvgpr_read_b32 v11, a3
  v_accvgpr_read_b32 v15, a19
  v_cvt_pk_bf16_f32 v16, v8, v9
  v_cvt_pk_bf16_f32 v17, v10, v11
  v_cvt_pk_bf16_f32 v18, v12, v13
  v_cvt_pk_bf16_f32 v19, v14, v15
  global_store_dwordx4 v1, v[16:19], s[14:15] offset:0 sc1
  s_nop 1
  v_accvgpr_read_b32 v8, a4
  v_accvgpr_read_b32 v12, a20
  v_accvgpr_read_b32 v9, a5
  v_accvgpr_read_b32 v13, a21
  v_accvgpr_read_b32 v10, a6
  v_accvgpr_read_b32 v14, a22
  v_accvgpr_read_b32 v11, a7
  v_accvgpr_read_b32 v15, a23
  v_cvt_pk_bf16_f32 v16, v8, v9
  v_cvt_pk_bf16_f32 v17, v10, v11
  v_cvt_pk_bf16_f32 v18, v12, v13
  v_cvt_pk_bf16_f32 v19, v14, v15
  global_store_dwordx4 v1, v[16:19], s[14:15] offset:1024 sc1
  s_nop 1
  v_accvgpr_read_b32 v8, a8
  v_accvgpr_read_b32 v12, a24
  v_accvgpr_read_b32 v9, a9
  v_accvgpr_read_b32 v13, a25
  v_accvgpr_read_b32 v10, a10
  v_accvgpr_read_b32 v14, a26
  v_accvgpr_read_b32 v11, a11
  v_accvgpr_read_b32 v15, a27
  v_cvt_pk_bf16_f32 v16, v8, v9
  v_cvt_pk_bf16_f32 v17, v10, v11
  v_cvt_pk_bf16_f32 v18, v12, v13
  v_cvt_pk_bf16_f32 v19, v14, v15
  global_store_dwordx4 v1, v[16:19], s[14:15] offset:2048 sc1
  s_nop 1
  v_accvgpr_read_b32 v8, a12
  v_accvgpr_read_b32 v12, a28
  v_accvgpr_read_b32 v9, a13
  v_accvgpr_read_b32 v13, a29
  v_accvgpr_read_b32 v10, a14
  v_accvgpr_read_b32 v14, a30
  v_accvgpr_read_b32 v11, a15
  v_accvgpr_read_b32 v15, a31
  v_cvt_pk_bf16_f32 v16, v8, v9
  v_cvt_pk_bf16_f32 v17, v10, v11
  v_cvt_pk_bf16_f32 v18, v12, v13
  v_cvt_pk_bf16_f32 v19, v14, v15
  global_store_dwordx4 v1, v[16:19], s[14:15] offset:3072 sc1
  s_nop 1
  s_add_u32 s14, s14, 0x40000
  s_addc_u32 s15, s15, 0
  v_accvgpr_read_b32 v8, a32
  v_accvgpr_read_b32 v12, a48
  v_accvgpr_read_b32 v9, a33
  v_accvgpr_read_b32 v13, a49
  v_accvgpr_read_b32 v10, a34
  v_accvgpr_read_b32 v14, a50
  v_accvgpr_read_b32 v11, a35
  v_accvgpr_read_b32 v15, a51
  v_cvt_pk_bf16_f32 v16, v8, v9
  v_cvt_pk_bf16_f32 v17, v10, v11
  v_cvt_pk_bf16_f32 v18, v12, v13
  v_cvt_pk_bf16_f32 v19, v14, v15
  global_store_dwordx4 v1, v[16:19], s[14:15] offset:0 sc1
  s_nop 1
  v_accvgpr_read_b32 v8, a36
  v_accvgpr_read_b32 v12, a52
  v_accvgpr_read_b32 v9, a37
  v_accvgpr_read_b32 v13, a53
  v_accvgpr_read_b32 v10, a38
  v_accvgpr_read_b32 v14, a54
  v_accvgpr_read_b32 v11, a39
  v_accvgpr_read_b32 v15, a55
  v_cvt_pk_bf16_f32 v16, v8, v9
  v_cvt_pk_bf16_f32 v17, v10, v11
  v_cvt_pk_bf16_f32 v18, v12, v13
  v_cvt_pk_bf16_f32 v19, v14, v15
  global_store_dwordx4 v1, v[16:19], s[14:15] offset:1024 sc1
  s_nop 1
  v_accvgpr_read_b32 v8, a40
  v_accvgpr_read_b32 v12, a56
  v_accvgpr_read_b32 v9, a41
  v_accvgpr_read_b32 v13, a57
  v_accvgpr_read_b32 v10, a42
  v_accvgpr_read_b32 v14, a58
  v_accvgpr_read_b32 v11, a43
  v_accvgpr_read_b32 v15, a59
  v_cvt_pk_bf16_f32 v16, v8, v9
  v_cvt_pk_bf16_f32 v17, v10, v11
  v_cvt_pk_bf16_f32 v18, v12, v13
  v_cvt_pk_bf16_f32 v19, v14, v15
  global_store_dwordx4 v1, v[16:19], s[14:15] offset:2048 sc1
  s_nop 1
  v_accvgpr_read_b32 v8, a44
  v_accvgpr_read_b32 v12, a60
  v_accvgpr_read_b32 v9, a45
  v_accvgpr_read_b32 v13, a61
  v_accvgpr_read_b32 v10, a46
  v_accvgpr_read_b32 v14, a62
  v_accvgpr_read_b32 v11, a47
  v_accvgpr_read_b32 v15, a63
  v_cvt_pk_bf16_f32 v16, v8, v9
  v_cvt_pk_bf16_f32 v17, v10, v11
  v_cvt_pk_bf16_f32 v18, v12, v13
  v_cvt_pk_bf16_f32 v19, v14, v15
  global_store_dwordx4 v1, v[16:19], s[14:15] offset:3072 sc1
  s_nop 1
  s_add_u32 s14, s14, 0x40000
  s_addc_u32 s15, s15, 0
  v_accvgpr_read_b32 v8, a64
  v_accvgpr_read_b32 v12, a80
  v_accvgpr_read_b32 v9, a65
  v_accvgpr_read_b32 v13, a81
  v_accvgpr_read_b32 v10, a66
  v_accvgpr_read_b32 v14, a82
  v_accvgpr_read_b32 v11, a67
  v_accvgpr_read_b32 v15, a83
  v_cvt_pk_bf16_f32 v16, v8, v9
  v_cvt_pk_bf16_f32 v17, v10, v11
  v_cvt_pk_bf16_f32 v18, v12, v13
  v_cvt_pk_bf16_f32 v19, v14, v15
  global_store_dwordx4 v1, v[16:19], s[14:15] offset:0 sc1
  s_nop 1
  v_accvgpr_read_b32 v8, a68
  v_accvgpr_read_b32 v12, a84
  v_accvgpr_read_b32 v9, a69
  v_accvgpr_read_b32 v13, a85
  v_accvgpr_read_b32 v10, a70
  v_accvgpr_read_b32 v14, a86
  v_accvgpr_read_b32 v11, a71
  v_accvgpr_read_b32 v15, a87
  v_cvt_pk_bf16_f32 v16, v8, v9
  v_cvt_pk_bf16_f32 v17, v10, v11
  v_cvt_pk_bf16_f32 v18, v12, v13
  v_cvt_pk_bf16_f32 v19, v14, v15
  global_store_dwordx4 v1, v[16:19], s[14:15] offset:1024 sc1
  s_nop 1
  v_accvgpr_read_b32 v8, a72
  v_accvgpr_read_b32 v12, a88
  v_accvgpr_read_b32 v9, a73
  v_accvgpr_read_b32 v13, a89
  v_accvgpr_read_b32 v10, a74
  v_accvgpr_read_b32 v14, a90
  v_accvgpr_read_b32 v11, a75
  v_accvgpr_read_b32 v15, a91
  v_cvt_pk_bf16_f32 v16, v8, v9
  v_cvt_pk_bf16_f32 v17, v10, v11
  v_cvt_pk_bf16_f32 v18, v12, v13
  v_cvt_pk_bf16_f32 v19, v14, v15
  global_store_dwordx4 v1, v[16:19], s[14:15] offset:2048 sc1
  s_nop 1
  v_accvgpr_read_b32 v8, a76
  v_accvgpr_read_b32 v12, a92
  v_accvgpr_read_b32 v9, a77
  v_accvgpr_read_b32 v13, a93
  v_accvgpr_read_b32 v10, a78
  v_accvgpr_read_b32 v14, a94
  v_accvgpr_read_b32 v11, a79
  v_accvgpr_read_b32 v15, a95
  v_cvt_pk_bf16_f32 v16, v8, v9
  v_cvt_pk_bf16_f32 v17, v10, v11
  v_cvt_pk_bf16_f32 v18, v12, v13
  v_cvt_pk_bf16_f32 v19, v14, v15
  global_store_dwordx4 v1, v[16:19], s[14:15] offset:3072 sc1
  s_nop 1
  s_add_u32 s14, s14, 0x40000
  s_addc_u32 s15, s15, 0
  v_accvgpr_read_b32 v8, a96
  v_accvgpr_read_b32 v12, a112
  v_accvgpr_read_b32 v9, a97
  v_accvgpr_read_b32 v13, a113
  v_accvgpr_read_b32 v10, a98
  v_accvgpr_read_b32 v14, a114
  v_accvgpr_read_b32 v11, a99
  v_accvgpr_read_b32 v15, a115
  v_cvt_pk_bf16_f32 v16, v8, v9
  v_cvt_pk_bf16_f32 v17, v10, v11
  v_cvt_pk_bf16_f32 v18, v12, v13
  v_cvt_pk_bf16_f32 v19, v14, v15
  global_store_dwordx4 v1, v[16:19], s[14:15] offset:0 sc1
  s_nop 1
  v_accvgpr_read_b32 v8, a100
  v_accvgpr_read_b32 v12, a116
  v_accvgpr_read_b32 v9, a101
  v_accvgpr_read_b32 v13, a117
  v_accvgpr_read_b32 v10, a102
  v_accvgpr_read_b32 v14, a118
  v_accvgpr_read_b32 v11, a103
  v_accvgpr_read_b32 v15, a119
  v_cvt_pk_bf16_f32 v16, v8, v9
  v_cvt_pk_bf16_f32 v17, v10, v11
  v_cvt_pk_bf16_f32 v18, v12, v13
  v_cvt_pk_bf16_f32 v19, v14, v15
  global_store_dwordx4 v1, v[16:19], s[14:15] offset:1024 sc1
  s_nop 1
  v_accvgpr_read_b32 v8, a104
  v_accvgpr_read_b32 v12, a120
  v_accvgpr_read_b32 v9, a105
  v_accvgpr_read_b32 v13, a121
  v_accvgpr_read_b32 v10, a106
  v_accvgpr_read_b32 v14, a122
  v_accvgpr_read_b32 v11, a107
  v_accvgpr_read_b32 v15, a123
  v_cvt_pk_bf16_f32 v16, v8, v9
  v_cvt_pk_bf16_f32 v17, v10, v11
  v_cvt_pk_bf16_f32 v18, v12, v13
  v_cvt_pk_bf16_f32 v19, v14, v15
  global_store_dwordx4 v1, v[16:19], s[14:15] offset:2048 sc1
  s_nop 1
  v_accvgpr_read_b32 v8, a108
  v_accvgpr_read_b32 v12, a124
  v_accvgpr_read_b32 v9, a109
  v_accvgpr_read_b32 v13, a125
  v_accvgpr_read_b32 v10, a110
  v_accvgpr_read_b32 v14, a126
  v_accvgpr_read_b32 v11, a111
  v_accvgpr_read_b32 v15, a127
  v_cvt_pk_bf16_f32 v16, v8, v9
  v_cvt_pk_bf16_f32 v17, v10, v11
  v_cvt_pk_bf16_f32 v18, v12, v13
  v_cvt_pk_bf16_f32 v19, v14, v15
  global_store_dwordx4 v1, v[16:19], s[14:15] offset:3072 sc1
  s_nop 1
  s_add_u32 s14, s14, 0x40000
  s_addc_u32 s15, s15, 0
qbulk_sig:
  s_waitcnt vmcnt(0)
  s_barrier
  s_cmp_lg_u32 s22, 0
  s_cbranch_scc1 qbulk_next
  s_lshl_b32 s10, s20, 2
  s_add_u32 s11, s10, 128
  s_add_u32 s12, s6, 0x8c00500
  s_addc_u32 s13, s7, 0
  s_cmp_ge_u32 s98, 448
  s_cselect_b32 s12, s12, s70
  s_cselect_b32 s13, s13, s71
  s_cselect_b32 s10, s10, s11
  v_mov_b32 v8, s10
  v_mov_b32 v9, 1
  s_mov_b64 s[56:57], exec
  s_mov_b64 exec, 1
  global_atomic_add v8, v9, s[12:13]
  s_mov_b64 exec, s[56:57]
qbulk_next:
  s_add_u32 s98, s98, 96
  s_cmp_lt_u32 s98, 704
  s_cbranch_scc1 qbulk_tile
  v_lshrrev_b32 v8, 6, v0
  s_nop 0
  v_readfirstlane_b32 s99, v8
dyn_loop:
  s_barrier
  s_load_dwordx2 s[6:7], s[0:1], 104
  s_load_dwordx2 s[70:71], s[0:1], 96
  s_waitcnt lgkmcnt(0)
  s_add_u32 s90, s6, 0x8c00400
  s_addc_u32 s91, s7, 0
  s_cmp_lg_u32 s99, 0
  s_cbranch_scc1 dyn_tkw
  v_mov_b32 v8, 320
  v_mov_b32 v9, 1
  v_mov_b32 v11, 150016
  s_mov_b64 s[56:57], exec
  s_mov_b64 exec, 1
  global_atomic_add v10, v8, v9, s[90:91] sc0
  s_waitcnt vmcnt(0)
  ds_write_b32 v11, v10
  s_waitcnt lgkmcnt(0)
  s_mov_b64 exec, s[56:57]
dyn_tkw:
  s_barrier
  v_mov_b32 v11, 150016
  ds_read_b32 v10, v11
  s_waitcnt lgkmcnt(0)
  s_nop 0
  v_readfirstlane_b32 s98, v10
  s_nop 3
  s_cmp_ge_u32 s98, 812
  s_cbranch_scc1 chain_done
  s_mul_i32 s92, s98, 1130
  s_lshr_b32 s92, s92, 16
  s_mul_i32 s93, s92, 58
  s_sub_u32 s93, s98, s93
  s_cmp_lt_u32 s93, 16
  s_cbranch_scc1 dyn_awl
  s_cmp_lt_u32 s93, 43
  s_cbranch_scc1 dyn_f1
  s_sub_u32 s94, s92, 2
  s_cmp_ge_u32 s94, 12
  s_cbranch_scc1 dyn_loop
  s_lshl_b32 s95, s94, 2
  s_add_u32 s95, s95, 192
  s_cmp_lg_u32 s99, 0
  s_cbranch_scc1 dw2_w
  v_mov_b32 v8, s95
  s_mov_b32 s58, 0
dw2_p:
  global_load_dword v9, v8, s[90:91] sc1
  s_waitcnt vmcnt(0)
  v_readfirstlane_b32 s59, v9
  s_add_u32 s58, s58, 1
  s_cmp_gt_u32 s58, 100000
  s_cbranch_scc1 dw2_w
  s_cmp_ge_u32 s59, 27
  s_cbranch_scc1 dw2_w
  s_sleep 40
  s_branch dw2_p
dw2_w:
  s_barrier
  s_load_dwordx2 s[6:7], s[0:1], 104
  s_load_dwordx2 s[4:5], s[0:1], 0
  s_load_dwordx2 s[8:9], s[0:1], 88
  v_lshrrev_b32 v5, 6, v0
  v_and_b32 v6, 63, v0
  s_nop 0
  v_readfirstlane_b32 s22, v5
  v_lshlrev_b32 v1, 4, v6
  s_mov_b32 s20, s94
  s_sub_u32 s13, s93, 43
  s_mul_i32 s19, s13, 52429
  s_lshr_b32 s19, s19, 18
  s_mul_i32 s14, s19, 5
  s_sub_u32 s21, s13, s14
  s_waitcnt lgkmcnt(0)
  s_lshr_b32 s23, s22, 1
  s_and_b32 s24, s22, 1
  s_add_u32 s25, s22, 0
  s_mul_i32 s26, s20, 8
  s_add_u32 s26, s26, s25
  s_mul_i32 s26, s26, 55296
  s_add_u32 s26, s26, 0x7800000
  s_mul_i32 s27, s21, 8
  s_add_u32 s27, s27, s25
  s_sub_u32 s27, s27, 8
  s_mul_i32 s27, s27, 55296
  s_add_u32 s27, s27, 0x1b40000
  s_cmp_lt_u32 s25, 8
  s_cselect_b32 s26, s26, s27
  s_add_u32 s40, s6, s26
  s_addc_u32 s41, s7, 0
  s_add_u32 s25, s22, 4
  s_mul_i32 s26, s20, 8
  s_add_u32 s26, s26, s25
  s_mul_i32 s26, s26, 55296
  s_add_u32 s26, s26, 0x7800000
  s_mul_i32 s27, s21, 8
  s_add_u32 s27, s27, s25
  s_sub_u32 s27, s27, 8
  s_mul_i32 s27, s27, 55296
  s_add_u32 s27, s27, 0x1b40000
  s_cmp_lt_u32 s25, 8
  s_cselect_b32 s26, s26, s27
  s_add_u32 s42, s6, s26
  s_addc_u32 s43, s7, 0
  s_add_u32 s25, s22, 8
  s_mul_i32 s26, s20, 8
  s_add_u32 s26, s26, s25
  s_mul_i32 s26, s26, 55296
  s_add_u32 s26, s26, 0x7800000
  s_mul_i32 s27, s21, 8
  s_add_u32 s27, s27, s25
  s_sub_u32 s27, s27, 8
  s_mul_i32 s27, s27, 55296
  s_add_u32 s27, s27, 0x1b40000
  s_cmp_lt_u32 s25, 8
  s_cselect_b32 s26, s26, s27
  s_add_u32 s44, s6, s26
  s_addc_u32 s45, s7, 0
  s_add_u32 s25, s22, 12
  s_mul_i32 s26, s20, 8
  s_add_u32 s26, s26, s25
  s_mul_i32 s26, s26, 55296
  s_add_u32 s26, s26, 0x7800000
  s_mul_i32 s27, s21, 8
  s_add_u32 s27, s27, s25
  s_sub_u32 s27, s27, 8
  s_mul_i32 s27, s27, 55296
  s_add_u32 s27, s27, 0x1b40000
  s_cmp_lt_u32 s25, 8
  s_cselect_b32 s26, s26, s27
  s_add_u32 s46, s6, s26
  s_addc_u32 s47, s7, 0
  s_mul_i32 s28, s22, 1024
  s_mul_i32 s25, s19, 18432
  v_add_u32 v2, s25, v1
  s_mul_i32 s29, s23, 4096
  s_mul_i32 s30, s24, 4096
  s_add_u32 s30, s30, 8192
  s_mov_b32 s31, 0
  s_mov_b32 s32, 0
  s_add_u32 s33, s32, s28
  s_add_u32 m0, s33, 0
  s_nop 0
  global_load_lds_dwordx4 v2, s[40:41]
  s_add_u32 m0, s33, 4096
  s_nop 0
  global_load_lds_dwordx4 v2, s[42:43]
  s_add_u32 m0, s33, 8192
  s_nop 0
  global_load_lds_dwordx4 v2, s[44:45]
  s_add_u32 m0, s33, 12288
  s_nop 0
  global_load_lds_dwordx4 v2, s[46:47]
  v_add_u32 v2, 1024, v2
  s_add_u32 s32, s32, 16384
  s_cmp_ge_u32 s32, 65536
  s_cselect_b32 s32, 0, s32
  s_add_u32 s33, s32, s28
  s_add_u32 m0, s33, 0
  s_nop 0
  global_load_lds_dwordx4 v2, s[40:41]
  s_add_u32 m0, s33, 4096
  s_nop 0
  global_load_lds_dwordx4 v2, s[42:43]
  s_add_u32 m0, s33, 8192
  s_nop 0
  global_load_lds_dwordx4 v2, s[44:45]
  s_add_u32 m0, s33, 12288
  s_nop 0
  global_load_lds_dwordx4 v2, s[46:47]
  v_add_u32 v2, 1024, v2
  s_add_u32 s32, s32, 16384
  s_cmp_ge_u32 s32, 65536
  s_cselect_b32 s32, 0, s32
  s_add_u32 s33, s32, s28
  s_add_u32 m0, s33, 0
  s_nop 0
  global_load_lds_dwordx4 v2, s[40:41]
  s_add_u32 m0, s33, 4096
  s_nop 0
  global_load_lds_dwordx4 v2, s[42:43]
  s_add_u32 m0, s33, 8192
  s_nop 0
  global_load_lds_dwordx4 v2, s[44:45]
  s_add_u32 m0, s33, 12288
  s_nop 0
  global_load_lds_dwordx4 v2, s[46:47]
  v_add_u32 v2, 1024, v2
  s_add_u32 s32, s32, 16384
  s_cmp_ge_u32 s32, 65536
  s_cselect_b32 s32, 0, s32
  s_add_u32 s33, s32, s28
  s_add_u32 m0, s33, 0
  s_nop 0
  global_load_lds_dwordx4 v2, s[40:41]
  s_add_u32 m0, s33, 4096
  s_nop 0
  global_load_lds_dwordx4 v2, s[42:43]
  s_add_u32 m0, s33, 8192
  s_nop 0
  global_load_lds_dwordx4 v2, s[44:45]
  s_add_u32 m0, s33, 12288
  s_nop 0
  global_load_lds_dwordx4 v2, s[46:47]
  v_add_u32 v2, 1024, v2
  s_add_u32 s32, s32, 16384
  s_cmp_ge_u32 s32, 65536
  s_cselect_b32 s32, 0, s32
  v_accvgpr_write_b32 a0, 0
  v_accvgpr_write_b32 a1, 0
  v_accvgpr_write_b32 a2, 0
  v_accvgpr_write_b32 a3, 0
  v_accvgpr_write_b32 a4, 0
  v_accvgpr_write_b32 a5, 0
  v_accvgpr_write_b32 a6, 0
  v_accvgpr_write_b32 a7, 0
  v_accvgpr_write_b32 a8, 0
  v_accvgpr_write_b32 a9, 0
  v_accvgpr_write_b32 a10, 0
  v_accvgpr_write_b32 a11, 0
  v_accvgpr_write_b32 a12, 0
  v_accvgpr_write_b32 a13, 0
  v_accvgpr_write_b32 a14, 0
  v_accvgpr_write_b32 a15, 0
  v_accvgpr_write_b32 a16, 0
  v_accvgpr_write_b32 a17, 0
  v_accvgpr_write_b32 a18, 0
  v_accvgpr_write_b32 a19, 0
  v_accvgpr_write_b32 a20, 0
  v_accvgpr_write_b32 a21, 0
  v_accvgpr_write_b32 a22, 0
  v_accvgpr_write_b32 a23, 0
  v_accvgpr_write_b32 a24, 0
  v_accvgpr_write_b32 a25, 0
  v_accvgpr_write_b32 a26, 0
  v_accvgpr_write_b32 a27, 0
  v_accvgpr_write_b32 a28, 0
  v_accvgpr_write_b32 a29, 0
  v_accvgpr_write_b32 a30, 0
  v_accvgpr_write_b32 a31, 0
  v_accvgpr_write_b32 a32, 0
  v_accvgpr_write_b32 a33, 0
  v_accvgpr_write_b32 a34, 0
  v_accvgpr_write_b32 a35, 0
  v_accvgpr_write_b32 a36, 0
  v_accvgpr_write_b32 a37, 0
  v_accvgpr_write_b32 a38, 0
  v_accvgpr_write_b32 a39, 0
  v_accvgpr_write_b32 a40, 0
  v_accvgpr_write_b32 a41, 0
  v_accvgpr_write_b32 a42, 0
  v_accvgpr_write_b32 a43, 0
  v_accvgpr_write_b32 a44, 0
  v_accvgpr_write_b32 a45, 0
  v_accvgpr_write_b32 a46, 0
  v_accvgpr_write_b32 a47, 0
  v_accvgpr_write_b32 a48, 0
  v_accvgpr_write_b32 a49, 0
  v_accvgpr_write_b32 a50, 0
  v_accvgpr_write_b32 a51, 0
  v_accvgpr_write_b32 a52, 0
  v_accvgpr_write_b32 a53, 0
  v_accvgpr_write_b32 a54, 0
  v_accvgpr_write_b32 a55, 0
  v_accvgpr_write_b32 a56, 0
  v_accvgpr_write_b32 a57, 0
  v_accvgpr_write_b32 a58, 0
  v_accvgpr_write_b32 a59, 0
  v_accvgpr_write_b32 a60, 0
  v_accvgpr_write_b32 a61, 0
  v_accvgpr_write_b32 a62, 0
  v_accvgpr_write_b32 a63, 0
  s_waitcnt vmcnt(12)
  s_barrier
  s_add_u32 s34, s31, s29
  s_add_u32 s35, s31, s30
  v_add_u32 v3, s34, v1
  v_add_u32 v4, s35, v1
  ds_read_b128 v[8:11], v4 offset:0
  ds_read_b128 v[12:15], v4 offset:1024
  ds_read_b128 v[16:19], v4 offset:2048
  ds_read_b128 v[20:23], v4 offset:3072
  ds_read_b128 v[24:27], v3 offset:0
  ds_read_b128 v[28:31], v3 offset:1024
  ds_read_b128 v[32:35], v3 offset:2048
  ds_read_b128 v[36:39], v3 offset:3072
  s_add_u32 s31, s31, 16384
  s_cmp_ge_u32 s31, 65536
  s_cselect_b32 s31, 0, s31
  s_mov_b32 s36, 0
bf2_loop:
  s_waitcnt vmcnt(8) lgkmcnt(0)
  s_barrier
  v_mfma_f32_16x16x32_bf16 a[0:3], v[8:11], v[24:27], a[0:3]
  s_add_u32 s34, s31, s29
  s_add_u32 s35, s31, s30
  v_add_u32 v3, s34, v1
  v_add_u32 v4, s35, v1
  v_mfma_f32_16x16x32_bf16 a[4:7], v[12:15], v[24:27], a[4:7]
  ds_read_b128 v[40:43], v4 offset:0
  v_mfma_f32_16x16x32_bf16 a[8:11], v[16:19], v[24:27], a[8:11]
  ds_read_b128 v[44:47], v4 offset:1024
  v_mfma_f32_16x16x32_bf16 a[12:15], v[20:23], v[24:27], a[12:15]
  ds_read_b128 v[48:51], v4 offset:2048
  v_mfma_f32_16x16x32_bf16 a[16:19], v[8:11], v[28:31], a[16:19]
  ds_read_b128 v[52:55], v4 offset:3072
  v_mfma_f32_16x16x32_bf16 a[20:23], v[12:15], v[28:31], a[20:23]
  ds_read_b128 v[56:59], v3 offset:0
  v_mfma_f32_16x16x32_bf16 a[24:27], v[16:19], v[28:31], a[24:27]
  ds_read_b128 v[60:63], v3 offset:1024
  v_mfma_f32_16x16x32_bf16 a[28:31], v[20:23], v[28:31], a[28:31]
  ds_read_b128 v[64:67], v3 offset:2048
  v_mfma_f32_16x16x32_bf16 a[32:35], v[8:11], v[32:35], a[32:35]
  ds_read_b128 v[68:71], v3 offset:3072
  v_mfma_f32_16x16x32_bf16 a[36:39], v[12:15], v[32:35], a[36:39]
  s_add_u32 s31, s31, 16384
  s_cmp_ge_u32 s31, 65536
  s_cselect_b32 s31, 0, s31
  v_mfma_f32_16x16x32_bf16 a[40:43], v[16:19], v[32:35], a[40:43]
  s_add_u32 s33, s32, s28
  v_mfma_f32_16x16x32_bf16 a[44:47], v[20:23], v[32:35], a[44:47]
  s_add_u32 m0, s33, 0
  s_nop 0
  global_load_lds_dwordx4 v2, s[40:41]
  v_mfma_f32_16x16x32_bf16 a[48:51], v[8:11], v[36:39], a[48:51]
  s_add_u32 m0, s33, 4096
  s_nop 0
  global_load_lds_dwordx4 v2, s[42:43]
  v_mfma_f32_16x16x32_bf16 a[52:55], v[12:15], v[36:39], a[52:55]
  s_add_u32 m0, s33, 8192
  s_nop 0
  global_load_lds_dwordx4 v2, s[44:45]
  v_mfma_f32_16x16x32_bf16 a[56:59], v[16:19], v[36:39], a[56:59]
  s_add_u32 m0, s33, 12288
  s_nop 0
  global_load_lds_dwordx4 v2, s[46:47]
  v_mfma_f32_16x16x32_bf16 a[60:63], v[20:23], v[36:39], a[60:63]
  v_add_u32 v2, 1024, v2
  s_add_u32 s32, s32, 16384
  s_cmp_ge_u32 s32, 65536
  s_cselect_b32 s32, 0, s32
  s_waitcnt vmcnt(8) lgkmcnt(0)
  s_barrier
  v_mfma_f32_16x16x32_bf16 a[0:3], v[40:43], v[56:59], a[0:3]
  s_add_u32 s34, s31, s29
  s_add_u32 s35, s31, s30
  v_add_u32 v3, s34, v1
  v_add_u32 v4, s35, v1
  v_mfma_f32_16x16x32_bf16 a[4:7], v[44:47], v[56:59], a[4:7]
  ds_read_b128 v[8:11], v4 offset:0
  v_mfma_f32_16x16x32_bf16 a[8:11], v[48:51], v[56:59], a[8:11]
  ds_read_b128 v[12:15], v4 offset:1024
  v_mfma_f32_16x16x32_bf16 a[12:15], v[52:55], v[56:59], a[12:15]
  ds_read_b128 v[16:19], v4 offset:2048
  v_mfma_f32_16x16x32_bf16 a[16:19], v[40:43], v[60:63], a[16:19]
  ds_read_b128 v[20:23], v4 offset:3072
  v_mfma_f32_16x16x32_bf16 a[20:23], v[44:47], v[60:63], a[20:23]
  ds_read_b128 v[24:27], v3 offset:0
  v_mfma_f32_16x16x32_bf16 a[24:27], v[48:51], v[60:63], a[24:27]
  ds_read_b128 v[28:31], v3 offset:1024
  v_mfma_f32_16x16x32_bf16 a[28:31], v[52:55], v[60:63], a[28:31]
  ds_read_b128 v[32:35], v3 offset:2048
  v_mfma_f32_16x16x32_bf16 a[32:35], v[40:43], v[64:67], a[32:35]
  ds_read_b128 v[36:39], v3 offset:3072
  v_mfma_f32_16x16x32_bf16 a[36:39], v[44:47], v[64:67], a[36:39]
  s_add_u32 s31, s31, 16384
  s_cmp_ge_u32 s31, 65536
  s_cselect_b32 s31, 0, s31
  v_mfma_f32_16x16x32_bf16 a[40:43], v[48:51], v[64:67], a[40:43]
  s_add_u32 s33, s32, s28
  v_mfma_f32_16x16x32_bf16 a[44:47], v[52:55], v[64:67], a[44:47]
  s_add_u32 m0, s33, 0
  s_nop 0
  global_load_lds_dwordx4 v2, s[40:41]
  v_mfma_f32_16x16x32_bf16 a[48:51], v[40:43], v[68:71], a[48:51]
  s_add_u32 m0, s33, 4096
  s_nop 0
  global_load_lds_dwordx4 v2, s[42:43]
  v_mfma_f32_16x16x32_bf16 a[52:55], v[44:47], v[68:71], a[52:55]
  s_add_u32 m0, s33, 8192
  s_nop 0
  global_load_lds_dwordx4 v2, s[44:45]
  v_mfma_f32_16x16x32_bf16 a[56:59], v[48:51], v[68:71], a[56:59]
  s_add_u32 m0, s33, 12288
  s_nop 0
  global_load_lds_dwordx4 v2, s[46:47]
  v_mfma_f32_16x16x32_bf16 a[60:63], v[52:55], v[68:71], a[60:63]
  v_add_u32 v2, 1024, v2
  s_add_u32 s32, s32, 16384
  s_cmp_ge_u32 s32, 65536
  s_cselect_b32 s32, 0, s32
  s_add_u32 s36, s36, 2
  s_cmp_lt_u32 s36, 14
  s_cbranch_scc1 bf2_loop
  s_waitcnt vmcnt(8) lgkmcnt(0)
  s_barrier
  v_mfma_f32_16x16x32_bf16 a[0:3], v[8:11], v[24:27], a[0:3]
  s_add_u32 s34, s31, s29
  s_add_u32 s35, s31, s30
  v_add_u32 v3, s34, v1
  v_add_u32 v4, s35, v1
  v_mfma_f32_16x16x32_bf16 a[4:7], v[12:15], v[24:27], a[4:7]
  ds_read_b128 v[40:43], v4 offset:0
  v_mfma_f32_16x16x32_bf16 a[8:11], v[16:19], v[24:27], a[8:11]
  v_mfma_f32_16x16x32_bf16 a[12:15], v[20:23], v[24:27], a[12:15]
  ds_read_b128 v[44:47], v4 offset:1024
  v_mfma_f32_16x16x32_bf16 a[16:19], v[8:11], v[28:31], a[16:19]
  ds_read_b128 v[48:51], v4 offset:2048
  v_mfma_f32_16x16x32_bf16 a[20:23], v[12:15], v[28:31], a[20:23]
  v_mfma_f32_16x16x32_bf16 a[24:27], v[16:19], v[28:31], a[24:27]
  ds_read_b128 v[52:55], v4 offset:3072
  v_mfma_f32_16x16x32_bf16 a[28:31], v[20:23], v[28:31], a[28:31]
  v_mfma_f32_16x16x32_bf16 a[32:35], v[8:11], v[32:35], a[32:35]
  ds_read_b128 v[56:59], v3 offset:0
  v_mfma_f32_16x16x32_bf16 a[36:39], v[12:15], v[32:35], a[36:39]
  ds_read_b128 v[60:63], v3 offset:1024
  v_mfma_f32_16x16x32_bf16 a[40:43], v[16:19], v[32:35], a[40:43]
  v_mfma_f32_16x16x32_bf16 a[44:47], v[20:23], v[32:35], a[44:47]
  ds_read_b128 v[64:67], v3 offset:2048
  v_mfma_f32_16x16x32_bf16 a[48:51], v[8:11], v[36:39], a[48:51]
  ds_read_b128 v[68:71], v3 offset:3072
  v_mfma_f32_16x16x32_bf16 a[52:55], v[12:15], v[36:39], a[52:55]
  v_mfma_f32_16x16x32_bf16 a[56:59], v[16:19], v[36:39], a[56:59]
  s_add_u32 s31, s31, 16384
  s_cmp_ge_u32 s31, 65536
  s_cselect_b32 s31, 0, s31
  v_mfma_f32_16x16x32_bf16 a[60:63], v[20:23], v[36:39], a[60:63]
  s_waitcnt vmcnt(4) lgkmcnt(0)
  s_barrier
  v_mfma_f32_16x16x32_bf16 a[0:3], v[40:43], v[56:59], a[0:3]
  s_add_u32 s34, s31, s29
  s_add_u32 s35, s31, s30
  v_add_u32 v3, s34, v1
  v_add_u32 v4, s35, v1
  v_mfma_f32_16x16x32_bf16 a[4:7], v[44:47], v[56:59], a[4:7]
  ds_read_b128 v[8:11], v4 offset:0
  v_mfma_f32_16x16x32_bf16 a[8:11], v[48:51], v[56:59], a[8:11]
  v_mfma_f32_16x16x32_bf16 a[12:15], v[52:55], v[56:59], a[12:15]
  ds_read_b128 v[12:15], v4 offset:1024
  v_mfma_f32_16x16x32_bf16 a[16:19], v[40:43], v[60:63], a[16:19]
  ds_read_b128 v[16:19], v4 offset:2048
  v_mfma_f32_16x16x32_bf16 a[20:23], v[44:47], v[60:63], a[20:23]
  v_mfma_f32_16x16x32_bf16 a[24:27], v[48:51], v[60:63], a[24:27]
  ds_read_b128 v[20:23], v4 offset:3072
  v_mfma_f32_16x16x32_bf16 a[28:31], v[52:55], v[60:63], a[28:31]
  v_mfma_f32_16x16x32_bf16 a[32:35], v[40:43], v[64:67], a[32:35]
  ds_read_b128 v[24:27], v3 offset:0
  v_mfma_f32_16x16x32_bf16 a[36:39], v[44:47], v[64:67], a[36:39]
  ds_read_b128 v[28:31], v3 offset:1024
  v_mfma_f32_16x16x32_bf16 a[40:43], v[48:51], v[64:67], a[40:43]
  v_mfma_f32_16x16x32_bf16 a[44:47], v[52:55], v[64:67], a[44:47]
  ds_read_b128 v[32:35], v3 offset:2048
  v_mfma_f32_16x16x32_bf16 a[48:51], v[40:43], v[68:71], a[48:51]
  ds_read_b128 v[36:39], v3 offset:3072
  v_mfma_f32_16x16x32_bf16 a[52:55], v[44:47], v[68:71], a[52:55]
  v_mfma_f32_16x16x32_bf16 a[56:59], v[48:51], v[68:71], a[56:59]
  s_add_u32 s31, s31, 16384
  s_cmp_ge_u32 s31, 65536
  s_cselect_b32 s31, 0, s31
  v_mfma_f32_16x16x32_bf16 a[60:63], v[52:55], v[68:71], a[60:63]
  s_waitcnt vmcnt(0) lgkmcnt(0)
  s_barrier
  v_mfma_f32_16x16x32_bf16 a[0:3], v[8:11], v[24:27], a[0:3]
  s_add_u32 s34, s31, s29
  s_add_u32 s35, s31, s30
  v_add_u32 v3, s34, v1
  v_add_u32 v4, s35, v1
  v_mfma_f32_16x16x32_bf16 a[4:7], v[12:15], v[24:27], a[4:7]
  ds_read_b128 v[40:43], v4 offset:0
  v_mfma_f32_16x16x32_bf16 a[8:11], v[16:19], v[24:27], a[8:11]
  v_mfma_f32_16x16x32_bf16 a[12:15], v[20:23], v[24:27], a[12:15]
  ds_read_b128 v[44:47], v4 offset:1024
  v_mfma_f32_16x16x32_bf16 a[16:19], v[8:11], v[28:31], a[16:19]
  ds_read_b128 v[48:51], v4 offset:2048
  v_mfma_f32_16x16x32_bf16 a[20:23], v[12:15], v[28:31], a[20:23]
  v_mfma_f32_16x16x32_bf16 a[24:27], v[16:19], v[28:31], a[24:27]
  ds_read_b128 v[52:55], v4 offset:3072
  v_mfma_f32_16x16x32_bf16 a[28:31], v[20:23], v[28:31], a[28:31]
  v_mfma_f32_16x16x32_bf16 a[32:35], v[8:11], v[32:35], a[32:35]
  ds_read_b128 v[56:59], v3 offset:0
  v_mfma_f32_16x16x32_bf16 a[36:39], v[12:15], v[32:35], a[36:39]
  ds_read_b128 v[60:63], v3 offset:1024
  v_mfma_f32_16x16x32_bf16 a[40:43], v[16:19], v[32:35], a[40:43]
  v_mfma_f32_16x16x32_bf16 a[44:47], v[20:23], v[32:35], a[44:47]
  ds_read_b128 v[64:67], v3 offset:2048
  v_mfma_f32_16x16x32_bf16 a[48:51], v[8:11], v[36:39], a[48:51]
  ds_read_b128 v[68:71], v3 offset:3072
  v_mfma_f32_16x16x32_bf16 a[52:55], v[12:15], v[36:39], a[52:55]
  v_mfma_f32_16x16x32_bf16 a[56:59], v[16:19], v[36:39], a[56:59]
  s_add_u32 s31, s31, 16384
  s_cmp_ge_u32 s31, 65536
  s_cselect_b32 s31, 0, s31
  v_mfma_f32_16x16x32_bf16 a[60:63], v[20:23], v[36:39], a[60:63]
  s_waitcnt lgkmcnt(0)
  v_mfma_f32_16x16x32_bf16 a[0:3], v[40:43], v[56:59], a[0:3]
  v_mfma_f32_16x16x32_bf16 a[4:7], v[44:47], v[56:59], a[4:7]
  v_mfma_f32_16x16x32_bf16 a[8:11], v[48:51], v[56:59], a[8:11]
  v_mfma_f32_16x16x32_bf16 a[12:15], v[52:55], v[56:59], a[12:15]
  v_mfma_f32_16x16x32_bf16 a[16:19], v[40:43], v[60:63], a[16:19]
  v_mfma_f32_16x16x32_bf16 a[20:23], v[44:47], v[60:63], a[20:23]
  v_mfma_f32_16x16x32_bf16 a[24:27], v[48:51], v[60:63], a[24:27]
  v_mfma_f32_16x16x32_bf16 a[28:31], v[52:55], v[60:63], a[28:31]
  v_mfma_f32_16x16x32_bf16 a[32:35], v[40:43], v[64:67], a[32:35]
  v_mfma_f32_16x16x32_bf16 a[36:39], v[44:47], v[64:67], a[36:39]
  v_mfma_f32_16x16x32_bf16 a[40:43], v[48:51], v[64:67], a[40:43]
  v_mfma_f32_16x16x32_bf16 a[44:47], v[52:55], v[64:67], a[44:47]
  v_mfma_f32_16x16x32_bf16 a[48:51], v[40:43], v[68:71], a[48:51]
  v_mfma_f32_16x16x32_bf16 a[52:55], v[44:47], v[68:71], a[52:55]
  v_mfma_f32_16x16x32_bf16 a[56:59], v[48:51], v[68:71], a[56:59]
  v_mfma_f32_16x16x32_bf16 a[60:63], v[52:55], v[68:71], a[60:63]
  s_nop 7
  s_nop 3
  s_mul_i32 s10, s20, 5
  s_add_u32 s10, s10, s21
  s_mul_i32 s11, s10, 196608
  s_mul_i32 s12, s22, 16384
  s_add_u32 s11, s11, s12
  s_add_u32 s11, s11, 0xb000000
  s_add_u32 s14, s6, s11
  s_addc_u32 s15, s7, 0
  s_mul_i32 s12, s19, 65536
  s_add_u32 s16, s14, s12
  s_addc_u32 s17, s15, 0
  v_mov_b32 v5, v1
  global_store_dwordx4 v5, a[0:3], s[16:17] offset:0 sc1
  global_store_dwordx4 v5, a[4:7], s[16:17] offset:1024 sc1
  global_store_dwordx4 v5, a[8:11], s[16:17] offset:2048 sc1
  global_store_dwordx4 v5, a[12:15], s[16:17] offset:3072 sc1
  v_add_u32 v5, 0x1000, v5
  global_store_dwordx4 v5, a[16:19], s[16:17] offset:0 sc1
  global_store_dwordx4 v5, a[20:23], s[16:17] offset:1024 sc1
  global_store_dwordx4 v5, a[24:27], s[16:17] offset:2048 sc1
  global_store_dwordx4 v5, a[28:31], s[16:17] offset:3072 sc1
  v_add_u32 v5, 0x1000, v5
  global_store_dwordx4 v5, a[32:35], s[16:17] offset:0 sc1
  global_store_dwordx4 v5, a[36:39], s[16:17] offset:1024 sc1
  global_store_dwordx4 v5, a[40:43], s[16:17] offset:2048 sc1
  global_store_dwordx4 v5, a[44:47], s[16:17] offset:3072 sc1
  v_add_u32 v5, 0x1000, v5
  global_store_dwordx4 v5, a[48:51], s[16:17] offset:0 sc1
  global_store_dwordx4 v5, a[52:55], s[16:17] offset:1024 sc1
  global_store_dwordx4 v5, a[56:59], s[16:17] offset:2048 sc1
  global_store_dwordx4 v5, a[60:63], s[16:17] offset:3072 sc1
  v_add_u32 v5, 0x1000, v5
  s_waitcnt vmcnt(0)
  s_barrier
  s_cmp_lg_u32 s22, 0
  s_cbranch_scc1 bf2_skw
  s_lshl_b32 s12, s10, 2
  s_add_u32 s12, s12, 0x8c00200
  s_add_u32 s16, s6, s12
  s_addc_u32 s17, s7, 0
  v_mov_b32 v8, 0
  v_mov_b32 v9, 1
  s_mov_b64 s[56:57], exec
  s_mov_b64 exec, 1
  global_atomic_add v10, v8, v9, s[16:17] sc0
  s_waitcnt vmcnt(0)
  ds_write_b32 v8, v10
  s_waitcnt lgkmcnt(0)
  s_mov_b64 exec, s[56:57]
bf2_skw:
  s_barrier
  v_mov_b32 v8, 0
  ds_read_b32 v10, v8
  s_waitcnt lgkmcnt(0)
  s_nop 0
  v_readfirstlane_b32 s12, v10
  s_nop 3
  s_cmp_lg_u32 s12, 2
  s_cbranch_scc1 bf2_done
  v_add_u32 v5, 0, v1
  s_add_u32 s16, s14, 0
  s_addc_u32 s17, s15, 0
  global_load_dwordx4 v[8:11], v5, s[16:17] offset:0 sc1
  global_load_dwordx4 v[12:15], v5, s[16:17] offset:1024 sc1
  global_load_dwordx4 v[16:19], v5, s[16:17] offset:2048 sc1
  global_load_dwordx4 v[20:23], v5, s[16:17] offset:3072 sc1
  s_add_u32 s16, s14, 65536
  s_addc_u32 s17, s15, 0
  global_load_dwordx4 v[24:27], v5, s[16:17] offset:0 sc1
  global_load_dwordx4 v[28:31], v5, s[16:17] offset:1024 sc1
  global_load_dwordx4 v[32:35], v5, s[16:17] offset:2048 sc1
  global_load_dwordx4 v[36:39], v5, s[16:17] offset:3072 sc1
  s_add_u32 s16, s14, 131072
  s_addc_u32 s17, s15, 0
  global_load_dwordx4 v[40:43], v5, s[16:17] offset:0 sc1
  global_load_dwordx4 v[44:47], v5, s[16:17] offset:1024 sc1
  global_load_dwordx4 v[48:51], v5, s[16:17] offset:2048 sc1
  global_load_dwordx4 v[52:55], v5, s[16:17] offset:3072 sc1
  s_waitcnt vmcnt(0)
  v_pk_add_f32 v[8:9], v[8:9], v[24:25]
  v_pk_add_f32 v[10:11], v[10:11], v[26:27]
  v_pk_add_f32 v[12:13], v[12:13], v[28:29]
  v_pk_add_f32 v[14:15], v[14:15], v[30:31]
  v_pk_add_f32 v[16:17], v[16:17], v[32:33]
  v_pk_add_f32 v[18:19], v[18:19], v[34:35]
  v_pk_add_f32 v[20:21], v[20:21], v[36:37]
  v_pk_add_f32 v[22:23], v[22:23], v[38:39]
  v_pk_add_f32 v[8:9], v[8:9], v[40:41]
  v_pk_add_f32 v[10:11], v[10:11], v[42:43]
  v_pk_add_f32 v[12:13], v[12:13], v[44:45]
  v_pk_add_f32 v[14:15], v[14:15], v[46:47]
  v_pk_add_f32 v[16:17], v[16:17], v[48:49]
  v_pk_add_f32 v[18:19], v[18:19], v[50:51]
  v_pk_add_f32 v[20:21], v[20:21], v[52:53]
  v_pk_add_f32 v[22:23], v[22:23], v[54:55]
  v_accvgpr_write_b32 a0, v8
  v_accvgpr_write_b32 a1, v9
  v_accvgpr_write_b32 a2, v10
  v_accvgpr_write_b32 a3, v11
  v_accvgpr_write_b32 a4, v12
  v_accvgpr_write_b32 a5, v13
  v_accvgpr_write_b32 a6, v14
  v_accvgpr_write_b32 a7, v15
  v_accvgpr_write_b32 a8, v16
  v_accvgpr_write_b32 a9, v17
  v_accvgpr_write_b32 a10, v18
  v_accvgpr_write_b32 a11, v19
  v_accvgpr_write_b32 a12, v20
  v_accvgpr_write_b32 a13, v21
  v_accvgpr_write_b32 a14, v22
  v_accvgpr_write_b32 a15, v23
  v_add_u32 v5, 4096, v1
  s_add_u32 s16, s14, 0
  s_addc_u32 s17, s15, 0
  global_load_dwordx4 v[8:11], v5, s[16:17] offset:0 sc1
  global_load_dwordx4 v[12:15], v5, s[16:17] offset:1024 sc1
  global_load_dwordx4 v[16:19], v5, s[16:17] offset:2048 sc1
  global_load_dwordx4 v[20:23], v5, s[16:17] offset:3072 sc1
  s_add_u32 s16, s14, 65536
  s_addc_u32 s17, s15, 0
  global_load_dwordx4 v[24:27], v5, s[16:17] offset:0 sc1
  global_load_dwordx4 v[28:31], v5, s[16:17] offset:1024 sc1
  global_load_dwordx4 v[32:35], v5, s[16:17] offset:2048 sc1
  global_load_dwordx4 v[36:39], v5, s[16:17] offset:3072 sc1
  s_add_u32 s16, s14, 131072
  s_addc_u32 s17, s15, 0
  global_load_dwordx4 v[40:43], v5, s[16:17] offset:0 sc1
  global_load_dwordx4 v[44:47], v5, s[16:17] offset:1024 sc1
  global_load_dwordx4 v[48:51], v5, s[16:17] offset:2048 sc1
  global_load_dwordx4 v[52:55], v5, s[16:17] offset:3072 sc1
  s_waitcnt vmcnt(0)
  v_pk_add_f32 v[8:9], v[8:9], v[24:25]
  v_pk_add_f32 v[10:11], v[10:11], v[26:27]
  v_pk_add_f32 v[12:13], v[12:13], v[28:29]
  v_pk_add_f32 v[14:15], v[14:15], v[30:31]
  v_pk_add_f32 v[16:17], v[16:17], v[32:33]
  v_pk_add_f32 v[18:19], v[18:19], v[34:35]
  v_pk_add_f32 v[20:21], v[20:21], v[36:37]
  v_pk_add_f32 v[22:23], v[22:23], v[38:39]
  v_pk_add_f32 v[8:9], v[8:9], v[40:41]
  v_pk_add_f32 v[10:11], v[10:11], v[42:43]
  v_pk_add_f32 v[12:13], v[12:13], v[44:45]
  v_pk_add_f32 v[14:15], v[14:15], v[46:47]
  v_pk_add_f32 v[16:17], v[16:17], v[48:49]
  v_pk_add_f32 v[18:19], v[18:19], v[50:51]
  v_pk_add_f32 v[20:21], v[20:21], v[52:53]
  v_pk_add_f32 v[22:23], v[22:23], v[54:55]
  v_accvgpr_write_b32 a16, v8
  v_accvgpr_write_b32 a17, v9
  v_accvgpr_write_b32 a18, v10
  v_accvgpr_write_b32 a19, v11
  v_accvgpr_write_b32 a20, v12
  v_accvgpr_write_b32 a21, v13
  v_accvgpr_write_b32 a22, v14
  v_accvgpr_write_b32 a23, v15
  v_accvgpr_write_b32 a24, v16
  v_accvgpr_write_b32 a25, v17
  v_accvgpr_write_b32 a26, v18
  v_accvgpr_write_b32 a27, v19
  v_accvgpr_write_b32 a28, v20
  v_accvgpr_write_b32 a29, v21
  v_accvgpr_write_b32 a30, v22
  v_accvgpr_write_b32 a31, v23
  v_add_u32 v5, 8192, v1
  s_add_u32 s16, s14, 0
  s_addc_u32 s17, s15, 0
  global_load_dwordx4 v[8:11], v5, s[16:17] offset:0 sc1
  global_load_dwordx4 v[12:15], v5, s[16:17] offset:1024 sc1
  global_load_dwordx4 v[16:19], v5, s[16:17] offset:2048 sc1
  global_load_dwordx4 v[20:23], v5, s[16:17] offset:3072 sc1
  s_add_u32 s16, s14, 65536
  s_addc_u32 s17, s15, 0
  global_load_dwordx4 v[24:27], v5, s[16:17] offset:0 sc1
  global_load_dwordx4 v[28:31], v5, s[16:17] offset:1024 sc1
  global_load_dwordx4 v[32:35], v5, s[16:17] offset:2048 sc1
  global_load_dwordx4 v[36:39], v5, s[16:17] offset:3072 sc1
  s_add_u32 s16, s14, 131072
  s_addc_u32 s17, s15, 0
  global_load_dwordx4 v[40:43], v5, s[16:17] offset:0 sc1
  global_load_dwordx4 v[44:47], v5, s[16:17] offset:1024 sc1
  global_load_dwordx4 v[48:51], v5, s[16:17] offset:2048 sc1
  global_load_dwordx4 v[52:55], v5, s[16:17] offset:3072 sc1
  s_waitcnt vmcnt(0)
  v_pk_add_f32 v[8:9], v[8:9], v[24:25]
  v_pk_add_f32 v[10:11], v[10:11], v[26:27]
  v_pk_add_f32 v[12:13], v[12:13], v[28:29]
  v_pk_add_f32 v[14:15], v[14:15], v[30:31]
  v_pk_add_f32 v[16:17], v[16:17], v[32:33]
  v_pk_add_f32 v[18:19], v[18:19], v[34:35]
  v_pk_add_f32 v[20:21], v[20:21], v[36:37]
  v_pk_add_f32 v[22:23], v[22:23], v[38:39]
  v_pk_add_f32 v[8:9], v[8:9], v[40:41]
  v_pk_add_f32 v[10:11], v[10:11], v[42:43]
  v_pk_add_f32 v[12:13], v[12:13], v[44:45]
  v_pk_add_f32 v[14:15], v[14:15], v[46:47]
  v_pk_add_f32 v[16:17], v[16:17], v[48:49]
  v_pk_add_f32 v[18:19], v[18:19], v[50:51]
  v_pk_add_f32 v[20:21], v[20:21], v[52:53]
  v_pk_add_f32 v[22:23], v[22:23], v[54:55]
  v_accvgpr_write_b32 a32, v8
  v_accvgpr_write_b32 a33, v9
  v_accvgpr_write_b32 a34, v10
  v_accvgpr_write_b32 a35, v11
  v_accvgpr_write_b32 a36, v12
  v_accvgpr_write_b32 a37, v13
  v_accvgpr_write_b32 a38, v14
  v_accvgpr_write_b32 a39, v15
  v_accvgpr_write_b32 a40, v16
  v_accvgpr_write_b32 a41, v17
  v_accvgpr_write_b32 a42, v18
  v_accvgpr_write_b32 a43, v19
  v_accvgpr_write_b32 a44, v20
  v_accvgpr_write_b32 a45, v21
  v_accvgpr_write_b32 a46, v22
  v_accvgpr_write_b32 a47, v23
  v_add_u32 v5, 12288, v1
  s_add_u32 s16, s14, 0
  s_addc_u32 s17, s15, 0
  global_load_dwordx4 v[8:11], v5, s[16:17] offset:0 sc1
  global_load_dwordx4 v[12:15], v5, s[16:17] offset:1024 sc1
  global_load_dwordx4 v[16:19], v5, s[16:17] offset:2048 sc1
  global_load_dwordx4 v[20:23], v5, s[16:17] offset:3072 sc1
  s_add_u32 s16, s14, 65536
  s_addc_u32 s17, s15, 0
  global_load_dwordx4 v[24:27], v5, s[16:17] offset:0 sc1
  global_load_dwordx4 v[28:31], v5, s[16:17] offset:1024 sc1
  global_load_dwordx4 v[32:35], v5, s[16:17] offset:2048 sc1
  global_load_dwordx4 v[36:39], v5, s[16:17] offset:3072 sc1
  s_add_u32 s16, s14, 131072
  s_addc_u32 s17, s15, 0
  global_load_dwordx4 v[40:43], v5, s[16:17] offset:0 sc1
  global_load_dwordx4 v[44:47], v5, s[16:17] offset:1024 sc1
  global_load_dwordx4 v[48:51], v5, s[16:17] offset:2048 sc1
  global_load_dwordx4 v[52:55], v5, s[16:17] offset:3072 sc1
  s_waitcnt vmcnt(0)
  v_pk_add_f32 v[8:9], v[8:9], v[24:25]
  v_pk_add_f32 v[10:11], v[10:11], v[26:27]
  v_pk_add_f32 v[12:13], v[12:13], v[28:29]
  v_pk_add_f32 v[14:15], v[14:15], v[30:31]
  v_pk_add_f32 v[16:17], v[16:17], v[32:33]
  v_pk_add_f32 v[18:19], v[18:19], v[34:35]
  v_pk_add_f32 v[20:21], v[20:21], v[36:37]
  v_pk_add_f32 v[22:23], v[22:23], v[38:39]
  v_pk_add_f32 v[8:9], v[8:9], v[40:41]
  v_pk_add_f32 v[10:11], v[10:11], v[42:43]
  v_pk_add_f32 v[12:13], v[12:13], v[44:45]
  v_pk_add_f32 v[14:15], v[14:15], v[46:47]
  v_pk_add_f32 v[16:17], v[16:17], v[48:49]
  v_pk_add_f32 v[18:19], v[18:19], v[50:51]
  v_pk_add_f32 v[20:21], v[20:21], v[52:53]
  v_pk_add_f32 v[22:23], v[22:23], v[54:55]
  v_accvgpr_write_b32 a48, v8
  v_accvgpr_write_b32 a49, v9
  v_accvgpr_write_b32 a50, v10
  v_accvgpr_write_b32 a51, v11
  v_accvgpr_write_b32 a52, v12
  v_accvgpr_write_b32 a53, v13
  v_accvgpr_write_b32 a54, v14
  v_accvgpr_write_b32 a55, v15
  v_accvgpr_write_b32 a56, v16
  v_accvgpr_write_b32 a57, v17
  v_accvgpr_write_b32 a58, v18
  v_accvgpr_write_b32 a59, v19
  v_accvgpr_write_b32 a60, v20
  v_accvgpr_write_b32 a61, v21
  v_accvgpr_write_b32 a62, v22
  v_accvgpr_write_b32 a63, v23
  s_nop 1
  s_add_u32 s14, s6, 0x7000000
  s_addc_u32 s15, s7, 0
  v_and_b32 v5, 15, v0
  v_bfe_u32 v6, v0, 4, 2
  s_mul_i32 s10, s20, 8
  s_mul_i32 s11, s23, 4
  s_add_u32 s10, s10, s11
  s_lshl_b32 s10, s10, 4
  v_add_u32 v5, s10, v5
  v_mul_u32_u24 v5, 0x500, v5
  s_mul_i32 s10, s21, 8
  s_mul_i32 s11, s24, 4
  s_add_u32 s10, s10, s11
  s_lshl_b32 s10, s10, 5
  v_lshl_add_u32 v5, v6, 3, v5
  v_add_u32 v5, s10, v5
  s_mov_b32 s54, 0xffff0000
  global_load_dwordx2 v[32:33], v5, s[14:15] offset:0
  global_load_dwordx2 v[34:35], v5, s[14:15] offset:32
  global_load_dwordx2 v[36:37], v5, s[14:15] offset:64
  global_load_dwordx2 v[38:39], v5, s[14:15] offset:96
  v_add_u32 v5, 20480, v5
  global_load_dwordx2 v[40:41], v5, s[14:15] offset:0
  global_load_dwordx2 v[42:43], v5, s[14:15] offset:32
  global_load_dwordx2 v[44:45], v5, s[14:15] offset:64
  global_load_dwordx2 v[46:47], v5, s[14:15] offset:96
  v_add_u32 v5, 20480, v5
  global_load_dwordx2 v[48:49], v5, s[14:15] offset:0
  global_load_dwordx2 v[50:51], v5, s[14:15] offset:32
  global_load_dwordx2 v[52:53], v5, s[14:15] offset:64
  global_load_dwordx2 v[54:55], v5, s[14:15] offset:96
  v_add_u32 v5, 20480, v5
  global_load_dwordx2 v[56:57], v5, s[14:15] offset:0
  global_load_dwordx2 v[58:59], v5, s[14:15] offset:32
  global_load_dwordx2 v[60:61], v5, s[14:15] offset:64
  global_load_dwordx2 v[62:63], v5, s[14:15] offset:96
  v_subrev_u32 v5, 61440, v5
  v_accvgpr_read_b32 v8, a0
  v_accvgpr_read_b32 v9, a1
  v_accvgpr_read_b32 v10, a2
  v_accvgpr_read_b32 v11, a3
  v_cvt_pk_bf16_f32 v12, v8, v9
  v_cvt_pk_bf16_f32 v13, v10, v11
  v_lshlrev_b32 v8, 16, v12
  v_and_b32 v9, s54, v12
  v_lshlrev_b32 v10, 16, v13
  v_and_b32 v11, s54, v13
  s_waitcnt vmcnt(15)
  v_lshlrev_b32 v14, 16, v32
  v_and_b32 v15, s54, v32
  v_lshlrev_b32 v16, 16, v33
  v_and_b32 v17, s54, v33
  v_add_f32 v8, v8, v14
  v_add_f32 v9, v9, v15
  v_add_f32 v10, v10, v16
  v_add_f32 v11, v11, v17
  v_cvt_pk_bf16_f32 v20, v8, v9
  v_cvt_pk_bf16_f32 v21, v10, v11
  global_store_dwordx2 v5, v[20:21], s[8:9] offset:0
  v_accvgpr_read_b32 v8, a4
  v_accvgpr_read_b32 v9, a5
  v_accvgpr_read_b32 v10, a6
  v_accvgpr_read_b32 v11, a7
  v_cvt_pk_bf16_f32 v12, v8, v9
  v_cvt_pk_bf16_f32 v13, v10, v11
  v_lshlrev_b32 v8, 16, v12
  v_and_b32 v9, s54, v12
  v_lshlrev_b32 v10, 16, v13
  v_and_b32 v11, s54, v13
  s_waitcnt vmcnt(15)
  v_lshlrev_b32 v14, 16, v34
  v_and_b32 v15, s54, v34
  v_lshlrev_b32 v16, 16, v35
  v_and_b32 v17, s54, v35
  v_add_f32 v8, v8, v14
  v_add_f32 v9, v9, v15
  v_add_f32 v10, v10, v16
  v_add_f32 v11, v11, v17
  v_cvt_pk_bf16_f32 v22, v8, v9
  v_cvt_pk_bf16_f32 v23, v10, v11
  global_store_dwordx2 v5, v[22:23], s[8:9] offset:32
  v_accvgpr_read_b32 v8, a8
  v_accvgpr_read_b32 v9, a9
  v_accvgpr_read_b32 v10, a10
  v_accvgpr_read_b32 v11, a11
  v_cvt_pk_bf16_f32 v12, v8, v9
  v_cvt_pk_bf16_f32 v13, v10, v11
  v_lshlrev_b32 v8, 16, v12
  v_and_b32 v9, s54, v12
  v_lshlrev_b32 v10, 16, v13
  v_and_b32 v11, s54, v13
  s_waitcnt vmcnt(15)
  v_lshlrev_b32 v14, 16, v36
  v_and_b32 v15, s54, v36
  v_lshlrev_b32 v16, 16, v37
  v_and_b32 v17, s54, v37
  v_add_f32 v8, v8, v14
  v_add_f32 v9, v9, v15
  v_add_f32 v10, v10, v16
  v_add_f32 v11, v11, v17
  v_cvt_pk_bf16_f32 v24, v8, v9
  v_cvt_pk_bf16_f32 v25, v10, v11
  global_store_dwordx2 v5, v[24:25], s[8:9] offset:64
  v_accvgpr_read_b32 v8, a12
  v_accvgpr_read_b32 v9, a13
  v_accvgpr_read_b32 v10, a14
  v_accvgpr_read_b32 v11, a15
  v_cvt_pk_bf16_f32 v12, v8, v9
  v_cvt_pk_bf16_f32 v13, v10, v11
  v_lshlrev_b32 v8, 16, v12
  v_and_b32 v9, s54, v12
  v_lshlrev_b32 v10, 16, v13
  v_and_b32 v11, s54, v13
  s_waitcnt vmcnt(15)
  v_lshlrev_b32 v14, 16, v38
  v_and_b32 v15, s54, v38
  v_lshlrev_b32 v16, 16, v39
  v_and_b32 v17, s54, v39
  v_add_f32 v8, v8, v14
  v_add_f32 v9, v9, v15
  v_add_f32 v10, v10, v16
  v_add_f32 v11, v11, v17
  v_cvt_pk_bf16_f32 v26, v8, v9
  v_cvt_pk_bf16_f32 v27, v10, v11
  global_store_dwordx2 v5, v[26:27], s[8:9] offset:96
  v_add_u32 v5, 20480, v5
  v_accvgpr_read_b32 v8, a16
  v_accvgpr_read_b32 v9, a17
  v_accvgpr_read_b32 v10, a18
  v_accvgpr_read_b32 v11, a19
  v_cvt_pk_bf16_f32 v12, v8, v9
  v_cvt_pk_bf16_f32 v13, v10, v11
  v_lshlrev_b32 v8, 16, v12
  v_and_b32 v9, s54, v12
  v_lshlrev_b32 v10, 16, v13
  v_and_b32 v11, s54, v13
  s_waitcnt vmcnt(15)
  v_lshlrev_b32 v14, 16, v40
  v_and_b32 v15, s54, v40
  v_lshlrev_b32 v16, 16, v41
  v_and_b32 v17, s54, v41
  v_add_f32 v8, v8, v14
  v_add_f32 v9, v9, v15
  v_add_f32 v10, v10, v16
  v_add_f32 v11, v11, v17
  v_cvt_pk_bf16_f32 v20, v8, v9
  v_cvt_pk_bf16_f32 v21, v10, v11
  global_store_dwordx2 v5, v[20:21], s[8:9] offset:0
  v_accvgpr_read_b32 v8, a20
  v_accvgpr_read_b32 v9, a21
  v_accvgpr_read_b32 v10, a22
  v_accvgpr_read_b32 v11, a23
  v_cvt_pk_bf16_f32 v12, v8, v9
  v_cvt_pk_bf16_f32 v13, v10, v11
  v_lshlrev_b32 v8, 16, v12
  v_and_b32 v9, s54, v12
  v_lshlrev_b32 v10, 16, v13
  v_and_b32 v11, s54, v13
  s_waitcnt vmcnt(15)
  v_lshlrev_b32 v14, 16, v42
  v_and_b32 v15, s54, v42
  v_lshlrev_b32 v16, 16, v43
  v_and_b32 v17, s54, v43
  v_add_f32 v8, v8, v14
  v_add_f32 v9, v9, v15
  v_add_f32 v10, v10, v16
  v_add_f32 v11, v11, v17
  v_cvt_pk_bf16_f32 v22, v8, v9
  v_cvt_pk_bf16_f32 v23, v10, v11
  global_store_dwordx2 v5, v[22:23], s[8:9] offset:32
  v_accvgpr_read_b32 v8, a24
  v_accvgpr_read_b32 v9, a25
  v_accvgpr_read_b32 v10, a26
  v_accvgpr_read_b32 v11, a27
  v_cvt_pk_bf16_f32 v12, v8, v9
  v_cvt_pk_bf16_f32 v13, v10, v11
  v_lshlrev_b32 v8, 16, v12
  v_and_b32 v9, s54, v12
  v_lshlrev_b32 v10, 16, v13
  v_and_b32 v11, s54, v13
  s_waitcnt vmcnt(15)
  v_lshlrev_b32 v14, 16, v44
  v_and_b32 v15, s54, v44
  v_lshlrev_b32 v16, 16, v45
  v_and_b32 v17, s54, v45
  v_add_f32 v8, v8, v14
  v_add_f32 v9, v9, v15
  v_add_f32 v10, v10, v16
  v_add_f32 v11, v11, v17
  v_cvt_pk_bf16_f32 v24, v8, v9
  v_cvt_pk_bf16_f32 v25, v10, v11
  global_store_dwordx2 v5, v[24:25], s[8:9] offset:64
  v_accvgpr_read_b32 v8, a28
  v_accvgpr_read_b32 v9, a29
  v_accvgpr_read_b32 v10, a30
  v_accvgpr_read_b32 v11, a31
  v_cvt_pk_bf16_f32 v12, v8, v9
  v_cvt_pk_bf16_f32 v13, v10, v11
  v_lshlrev_b32 v8, 16, v12
  v_and_b32 v9, s54, v12
  v_lshlrev_b32 v10, 16, v13
  v_and_b32 v11, s54, v13
  s_waitcnt vmcnt(15)
  v_lshlrev_b32 v14, 16, v46
  v_and_b32 v15, s54, v46
  v_lshlrev_b32 v16, 16, v47
  v_and_b32 v17, s54, v47
  v_add_f32 v8, v8, v14
  v_add_f32 v9, v9, v15
  v_add_f32 v10, v10, v16
  v_add_f32 v11, v11, v17
  v_cvt_pk_bf16_f32 v26, v8, v9
  v_cvt_pk_bf16_f32 v27, v10, v11
  global_store_dwordx2 v5, v[26:27], s[8:9] offset:96
  v_add_u32 v5, 20480, v5
  v_accvgpr_read_b32 v8, a32
  v_accvgpr_read_b32 v9, a33
  v_accvgpr_read_b32 v10, a34
  v_accvgpr_read_b32 v11, a35
  v_cvt_pk_bf16_f32 v12, v8, v9
  v_cvt_pk_bf16_f32 v13, v10, v11
  v_lshlrev_b32 v8, 16, v12
  v_and_b32 v9, s54, v12
  v_lshlrev_b32 v10, 16, v13
  v_and_b32 v11, s54, v13
  s_waitcnt vmcnt(15)
  v_lshlrev_b32 v14, 16, v48
  v_and_b32 v15, s54, v48
  v_lshlrev_b32 v16, 16, v49
  v_and_b32 v17, s54, v49
  v_add_f32 v8, v8, v14
  v_add_f32 v9, v9, v15
  v_add_f32 v10, v10, v16
  v_add_f32 v11, v11, v17
  v_cvt_pk_bf16_f32 v20, v8, v9
  v_cvt_pk_bf16_f32 v21, v10, v11
  global_store_dwordx2 v5, v[20:21], s[8:9] offset:0
  v_accvgpr_read_b32 v8, a36
  v_accvgpr_read_b32 v9, a37
  v_accvgpr_read_b32 v10, a38
  v_accvgpr_read_b32 v11, a39
  v_cvt_pk_bf16_f32 v12, v8, v9
  v_cvt_pk_bf16_f32 v13, v10, v11
  v_lshlrev_b32 v8, 16, v12
  v_and_b32 v9, s54, v12
  v_lshlrev_b32 v10, 16, v13
  v_and_b32 v11, s54, v13
  s_waitcnt vmcnt(15)
  v_lshlrev_b32 v14, 16, v50
  v_and_b32 v15, s54, v50
  v_lshlrev_b32 v16, 16, v51
  v_and_b32 v17, s54, v51
  v_add_f32 v8, v8, v14
  v_add_f32 v9, v9, v15
  v_add_f32 v10, v10, v16
  v_add_f32 v11, v11, v17
  v_cvt_pk_bf16_f32 v22, v8, v9
  v_cvt_pk_bf16_f32 v23, v10, v11
  global_store_dwordx2 v5, v[22:23], s[8:9] offset:32
  v_accvgpr_read_b32 v8, a40
  v_accvgpr_read_b32 v9, a41
  v_accvgpr_read_b32 v10, a42
  v_accvgpr_read_b32 v11, a43
  v_cvt_pk_bf16_f32 v12, v8, v9
  v_cvt_pk_bf16_f32 v13, v10, v11
  v_lshlrev_b32 v8, 16, v12
  v_and_b32 v9, s54, v12
  v_lshlrev_b32 v10, 16, v13
  v_and_b32 v11, s54, v13
  s_waitcnt vmcnt(15)
  v_lshlrev_b32 v14, 16, v52
  v_and_b32 v15, s54, v52
  v_lshlrev_b32 v16, 16, v53
  v_and_b32 v17, s54, v53
  v_add_f32 v8, v8, v14
  v_add_f32 v9, v9, v15
  v_add_f32 v10, v10, v16
  v_add_f32 v11, v11, v17
  v_cvt_pk_bf16_f32 v24, v8, v9
  v_cvt_pk_bf16_f32 v25, v10, v11
  global_store_dwordx2 v5, v[24:25], s[8:9] offset:64
  v_accvgpr_read_b32 v8, a44
  v_accvgpr_read_b32 v9, a45
  v_accvgpr_read_b32 v10, a46
  v_accvgpr_read_b32 v11, a47
  v_cvt_pk_bf16_f32 v12, v8, v9
  v_cvt_pk_bf16_f32 v13, v10, v11
  v_lshlrev_b32 v8, 16, v12
  v_and_b32 v9, s54, v12
  v_lshlrev_b32 v10, 16, v13
  v_and_b32 v11, s54, v13
  s_waitcnt vmcnt(15)
  v_lshlrev_b32 v14, 16, v54
  v_and_b32 v15, s54, v54
  v_lshlrev_b32 v16, 16, v55
  v_and_b32 v17, s54, v55
  v_add_f32 v8, v8, v14
  v_add_f32 v9, v9, v15
  v_add_f32 v10, v10, v16
  v_add_f32 v11, v11, v17
  v_cvt_pk_bf16_f32 v26, v8, v9
  v_cvt_pk_bf16_f32 v27, v10, v11
  global_store_dwordx2 v5, v[26:27], s[8:9] offset:96
  v_add_u32 v5, 20480, v5
  v_accvgpr_read_b32 v8, a48
  v_accvgpr_read_b32 v9, a49
  v_accvgpr_read_b32 v10, a50
  v_accvgpr_read_b32 v11, a51
  v_cvt_pk_bf16_f32 v12, v8, v9
  v_cvt_pk_bf16_f32 v13, v10, v11
  v_lshlrev_b32 v8, 16, v12
  v_and_b32 v9, s54, v12
  v_lshlrev_b32 v10, 16, v13
  v_and_b32 v11, s54, v13
  s_waitcnt vmcnt(15)
  v_lshlrev_b32 v14, 16, v56
  v_and_b32 v15, s54, v56
  v_lshlrev_b32 v16, 16, v57
  v_and_b32 v17, s54, v57
  v_add_f32 v8, v8, v14
  v_add_f32 v9, v9, v15
  v_add_f32 v10, v10, v16
  v_add_f32 v11, v11, v17
  v_cvt_pk_bf16_f32 v20, v8, v9
  v_cvt_pk_bf16_f32 v21, v10, v11
  global_store_dwordx2 v5, v[20:21], s[8:9] offset:0
  v_accvgpr_read_b32 v8, a52
  v_accvgpr_read_b32 v9, a53
  v_accvgpr_read_b32 v10, a54
  v_accvgpr_read_b32 v11, a55
  v_cvt_pk_bf16_f32 v12, v8, v9
  v_cvt_pk_bf16_f32 v13, v10, v11
  v_lshlrev_b32 v8, 16, v12
  v_and_b32 v9, s54, v12
  v_lshlrev_b32 v10, 16, v13
  v_and_b32 v11, s54, v13
  s_waitcnt vmcnt(15)
  v_lshlrev_b32 v14, 16, v58
  v_and_b32 v15, s54, v58
  v_lshlrev_b32 v16, 16, v59
  v_and_b32 v17, s54, v59
  v_add_f32 v8, v8, v14
  v_add_f32 v9, v9, v15
  v_add_f32 v10, v10, v16
  v_add_f32 v11, v11, v17
  v_cvt_pk_bf16_f32 v22, v8, v9
  v_cvt_pk_bf16_f32 v23, v10, v11
  global_store_dwordx2 v5, v[22:23], s[8:9] offset:32
  v_accvgpr_read_b32 v8, a56
  v_accvgpr_read_b32 v9, a57
  v_accvgpr_read_b32 v10, a58
  v_accvgpr_read_b32 v11, a59
  v_cvt_pk_bf16_f32 v12, v8, v9
  v_cvt_pk_bf16_f32 v13, v10, v11
  v_lshlrev_b32 v8, 16, v12
  v_and_b32 v9, s54, v12
  v_lshlrev_b32 v10, 16, v13
  v_and_b32 v11, s54, v13
  s_waitcnt vmcnt(15)
  v_lshlrev_b32 v14, 16, v60
  v_and_b32 v15, s54, v60
  v_lshlrev_b32 v16, 16, v61
  v_and_b32 v17, s54, v61
  v_add_f32 v8, v8, v14
  v_add_f32 v9, v9, v15
  v_add_f32 v10, v10, v16
  v_add_f32 v11, v11, v17
  v_cvt_pk_bf16_f32 v24, v8, v9
  v_cvt_pk_bf16_f32 v25, v10, v11
  global_store_dwordx2 v5, v[24:25], s[8:9] offset:64
  v_accvgpr_read_b32 v8, a60
  v_accvgpr_read_b32 v9, a61
  v_accvgpr_read_b32 v10, a62
  v_accvgpr_read_b32 v11, a63
  v_cvt_pk_bf16_f32 v12, v8, v9
  v_cvt_pk_bf16_f32 v13, v10, v11
  v_lshlrev_b32 v8, 16, v12
  v_and_b32 v9, s54, v12
  v_lshlrev_b32 v10, 16, v13
  v_and_b32 v11, s54, v13
  s_waitcnt vmcnt(15)
  v_lshlrev_b32 v14, 16, v62
  v_and_b32 v15, s54, v62
  v_lshlrev_b32 v16, 16, v63
  v_and_b32 v17, s54, v63
  v_add_f32 v8, v8, v14
  v_add_f32 v9, v9, v15
  v_add_f32 v10, v10, v16
  v_add_f32 v11, v11, v17
  v_cvt_pk_bf16_f32 v26, v8, v9
  v_cvt_pk_bf16_f32 v27, v10, v11
  global_store_dwordx2 v5, v[26:27], s[8:9] offset:96
bf2_done:
  s_waitcnt vmcnt(0)
  s_branch dyn_loop
dyn_f1:
  s_sub_u32 s94, s92, 1
  s_cmp_ge_u32 s94, 12
  s_cbranch_scc1 dyn_loop
  s_lshl_b32 s95, s94, 2
  s_add_u32 s95, s95, 128
  s_cmp_lg_u32 s99, 0
  s_cbranch_scc1 dw1_w
  v_mov_b32 v8, s95
  s_mov_b32 s58, 0
dw1_p:
  global_load_dword v9, v8, s[90:91] sc1
  s_waitcnt vmcnt(0)
  v_readfirstlane_b32 s59, v9
  s_add_u32 s58, s58, 1
  s_cmp_gt_u32 s58, 100000
  s_cbranch_scc1 dw1_w
  s_cmp_ge_u32 s59, 16
  s_cbranch_scc1 dw1_w
  s_sleep 40
  s_branch dw1_p
dw1_w:
  s_barrier
  s_load_dwordx2 s[6:7], s[0:1], 104
  s_load_dwordx2 s[4:5], s[0:1], 0
  s_load_dwordx2 s[8:9], s[0:1], 88
  v_lshrrev_b32 v5, 6, v0
  v_and_b32 v6, 63, v0
  s_nop 0
  v_readfirstlane_b32 s22, v5
  v_lshlrev_b32 v1, 4, v6
  s_mov_b32 s20, s94
  s_sub_u32 s21, s93, 16
  s_mov_b32 s19, 0
  s_waitcnt lgkmcnt(0)
  s_lshr_b32 s23, s22, 1
  s_and_b32 s24, s22, 1
  s_add_u32 s25, s22, 0
  s_mul_i32 s26, s20, 8
  s_add_u32 s26, s26, s25
  s_mul_i32 s26, s26, 20480
  s_add_u32 s26, s26, 0x7400000
  s_mul_i32 s27, s21, 8
  s_add_u32 s27, s27, s25
  s_sub_u32 s27, s27, 8
  s_mul_i32 s27, s27, 20480
  s_add_u32 s27, s27, 0x1700000
  s_cmp_lt_u32 s25, 8
  s_cselect_b32 s26, s26, s27
  s_add_u32 s40, s6, s26
  s_addc_u32 s41, s7, 0
  s_add_u32 s25, s22, 4
  s_mul_i32 s26, s20, 8
  s_add_u32 s26, s26, s25
  s_mul_i32 s26, s26, 20480
  s_add_u32 s26, s26, 0x7400000
  s_mul_i32 s27, s21, 8
  s_add_u32 s27, s27, s25
  s_sub_u32 s27, s27, 8
  s_mul_i32 s27, s27, 20480
  s_add_u32 s27, s27, 0x1700000
  s_cmp_lt_u32 s25, 8
  s_cselect_b32 s26, s26, s27
  s_add_u32 s42, s6, s26
  s_addc_u32 s43, s7, 0
  s_add_u32 s25, s22, 8
  s_mul_i32 s26, s20, 8
  s_add_u32 s26, s26, s25
  s_mul_i32 s26, s26, 20480
  s_add_u32 s26, s26, 0x7400000
  s_mul_i32 s27, s21, 8
  s_add_u32 s27, s27, s25
  s_sub_u32 s27, s27, 8
  s_mul_i32 s27, s27, 20480
  s_add_u32 s27, s27, 0x1700000
  s_cmp_lt_u32 s25, 8
  s_cselect_b32 s26, s26, s27
  s_add_u32 s44, s6, s26
  s_addc_u32 s45, s7, 0
  s_add_u32 s25, s22, 12
  s_mul_i32 s26, s20, 8
  s_add_u32 s26, s26, s25
  s_mul_i32 s26, s26, 20480
  s_add_u32 s26, s26, 0x7400000
  s_mul_i32 s27, s21, 8
  s_add_u32 s27, s27, s25
  s_sub_u32 s27, s27, 8
  s_mul_i32 s27, s27, 20480
  s_add_u32 s27, s27, 0x1700000
  s_cmp_lt_u32 s25, 8
  s_cselect_b32 s26, s26, s27
  s_add_u32 s46, s6, s26
  s_addc_u32 s47, s7, 0
  s_mul_i32 s28, s22, 1024
  s_mul_i32 s25, s19, 0
  v_add_u32 v2, s25, v1
  s_mul_i32 s29, s23, 4096
  s_mul_i32 s30, s24, 4096
  s_add_u32 s30, s30, 8192
  s_mov_b32 s31, 0
  s_mov_b32 s32, 0
  s_add_u32 s33, s32, s28
  s_add_u32 m0, s33, 0
  s_nop 0
  global_load_lds_dwordx4 v2, s[40:41]
  s_add_u32 m0, s33, 4096
  s_nop 0
  global_load_lds_dwordx4 v2, s[42:43]
  s_add_u32 m0, s33, 8192
  s_nop 0
  global_load_lds_dwordx4 v2, s[44:45]
  s_add_u32 m0, s33, 12288
  s_nop 0
  global_load_lds_dwordx4 v2, s[46:47]
  v_add_u32 v2, 1024, v2
  s_add_u32 s32, s32, 16384
  s_cmp_ge_u32 s32, 65536
  s_cselect_b32 s32, 0, s32
  s_add_u32 s33, s32, s28
  s_add_u32 m0, s33, 0
  s_nop 0
  global_load_lds_dwordx4 v2, s[40:41]
  s_add_u32 m0, s33, 4096
  s_nop 0
  global_load_lds_dwordx4 v2, s[42:43]
  s_add_u32 m0, s33, 8192
  s_nop 0
  global_load_lds_dwordx4 v2, s[44:45]
  s_add_u32 m0, s33, 12288
  s_nop 0
  global_load_lds_dwordx4 v2, s[46:47]
  v_add_u32 v2, 1024, v2
  s_add_u32 s32, s32, 16384
  s_cmp_ge_u32 s32, 65536
  s_cselect_b32 s32, 0, s32
  s_add_u32 s33, s32, s28
  s_add_u32 m0, s33, 0
  s_nop 0
  global_load_lds_dwordx4 v2, s[40:41]
  s_add_u32 m0, s33, 4096
  s_nop 0
  global_load_lds_dwordx4 v2, s[42:43]
  s_add_u32 m0, s33, 8192
  s_nop 0
  global_load_lds_dwordx4 v2, s[44:45]
  s_add_u32 m0, s33, 12288
  s_nop 0
  global_load_lds_dwordx4 v2, s[46:47]
  v_add_u32 v2, 1024, v2
  s_add_u32 s32, s32, 16384
  s_cmp_ge_u32 s32, 65536
  s_cselect_b32 s32, 0, s32
  s_add_u32 s33, s32, s28
  s_add_u32 m0, s33, 0
  s_nop 0
  global_load_lds_dwordx4 v2, s[40:41]
  s_add_u32 m0, s33, 4096
  s_nop 0
  global_load_lds_dwordx4 v2, s[42:43]
  s_add_u32 m0, s33, 8192
  s_nop 0
  global_load_lds_dwordx4 v2, s[44:45]
  s_add_u32 m0, s33, 12288
  s_nop 0
  global_load_lds_dwordx4 v2, s[46:47]
  v_add_u32 v2, 1024, v2
  s_add_u32 s32, s32, 16384
  s_cmp_ge_u32 s32, 65536
  s_cselect_b32 s32, 0, s32
  v_accvgpr_write_b32 a0, 0
  v_accvgpr_write_b32 a1, 0
  v_accvgpr_write_b32 a2, 0
  v_accvgpr_write_b32 a3, 0
  v_accvgpr_write_b32 a4, 0
  v_accvgpr_write_b32 a5, 0
  v_accvgpr_write_b32 a6, 0
  v_accvgpr_write_b32 a7, 0
  v_accvgpr_write_b32 a8, 0
  v_accvgpr_write_b32 a9, 0
  v_accvgpr_write_b32 a10, 0
  v_accvgpr_write_b32 a11, 0
  v_accvgpr_write_b32 a12, 0
  v_accvgpr_write_b32 a13, 0
  v_accvgpr_write_b32 a14, 0
  v_accvgpr_write_b32 a15, 0
  v_accvgpr_write_b32 a16, 0
  v_accvgpr_write_b32 a17, 0
  v_accvgpr_write_b32 a18, 0
  v_accvgpr_write_b32 a19, 0
  v_accvgpr_write_b32 a20, 0
  v_accvgpr_write_b32 a21, 0
  v_accvgpr_write_b32 a22, 0
  v_accvgpr_write_b32 a23, 0
  v_accvgpr_write_b32 a24, 0
  v_accvgpr_write_b32 a25, 0
  v_accvgpr_write_b32 a26, 0
  v_accvgpr_write_b32 a27, 0
  v_accvgpr_write_b32 a28, 0
  v_accvgpr_write_b32 a29, 0
  v_accvgpr_write_b32 a30, 0
  v_accvgpr_write_b32 a31, 0
  v_accvgpr_write_b32 a32, 0
  v_accvgpr_write_b32 a33, 0
  v_accvgpr_write_b32 a34, 0
  v_accvgpr_write_b32 a35, 0
  v_accvgpr_write_b32 a36, 0
  v_accvgpr_write_b32 a37, 0
  v_accvgpr_write_b32 a38, 0
  v_accvgpr_write_b32 a39, 0
  v_accvgpr_write_b32 a40, 0
  v_accvgpr_write_b32 a41, 0
  v_accvgpr_write_b32 a42, 0
  v_accvgpr_write_b32 a43, 0
  v_accvgpr_write_b32 a44, 0
  v_accvgpr_write_b32 a45, 0
  v_accvgpr_write_b32 a46, 0
  v_accvgpr_write_b32 a47, 0
  v_accvgpr_write_b32 a48, 0
  v_accvgpr_write_b32 a49, 0
  v_accvgpr_write_b32 a50, 0
  v_accvgpr_write_b32 a51, 0
  v_accvgpr_write_b32 a52, 0
  v_accvgpr_write_b32 a53, 0
  v_accvgpr_write_b32 a54, 0
  v_accvgpr_write_b32 a55, 0
  v_accvgpr_write_b32 a56, 0
  v_accvgpr_write_b32 a57, 0
  v_accvgpr_write_b32 a58, 0
  v_accvgpr_write_b32 a59, 0
  v_accvgpr_write_b32 a60, 0
  v_accvgpr_write_b32 a61, 0
  v_accvgpr_write_b32 a62, 0
  v_accvgpr_write_b32 a63, 0
  s_waitcnt vmcnt(12)
  s_barrier
  s_add_u32 s34, s31, s29
  s_add_u32 s35, s31, s30
  v_add_u32 v3, s34, v1
  v_add_u32 v4, s35, v1
  ds_read_b128 v[8:11], v4 offset:0
  ds_read_b128 v[12:15], v4 offset:1024
  ds_read_b128 v[16:19], v4 offset:2048
  ds_read_b128 v[20:23], v4 offset:3072
  ds_read_b128 v[24:27], v3 offset:0
  ds_read_b128 v[28:31], v3 offset:1024
  ds_read_b128 v[32:35], v3 offset:2048
  ds_read_b128 v[36:39], v3 offset:3072
  s_add_u32 s31, s31, 16384
  s_cmp_ge_u32 s31, 65536
  s_cselect_b32 s31, 0, s31
  s_mov_b32 s36, 0
bf1_loop:
  s_waitcnt vmcnt(8) lgkmcnt(0)
  s_barrier
  v_mfma_f32_16x16x32_bf16 a[0:3], v[8:11], v[24:27], a[0:3]
  s_add_u32 s34, s31, s29
  s_add_u32 s35, s31, s30
  v_add_u32 v3, s34, v1
  v_add_u32 v4, s35, v1
  v_mfma_f32_16x16x32_bf16 a[4:7], v[12:15], v[24:27], a[4:7]
  ds_read_b128 v[40:43], v4 offset:0
  v_mfma_f32_16x16x32_bf16 a[8:11], v[16:19], v[24:27], a[8:11]
  ds_read_b128 v[44:47], v4 offset:1024
  v_mfma_f32_16x16x32_bf16 a[12:15], v[20:23], v[24:27], a[12:15]
  ds_read_b128 v[48:51], v4 offset:2048
  v_mfma_f32_16x16x32_bf16 a[16:19], v[8:11], v[28:31], a[16:19]
  ds_read_b128 v[52:55], v4 offset:3072
  v_mfma_f32_16x16x32_bf16 a[20:23], v[12:15], v[28:31], a[20:23]
  ds_read_b128 v[56:59], v3 offset:0
  v_mfma_f32_16x16x32_bf16 a[24:27], v[16:19], v[28:31], a[24:27]
  ds_read_b128 v[60:63], v3 offset:1024
  v_mfma_f32_16x16x32_bf16 a[28:31], v[20:23], v[28:31], a[28:31]
  ds_read_b128 v[64:67], v3 offset:2048
  v_mfma_f32_16x16x32_bf16 a[32:35], v[8:11], v[32:35], a[32:35]
  ds_read_b128 v[68:71], v3 offset:3072
  v_mfma_f32_16x16x32_bf16 a[36:39], v[12:15], v[32:35], a[36:39]
  s_add_u32 s31, s31, 16384
  s_cmp_ge_u32 s31, 65536
  s_cselect_b32 s31, 0, s31
  v_mfma_f32_16x16x32_bf16 a[40:43], v[16:19], v[32:35], a[40:43]
  s_add_u32 s33, s32, s28
  v_mfma_f32_16x16x32_bf16 a[44:47], v[20:23], v[32:35], a[44:47]
  s_add_u32 m0, s33, 0
  s_nop 0
  global_load_lds_dwordx4 v2, s[40:41]
  v_mfma_f32_16x16x32_bf16 a[48:51], v[8:11], v[36:39], a[48:51]
  s_add_u32 m0, s33, 4096
  s_nop 0
  global_load_lds_dwordx4 v2, s[42:43]
  v_mfma_f32_16x16x32_bf16 a[52:55], v[12:15], v[36:39], a[52:55]
  s_add_u32 m0, s33, 8192
  s_nop 0
  global_load_lds_dwordx4 v2, s[44:45]
  v_mfma_f32_16x16x32_bf16 a[56:59], v[16:19], v[36:39], a[56:59]
  s_add_u32 m0, s33, 12288
  s_nop 0
  global_load_lds_dwordx4 v2, s[46:47]
  v_mfma_f32_16x16x32_bf16 a[60:63], v[20:23], v[36:39], a[60:63]
  v_add_u32 v2, 1024, v2
  s_add_u32 s32, s32, 16384
  s_cmp_ge_u32 s32, 65536
  s_cselect_b32 s32, 0, s32
  s_waitcnt vmcnt(8) lgkmcnt(0)
  s_barrier
  v_mfma_f32_16x16x32_bf16 a[0:3], v[40:43], v[56:59], a[0:3]
  s_add_u32 s34, s31, s29
  s_add_u32 s35, s31, s30
  v_add_u32 v3, s34, v1
  v_add_u32 v4, s35, v1
  v_mfma_f32_16x16x32_bf16 a[4:7], v[44:47], v[56:59], a[4:7]
  ds_read_b128 v[8:11], v4 offset:0
  v_mfma_f32_16x16x32_bf16 a[8:11], v[48:51], v[56:59], a[8:11]
  ds_read_b128 v[12:15], v4 offset:1024
  v_mfma_f32_16x16x32_bf16 a[12:15], v[52:55], v[56:59], a[12:15]
  ds_read_b128 v[16:19], v4 offset:2048
  v_mfma_f32_16x16x32_bf16 a[16:19], v[40:43], v[60:63], a[16:19]
  ds_read_b128 v[20:23], v4 offset:3072
  v_mfma_f32_16x16x32_bf16 a[20:23], v[44:47], v[60:63], a[20:23]
  ds_read_b128 v[24:27], v3 offset:0
  v_mfma_f32_16x16x32_bf16 a[24:27], v[48:51], v[60:63], a[24:27]
  ds_read_b128 v[28:31], v3 offset:1024
  v_mfma_f32_16x16x32_bf16 a[28:31], v[52:55], v[60:63], a[28:31]
  ds_read_b128 v[32:35], v3 offset:2048
  v_mfma_f32_16x16x32_bf16 a[32:35], v[40:43], v[64:67], a[32:35]
  ds_read_b128 v[36:39], v3 offset:3072
  v_mfma_f32_16x16x32_bf16 a[36:39], v[44:47], v[64:67], a[36:39]
  s_add_u32 s31, s31, 16384
  s_cmp_ge_u32 s31, 65536
  s_cselect_b32 s31, 0, s31
  v_mfma_f32_16x16x32_bf16 a[40:43], v[48:51], v[64:67], a[40:43]
  s_add_u32 s33, s32, s28
  v_mfma_f32_16x16x32_bf16 a[44:47], v[52:55], v[64:67], a[44:47]
  s_add_u32 m0, s33, 0
  s_nop 0
  global_load_lds_dwordx4 v2, s[40:41]
  v_mfma_f32_16x16x32_bf16 a[48:51], v[40:43], v[68:71], a[48:51]
  s_add_u32 m0, s33, 4096
  s_nop 0
  global_load_lds_dwordx4 v2, s[42:43]
  v_mfma_f32_16x16x32_bf16 a[52:55], v[44:47], v[68:71], a[52:55]
  s_add_u32 m0, s33, 8192
  s_nop 0
  global_load_lds_dwordx4 v2, s[44:45]
  v_mfma_f32_16x16x32_bf16 a[56:59], v[48:51], v[68:71], a[56:59]
  s_add_u32 m0, s33, 12288
  s_nop 0
  global_load_lds_dwordx4 v2, s[46:47]
  v_mfma_f32_16x16x32_bf16 a[60:63], v[52:55], v[68:71], a[60:63]
  v_add_u32 v2, 1024, v2
  s_add_u32 s32, s32, 16384
  s_cmp_ge_u32 s32, 65536
  s_cselect_b32 s32, 0, s32
  s_add_u32 s36, s36, 2
  s_cmp_lt_u32 s36, 16
  s_cbranch_scc1 bf1_loop
  s_waitcnt vmcnt(8) lgkmcnt(0)
  s_barrier
  v_mfma_f32_16x16x32_bf16 a[0:3], v[8:11], v[24:27], a[0:3]
  s_add_u32 s34, s31, s29
  s_add_u32 s35, s31, s30
  v_add_u32 v3, s34, v1
  v_add_u32 v4, s35, v1
  v_mfma_f32_16x16x32_bf16 a[4:7], v[12:15], v[24:27], a[4:7]
  ds_read_b128 v[40:43], v4 offset:0
  v_mfma_f32_16x16x32_bf16 a[8:11], v[16:19], v[24:27], a[8:11]
  v_mfma_f32_16x16x32_bf16 a[12:15], v[20:23], v[24:27], a[12:15]
  ds_read_b128 v[44:47], v4 offset:1024
  v_mfma_f32_16x16x32_bf16 a[16:19], v[8:11], v[28:31], a[16:19]
  ds_read_b128 v[48:51], v4 offset:2048
  v_mfma_f32_16x16x32_bf16 a[20:23], v[12:15], v[28:31], a[20:23]
  v_mfma_f32_16x16x32_bf16 a[24:27], v[16:19], v[28:31], a[24:27]
  ds_read_b128 v[52:55], v4 offset:3072
  v_mfma_f32_16x16x32_bf16 a[28:31], v[20:23], v[28:31], a[28:31]
  v_mfma_f32_16x16x32_bf16 a[32:35], v[8:11], v[32:35], a[32:35]
  ds_read_b128 v[56:59], v3 offset:0
  v_mfma_f32_16x16x32_bf16 a[36:39], v[12:15], v[32:35], a[36:39]
  ds_read_b128 v[60:63], v3 offset:1024
  v_mfma_f32_16x16x32_bf16 a[40:43], v[16:19], v[32:35], a[40:43]
  v_mfma_f32_16x16x32_bf16 a[44:47], v[20:23], v[32:35], a[44:47]
  ds_read_b128 v[64:67], v3 offset:2048
  v_mfma_f32_16x16x32_bf16 a[48:51], v[8:11], v[36:39], a[48:51]
  ds_read_b128 v[68:71], v3 offset:3072
  v_mfma_f32_16x16x32_bf16 a[52:55], v[12:15], v[36:39], a[52:55]
  v_mfma_f32_16x16x32_bf16 a[56:59], v[16:19], v[36:39], a[56:59]
  s_add_u32 s31, s31, 16384
  s_cmp_ge_u32 s31, 65536
  s_cselect_b32 s31, 0, s31
  v_mfma_f32_16x16x32_bf16 a[60:63], v[20:23], v[36:39], a[60:63]
  s_waitcnt vmcnt(4) lgkmcnt(0)
  s_barrier
  v_mfma_f32_16x16x32_bf16 a[0:3], v[40:43], v[56:59], a[0:3]
  s_add_u32 s34, s31, s29
  s_add_u32 s35, s31, s30
  v_add_u32 v3, s34, v1
  v_add_u32 v4, s35, v1
  v_mfma_f32_16x16x32_bf16 a[4:7], v[44:47], v[56:59], a[4:7]
  ds_read_b128 v[8:11], v4 offset:0
  v_mfma_f32_16x16x32_bf16 a[8:11], v[48:51], v[56:59], a[8:11]
  v_mfma_f32_16x16x32_bf16 a[12:15], v[52:55], v[56:59], a[12:15]
  ds_read_b128 v[12:15], v4 offset:1024
  v_mfma_f32_16x16x32_bf16 a[16:19], v[40:43], v[60:63], a[16:19]
  ds_read_b128 v[16:19], v4 offset:2048
  v_mfma_f32_16x16x32_bf16 a[20:23], v[44:47], v[60:63], a[20:23]
  v_mfma_f32_16x16x32_bf16 a[24:27], v[48:51], v[60:63], a[24:27]
  ds_read_b128 v[20:23], v4 offset:3072
  v_mfma_f32_16x16x32_bf16 a[28:31], v[52:55], v[60:63], a[28:31]
  v_mfma_f32_16x16x32_bf16 a[32:35], v[40:43], v[64:67], a[32:35]
  ds_read_b128 v[24:27], v3 offset:0
  v_mfma_f32_16x16x32_bf16 a[36:39], v[44:47], v[64:67], a[36:39]
  ds_read_b128 v[28:31], v3 offset:1024
  v_mfma_f32_16x16x32_bf16 a[40:43], v[48:51], v[64:67], a[40:43]
  v_mfma_f32_16x16x32_bf16 a[44:47], v[52:55], v[64:67], a[44:47]
  ds_read_b128 v[32:35], v3 offset:2048
  v_mfma_f32_16x16x32_bf16 a[48:51], v[40:43], v[68:71], a[48:51]
  ds_read_b128 v[36:39], v3 offset:3072
  v_mfma_f32_16x16x32_bf16 a[52:55], v[44:47], v[68:71], a[52:55]
  v_mfma_f32_16x16x32_bf16 a[56:59], v[48:51], v[68:71], a[56:59]
  s_add_u32 s31, s31, 16384
  s_cmp_ge_u32 s31, 65536
  s_cselect_b32 s31, 0, s31
  v_mfma_f32_16x16x32_bf16 a[60:63], v[52:55], v[68:71], a[60:63]
  s_waitcnt vmcnt(0) lgkmcnt(0)
  s_barrier
  v_mfma_f32_16x16x32_bf16 a[0:3], v[8:11], v[24:27], a[0:3]
  s_add_u32 s34, s31, s29
  s_add_u32 s35, s31, s30
  v_add_u32 v3, s34, v1
  v_add_u32 v4, s35, v1
  v_mfma_f32_16x16x32_bf16 a[4:7], v[12:15], v[24:27], a[4:7]
  ds_read_b128 v[40:43], v4 offset:0
  v_mfma_f32_16x16x32_bf16 a[8:11], v[16:19], v[24:27], a[8:11]
  v_mfma_f32_16x16x32_bf16 a[12:15], v[20:23], v[24:27], a[12:15]
  ds_read_b128 v[44:47], v4 offset:1024
  v_mfma_f32_16x16x32_bf16 a[16:19], v[8:11], v[28:31], a[16:19]
  ds_read_b128 v[48:51], v4 offset:2048
  v_mfma_f32_16x16x32_bf16 a[20:23], v[12:15], v[28:31], a[20:23]
  v_mfma_f32_16x16x32_bf16 a[24:27], v[16:19], v[28:31], a[24:27]
  ds_read_b128 v[52:55], v4 offset:3072
  v_mfma_f32_16x16x32_bf16 a[28:31], v[20:23], v[28:31], a[28:31]
  v_mfma_f32_16x16x32_bf16 a[32:35], v[8:11], v[32:35], a[32:35]
  ds_read_b128 v[56:59], v3 offset:0
  v_mfma_f32_16x16x32_bf16 a[36:39], v[12:15], v[32:35], a[36:39]
  ds_read_b128 v[60:63], v3 offset:1024
  v_mfma_f32_16x16x32_bf16 a[40:43], v[16:19], v[32:35], a[40:43]
  v_mfma_f32_16x16x32_bf16 a[44:47], v[20:23], v[32:35], a[44:47]
  ds_read_b128 v[64:67], v3 offset:2048
  v_mfma_f32_16x16x32_bf16 a[48:51], v[8:11], v[36:39], a[48:51]
  ds_read_b128 v[68:71], v3 offset:3072
  v_mfma_f32_16x16x32_bf16 a[52:55], v[12:15], v[36:39], a[52:55]
  v_mfma_f32_16x16x32_bf16 a[56:59], v[16:19], v[36:39], a[56:59]
  s_add_u32 s31, s31, 16384
  s_cmp_ge_u32 s31, 65536
  s_cselect_b32 s31, 0, s31
  v_mfma_f32_16x16x32_bf16 a[60:63], v[20:23], v[36:39], a[60:63]
  s_waitcnt lgkmcnt(0)
  v_mfma_f32_16x16x32_bf16 a[0:3], v[40:43], v[56:59], a[0:3]
  v_mfma_f32_16x16x32_bf16 a[4:7], v[44:47], v[56:59], a[4:7]
  v_mfma_f32_16x16x32_bf16 a[8:11], v[48:51], v[56:59], a[8:11]
  v_mfma_f32_16x16x32_bf16 a[12:15], v[52:55], v[56:59], a[12:15]
  v_mfma_f32_16x16x32_bf16 a[16:19], v[40:43], v[60:63], a[16:19]
  v_mfma_f32_16x16x32_bf16 a[20:23], v[44:47], v[60:63], a[20:23]
  v_mfma_f32_16x16x32_bf16 a[24:27], v[48:51], v[60:63], a[24:27]
  v_mfma_f32_16x16x32_bf16 a[28:31], v[52:55], v[60:63], a[28:31]
  v_mfma_f32_16x16x32_bf16 a[32:35], v[40:43], v[64:67], a[32:35]
  v_mfma_f32_16x16x32_bf16 a[36:39], v[44:47], v[64:67], a[36:39]
  v_mfma_f32_16x16x32_bf16 a[40:43], v[48:51], v[64:67], a[40:43]
  v_mfma_f32_16x16x32_bf16 a[44:47], v[52:55], v[64:67], a[44:47]
  v_mfma_f32_16x16x32_bf16 a[48:51], v[40:43], v[68:71], a[48:51]
  v_mfma_f32_16x16x32_bf16 a[52:55], v[44:47], v[68:71], a[52:55]
  v_mfma_f32_16x16x32_bf16 a[56:59], v[48:51], v[68:71], a[56:59]
  v_mfma_f32_16x16x32_bf16 a[60:63], v[52:55], v[68:71], a[60:63]
  s_nop 7
  s_nop 3
  s_lshl_b32 s10, s20, 3
  s_lshl_b32 s11, s23, 2
  s_add_u32 s10, s10, s11
  s_mul_i32 s10, s10, 54
  s_lshl_b32 s11, s21, 1
  s_add_u32 s10, s10, s11
  s_add_u32 s10, s10, s24
  s_lshl_b32 s10, s10, 10
  s_add_u32 s10, s10, 0x7800000
  s_add_u32 s14, s6, s10
  s_addc_u32 s15, s7, 0
  s_mov_b32 s54, 0xffff0000
  v_accvgpr_read_b32 v8, a0
  v_accvgpr_read_b32 v12, a8
  v_accvgpr_read_b32 v9, a1
  v_accvgpr_read_b32 v13, a9
  v_accvgpr_read_b32 v10, a2
  v_accvgpr_read_b32 v14, a10
  v_accvgpr_read_b32 v11, a3
  v_accvgpr_read_b32 v15, a11
  v_cvt_pk_bf16_f32 v16, v8, v9
  v_cvt_pk_bf16_f32 v17, v10, v11
  v_cvt_pk_bf16_f32 v18, v12, v13
  v_cvt_pk_bf16_f32 v19, v14, v15
  v_lshlrev_b32 v8, 16, v16
  v_and_b32 v9, s54, v16
  v_lshlrev_b32 v10, 16, v17
  v_and_b32 v11, s54, v17
  v_lshlrev_b32 v12, 16, v18
  v_and_b32 v13, s54, v18
  v_lshlrev_b32 v14, 16, v19
  v_and_b32 v15, s54, v19
  v_max_f32 v8, 0, v8
  v_max_f32 v9, 0, v9
  v_max_f32 v10, 0, v10
  v_max_f32 v11, 0, v11
  v_mul_f32 v8, v8, v12
  v_mul_f32 v9, v9, v13
  v_mul_f32 v10, v10, v14
  v_mul_f32 v11, v11, v15
  v_cvt_pk_bf16_f32 v20, v8, v9
  v_cvt_pk_bf16_f32 v21, v10, v11
  v_accvgpr_read_b32 v8, a4
  v_accvgpr_read_b32 v12, a12
  v_accvgpr_read_b32 v9, a5
  v_accvgpr_read_b32 v13, a13
  v_accvgpr_read_b32 v10, a6
  v_accvgpr_read_b32 v14, a14
  v_accvgpr_read_b32 v11, a7
  v_accvgpr_read_b32 v15, a15
  v_cvt_pk_bf16_f32 v16, v8, v9
  v_cvt_pk_bf16_f32 v17, v10, v11
  v_cvt_pk_bf16_f32 v18, v12, v13
  v_cvt_pk_bf16_f32 v19, v14, v15
  v_lshlrev_b32 v8, 16, v16
  v_and_b32 v9, s54, v16
  v_lshlrev_b32 v10, 16, v17
  v_and_b32 v11, s54, v17
  v_lshlrev_b32 v12, 16, v18
  v_and_b32 v13, s54, v18
  v_lshlrev_b32 v14, 16, v19
  v_and_b32 v15, s54, v19
  v_max_f32 v8, 0, v8
  v_max_f32 v9, 0, v9
  v_max_f32 v10, 0, v10
  v_max_f32 v11, 0, v11
  v_mul_f32 v8, v8, v12
  v_mul_f32 v9, v9, v13
  v_mul_f32 v10, v10, v14
  v_mul_f32 v11, v11, v15
  v_cvt_pk_bf16_f32 v22, v8, v9
  v_cvt_pk_bf16_f32 v23, v10, v11
  global_store_dwordx4 v1, v[20:23], s[14:15] sc1
  s_add_u32 s14, s14, 55296
  s_addc_u32 s15, s15, 0
  v_accvgpr_read_b32 v8, a16
  v_accvgpr_read_b32 v12, a24
  v_accvgpr_read_b32 v9, a17
  v_accvgpr_read_b32 v13, a25
  v_accvgpr_read_b32 v10, a18
  v_accvgpr_read_b32 v14, a26
  v_accvgpr_read_b32 v11, a19
  v_accvgpr_read_b32 v15, a27
  v_cvt_pk_bf16_f32 v16, v8, v9
  v_cvt_pk_bf16_f32 v17, v10, v11
  v_cvt_pk_bf16_f32 v18, v12, v13
  v_cvt_pk_bf16_f32 v19, v14, v15
  v_lshlrev_b32 v8, 16, v16
  v_and_b32 v9, s54, v16
  v_lshlrev_b32 v10, 16, v17
  v_and_b32 v11, s54, v17
  v_lshlrev_b32 v12, 16, v18
  v_and_b32 v13, s54, v18
  v_lshlrev_b32 v14, 16, v19
  v_and_b32 v15, s54, v19
  v_max_f32 v8, 0, v8
  v_max_f32 v9, 0, v9
  v_max_f32 v10, 0, v10
  v_max_f32 v11, 0, v11
  v_mul_f32 v8, v8, v12
  v_mul_f32 v9, v9, v13
  v_mul_f32 v10, v10, v14
  v_mul_f32 v11, v11, v15
  v_cvt_pk_bf16_f32 v24, v8, v9
  v_cvt_pk_bf16_f32 v25, v10, v11
  v_accvgpr_read_b32 v8, a20
  v_accvgpr_read_b32 v12, a28
  v_accvgpr_read_b32 v9, a21
  v_accvgpr_read_b32 v13, a29
  v_accvgpr_read_b32 v10, a22
  v_accvgpr_read_b32 v14, a30
  v_accvgpr_read_b32 v11, a23
  v_accvgpr_read_b32 v15, a31
  v_cvt_pk_bf16_f32 v16, v8, v9
  v_cvt_pk_bf16_f32 v17, v10, v11
  v_cvt_pk_bf16_f32 v18, v12, v13
  v_cvt_pk_bf16_f32 v19, v14, v15
  v_lshlrev_b32 v8, 16, v16
  v_and_b32 v9, s54, v16
  v_lshlrev_b32 v10, 16, v17
  v_and_b32 v11, s54, v17
  v_lshlrev_b32 v12, 16, v18
  v_and_b32 v13, s54, v18
  v_lshlrev_b32 v14, 16, v19
  v_and_b32 v15, s54, v19
  v_max_f32 v8, 0, v8
  v_max_f32 v9, 0, v9
  v_max_f32 v10, 0, v10
  v_max_f32 v11, 0, v11
  v_mul_f32 v8, v8, v12
  v_mul_f32 v9, v9, v13
  v_mul_f32 v10, v10, v14
  v_mul_f32 v11, v11, v15
  v_cvt_pk_bf16_f32 v26, v8, v9
  v_cvt_pk_bf16_f32 v27, v10, v11
  global_store_dwordx4 v1, v[24:27], s[14:15] sc1
  s_add_u32 s14, s14, 55296
  s_addc_u32 s15, s15, 0
  v_accvgpr_read_b32 v8, a32
  v_accvgpr_read_b32 v12, a40
  v_accvgpr_read_b32 v9, a33
  v_accvgpr_read_b32 v13, a41
  v_accvgpr_read_b32 v10, a34
  v_accvgpr_read_b32 v14, a42
  v_accvgpr_read_b32 v11, a35
  v_accvgpr_read_b32 v15, a43
  v_cvt_pk_bf16_f32 v16, v8, v9
  v_cvt_pk_bf16_f32 v17, v10, v11
  v_cvt_pk_bf16_f32 v18, v12, v13
  v_cvt_pk_bf16_f32 v19, v14, v15
  v_lshlrev_b32 v8, 16, v16
  v_and_b32 v9, s54, v16
  v_lshlrev_b32 v10, 16, v17
  v_and_b32 v11, s54, v17
  v_lshlrev_b32 v12, 16, v18
  v_and_b32 v13, s54, v18
  v_lshlrev_b32 v14, 16, v19
  v_and_b32 v15, s54, v19
  v_max_f32 v8, 0, v8
  v_max_f32 v9, 0, v9
  v_max_f32 v10, 0, v10
  v_max_f32 v11, 0, v11
  v_mul_f32 v8, v8, v12
  v_mul_f32 v9, v9, v13
  v_mul_f32 v10, v10, v14
  v_mul_f32 v11, v11, v15
  v_cvt_pk_bf16_f32 v20, v8, v9
  v_cvt_pk_bf16_f32 v21, v10, v11
  v_accvgpr_read_b32 v8, a36
  v_accvgpr_read_b32 v12, a44
  v_accvgpr_read_b32 v9, a37
  v_accvgpr_read_b32 v13, a45
  v_accvgpr_read_b32 v10, a38
  v_accvgpr_read_b32 v14, a46
  v_accvgpr_read_b32 v11, a39
  v_accvgpr_read_b32 v15, a47
  v_cvt_pk_bf16_f32 v16, v8, v9
  v_cvt_pk_bf16_f32 v17, v10, v11
  v_cvt_pk_bf16_f32 v18, v12, v13
  v_cvt_pk_bf16_f32 v19, v14, v15
  v_lshlrev_b32 v8, 16, v16
  v_and_b32 v9, s54, v16
  v_lshlrev_b32 v10, 16, v17
  v_and_b32 v11, s54, v17
  v_lshlrev_b32 v12, 16, v18
  v_and_b32 v13, s54, v18
  v_lshlrev_b32 v14, 16, v19
  v_and_b32 v15, s54, v19
  v_max_f32 v8, 0, v8
  v_max_f32 v9, 0, v9
  v_max_f32 v10, 0, v10
  v_max_f32 v11, 0, v11
  v_mul_f32 v8, v8, v12
  v_mul_f32 v9, v9, v13
  v_mul_f32 v10, v10, v14
  v_mul_f32 v11, v11, v15
  v_cvt_pk_bf16_f32 v22, v8, v9
  v_cvt_pk_bf16_f32 v23, v10, v11
  global_store_dwordx4 v1, v[20:23], s[14:15] sc1
  s_add_u32 s14, s14, 55296
  s_addc_u32 s15, s15, 0
  v_accvgpr_read_b32 v8, a48
  v_accvgpr_read_b32 v12, a56
  v_accvgpr_read_b32 v9, a49
  v_accvgpr_read_b32 v13, a57
  v_accvgpr_read_b32 v10, a50
  v_accvgpr_read_b32 v14, a58
  v_accvgpr_read_b32 v11, a51
  v_accvgpr_read_b32 v15, a59
  v_cvt_pk_bf16_f32 v16, v8, v9
  v_cvt_pk_bf16_f32 v17, v10, v11
  v_cvt_pk_bf16_f32 v18, v12, v13
  v_cvt_pk_bf16_f32 v19, v14, v15
  v_lshlrev_b32 v8, 16, v16
  v_and_b32 v9, s54, v16
  v_lshlrev_b32 v10, 16, v17
  v_and_b32 v11, s54, v17
  v_lshlrev_b32 v12, 16, v18
  v_and_b32 v13, s54, v18
  v_lshlrev_b32 v14, 16, v19
  v_and_b32 v15, s54, v19
  v_max_f32 v8, 0, v8
  v_max_f32 v9, 0, v9
  v_max_f32 v10, 0, v10
  v_max_f32 v11, 0, v11
  v_mul_f32 v8, v8, v12
  v_mul_f32 v9, v9, v13
  v_mul_f32 v10, v10, v14
  v_mul_f32 v11, v11, v15
  v_cvt_pk_bf16_f32 v24, v8, v9
  v_cvt_pk_bf16_f32 v25, v10, v11
  v_accvgpr_read_b32 v8, a52
  v_accvgpr_read_b32 v12, a60
  v_accvgpr_read_b32 v9, a53
  v_accvgpr_read_b32 v13, a61
  v_accvgpr_read_b32 v10, a54
  v_accvgpr_read_b32 v14, a62
  v_accvgpr_read_b32 v11, a55
  v_accvgpr_read_b32 v15, a63
  v_cvt_pk_bf16_f32 v16, v8, v9
  v_cvt_pk_bf16_f32 v17, v10, v11
  v_cvt_pk_bf16_f32 v18, v12, v13
  v_cvt_pk_bf16_f32 v19, v14, v15
  v_lshlrev_b32 v8, 16, v16
  v_and_b32 v9, s54, v16
  v_lshlrev_b32 v10, 16, v17
  v_and_b32 v11, s54, v17
  v_lshlrev_b32 v12, 16, v18
  v_and_b32 v13, s54, v18
  v_lshlrev_b32 v14, 16, v19
  v_and_b32 v15, s54, v19
  v_max_f32 v8, 0, v8
  v_max_f32 v9, 0, v9
  v_max_f32 v10, 0, v10
  v_max_f32 v11, 0, v11
  v_mul_f32 v8, v8, v12
  v_mul_f32 v9, v9, v13
  v_mul_f32 v10, v10, v14
  v_mul_f32 v11, v11, v15
  v_cvt_pk_bf16_f32 v26, v8, v9
  v_cvt_pk_bf16_f32 v27, v10, v11
  global_store_dwordx4 v1, v[24:27], s[14:15] sc1
  s_add_u32 s14, s14, 55296
  s_addc_u32 s15, s15, 0
  s_lshl_b32 s95, s94, 2
  s_add_u32 s95, s95, 192
  s_waitcnt vmcnt(0)
  s_barrier
  s_cmp_lg_u32 s99, 0
  s_cbranch_scc1 dyn_loop
  s_load_dwordx2 s[6:7], s[0:1], 104
  s_waitcnt lgkmcnt(0)
  s_add_u32 s12, s6, 0x8c00400
  s_addc_u32 s13, s7, 0
  v_mov_b32 v8, s95
  v_mov_b32 v9, 1
  s_mov_b64 s[56:57], exec
  s_mov_b64 exec, 1
  global_atomic_add v8, v9, s[12:13]
  s_mov_b64 exec, s[56:57]
  s_branch dyn_loop
dyn_awl:
  s_lshl_b32 s45, s92, 1
  s_lshr_b32 s94, s93, 3
  s_add_u32 s45, s45, s94
  s_and_b32 s44, s93, 7
  s_cmp_ge_u32 s45, 24
  s_cbranch_scc1 dyn_loop
  s_lshl_b32 s95, s45, 2
  s_cmp_lg_u32 s99, 0
  s_cbranch_scc1 dwa_w
  v_mov_b32 v8, s95
  s_mov_b32 s58, 0
dwa_p:
  global_load_dword v9, v8, s[90:91] sc1
  s_waitcnt vmcnt(0)
  v_readfirstlane_b32 s59, v9
  s_add_u32 s58, s58, 1
  s_cmp_gt_u32 s58, 100000
  s_cbranch_scc1 dwa_w
  s_cmp_ge_u32 s59, 256
  s_cbranch_scc1 dwa_w
  s_sleep 40
  s_branch dwa_p
dwa_w:
  s_barrier
  s_lshr_b32 s94, s45, 2
  s_lshl_b32 s95, s94, 2
  s_add_u32 s95, s95, 256
  s_cmp_lg_u32 s99, 0
  s_cbranch_scc1 dwq_w
  v_mov_b32 v8, s95
  s_mov_b32 s58, 0
dwq_p:
  global_load_dword v9, v8, s[90:91] sc1
  s_waitcnt vmcnt(0)
  v_readfirstlane_b32 s59, v9
  s_add_u32 s58, s58, 1
  s_cmp_gt_u32 s58, 100000
  s_cbranch_scc1 dwq_w
  s_cmp_ge_u32 s59, 32
  s_cbranch_scc1 dwq_w
  s_sleep 40
  s_branch dwq_p
dwq_w:
  s_barrier
  s_cmp_eq_u32 s94, 0
  s_cbranch_scc1 dyn_awl_go
  s_lshl_b32 s95, s94, 2
  s_add_u32 s95, s95, 128
  s_cmp_lg_u32 s99, 0
  s_cbranch_scc1 dwk_w
  v_mov_b32 v8, s95
  s_mov_b32 s58, 0
dwk_p:
  global_load_dword v9, v8, s[70:71] sc1
  s_waitcnt vmcnt(0)
  v_readfirstlane_b32 s59, v9
  s_add_u32 s58, s58, 1
  s_cmp_gt_u32 s58, 100000
  s_cbranch_scc1 dwk_w
  s_cmp_ge_u32 s59, 64
  s_cbranch_scc1 dwk_w
  s_sleep 40
  s_branch dwk_p
dwk_w:
  s_barrier
dyn_awl_go:
  s_mov_b32 s96, s45
  s_load_dwordx2 s[6:7], s[0:1], 104
  s_load_dwordx2 s[4:5], s[0:1], 0
  v_lshrrev_b32 v2, 6, v0
  v_and_b32 v3, 63, v0
  s_nop 0
  v_readfirstlane_b32 s8, v2
  v_lshlrev_b32 v1, 4, v3
  v_lshlrev_b32 v7, 3, v3
  v_and_b32 v4, 15, v3
  v_lshrrev_b32 v5, 4, v3
  v_add_u32 v6, 0x1000, v1
  s_mov_b32 s52, 0x3db504f3
  s_mov_b32 s53, 0x3fb8aa3b
  s_mov_b32 s54, 0xffff0000
  v_mov_b32 v8, 0xff800000
  v_lshlrev_b32 v9, 2, v5
  s_waitcnt lgkmcnt(0)
  s_mul_i32 s10, s8, 1290
  s_lshl_b32 s11, s44, 4
  s_add_u32 s10, s10, s11
  s_lshl_b32 s10, s10, 10
  s_add_u32 s10, s10, 0x1180000
  s_add_u32 s60, s6, s10
  s_addc_u32 s61, s7, 0
  s_add_u32 s62, s60, 132096
  s_addc_u32 s63, s61, 0
  s_add_u32 s64, s62, 132096
  s_addc_u32 s65, s63, 0
  s_add_u32 s66, s64, 132096
  s_addc_u32 s67, s65, 0
  s_add_u32 s68, s66, 132096
  s_addc_u32 s69, s67, 0
  s_add_u32 s70, s68, 132096
  s_addc_u32 s71, s69, 0
  s_add_u32 s72, s70, 132096
  s_addc_u32 s73, s71, 0
  s_add_u32 s74, s72, 132096
  s_addc_u32 s75, s73, 0
  s_add_u32 s76, s74, 132096
  s_addc_u32 s77, s75, 0
  s_add_u32 s78, s76, 132096
  s_addc_u32 s79, s77, 0
  s_lshl_b32 s41, s44, 2
  s_add_u32 s41, s41, s8
  s_lshl_b32 s40, s45, 1
  s_lshl_b32 s42, s8, 12
  s_lshl_b32 s9, s40, 5
  s_add_u32 s9, s9, s41
  s_lshl_b32 s10, s9, 13
  s_add_u32 s11, s10, 0x2000000
  s_add_u32 s12, s6, s11
  s_addc_u32 s13, s7, 0
  s_add_u32 s11, s10, 0x3000000
  s_add_u32 s14, s6, s11
  s_addc_u32 s15, s7, 0
  s_add_u32 s11, s10, 0x4000000
  s_add_u32 s16, s6, s11
  s_addc_u32 s17, s7, 0
  s_lshl_b32 s10, s9, 12
  s_add_u32 s11, s10, 0xc000000
  s_add_u32 s18, s6, s11
  s_addc_u32 s19, s7, 0
  s_add_u32 s11, s10, 0xc800000
  s_add_u32 s20, s6, s11
  s_addc_u32 s21, s7, 0
  global_load_dwordx4 v[16:19], v1, s[12:13] offset:0
  global_load_dwordx4 v[48:51], v1, s[14:15] offset:0
  global_load_dwordx4 v[20:23], v1, s[12:13] offset:1024
  global_load_dwordx4 v[52:55], v1, s[14:15] offset:1024
  global_load_dwordx4 v[24:27], v1, s[12:13] offset:2048
  global_load_dwordx4 v[56:59], v1, s[14:15] offset:2048
  global_load_dwordx4 v[28:31], v1, s[12:13] offset:3072
  global_load_dwordx4 v[60:63], v1, s[14:15] offset:3072
  global_load_dwordx4 v[32:35], v6, s[12:13] offset:0
  global_load_dwordx4 v[64:67], v6, s[14:15] offset:0
  global_load_dwordx4 v[36:39], v6, s[12:13] offset:1024
  global_load_dwordx4 v[68:71], v6, s[14:15] offset:1024
  global_load_dwordx4 v[40:43], v6, s[12:13] offset:2048
  global_load_dwordx4 v[72:75], v6, s[14:15] offset:2048
  global_load_dwordx4 v[44:47], v6, s[12:13] offset:3072
  global_load_dwordx4 v[76:79], v6, s[14:15] offset:3072
  global_load_dwordx4 v[80:83], v1, s[18:19] offset:0
  global_load_dwordx4 v[84:87], v1, s[18:19] offset:1024
  global_load_dwordx4 v[88:91], v1, s[18:19] offset:2048
  global_load_dwordx4 v[92:95], v1, s[18:19] offset:3072
  global_load_dwordx4 v[96:99], v1, s[16:17] offset:0
  global_load_dwordx4 v[100:103], v1, s[16:17] offset:1024
  global_load_dwordx4 v[104:107], v1, s[16:17] offset:2048
  global_load_dwordx4 v[108:111], v1, s[16:17] offset:3072
  global_load_dwordx4 v[112:115], v6, s[16:17] offset:0
  global_load_dwordx4 v[116:119], v6, s[16:17] offset:1024
  global_load_dwordx4 v[120:123], v6, s[16:17] offset:2048
  global_load_dwordx4 v[124:127], v6, s[16:17] offset:3072
  global_load_dwordx2 v[128:129], v7, s[20:21] offset:0
  global_load_dwordx2 v[130:131], v7, s[20:21] offset:512
  global_load_dwordx2 v[132:133], v7, s[20:21] offset:1024
  global_load_dwordx2 v[134:135], v7, s[20:21] offset:1536
  global_load_dwordx2 v[136:137], v7, s[20:21] offset:2048
  global_load_dwordx2 v[138:139], v7, s[20:21] offset:2560
  global_load_dwordx2 v[140:141], v7, s[20:21] offset:3072
  global_load_dwordx2 v[142:143], v7, s[20:21] offset:3584
  s_add_u32 s40, s40, 1
  s_lshl_b32 s9, s40, 5
  s_add_u32 s9, s9, s41
  s_lshl_b32 s10, s9, 13
  s_add_u32 s11, s10, 0x2000000
  s_add_u32 s12, s6, s11
  s_addc_u32 s13, s7, 0
  s_add_u32 s11, s10, 0x3000000
  s_add_u32 s14, s6, s11
  s_addc_u32 s15, s7, 0
  s_add_u32 s11, s10, 0x4000000
  s_add_u32 s16, s6, s11
  s_addc_u32 s17, s7, 0
  s_lshl_b32 s10, s9, 12
  s_add_u32 s11, s10, 0xc000000
  s_add_u32 s18, s6, s11
  s_addc_u32 s19, s7, 0
  s_add_u32 s11, s10, 0xc800000
  s_add_u32 s20, s6, s11
  s_addc_u32 s21, s7, 0
  global_load_dwordx4 a[0:3], v1, s[12:13] offset:0
  global_load_dwordx4 a[32:35], v1, s[14:15] offset:0
  global_load_dwordx4 a[4:7], v1, s[12:13] offset:1024
  global_load_dwordx4 a[36:39], v1, s[14:15] offset:1024
  global_load_dwordx4 a[8:11], v1, s[12:13] offset:2048
  global_load_dwordx4 a[40:43], v1, s[14:15] offset:2048
  global_load_dwordx4 a[12:15], v1, s[12:13] offset:3072
  global_load_dwordx4 a[44:47], v1, s[14:15] offset:3072
  global_load_dwordx4 a[16:19], v6, s[12:13] offset:0
  global_load_dwordx4 a[48:51], v6, s[14:15] offset:0
  global_load_dwordx4 a[20:23], v6, s[12:13] offset:1024
  global_load_dwordx4 a[52:55], v6, s[14:15] offset:1024
  global_load_dwordx4 a[24:27], v6, s[12:13] offset:2048
  global_load_dwordx4 a[56:59], v6, s[14:15] offset:2048
  global_load_dwordx4 a[28:31], v6, s[12:13] offset:3072
  global_load_dwordx4 a[60:63], v6, s[14:15] offset:3072
  global_load_dwordx4 a[64:67], v1, s[18:19] offset:0
  global_load_dwordx4 a[68:71], v1, s[18:19] offset:1024
  global_load_dwordx4 a[72:75], v1, s[18:19] offset:2048
  global_load_dwordx4 a[76:79], v1, s[18:19] offset:3072
  global_load_dwordx4 a[80:83], v1, s[16:17] offset:0
  global_load_dwordx4 a[84:87], v1, s[16:17] offset:1024
  global_load_dwordx4 a[88:91], v1, s[16:17] offset:2048
  global_load_dwordx4 a[92:95], v1, s[16:17] offset:3072
  global_load_dwordx4 a[96:99], v6, s[16:17] offset:0
  global_load_dwordx4 a[100:103], v6, s[16:17] offset:1024
  global_load_dwordx4 a[104:107], v6, s[16:17] offset:2048
  global_load_dwordx4 a[108:111], v6, s[16:17] offset:3072
  global_load_dwordx2 a[112:113], v7, s[20:21] offset:0
  global_load_dwordx2 a[114:115], v7, s[20:21] offset:512
  global_load_dwordx2 a[116:117], v7, s[20:21] offset:1024
  global_load_dwordx2 a[118:119], v7, s[20:21] offset:1536
  global_load_dwordx2 a[120:121], v7, s[20:21] offset:2048
  global_load_dwordx2 a[122:123], v7, s[20:21] offset:2560
  global_load_dwordx2 a[124:125], v7, s[20:21] offset:3072
  global_load_dwordx2 a[126:127], v7, s[20:21] offset:3584
  s_waitcnt vmcnt(52)
  v_mfma_f32_16x16x32_bf16 v[144:147], v[80:83], v[16:19], 0
  v_mfma_f32_16x16x32_bf16 v[148:151], v[48:51], v[16:19], 0
  v_mfma_f32_16x16x32_bf16 v[152:155], v[80:83], v[20:23], 0
  v_mfma_f32_16x16x32_bf16 v[156:159], v[48:51], v[20:23], 0
  v_mfma_f32_16x16x32_bf16 v[160:163], v[52:55], v[20:23], 0
  v_mfma_f32_16x16x32_bf16 v[144:147], v[84:87], v[24:27], v[144:147]
  v_mfma_f32_16x16x32_bf16 v[148:151], v[56:59], v[24:27], v[148:151]
  v_mfma_f32_16x16x32_bf16 v[152:155], v[84:87], v[28:31], v[152:155]
  v_mfma_f32_16x16x32_bf16 v[156:159], v[56:59], v[28:31], v[156:159]
  v_mfma_f32_16x16x32_bf16 v[160:163], v[60:63], v[28:31], v[160:163]
  v_mfma_f32_16x16x32_bf16 v[144:147], v[88:91], v[32:35], v[144:147]
  v_mfma_f32_16x16x32_bf16 v[148:151], v[64:67], v[32:35], v[148:151]
  v_mfma_f32_16x16x32_bf16 v[152:155], v[88:91], v[36:39], v[152:155]
  v_mfma_f32_16x16x32_bf16 v[156:159], v[64:67], v[36:39], v[156:159]
  v_mfma_f32_16x16x32_bf16 v[160:163], v[68:71], v[36:39], v[160:163]
  v_mfma_f32_16x16x32_bf16 v[144:147], v[92:95], v[40:43], v[144:147]
  v_mfma_f32_16x16x32_bf16 v[148:151], v[72:75], v[40:43], v[148:151]
  v_mfma_f32_16x16x32_bf16 v[152:155], v[92:95], v[44:47], v[152:155]
  v_mfma_f32_16x16x32_bf16 v[156:159], v[72:75], v[44:47], v[156:159]
  v_mfma_f32_16x16x32_bf16 v[160:163], v[76:79], v[44:47], v[160:163]
  s_nop 7
  v_cvt_pk_bf16_f32 v10, v144, v145
  v_lshlrev_b32 v144, 16, v10
  v_and_b32 v145, s54, v10
  v_mul_f32 v144, s52, v144
  v_mul_f32 v145, s52, v145
  v_cvt_pk_bf16_f32 v10, v144, v145
  v_lshlrev_b32 v144, 16, v10
  v_and_b32 v145, s54, v10
  v_cvt_pk_bf16_f32 v10, v146, v147
  v_lshlrev_b32 v146, 16, v10
  v_and_b32 v147, s54, v10
  v_mul_f32 v146, s52, v146
  v_mul_f32 v147, s52, v147
  v_cvt_pk_bf16_f32 v10, v146, v147
  v_lshlrev_b32 v146, 16, v10
  v_and_b32 v147, s54, v10
  v_cvt_pk_bf16_f32 v10, v148, v149
  v_lshlrev_b32 v148, 16, v10
  v_and_b32 v149, s54, v10
  v_mul_f32 v148, s52, v148
  v_mul_f32 v149, s52, v149
  v_cvt_pk_bf16_f32 v10, v148, v149
  v_lshlrev_b32 v148, 16, v10
  v_and_b32 v149, s54, v10
  v_cvt_pk_bf16_f32 v10, v150, v151
  v_lshlrev_b32 v150, 16, v10
  v_and_b32 v151, s54, v10
  v_mul_f32 v150, s52, v150
  v_mul_f32 v151, s52, v151
  v_cvt_pk_bf16_f32 v10, v150, v151
  v_lshlrev_b32 v150, 16, v10
  v_and_b32 v151, s54, v10
  v_cvt_pk_bf16_f32 v10, v152, v153
  v_lshlrev_b32 v152, 16, v10
  v_and_b32 v153, s54, v10
  v_mul_f32 v152, s52, v152
  v_mul_f32 v153, s52, v153
  v_cvt_pk_bf16_f32 v10, v152, v153
  v_lshlrev_b32 v152, 16, v10
  v_and_b32 v153, s54, v10
  v_cvt_pk_bf16_f32 v10, v154, v155
  v_lshlrev_b32 v154, 16, v10
  v_and_b32 v155, s54, v10
  v_mul_f32 v154, s52, v154
  v_mul_f32 v155, s52, v155
  v_cvt_pk_bf16_f32 v10, v154, v155
  v_lshlrev_b32 v154, 16, v10
  v_and_b32 v155, s54, v10
  v_cvt_pk_bf16_f32 v10, v156, v157
  v_lshlrev_b32 v156, 16, v10
  v_and_b32 v157, s54, v10
  v_mul_f32 v156, s52, v156
  v_mul_f32 v157, s52, v157
  v_cvt_pk_bf16_f32 v10, v156, v157
  v_lshlrev_b32 v156, 16, v10
  v_and_b32 v157, s54, v10
  v_cvt_pk_bf16_f32 v10, v158, v159
  v_lshlrev_b32 v158, 16, v10
  v_and_b32 v159, s54, v10
  v_mul_f32 v158, s52, v158
  v_mul_f32 v159, s52, v159
  v_cvt_pk_bf16_f32 v10, v158, v159
  v_lshlrev_b32 v158, 16, v10
  v_and_b32 v159, s54, v10
  v_cvt_pk_bf16_f32 v10, v160, v161
  v_lshlrev_b32 v160, 16, v10
  v_and_b32 v161, s54, v10
  v_mul_f32 v160, s52, v160
  v_mul_f32 v161, s52, v161
  v_cvt_pk_bf16_f32 v10, v160, v161
  v_lshlrev_b32 v160, 16, v10
  v_and_b32 v161, s54, v10
  v_cvt_pk_bf16_f32 v10, v162, v163
  v_lshlrev_b32 v162, 16, v10
  v_and_b32 v163, s54, v10
  v_mul_f32 v162, s52, v162
  v_mul_f32 v163, s52, v163
  v_cvt_pk_bf16_f32 v10, v162, v163
  v_lshlrev_b32 v162, 16, v10
  v_and_b32 v163, s54, v10
  v_cmp_lt_u32 vcc, 31, v3
  s_nop 1
  v_cndmask_b32 v144, v144, v8, vcc
  v_cndmask_b32 v145, v145, v8, vcc
  v_cndmask_b32 v146, v146, v8, vcc
  v_cndmask_b32 v147, v147, v8, vcc
  v_cndmask_b32 v152, v152, v8, vcc
  v_cndmask_b32 v153, v153, v8, vcc
  v_cndmask_b32 v154, v154, v8, vcc
  v_cndmask_b32 v155, v155, v8, vcc
  v_add_u32 v10, 0, v9
  v_cmp_gt_u32 vcc, v10, v4
  s_nop 1
  v_cndmask_b32 v148, v148, v8, vcc
  v_cndmask_b32 v160, v160, v8, vcc
  v_add_u32 v10, 1, v9
  v_cmp_gt_u32 vcc, v10, v4
  s_nop 1
  v_cndmask_b32 v149, v149, v8, vcc
  v_cndmask_b32 v161, v161, v8, vcc
  v_add_u32 v10, 2, v9
  v_cmp_gt_u32 vcc, v10, v4
  s_nop 1
  v_cndmask_b32 v150, v150, v8, vcc
  v_cndmask_b32 v162, v162, v8, vcc
  v_add_u32 v10, 3, v9
  v_cmp_gt_u32 vcc, v10, v4
  s_nop 1
  v_cndmask_b32 v151, v151, v8, vcc
  v_cndmask_b32 v163, v163, v8, vcc
  v_max3_f32 v10, v144, v145, v146
  v_max3_f32 v10, v10, v147, v148
  v_max3_f32 v10, v10, v149, v150
  v_max_f32 v10, v10, v151
  s_nop 1
  v_mov_b32 v11, v10
  s_nop 1
  v_permlane16_swap_b32 v10, v11
  v_max_f32 v10, v10, v11
  s_nop 1
  v_mov_b32 v11, v10
  s_nop 1
  v_permlane32_swap_b32 v10, v11
  v_max_f32 v10, v10, v11
  v_sub_f32 v144, v144, v10
  v_mul_f32 v144, s53, v144
  v_sub_f32 v145, v145, v10
  v_mul_f32 v145, s53, v145
  v_sub_f32 v146, v146, v10
  v_mul_f32 v146, s53, v146
  v_sub_f32 v147, v147, v10
  v_mul_f32 v147, s53, v147
  v_sub_f32 v148, v148, v10
  v_mul_f32 v148, s53, v148
  v_sub_f32 v149, v149, v10
  v_mul_f32 v149, s53, v149
  v_sub_f32 v150, v150, v10
  v_mul_f32 v150, s53, v150
  v_sub_f32 v151, v151, v10
  v_mul_f32 v151, s53, v151
  v_exp_f32 v144, v144
  v_exp_f32 v145, v145
  v_exp_f32 v146, v146
  v_exp_f32 v147, v147
  v_exp_f32 v148, v148
  v_exp_f32 v149, v149
  v_exp_f32 v150, v150
  v_exp_f32 v151, v151
  s_nop 0
  v_add_f32 v10, v144, v145
  v_add_f32 v10, v10, v146
  v_add_f32 v10, v10, v147
  v_add_f32 v10, v10, v148
  v_add_f32 v10, v10, v149
  v_add_f32 v10, v10, v150
  v_add_f32 v10, v10, v151
  s_nop 1
  v_mov_b32 v11, v10
  s_nop 1
  v_permlane16_swap_b32 v10, v11
  v_add_f32 v10, v10, v11
  s_nop 1
  v_mov_b32 v11, v10
  s_nop 1
  v_permlane32_swap_b32 v10, v11
  v_add_f32 v10, v10, v11
  v_rcp_f32 v11, v10
  s_nop 0
  v_fma_f32 v12, -v10, v11, 1.0
  v_fma_f32 v11, v12, v11, v11
  v_mul_f32 v144, v144, v11
  v_mul_f32 v145, v145, v11
  v_mul_f32 v146, v146, v11
  v_mul_f32 v147, v147, v11
  v_mul_f32 v148, v148, v11
  v_mul_f32 v149, v149, v11
  v_mul_f32 v150, v150, v11
  v_mul_f32 v151, v151, v11
  v_max3_f32 v10, v152, v153, v154
  v_max3_f32 v10, v10, v155, v156
  v_max3_f32 v10, v10, v157, v158
  v_max3_f32 v10, v10, v159, v160
  v_max3_f32 v10, v10, v161, v162
  v_max_f32 v10, v10, v163
  s_nop 1
  v_mov_b32 v11, v10
  s_nop 1
  v_permlane16_swap_b32 v10, v11
  v_max_f32 v10, v10, v11
  s_nop 1
  v_mov_b32 v11, v10
  s_nop 1
  v_permlane32_swap_b32 v10, v11
  v_max_f32 v10, v10, v11
  v_sub_f32 v152, v152, v10
  v_mul_f32 v152, s53, v152
  v_sub_f32 v153, v153, v10
  v_mul_f32 v153, s53, v153
  v_sub_f32 v154, v154, v10
  v_mul_f32 v154, s53, v154
  v_sub_f32 v155, v155, v10
  v_mul_f32 v155, s53, v155
  v_sub_f32 v156, v156, v10
  v_mul_f32 v156, s53, v156
  v_sub_f32 v157, v157, v10
  v_mul_f32 v157, s53, v157
  v_sub_f32 v158, v158, v10
  v_mul_f32 v158, s53, v158
  v_sub_f32 v159, v159, v10
  v_mul_f32 v159, s53, v159
  v_sub_f32 v160, v160, v10
  v_mul_f32 v160, s53, v160
  v_sub_f32 v161, v161, v10
  v_mul_f32 v161, s53, v161
  v_sub_f32 v162, v162, v10
  v_mul_f32 v162, s53, v162
  v_sub_f32 v163, v163, v10
  v_mul_f32 v163, s53, v163
  v_exp_f32 v152, v152
  v_exp_f32 v153, v153
  v_exp_f32 v154, v154
  v_exp_f32 v155, v155
  v_exp_f32 v156, v156
  v_exp_f32 v157, v157
  v_exp_f32 v158, v158
  v_exp_f32 v159, v159
  v_exp_f32 v160, v160
  v_exp_f32 v161, v161
  v_exp_f32 v162, v162
  v_exp_f32 v163, v163
  s_nop 0
  v_add_f32 v10, v152, v153
  v_add_f32 v10, v10, v154
  v_add_f32 v10, v10, v155
  v_add_f32 v10, v10, v156
  v_add_f32 v10, v10, v157
  v_add_f32 v10, v10, v158
  v_add_f32 v10, v10, v159
  v_add_f32 v10, v10, v160
  v_add_f32 v10, v10, v161
  v_add_f32 v10, v10, v162
  v_add_f32 v10, v10, v163
  s_nop 1
  v_mov_b32 v11, v10
  s_nop 1
  v_permlane16_swap_b32 v10, v11
  v_add_f32 v10, v10, v11
  s_nop 1
  v_mov_b32 v11, v10
  s_nop 1
  v_permlane32_swap_b32 v10, v11
  v_add_f32 v10, v10, v11
  v_rcp_f32 v11, v10
  s_nop 0
  v_fma_f32 v12, -v10, v11, 1.0
  v_fma_f32 v11, v12, v11, v11
  v_mul_f32 v152, v152, v11
  v_mul_f32 v153, v153, v11
  v_mul_f32 v154, v154, v11
  v_mul_f32 v155, v155, v11
  v_mul_f32 v156, v156, v11
  v_mul_f32 v157, v157, v11
  v_mul_f32 v158, v158, v11
  v_mul_f32 v159, v159, v11
  v_mul_f32 v160, v160, v11
  v_mul_f32 v161, v161, v11
  v_mul_f32 v162, v162, v11
  v_mul_f32 v163, v163, v11
  v_cvt_pk_bf16_f32 v164, v144, v145
  v_cvt_pk_bf16_f32 v165, v146, v147
  v_cvt_pk_bf16_f32 v166, v148, v149
  v_cvt_pk_bf16_f32 v167, v150, v151
  v_mov_b32 v168, 0
  v_mov_b32 v169, 0
  v_cvt_pk_bf16_f32 v170, v152, v153
  v_cvt_pk_bf16_f32 v171, v154, v155
  v_cvt_pk_bf16_f32 v172, v156, v157
  v_cvt_pk_bf16_f32 v173, v158, v159
  v_cvt_pk_bf16_f32 v174, v160, v161
  v_cvt_pk_bf16_f32 v175, v162, v163
  s_waitcnt vmcnt(36)
  v_mfma_f32_16x16x16_bf16 v[16:19], v[128:129], v[164:165], 0
  v_mfma_f32_16x16x16_bf16 v[20:23], v[130:131], v[164:165], 0
  v_mfma_f32_16x16x16_bf16 v[24:27], v[132:133], v[164:165], 0
  v_mfma_f32_16x16x16_bf16 v[28:31], v[134:135], v[164:165], 0
  v_mfma_f32_16x16x16_bf16 v[32:35], v[136:137], v[164:165], 0
  v_mfma_f32_16x16x16_bf16 v[36:39], v[138:139], v[164:165], 0
  v_mfma_f32_16x16x16_bf16 v[40:43], v[140:141], v[164:165], 0
  v_mfma_f32_16x16x16_bf16 v[44:47], v[142:143], v[164:165], 0
  v_mfma_f32_16x16x16_bf16 v[48:51], v[128:129], v[170:171], 0
  v_mfma_f32_16x16x16_bf16 v[52:55], v[130:131], v[170:171], 0
  v_mfma_f32_16x16x16_bf16 v[56:59], v[132:133], v[170:171], 0
  v_mfma_f32_16x16x16_bf16 v[60:63], v[134:135], v[170:171], 0
  v_mfma_f32_16x16x16_bf16 v[64:67], v[136:137], v[170:171], 0
  v_mfma_f32_16x16x16_bf16 v[68:71], v[138:139], v[170:171], 0
  v_mfma_f32_16x16x16_bf16 v[72:75], v[140:141], v[170:171], 0
  v_mfma_f32_16x16x16_bf16 v[76:79], v[142:143], v[170:171], 0
  v_mfma_f32_16x16x32_bf16 v[16:19], v[96:99], v[166:169], v[16:19]
  v_mfma_f32_16x16x32_bf16 v[20:23], v[100:103], v[166:169], v[20:23]
  v_mfma_f32_16x16x32_bf16 v[24:27], v[104:107], v[166:169], v[24:27]
  v_mfma_f32_16x16x32_bf16 v[28:31], v[108:111], v[166:169], v[28:31]
  v_mfma_f32_16x16x32_bf16 v[32:35], v[112:115], v[166:169], v[32:35]
  v_mfma_f32_16x16x32_bf16 v[36:39], v[116:119], v[166:169], v[36:39]
  v_mfma_f32_16x16x32_bf16 v[40:43], v[120:123], v[166:169], v[40:43]
  v_mfma_f32_16x16x32_bf16 v[44:47], v[124:127], v[166:169], v[44:47]
  v_mfma_f32_16x16x32_bf16 v[48:51], v[96:99], v[172:175], v[48:51]
  v_mfma_f32_16x16x32_bf16 v[52:55], v[100:103], v[172:175], v[52:55]
  v_mfma_f32_16x16x32_bf16 v[56:59], v[104:107], v[172:175], v[56:59]
  v_mfma_f32_16x16x32_bf16 v[60:63], v[108:111], v[172:175], v[60:63]
  v_mfma_f32_16x16x32_bf16 v[64:67], v[112:115], v[172:175], v[64:67]
  v_mfma_f32_16x16x32_bf16 v[68:71], v[116:119], v[172:175], v[68:71]
  v_mfma_f32_16x16x32_bf16 v[72:75], v[120:123], v[172:175], v[72:75]
  v_mfma_f32_16x16x32_bf16 v[76:79], v[124:127], v[172:175], v[76:79]
  v_add_u32 v11, s42, v1
  s_nop 6
  v_cvt_pk_bf16_f32 v80, v16, v17
  v_cvt_pk_bf16_f32 v81, v18, v19
  v_cvt_pk_bf16_f32 v82, v20, v21
  v_cvt_pk_bf16_f32 v83, v22, v23
  ds_write_b128 v11, v[80:83] offset:0
  v_cvt_pk_bf16_f32 v84, v24, v25
  v_cvt_pk_bf16_f32 v85, v26, v27
  v_cvt_pk_bf16_f32 v86, v28, v29
  v_cvt_pk_bf16_f32 v87, v30, v31
  ds_write_b128 v11, v[84:87] offset:1024
  v_cvt_pk_bf16_f32 v88, v32, v33
  v_cvt_pk_bf16_f32 v89, v34, v35
  v_cvt_pk_bf16_f32 v90, v36, v37
  v_cvt_pk_bf16_f32 v91, v38, v39
  ds_write_b128 v11, v[88:91] offset:2048
  v_cvt_pk_bf16_f32 v92, v40, v41
  v_cvt_pk_bf16_f32 v93, v42, v43
  v_cvt_pk_bf16_f32 v94, v44, v45
  v_cvt_pk_bf16_f32 v95, v46, v47
  ds_write_b128 v11, v[92:95] offset:3072
  s_waitcnt lgkmcnt(0)
  v_cvt_pk_bf16_f32 v80, v48, v49
  v_cvt_pk_bf16_f32 v81, v50, v51
  v_cvt_pk_bf16_f32 v82, v52, v53
  v_cvt_pk_bf16_f32 v83, v54, v55
  ds_write_b128 v11, v[80:83] offset:16384
  v_cvt_pk_bf16_f32 v84, v56, v57
  v_cvt_pk_bf16_f32 v85, v58, v59
  v_cvt_pk_bf16_f32 v86, v60, v61
  v_cvt_pk_bf16_f32 v87, v62, v63
  ds_write_b128 v11, v[84:87] offset:17408
  v_cvt_pk_bf16_f32 v88, v64, v65
  v_cvt_pk_bf16_f32 v89, v66, v67
  v_cvt_pk_bf16_f32 v90, v68, v69
  v_cvt_pk_bf16_f32 v91, v70, v71
  ds_write_b128 v11, v[88:91] offset:18432
  v_cvt_pk_bf16_f32 v92, v72, v73
  v_cvt_pk_bf16_f32 v93, v74, v75
  v_cvt_pk_bf16_f32 v94, v76, v77
  v_cvt_pk_bf16_f32 v95, v78, v79
  ds_write_b128 v11, v[92:95] offset:19456
  s_waitcnt lgkmcnt(0)
  s_add_u32 s42, s42, 32768
  s_waitcnt vmcnt(16)
  v_mfma_f32_16x16x32_bf16 v[144:147], a[64:67], a[0:3], 0
  v_mfma_f32_16x16x32_bf16 v[148:151], a[32:35], a[0:3], 0
  v_mfma_f32_16x16x32_bf16 v[152:155], a[64:67], a[4:7], 0
  v_mfma_f32_16x16x32_bf16 v[156:159], a[32:35], a[4:7], 0
  v_mfma_f32_16x16x32_bf16 v[160:163], a[36:39], a[4:7], 0
  v_mfma_f32_16x16x32_bf16 v[144:147], a[68:71], a[8:11], v[144:147]
  v_mfma_f32_16x16x32_bf16 v[148:151], a[40:43], a[8:11], v[148:151]
  v_mfma_f32_16x16x32_bf16 v[152:155], a[68:71], a[12:15], v[152:155]
  v_mfma_f32_16x16x32_bf16 v[156:159], a[40:43], a[12:15], v[156:159]
  v_mfma_f32_16x16x32_bf16 v[160:163], a[44:47], a[12:15], v[160:163]
  v_mfma_f32_16x16x32_bf16 v[144:147], a[72:75], a[16:19], v[144:147]
  v_mfma_f32_16x16x32_bf16 v[148:151], a[48:51], a[16:19], v[148:151]
  v_mfma_f32_16x16x32_bf16 v[152:155], a[72:75], a[20:23], v[152:155]
  v_mfma_f32_16x16x32_bf16 v[156:159], a[48:51], a[20:23], v[156:159]
  v_mfma_f32_16x16x32_bf16 v[160:163], a[52:55], a[20:23], v[160:163]
  v_mfma_f32_16x16x32_bf16 v[144:147], a[76:79], a[24:27], v[144:147]
  v_mfma_f32_16x16x32_bf16 v[148:151], a[56:59], a[24:27], v[148:151]
  v_mfma_f32_16x16x32_bf16 v[152:155], a[76:79], a[28:31], v[152:155]
  v_mfma_f32_16x16x32_bf16 v[156:159], a[56:59], a[28:31], v[156:159]
  v_mfma_f32_16x16x32_bf16 v[160:163], a[60:63], a[28:31], v[160:163]
  s_nop 7
  v_cvt_pk_bf16_f32 v10, v144, v145
  v_lshlrev_b32 v144, 16, v10
  v_and_b32 v145, s54, v10
  v_mul_f32 v144, s52, v144
  v_mul_f32 v145, s52, v145
  v_cvt_pk_bf16_f32 v10, v144, v145
  v_lshlrev_b32 v144, 16, v10
  v_and_b32 v145, s54, v10
  v_cvt_pk_bf16_f32 v10, v146, v147
  v_lshlrev_b32 v146, 16, v10
  v_and_b32 v147, s54, v10
  v_mul_f32 v146, s52, v146
  v_mul_f32 v147, s52, v147
  v_cvt_pk_bf16_f32 v10, v146, v147
  v_lshlrev_b32 v146, 16, v10
  v_and_b32 v147, s54, v10
  v_cvt_pk_bf16_f32 v10, v148, v149
  v_lshlrev_b32 v148, 16, v10
  v_and_b32 v149, s54, v10
  v_mul_f32 v148, s52, v148
  v_mul_f32 v149, s52, v149
  v_cvt_pk_bf16_f32 v10, v148, v149
  v_lshlrev_b32 v148, 16, v10
  v_and_b32 v149, s54, v10
  v_cvt_pk_bf16_f32 v10, v150, v151
  v_lshlrev_b32 v150, 16, v10
  v_and_b32 v151, s54, v10
  v_mul_f32 v150, s52, v150
  v_mul_f32 v151, s52, v151
  v_cvt_pk_bf16_f32 v10, v150, v151
  v_lshlrev_b32 v150, 16, v10
  v_and_b32 v151, s54, v10
  v_cvt_pk_bf16_f32 v10, v152, v153
  v_lshlrev_b32 v152, 16, v10
  v_and_b32 v153, s54, v10
  v_mul_f32 v152, s52, v152
  v_mul_f32 v153, s52, v153
  v_cvt_pk_bf16_f32 v10, v152, v153
  v_lshlrev_b32 v152, 16, v10
  v_and_b32 v153, s54, v10
  v_cvt_pk_bf16_f32 v10, v154, v155
  v_lshlrev_b32 v154, 16, v10
  v_and_b32 v155, s54, v10
  v_mul_f32 v154, s52, v154
  v_mul_f32 v155, s52, v155
  v_cvt_pk_bf16_f32 v10, v154, v155
  v_lshlrev_b32 v154, 16, v10
  v_and_b32 v155, s54, v10
  v_cvt_pk_bf16_f32 v10, v156, v157
  v_lshlrev_b32 v156, 16, v10
  v_and_b32 v157, s54, v10
  v_mul_f32 v156, s52, v156
  v_mul_f32 v157, s52, v157
  v_cvt_pk_bf16_f32 v10, v156, v157
  v_lshlrev_b32 v156, 16, v10
  v_and_b32 v157, s54, v10
  v_cvt_pk_bf16_f32 v10, v158, v159
  v_lshlrev_b32 v158, 16, v10
  v_and_b32 v159, s54, v10
  v_mul_f32 v158, s52, v158
  v_mul_f32 v159, s52, v159
  v_cvt_pk_bf16_f32 v10, v158, v159
  v_lshlrev_b32 v158, 16, v10
  v_and_b32 v159, s54, v10
  v_cvt_pk_bf16_f32 v10, v160, v161
  v_lshlrev_b32 v160, 16, v10
  v_and_b32 v161, s54, v10
  v_mul_f32 v160, s52, v160
  v_mul_f32 v161, s52, v161
  v_cvt_pk_bf16_f32 v10, v160, v161
  v_lshlrev_b32 v160, 16, v10
  v_and_b32 v161, s54, v10
  v_cvt_pk_bf16_f32 v10, v162, v163
  v_lshlrev_b32 v162, 16, v10
  v_and_b32 v163, s54, v10
  v_mul_f32 v162, s52, v162
  v_mul_f32 v163, s52, v163
  v_cvt_pk_bf16_f32 v10, v162, v163
  v_lshlrev_b32 v162, 16, v10
  v_and_b32 v163, s54, v10
  v_cmp_lt_u32 vcc, 31, v3
  s_nop 1
  v_cndmask_b32 v144, v144, v8, vcc
  v_cndmask_b32 v145, v145, v8, vcc
  v_cndmask_b32 v146, v146, v8, vcc
  v_cndmask_b32 v147, v147, v8, vcc
  v_cndmask_b32 v152, v152, v8, vcc
  v_cndmask_b32 v153, v153, v8, vcc
  v_cndmask_b32 v154, v154, v8, vcc
  v_cndmask_b32 v155, v155, v8, vcc
  v_add_u32 v10, 0, v9
  v_cmp_gt_u32 vcc, v10, v4
  s_nop 1
  v_cndmask_b32 v148, v148, v8, vcc
  v_cndmask_b32 v160, v160, v8, vcc
  v_add_u32 v10, 1, v9
  v_cmp_gt_u32 vcc, v10, v4
  s_nop 1
  v_cndmask_b32 v149, v149, v8, vcc
  v_cndmask_b32 v161, v161, v8, vcc
  v_add_u32 v10, 2, v9
  v_cmp_gt_u32 vcc, v10, v4
  s_nop 1
  v_cndmask_b32 v150, v150, v8, vcc
  v_cndmask_b32 v162, v162, v8, vcc
  v_add_u32 v10, 3, v9
  v_cmp_gt_u32 vcc, v10, v4
  s_nop 1
  v_cndmask_b32 v151, v151, v8, vcc
  v_cndmask_b32 v163, v163, v8, vcc
  v_max3_f32 v10, v144, v145, v146
  v_max3_f32 v10, v10, v147, v148
  v_max3_f32 v10, v10, v149, v150
  v_max_f32 v10, v10, v151
  s_nop 1
  v_mov_b32 v11, v10
  s_nop 1
  v_permlane16_swap_b32 v10, v11
  v_max_f32 v10, v10, v11
  s_nop 1
  v_mov_b32 v11, v10
  s_nop 1
  v_permlane32_swap_b32 v10, v11
  v_max_f32 v10, v10, v11
  v_sub_f32 v144, v144, v10
  v_mul_f32 v144, s53, v144
  v_sub_f32 v145, v145, v10
  v_mul_f32 v145, s53, v145
  v_sub_f32 v146, v146, v10
  v_mul_f32 v146, s53, v146
  v_sub_f32 v147, v147, v10
  v_mul_f32 v147, s53, v147
  v_sub_f32 v148, v148, v10
  v_mul_f32 v148, s53, v148
  v_sub_f32 v149, v149, v10
  v_mul_f32 v149, s53, v149
  v_sub_f32 v150, v150, v10
  v_mul_f32 v150, s53, v150
  v_sub_f32 v151, v151, v10
  v_mul_f32 v151, s53, v151
  v_exp_f32 v144, v144
  v_exp_f32 v145, v145
  v_exp_f32 v146, v146
  v_exp_f32 v147, v147
  v_exp_f32 v148, v148
  v_exp_f32 v149, v149
  v_exp_f32 v150, v150
  v_exp_f32 v151, v151
  s_nop 0
  v_add_f32 v10, v144, v145
  v_add_f32 v10, v10, v146
  v_add_f32 v10, v10, v147
  v_add_f32 v10, v10, v148
  v_add_f32 v10, v10, v149
  v_add_f32 v10, v10, v150
  v_add_f32 v10, v10, v151
  s_nop 1
  v_mov_b32 v11, v10
  s_nop 1
  v_permlane16_swap_b32 v10, v11
  v_add_f32 v10, v10, v11
  s_nop 1
  v_mov_b32 v11, v10
  s_nop 1
  v_permlane32_swap_b32 v10, v11
  v_add_f32 v10, v10, v11
  v_rcp_f32 v11, v10
  s_nop 0
  v_fma_f32 v12, -v10, v11, 1.0
  v_fma_f32 v11, v12, v11, v11
  v_mul_f32 v144, v144, v11
  v_mul_f32 v145, v145, v11
  v_mul_f32 v146, v146, v11
  v_mul_f32 v147, v147, v11
  v_mul_f32 v148, v148, v11
  v_mul_f32 v149, v149, v11
  v_mul_f32 v150, v150, v11
  v_mul_f32 v151, v151, v11
  v_max3_f32 v10, v152, v153, v154
  v_max3_f32 v10, v10, v155, v156
  v_max3_f32 v10, v10, v157, v158
  v_max3_f32 v10, v10, v159, v160
  v_max3_f32 v10, v10, v161, v162
  v_max_f32 v10, v10, v163
  s_nop 1
  v_mov_b32 v11, v10
  s_nop 1
  v_permlane16_swap_b32 v10, v11
  v_max_f32 v10, v10, v11
  s_nop 1
  v_mov_b32 v11, v10
  s_nop 1
  v_permlane32_swap_b32 v10, v11
  v_max_f32 v10, v10, v11
  v_sub_f32 v152, v152, v10
  v_mul_f32 v152, s53, v152
  v_sub_f32 v153, v153, v10
  v_mul_f32 v153, s53, v153
  v_sub_f32 v154, v154, v10
  v_mul_f32 v154, s53, v154
  v_sub_f32 v155, v155, v10
  v_mul_f32 v155, s53, v155
  v_sub_f32 v156, v156, v10
  v_mul_f32 v156, s53, v156
  v_sub_f32 v157, v157, v10
  v_mul_f32 v157, s53, v157
  v_sub_f32 v158, v158, v10
  v_mul_f32 v158, s53, v158
  v_sub_f32 v159, v159, v10
  v_mul_f32 v159, s53, v159
  v_sub_f32 v160, v160, v10
  v_mul_f32 v160, s53, v160
  v_sub_f32 v161, v161, v10
  v_mul_f32 v161, s53, v161
  v_sub_f32 v162, v162, v10
  v_mul_f32 v162, s53, v162
  v_sub_f32 v163, v163, v10
  v_mul_f32 v163, s53, v163
  v_exp_f32 v152, v152
  v_exp_f32 v153, v153
  v_exp_f32 v154, v154
  v_exp_f32 v155, v155
  v_exp_f32 v156, v156
  v_exp_f32 v157, v157
  v_exp_f32 v158, v158
  v_exp_f32 v159, v159
  v_exp_f32 v160, v160
  v_exp_f32 v161, v161
  v_exp_f32 v162, v162
  v_exp_f32 v163, v163
  s_nop 0
  v_add_f32 v10, v152, v153
  v_add_f32 v10, v10, v154
  v_add_f32 v10, v10, v155
  v_add_f32 v10, v10, v156
  v_add_f32 v10, v10, v157
  v_add_f32 v10, v10, v158
  v_add_f32 v10, v10, v159
  v_add_f32 v10, v10, v160
  v_add_f32 v10, v10, v161
  v_add_f32 v10, v10, v162
  v_add_f32 v10, v10, v163
  s_nop 1
  v_mov_b32 v11, v10
  s_nop 1
  v_permlane16_swap_b32 v10, v11
  v_add_f32 v10, v10, v11
  s_nop 1
  v_mov_b32 v11, v10
  s_nop 1
  v_permlane32_swap_b32 v10, v11
  v_add_f32 v10, v10, v11
  v_rcp_f32 v11, v10
  s_nop 0
  v_fma_f32 v12, -v10, v11, 1.0
  v_fma_f32 v11, v12, v11, v11
  v_mul_f32 v152, v152, v11
  v_mul_f32 v153, v153, v11
  v_mul_f32 v154, v154, v11
  v_mul_f32 v155, v155, v11
  v_mul_f32 v156, v156, v11
  v_mul_f32 v157, v157, v11
  v_mul_f32 v158, v158, v11
  v_mul_f32 v159, v159, v11
  v_mul_f32 v160, v160, v11
  v_mul_f32 v161, v161, v11
  v_mul_f32 v162, v162, v11
  v_mul_f32 v163, v163, v11
  v_cvt_pk_bf16_f32 v164, v144, v145
  v_cvt_pk_bf16_f32 v165, v146, v147
  v_cvt_pk_bf16_f32 v166, v148, v149
  v_cvt_pk_bf16_f32 v167, v150, v151
  v_mov_b32 v168, 0
  v_mov_b32 v169, 0
  v_cvt_pk_bf16_f32 v170, v152, v153
  v_cvt_pk_bf16_f32 v171, v154, v155
  v_cvt_pk_bf16_f32 v172, v156, v157
  v_cvt_pk_bf16_f32 v173, v158, v159
  v_cvt_pk_bf16_f32 v174, v160, v161
  v_cvt_pk_bf16_f32 v175, v162, v163
  s_waitcnt vmcnt(0)
  v_mfma_f32_16x16x16_bf16 v[16:19], a[112:113], v[164:165], 0
  v_mfma_f32_16x16x16_bf16 v[20:23], a[114:115], v[164:165], 0
  v_mfma_f32_16x16x16_bf16 v[24:27], a[116:117], v[164:165], 0
  v_mfma_f32_16x16x16_bf16 v[28:31], a[118:119], v[164:165], 0
  v_mfma_f32_16x16x16_bf16 v[32:35], a[120:121], v[164:165], 0
  v_mfma_f32_16x16x16_bf16 v[36:39], a[122:123], v[164:165], 0
  v_mfma_f32_16x16x16_bf16 v[40:43], a[124:125], v[164:165], 0
  v_mfma_f32_16x16x16_bf16 v[44:47], a[126:127], v[164:165], 0
  v_mfma_f32_16x16x16_bf16 v[48:51], a[112:113], v[170:171], 0
  v_mfma_f32_16x16x16_bf16 v[52:55], a[114:115], v[170:171], 0
  v_mfma_f32_16x16x16_bf16 v[56:59], a[116:117], v[170:171], 0
  v_mfma_f32_16x16x16_bf16 v[60:63], a[118:119], v[170:171], 0
  v_mfma_f32_16x16x16_bf16 v[64:67], a[120:121], v[170:171], 0
  v_mfma_f32_16x16x16_bf16 v[68:71], a[122:123], v[170:171], 0
  v_mfma_f32_16x16x16_bf16 v[72:75], a[124:125], v[170:171], 0
  v_mfma_f32_16x16x16_bf16 v[76:79], a[126:127], v[170:171], 0
  v_mfma_f32_16x16x32_bf16 v[16:19], a[80:83], v[166:169], v[16:19]
  v_mfma_f32_16x16x32_bf16 v[20:23], a[84:87], v[166:169], v[20:23]
  v_mfma_f32_16x16x32_bf16 v[24:27], a[88:91], v[166:169], v[24:27]
  v_mfma_f32_16x16x32_bf16 v[28:31], a[92:95], v[166:169], v[28:31]
  v_mfma_f32_16x16x32_bf16 v[32:35], a[96:99], v[166:169], v[32:35]
  v_mfma_f32_16x16x32_bf16 v[36:39], a[100:103], v[166:169], v[36:39]
  v_mfma_f32_16x16x32_bf16 v[40:43], a[104:107], v[166:169], v[40:43]
  v_mfma_f32_16x16x32_bf16 v[44:47], a[108:111], v[166:169], v[44:47]
  v_mfma_f32_16x16x32_bf16 v[48:51], a[80:83], v[172:175], v[48:51]
  v_mfma_f32_16x16x32_bf16 v[52:55], a[84:87], v[172:175], v[52:55]
  v_mfma_f32_16x16x32_bf16 v[56:59], a[88:91], v[172:175], v[56:59]
  v_mfma_f32_16x16x32_bf16 v[60:63], a[92:95], v[172:175], v[60:63]
  v_mfma_f32_16x16x32_bf16 v[64:67], a[96:99], v[172:175], v[64:67]
  v_mfma_f32_16x16x32_bf16 v[68:71], a[100:103], v[172:175], v[68:71]
  v_mfma_f32_16x16x32_bf16 v[72:75], a[104:107], v[172:175], v[72:75]
  v_mfma_f32_16x16x32_bf16 v[76:79], a[108:111], v[172:175], v[76:79]
  v_add_u32 v11, s42, v1
  s_nop 6
  v_cvt_pk_bf16_f32 v80, v16, v17
  v_cvt_pk_bf16_f32 v81, v18, v19
  v_cvt_pk_bf16_f32 v82, v20, v21
  v_cvt_pk_bf16_f32 v83, v22, v23
  ds_write_b128 v11, v[80:83] offset:0
  v_cvt_pk_bf16_f32 v84, v24, v25
  v_cvt_pk_bf16_f32 v85, v26, v27
  v_cvt_pk_bf16_f32 v86, v28, v29
  v_cvt_pk_bf16_f32 v87, v30, v31
  ds_write_b128 v11, v[84:87] offset:1024
  v_cvt_pk_bf16_f32 v88, v32, v33
  v_cvt_pk_bf16_f32 v89, v34, v35
  v_cvt_pk_bf16_f32 v90, v36, v37
  v_cvt_pk_bf16_f32 v91, v38, v39
  ds_write_b128 v11, v[88:91] offset:2048
  v_cvt_pk_bf16_f32 v92, v40, v41
  v_cvt_pk_bf16_f32 v93, v42, v43
  v_cvt_pk_bf16_f32 v94, v44, v45
  v_cvt_pk_bf16_f32 v95, v46, v47
  ds_write_b128 v11, v[92:95] offset:3072
  s_waitcnt lgkmcnt(0)
  v_cvt_pk_bf16_f32 v80, v48, v49
  v_cvt_pk_bf16_f32 v81, v50, v51
  v_cvt_pk_bf16_f32 v82, v52, v53
  v_cvt_pk_bf16_f32 v83, v54, v55
  ds_write_b128 v11, v[80:83] offset:16384
  v_cvt_pk_bf16_f32 v84, v56, v57
  v_cvt_pk_bf16_f32 v85, v58, v59
  v_cvt_pk_bf16_f32 v86, v60, v61
  v_cvt_pk_bf16_f32 v87, v62, v63
  ds_write_b128 v11, v[84:87] offset:17408
  v_cvt_pk_bf16_f32 v88, v64, v65
  v_cvt_pk_bf16_f32 v89, v66, v67
  v_cvt_pk_bf16_f32 v90, v68, v69
  v_cvt_pk_bf16_f32 v91, v70, v71
  ds_write_b128 v11, v[88:91] offset:18432
  v_cvt_pk_bf16_f32 v92, v72, v73
  v_cvt_pk_bf16_f32 v93, v74, v75
  v_cvt_pk_bf16_f32 v94, v76, v77
  v_cvt_pk_bf16_f32 v95, v78, v79
  ds_write_b128 v11, v[92:95] offset:19456
  s_waitcnt lgkmcnt(0)
  s_lshl_b32 s10, s45, 3
  s_add_u32 s10, s10, s44
  s_mul_i32 s10, s10, 163840
  s_mul_i32 s11, s8, 640
  s_add_u32 s10, s10, s11
  s_add_u32 s10, s10, 0xd000000
  s_add_u32 s12, s6, s10
  s_addc_u32 s13, s7, 0
  v_mul_u32_u24 v176, 2560, v4
  v_lshl_add_u32 v176, v5, 4, v176
  v_add_u32 v177, 40960, v176
  v_add_u32 v178, 81920, v176
  v_add_u32 v179, 122880, v176
  v_add_u32 v180, 0x1000, v1
  v_add_u32 v181, 0x2000, v1
  v_add_u32 v182, 0x3000, v1
  global_load_dwordx4 v[16:19], v1, s[60:61] offset:0
  global_load_dwordx4 v[20:23], v1, s[62:63] offset:0
  global_load_dwordx4 v[24:27], v1, s[60:61] offset:1024
  global_load_dwordx4 v[28:31], v1, s[62:63] offset:1024
  global_load_dwordx4 v[32:35], v1, s[60:61] offset:2048
  global_load_dwordx4 v[36:39], v1, s[62:63] offset:2048
  global_load_dwordx4 v[40:43], v1, s[60:61] offset:3072
  global_load_dwordx4 v[44:47], v1, s[62:63] offset:3072
  global_load_dwordx4 v[48:51], v180, s[60:61] offset:0
  global_load_dwordx4 v[52:55], v180, s[62:63] offset:0
  global_load_dwordx4 v[56:59], v180, s[60:61] offset:1024
  global_load_dwordx4 v[60:63], v180, s[62:63] offset:1024
  global_load_dwordx4 v[64:67], v180, s[60:61] offset:2048
  global_load_dwordx4 v[68:71], v180, s[62:63] offset:2048
  global_load_dwordx4 v[72:75], v180, s[60:61] offset:3072
  global_load_dwordx4 v[76:79], v180, s[62:63] offset:3072
  global_load_dwordx4 v[80:83], v181, s[60:61] offset:0
  global_load_dwordx4 v[84:87], v181, s[62:63] offset:0
  global_load_dwordx4 v[88:91], v181, s[60:61] offset:1024
  global_load_dwordx4 v[92:95], v181, s[62:63] offset:1024
  s_barrier
  ds_read_b128 v[112:115], v1 offset:0
  ds_read_b128 v[116:119], v1 offset:16384
  ds_read_b128 v[120:123], v1 offset:32768
  ds_read_b128 v[124:127], v1 offset:49152
  ds_read_b128 v[128:131], v1 offset:1024
  ds_read_b128 v[132:135], v1 offset:17408
  ds_read_b128 v[136:139], v1 offset:33792
  ds_read_b128 v[140:143], v1 offset:50176
  global_load_dwordx4 v[96:99], v181, s[60:61] offset:2048
  global_load_dwordx4 v[100:103], v181, s[62:63] offset:2048
  ds_read_b128 v[144:147], v1 offset:2048
  ds_read_b128 v[148:151], v1 offset:18432
  ds_read_b128 v[152:155], v1 offset:34816
  ds_read_b128 v[156:159], v1 offset:51200
  s_waitcnt vmcnt(20) lgkmcnt(8)
  v_mfma_f32_16x16x32_bf16 a[0:3], v[16:19], v[112:115], 0
  v_mfma_f32_16x16x32_bf16 a[4:7], v[16:19], v[116:119], 0
  v_mfma_f32_16x16x32_bf16 a[8:11], v[16:19], v[120:123], 0
  v_mfma_f32_16x16x32_bf16 a[12:15], v[16:19], v[124:127], 0
  v_mfma_f32_16x16x32_bf16 a[16:19], v[20:23], v[112:115], 0
  v_mfma_f32_16x16x32_bf16 a[20:23], v[20:23], v[116:119], 0
  v_mfma_f32_16x16x32_bf16 a[24:27], v[20:23], v[120:123], 0
  v_mfma_f32_16x16x32_bf16 a[28:31], v[20:23], v[124:127], 0
  global_load_dwordx4 v[16:19], v181, s[60:61] offset:3072
  global_load_dwordx4 v[20:23], v181, s[62:63] offset:3072
  ds_read_b128 v[112:115], v1 offset:3072
  ds_read_b128 v[116:119], v1 offset:19456
  ds_read_b128 v[120:123], v1 offset:35840
  ds_read_b128 v[124:127], v1 offset:52224
  s_waitcnt vmcnt(20) lgkmcnt(8)
  v_mfma_f32_16x16x32_bf16 a[0:3], v[24:27], v[128:131], a[0:3]
  v_mfma_f32_16x16x32_bf16 a[4:7], v[24:27], v[132:135], a[4:7]
  v_mfma_f32_16x16x32_bf16 a[8:11], v[24:27], v[136:139], a[8:11]
  v_mfma_f32_16x16x32_bf16 a[12:15], v[24:27], v[140:143], a[12:15]
  v_mfma_f32_16x16x32_bf16 a[16:19], v[28:31], v[128:131], a[16:19]
  v_mfma_f32_16x16x32_bf16 a[20:23], v[28:31], v[132:135], a[20:23]
  v_mfma_f32_16x16x32_bf16 a[24:27], v[28:31], v[136:139], a[24:27]
  v_mfma_f32_16x16x32_bf16 a[28:31], v[28:31], v[140:143], a[28:31]
  global_load_dwordx4 v[24:27], v182, s[60:61] offset:0
  global_load_dwordx4 v[28:31], v182, s[62:63] offset:0
  ds_read_b128 v[128:131], v1 offset:4096
  ds_read_b128 v[132:135], v1 offset:20480
  ds_read_b128 v[136:139], v1 offset:36864
  ds_read_b128 v[140:143], v1 offset:53248
  s_waitcnt vmcnt(20) lgkmcnt(8)
  v_mfma_f32_16x16x32_bf16 a[0:3], v[32:35], v[144:147], a[0:3]
  v_mfma_f32_16x16x32_bf16 a[4:7], v[32:35], v[148:151], a[4:7]
  v_mfma_f32_16x16x32_bf16 a[8:11], v[32:35], v[152:155], a[8:11]
  v_mfma_f32_16x16x32_bf16 a[12:15], v[32:35], v[156:159], a[12:15]
  v_mfma_f32_16x16x32_bf16 a[16:19], v[36:39], v[144:147], a[16:19]
  v_mfma_f32_16x16x32_bf16 a[20:23], v[36:39], v[148:151], a[20:23]
  v_mfma_f32_16x16x32_bf16 a[24:27], v[36:39], v[152:155], a[24:27]
  v_mfma_f32_16x16x32_bf16 a[28:31], v[36:39], v[156:159], a[28:31]
  global_load_dwordx4 v[32:35], v182, s[60:61] offset:1024
  global_load_dwordx4 v[36:39], v182, s[62:63] offset:1024
  ds_read_b128 v[144:147], v1 offset:5120
  ds_read_b128 v[148:151], v1 offset:21504
  ds_read_b128 v[152:155], v1 offset:37888
  ds_read_b128 v[156:159], v1 offset:54272
  s_waitcnt vmcnt(20) lgkmcnt(8)
  v_mfma_f32_16x16x32_bf16 a[0:3], v[40:43], v[112:115], a[0:3]
  v_mfma_f32_16x16x32_bf16 a[4:7], v[40:43], v[116:119], a[4:7]
  v_mfma_f32_16x16x32_bf16 a[8:11], v[40:43], v[120:123], a[8:11]
  v_mfma_f32_16x16x32_bf16 a[12:15], v[40:43], v[124:127], a[12:15]
  v_mfma_f32_16x16x32_bf16 a[16:19], v[44:47], v[112:115], a[16:19]
  v_mfma_f32_16x16x32_bf16 a[20:23], v[44:47], v[116:119], a[20:23]
  v_mfma_f32_16x16x32_bf16 a[24:27], v[44:47], v[120:123], a[24:27]
  v_mfma_f32_16x16x32_bf16 a[28:31], v[44:47], v[124:127], a[28:31]
  global_load_dwordx4 v[40:43], v182, s[60:61] offset:2048
  global_load_dwordx4 v[44:47], v182, s[62:63] offset:2048
  ds_read_b128 v[112:115], v1 offset:6144
  ds_read_b128 v[116:119], v1 offset:22528
  ds_read_b128 v[120:123], v1 offset:38912
  ds_read_b128 v[124:127], v1 offset:55296
  s_waitcnt vmcnt(20) lgkmcnt(8)
  v_mfma_f32_16x16x32_bf16 a[0:3], v[48:51], v[128:131], a[0:3]
  v_mfma_f32_16x16x32_bf16 a[4:7], v[48:51], v[132:135], a[4:7]
  v_mfma_f32_16x16x32_bf16 a[8:11], v[48:51], v[136:139], a[8:11]
  v_mfma_f32_16x16x32_bf16 a[12:15], v[48:51], v[140:143], a[12:15]
  v_mfma_f32_16x16x32_bf16 a[16:19], v[52:55], v[128:131], a[16:19]
  v_mfma_f32_16x16x32_bf16 a[20:23], v[52:55], v[132:135], a[20:23]
  v_mfma_f32_16x16x32_bf16 a[24:27], v[52:55], v[136:139], a[24:27]
  v_mfma_f32_16x16x32_bf16 a[28:31], v[52:55], v[140:143], a[28:31]
  global_load_dwordx4 v[48:51], v182, s[60:61] offset:3072
  global_load_dwordx4 v[52:55], v182, s[62:63] offset:3072
  ds_read_b128 v[128:131], v1 offset:7168
  ds_read_b128 v[132:135], v1 offset:23552
  ds_read_b128 v[136:139], v1 offset:39936
  ds_read_b128 v[140:143], v1 offset:56320
  s_waitcnt vmcnt(20) lgkmcnt(8)
  v_mfma_f32_16x16x32_bf16 a[0:3], v[56:59], v[144:147], a[0:3]
  v_mfma_f32_16x16x32_bf16 a[4:7], v[56:59], v[148:151], a[4:7]
  v_mfma_f32_16x16x32_bf16 a[8:11], v[56:59], v[152:155], a[8:11]
  v_mfma_f32_16x16x32_bf16 a[12:15], v[56:59], v[156:159], a[12:15]
  v_mfma_f32_16x16x32_bf16 a[16:19], v[60:63], v[144:147], a[16:19]
  v_mfma_f32_16x16x32_bf16 a[20:23], v[60:63], v[148:151], a[20:23]
  v_mfma_f32_16x16x32_bf16 a[24:27], v[60:63], v[152:155], a[24:27]
  v_mfma_f32_16x16x32_bf16 a[28:31], v[60:63], v[156:159], a[28:31]
  global_load_dwordx4 v[56:59], v1, s[64:65] offset:0
  global_load_dwordx4 v[60:63], v1, s[66:67] offset:0
  ds_read_b128 v[144:147], v1 offset:8192
  ds_read_b128 v[148:151], v1 offset:24576
  ds_read_b128 v[152:155], v1 offset:40960
  ds_read_b128 v[156:159], v1 offset:57344
  s_waitcnt vmcnt(20) lgkmcnt(8)
  v_mfma_f32_16x16x32_bf16 a[0:3], v[64:67], v[112:115], a[0:3]
  v_mfma_f32_16x16x32_bf16 a[4:7], v[64:67], v[116:119], a[4:7]
  v_mfma_f32_16x16x32_bf16 a[8:11], v[64:67], v[120:123], a[8:11]
  v_mfma_f32_16x16x32_bf16 a[12:15], v[64:67], v[124:127], a[12:15]
  v_mfma_f32_16x16x32_bf16 a[16:19], v[68:71], v[112:115], a[16:19]
  v_mfma_f32_16x16x32_bf16 a[20:23], v[68:71], v[116:119], a[20:23]
  v_mfma_f32_16x16x32_bf16 a[24:27], v[68:71], v[120:123], a[24:27]
  v_mfma_f32_16x16x32_bf16 a[28:31], v[68:71], v[124:127], a[28:31]
  global_load_dwordx4 v[64:67], v1, s[64:65] offset:1024
  global_load_dwordx4 v[68:71], v1, s[66:67] offset:1024
  ds_read_b128 v[112:115], v1 offset:9216
  ds_read_b128 v[116:119], v1 offset:25600
  ds_read_b128 v[120:123], v1 offset:41984
  ds_read_b128 v[124:127], v1 offset:58368
  s_waitcnt vmcnt(20) lgkmcnt(8)
  v_mfma_f32_16x16x32_bf16 a[0:3], v[72:75], v[128:131], a[0:3]
  v_mfma_f32_16x16x32_bf16 a[4:7], v[72:75], v[132:135], a[4:7]
  v_mfma_f32_16x16x32_bf16 a[8:11], v[72:75], v[136:139], a[8:11]
  v_mfma_f32_16x16x32_bf16 a[12:15], v[72:75], v[140:143], a[12:15]
  v_mfma_f32_16x16x32_bf16 a[16:19], v[76:79], v[128:131], a[16:19]
  v_mfma_f32_16x16x32_bf16 a[20:23], v[76:79], v[132:135], a[20:23]
  v_mfma_f32_16x16x32_bf16 a[24:27], v[76:79], v[136:139], a[24:27]
  v_mfma_f32_16x16x32_bf16 a[28:31], v[76:79], v[140:143], a[28:31]
  global_load_dwordx4 v[72:75], v1, s[64:65] offset:2048
  global_load_dwordx4 v[76:79], v1, s[66:67] offset:2048
  ds_read_b128 v[128:131], v1 offset:10240
  ds_read_b128 v[132:135], v1 offset:26624
  ds_read_b128 v[136:139], v1 offset:43008
  ds_read_b128 v[140:143], v1 offset:59392
  s_waitcnt vmcnt(20) lgkmcnt(8)
  v_mfma_f32_16x16x32_bf16 a[0:3], v[80:83], v[144:147], a[0:3]
  v_mfma_f32_16x16x32_bf16 a[4:7], v[80:83], v[148:151], a[4:7]
  v_mfma_f32_16x16x32_bf16 a[8:11], v[80:83], v[152:155], a[8:11]
  v_mfma_f32_16x16x32_bf16 a[12:15], v[80:83], v[156:159], a[12:15]
  v_mfma_f32_16x16x32_bf16 a[16:19], v[84:87], v[144:147], a[16:19]
  v_mfma_f32_16x16x32_bf16 a[20:23], v[84:87], v[148:151], a[20:23]
  v_mfma_f32_16x16x32_bf16 a[24:27], v[84:87], v[152:155], a[24:27]
  v_mfma_f32_16x16x32_bf16 a[28:31], v[84:87], v[156:159], a[28:31]
  global_load_dwordx4 v[80:83], v1, s[64:65] offset:3072
  global_load_dwordx4 v[84:87], v1, s[66:67] offset:3072
  ds_read_b128 v[144:147], v1 offset:11264
  ds_read_b128 v[148:151], v1 offset:27648
  ds_read_b128 v[152:155], v1 offset:44032
  ds_read_b128 v[156:159], v1 offset:60416
  s_waitcnt vmcnt(20) lgkmcnt(8)
  v_mfma_f32_16x16x32_bf16 a[0:3], v[88:91], v[112:115], a[0:3]
  v_mfma_f32_16x16x32_bf16 a[4:7], v[88:91], v[116:119], a[4:7]
  v_mfma_f32_16x16x32_bf16 a[8:11], v[88:91], v[120:123], a[8:11]
  v_mfma_f32_16x16x32_bf16 a[12:15], v[88:91], v[124:127], a[12:15]
  v_mfma_f32_16x16x32_bf16 a[16:19], v[92:95], v[112:115], a[16:19]
  v_mfma_f32_16x16x32_bf16 a[20:23], v[92:95], v[116:119], a[20:23]
  v_mfma_f32_16x16x32_bf16 a[24:27], v[92:95], v[120:123], a[24:27]
  v_mfma_f32_16x16x32_bf16 a[28:31], v[92:95], v[124:127], a[28:31]
  global_load_dwordx4 v[88:91], v180, s[64:65] offset:0
  global_load_dwordx4 v[92:95], v180, s[66:67] offset:0
  ds_read_b128 v[112:115], v1 offset:12288
  ds_read_b128 v[116:119], v1 offset:28672
  ds_read_b128 v[120:123], v1 offset:45056
  ds_read_b128 v[124:127], v1 offset:61440
  s_waitcnt vmcnt(20) lgkmcnt(8)
  v_mfma_f32_16x16x32_bf16 a[0:3], v[96:99], v[128:131], a[0:3]
  v_mfma_f32_16x16x32_bf16 a[4:7], v[96:99], v[132:135], a[4:7]
  v_mfma_f32_16x16x32_bf16 a[8:11], v[96:99], v[136:139], a[8:11]
  v_mfma_f32_16x16x32_bf16 a[12:15], v[96:99], v[140:143], a[12:15]
  v_mfma_f32_16x16x32_bf16 a[16:19], v[100:103], v[128:131], a[16:19]
  v_mfma_f32_16x16x32_bf16 a[20:23], v[100:103], v[132:135], a[20:23]
  v_mfma_f32_16x16x32_bf16 a[24:27], v[100:103], v[136:139], a[24:27]
  v_mfma_f32_16x16x32_bf16 a[28:31], v[100:103], v[140:143], a[28:31]
  global_load_dwordx4 v[96:99], v180, s[64:65] offset:1024
  global_load_dwordx4 v[100:103], v180, s[66:67] offset:1024
  ds_read_b128 v[128:131], v1 offset:13312
  ds_read_b128 v[132:135], v1 offset:29696
  ds_read_b128 v[136:139], v1 offset:46080
  ds_read_b128 v[140:143], v1 offset:62464
  s_waitcnt vmcnt(20) lgkmcnt(8)
  v_mfma_f32_16x16x32_bf16 a[0:3], v[16:19], v[144:147], a[0:3]
  v_mfma_f32_16x16x32_bf16 a[4:7], v[16:19], v[148:151], a[4:7]
  v_mfma_f32_16x16x32_bf16 a[8:11], v[16:19], v[152:155], a[8:11]
  v_mfma_f32_16x16x32_bf16 a[12:15], v[16:19], v[156:159], a[12:15]
  v_mfma_f32_16x16x32_bf16 a[16:19], v[20:23], v[144:147], a[16:19]
  v_mfma_f32_16x16x32_bf16 a[20:23], v[20:23], v[148:151], a[20:23]
  v_mfma_f32_16x16x32_bf16 a[24:27], v[20:23], v[152:155], a[24:27]
  v_mfma_f32_16x16x32_bf16 a[28:31], v[20:23], v[156:159], a[28:31]
  global_load_dwordx4 v[16:19], v180, s[64:65] offset:2048
  global_load_dwordx4 v[20:23], v180, s[66:67] offset:2048
  ds_read_b128 v[144:147], v1 offset:14336
  ds_read_b128 v[148:151], v1 offset:30720
  ds_read_b128 v[152:155], v1 offset:47104
  ds_read_b128 v[156:159], v1 offset:63488
  s_waitcnt vmcnt(20) lgkmcnt(8)
  v_mfma_f32_16x16x32_bf16 a[0:3], v[24:27], v[112:115], a[0:3]
  v_mfma_f32_16x16x32_bf16 a[4:7], v[24:27], v[116:119], a[4:7]
  v_mfma_f32_16x16x32_bf16 a[8:11], v[24:27], v[120:123], a[8:11]
  v_mfma_f32_16x16x32_bf16 a[12:15], v[24:27], v[124:127], a[12:15]
  v_mfma_f32_16x16x32_bf16 a[16:19], v[28:31], v[112:115], a[16:19]
  v_mfma_f32_16x16x32_bf16 a[20:23], v[28:31], v[116:119], a[20:23]
  v_mfma_f32_16x16x32_bf16 a[24:27], v[28:31], v[120:123], a[24:27]
  v_mfma_f32_16x16x32_bf16 a[28:31], v[28:31], v[124:127], a[28:31]
  global_load_dwordx4 v[24:27], v180, s[64:65] offset:3072
  global_load_dwordx4 v[28:31], v180, s[66:67] offset:3072
  ds_read_b128 v[112:115], v1 offset:15360
  ds_read_b128 v[116:119], v1 offset:31744
  ds_read_b128 v[120:123], v1 offset:48128
  ds_read_b128 v[124:127], v1 offset:64512
  s_waitcnt vmcnt(20) lgkmcnt(8)
  v_mfma_f32_16x16x32_bf16 a[0:3], v[32:35], v[128:131], a[0:3]
  v_mfma_f32_16x16x32_bf16 a[4:7], v[32:35], v[132:135], a[4:7]
  v_mfma_f32_16x16x32_bf16 a[8:11], v[32:35], v[136:139], a[8:11]
  v_mfma_f32_16x16x32_bf16 a[12:15], v[32:35], v[140:143], a[12:15]
  v_mfma_f32_16x16x32_bf16 a[16:19], v[36:39], v[128:131], a[16:19]
  v_mfma_f32_16x16x32_bf16 a[20:23], v[36:39], v[132:135], a[20:23]
  v_mfma_f32_16x16x32_bf16 a[24:27], v[36:39], v[136:139], a[24:27]
  v_mfma_f32_16x16x32_bf16 a[28:31], v[36:39], v[140:143], a[28:31]
  global_load_dwordx4 v[32:35], v181, s[64:65] offset:0
  global_load_dwordx4 v[36:39], v181, s[66:67] offset:0
  ds_read_b128 v[128:131], v1 offset:0
  ds_read_b128 v[132:135], v1 offset:16384
  ds_read_b128 v[136:139], v1 offset:32768
  ds_read_b128 v[140:143], v1 offset:49152
  s_waitcnt vmcnt(20) lgkmcnt(8)
  v_mfma_f32_16x16x32_bf16 a[0:3], v[40:43], v[144:147], a[0:3]
  v_mfma_f32_16x16x32_bf16 a[4:7], v[40:43], v[148:151], a[4:7]
  v_mfma_f32_16x16x32_bf16 a[8:11], v[40:43], v[152:155], a[8:11]
  v_mfma_f32_16x16x32_bf16 a[12:15], v[40:43], v[156:159], a[12:15]
  v_mfma_f32_16x16x32_bf16 a[16:19], v[44:47], v[144:147], a[16:19]
  v_mfma_f32_16x16x32_bf16 a[20:23], v[44:47], v[148:151], a[20:23]
  v_mfma_f32_16x16x32_bf16 a[24:27], v[44:47], v[152:155], a[24:27]
  v_mfma_f32_16x16x32_bf16 a[28:31], v[44:47], v[156:159], a[28:31]
  global_load_dwordx4 v[40:43], v181, s[64:65] offset:1024
  global_load_dwordx4 v[44:47], v181, s[66:67] offset:1024
  ds_read_b128 v[144:147], v1 offset:1024
  ds_read_b128 v[148:151], v1 offset:17408
  ds_read_b128 v[152:155], v1 offset:33792
  ds_read_b128 v[156:159], v1 offset:50176
  s_waitcnt vmcnt(20) lgkmcnt(8)
  v_mfma_f32_16x16x32_bf16 a[0:3], v[48:51], v[112:115], a[0:3]
  v_mfma_f32_16x16x32_bf16 a[4:7], v[48:51], v[116:119], a[4:7]
  v_mfma_f32_16x16x32_bf16 a[8:11], v[48:51], v[120:123], a[8:11]
  v_mfma_f32_16x16x32_bf16 a[12:15], v[48:51], v[124:127], a[12:15]
  v_mfma_f32_16x16x32_bf16 a[16:19], v[52:55], v[112:115], a[16:19]
  v_mfma_f32_16x16x32_bf16 a[20:23], v[52:55], v[116:119], a[20:23]
  v_mfma_f32_16x16x32_bf16 a[24:27], v[52:55], v[120:123], a[24:27]
  v_mfma_f32_16x16x32_bf16 a[28:31], v[52:55], v[124:127], a[28:31]
  global_load_dwordx4 v[48:51], v181, s[64:65] offset:2048
  global_load_dwordx4 v[52:55], v181, s[66:67] offset:2048
  ds_read_b128 v[112:115], v1 offset:2048
  ds_read_b128 v[116:119], v1 offset:18432
  ds_read_b128 v[120:123], v1 offset:34816
  ds_read_b128 v[124:127], v1 offset:51200
  s_waitcnt vmcnt(20) lgkmcnt(8)
  v_mfma_f32_16x16x32_bf16 a[32:35], v[56:59], v[128:131], 0
  v_mfma_f32_16x16x32_bf16 a[36:39], v[56:59], v[132:135], 0
  v_mfma_f32_16x16x32_bf16 a[40:43], v[56:59], v[136:139], 0
  v_mfma_f32_16x16x32_bf16 a[44:47], v[56:59], v[140:143], 0
  v_mfma_f32_16x16x32_bf16 a[48:51], v[60:63], v[128:131], 0
  v_mfma_f32_16x16x32_bf16 a[52:55], v[60:63], v[132:135], 0
  v_mfma_f32_16x16x32_bf16 a[56:59], v[60:63], v[136:139], 0
  v_mfma_f32_16x16x32_bf16 a[60:63], v[60:63], v[140:143], 0
  global_load_dwordx4 v[56:59], v181, s[64:65] offset:3072
  global_load_dwordx4 v[60:63], v181, s[66:67] offset:3072
  ds_read_b128 v[128:131], v1 offset:3072
  ds_read_b128 v[132:135], v1 offset:19456
  ds_read_b128 v[136:139], v1 offset:35840
  ds_read_b128 v[140:143], v1 offset:52224
  s_waitcnt vmcnt(20) lgkmcnt(8)
  v_mfma_f32_16x16x32_bf16 a[32:35], v[64:67], v[144:147], a[32:35]
  v_mfma_f32_16x16x32_bf16 a[36:39], v[64:67], v[148:151], a[36:39]
  v_mfma_f32_16x16x32_bf16 a[40:43], v[64:67], v[152:155], a[40:43]
  v_mfma_f32_16x16x32_bf16 a[44:47], v[64:67], v[156:159], a[44:47]
  v_mfma_f32_16x16x32_bf16 a[48:51], v[68:71], v[144:147], a[48:51]
  v_mfma_f32_16x16x32_bf16 a[52:55], v[68:71], v[148:151], a[52:55]
  v_mfma_f32_16x16x32_bf16 a[56:59], v[68:71], v[152:155], a[56:59]
  v_mfma_f32_16x16x32_bf16 a[60:63], v[68:71], v[156:159], a[60:63]
  global_load_dwordx4 v[64:67], v182, s[64:65] offset:0
  global_load_dwordx4 v[68:71], v182, s[66:67] offset:0
  ds_read_b128 v[144:147], v1 offset:4096
  ds_read_b128 v[148:151], v1 offset:20480
  ds_read_b128 v[152:155], v1 offset:36864
  ds_read_b128 v[156:159], v1 offset:53248
  s_waitcnt vmcnt(20) lgkmcnt(8)
  v_mfma_f32_16x16x32_bf16 a[32:35], v[72:75], v[112:115], a[32:35]
  v_mfma_f32_16x16x32_bf16 a[36:39], v[72:75], v[116:119], a[36:39]
  v_mfma_f32_16x16x32_bf16 a[40:43], v[72:75], v[120:123], a[40:43]
  v_mfma_f32_16x16x32_bf16 a[44:47], v[72:75], v[124:127], a[44:47]
  v_mfma_f32_16x16x32_bf16 a[48:51], v[76:79], v[112:115], a[48:51]
  v_mfma_f32_16x16x32_bf16 a[52:55], v[76:79], v[116:119], a[52:55]
  v_mfma_f32_16x16x32_bf16 a[56:59], v[76:79], v[120:123], a[56:59]
  v_mfma_f32_16x16x32_bf16 a[60:63], v[76:79], v[124:127], a[60:63]
  global_store_dwordx4 v176, a[0:3], s[12:13] offset:0 sc1
  global_store_dwordx4 v177, a[4:7], s[12:13] offset:0 sc1
  global_store_dwordx4 v178, a[8:11], s[12:13] offset:0 sc1
  global_store_dwordx4 v179, a[12:15], s[12:13] offset:0 sc1
  global_store_dwordx4 v176, a[16:19], s[12:13] offset:64 sc1
  global_store_dwordx4 v177, a[20:23], s[12:13] offset:64 sc1
  global_store_dwordx4 v178, a[24:27], s[12:13] offset:64 sc1
  global_store_dwordx4 v179, a[28:31], s[12:13] offset:64 sc1
  global_load_dwordx4 v[72:75], v182, s[64:65] offset:1024
  global_load_dwordx4 v[76:79], v182, s[66:67] offset:1024
  ds_read_b128 v[112:115], v1 offset:5120
  ds_read_b128 v[116:119], v1 offset:21504
  ds_read_b128 v[120:123], v1 offset:37888
  ds_read_b128 v[124:127], v1 offset:54272
  s_waitcnt vmcnt(28) lgkmcnt(8)
  v_mfma_f32_16x16x32_bf16 a[32:35], v[80:83], v[128:131], a[32:35]
  v_mfma_f32_16x16x32_bf16 a[36:39], v[80:83], v[132:135], a[36:39]
  v_mfma_f32_16x16x32_bf16 a[40:43], v[80:83], v[136:139], a[40:43]
  v_mfma_f32_16x16x32_bf16 a[44:47], v[80:83], v[140:143], a[44:47]
  v_mfma_f32_16x16x32_bf16 a[48:51], v[84:87], v[128:131], a[48:51]
  v_mfma_f32_16x16x32_bf16 a[52:55], v[84:87], v[132:135], a[52:55]
  v_mfma_f32_16x16x32_bf16 a[56:59], v[84:87], v[136:139], a[56:59]
  v_mfma_f32_16x16x32_bf16 a[60:63], v[84:87], v[140:143], a[60:63]
  global_load_dwordx4 v[80:83], v182, s[64:65] offset:2048
  global_load_dwordx4 v[84:87], v182, s[66:67] offset:2048
  ds_read_b128 v[128:131], v1 offset:6144
  ds_read_b128 v[132:135], v1 offset:22528
  ds_read_b128 v[136:139], v1 offset:38912
  ds_read_b128 v[140:143], v1 offset:55296
  s_waitcnt vmcnt(28) lgkmcnt(8)
  v_mfma_f32_16x16x32_bf16 a[32:35], v[88:91], v[144:147], a[32:35]
  v_mfma_f32_16x16x32_bf16 a[36:39], v[88:91], v[148:151], a[36:39]
  v_mfma_f32_16x16x32_bf16 a[40:43], v[88:91], v[152:155], a[40:43]
  v_mfma_f32_16x16x32_bf16 a[44:47], v[88:91], v[156:159], a[44:47]
  v_mfma_f32_16x16x32_bf16 a[48:51], v[92:95], v[144:147], a[48:51]
  v_mfma_f32_16x16x32_bf16 a[52:55], v[92:95], v[148:151], a[52:55]
  v_mfma_f32_16x16x32_bf16 a[56:59], v[92:95], v[152:155], a[56:59]
  v_mfma_f32_16x16x32_bf16 a[60:63], v[92:95], v[156:159], a[60:63]
  global_load_dwordx4 v[88:91], v182, s[64:65] offset:3072
  global_load_dwordx4 v[92:95], v182, s[66:67] offset:3072
  ds_read_b128 v[144:147], v1 offset:7168
  ds_read_b128 v[148:151], v1 offset:23552
  ds_read_b128 v[152:155], v1 offset:39936
  ds_read_b128 v[156:159], v1 offset:56320
  s_waitcnt vmcnt(28) lgkmcnt(8)
  v_mfma_f32_16x16x32_bf16 a[32:35], v[96:99], v[112:115], a[32:35]
  v_mfma_f32_16x16x32_bf16 a[36:39], v[96:99], v[116:119], a[36:39]
  v_mfma_f32_16x16x32_bf16 a[40:43], v[96:99], v[120:123], a[40:43]
  v_mfma_f32_16x16x32_bf16 a[44:47], v[96:99], v[124:127], a[44:47]
  v_mfma_f32_16x16x32_bf16 a[48:51], v[100:103], v[112:115], a[48:51]
  v_mfma_f32_16x16x32_bf16 a[52:55], v[100:103], v[116:119], a[52:55]
  v_mfma_f32_16x16x32_bf16 a[56:59], v[100:103], v[120:123], a[56:59]
  v_mfma_f32_16x16x32_bf16 a[60:63], v[100:103], v[124:127], a[60:63]
  global_load_dwordx4 v[96:99], v1, s[68:69] offset:0
  global_load_dwordx4 v[100:103], v1, s[70:71] offset:0
  ds_read_b128 v[112:115], v1 offset:8192
  ds_read_b128 v[116:119], v1 offset:24576
  ds_read_b128 v[120:123], v1 offset:40960
  ds_read_b128 v[124:127], v1 offset:57344
  s_waitcnt vmcnt(28) lgkmcnt(8)
  v_mfma_f32_16x16x32_bf16 a[32:35], v[16:19], v[128:131], a[32:35]
  v_mfma_f32_16x16x32_bf16 a[36:39], v[16:19], v[132:135], a[36:39]
  v_mfma_f32_16x16x32_bf16 a[40:43], v[16:19], v[136:139], a[40:43]
  v_mfma_f32_16x16x32_bf16 a[44:47], v[16:19], v[140:143], a[44:47]
  v_mfma_f32_16x16x32_bf16 a[48:51], v[20:23], v[128:131], a[48:51]
  v_mfma_f32_16x16x32_bf16 a[52:55], v[20:23], v[132:135], a[52:55]
  v_mfma_f32_16x16x32_bf16 a[56:59], v[20:23], v[136:139], a[56:59]
  v_mfma_f32_16x16x32_bf16 a[60:63], v[20:23], v[140:143], a[60:63]
  global_load_dwordx4 v[16:19], v1, s[68:69] offset:1024
  global_load_dwordx4 v[20:23], v1, s[70:71] offset:1024
  ds_read_b128 v[128:131], v1 offset:9216
  ds_read_b128 v[132:135], v1 offset:25600
  ds_read_b128 v[136:139], v1 offset:41984
  ds_read_b128 v[140:143], v1 offset:58368
  s_waitcnt vmcnt(28) lgkmcnt(8)
  v_mfma_f32_16x16x32_bf16 a[32:35], v[24:27], v[144:147], a[32:35]
  v_mfma_f32_16x16x32_bf16 a[36:39], v[24:27], v[148:151], a[36:39]
  v_mfma_f32_16x16x32_bf16 a[40:43], v[24:27], v[152:155], a[40:43]
  v_mfma_f32_16x16x32_bf16 a[44:47], v[24:27], v[156:159], a[44:47]
  v_mfma_f32_16x16x32_bf16 a[48:51], v[28:31], v[144:147], a[48:51]
  v_mfma_f32_16x16x32_bf16 a[52:55], v[28:31], v[148:151], a[52:55]
  v_mfma_f32_16x16x32_bf16 a[56:59], v[28:31], v[152:155], a[56:59]
  v_mfma_f32_16x16x32_bf16 a[60:63], v[28:31], v[156:159], a[60:63]
  global_load_dwordx4 v[24:27], v1, s[68:69] offset:2048
  global_load_dwordx4 v[28:31], v1, s[70:71] offset:2048
  ds_read_b128 v[144:147], v1 offset:10240
  ds_read_b128 v[148:151], v1 offset:26624
  ds_read_b128 v[152:155], v1 offset:43008
  ds_read_b128 v[156:159], v1 offset:59392
  s_waitcnt vmcnt(28) lgkmcnt(8)
  v_mfma_f32_16x16x32_bf16 a[32:35], v[32:35], v[112:115], a[32:35]
  v_mfma_f32_16x16x32_bf16 a[36:39], v[32:35], v[116:119], a[36:39]
  v_mfma_f32_16x16x32_bf16 a[40:43], v[32:35], v[120:123], a[40:43]
  v_mfma_f32_16x16x32_bf16 a[44:47], v[32:35], v[124:127], a[44:47]
  v_mfma_f32_16x16x32_bf16 a[48:51], v[36:39], v[112:115], a[48:51]
  v_mfma_f32_16x16x32_bf16 a[52:55], v[36:39], v[116:119], a[52:55]
  v_mfma_f32_16x16x32_bf16 a[56:59], v[36:39], v[120:123], a[56:59]
  v_mfma_f32_16x16x32_bf16 a[60:63], v[36:39], v[124:127], a[60:63]
  global_load_dwordx4 v[32:35], v1, s[68:69] offset:3072
  global_load_dwordx4 v[36:39], v1, s[70:71] offset:3072
  ds_read_b128 v[112:115], v1 offset:11264
  ds_read_b128 v[116:119], v1 offset:27648
  ds_read_b128 v[120:123], v1 offset:44032
  ds_read_b128 v[124:127], v1 offset:60416
  s_waitcnt vmcnt(28) lgkmcnt(8)
  v_mfma_f32_16x16x32_bf16 a[32:35], v[40:43], v[128:131], a[32:35]
  v_mfma_f32_16x16x32_bf16 a[36:39], v[40:43], v[132:135], a[36:39]
  v_mfma_f32_16x16x32_bf16 a[40:43], v[40:43], v[136:139], a[40:43]
  v_mfma_f32_16x16x32_bf16 a[44:47], v[40:43], v[140:143], a[44:47]
  v_mfma_f32_16x16x32_bf16 a[48:51], v[44:47], v[128:131], a[48:51]
  v_mfma_f32_16x16x32_bf16 a[52:55], v[44:47], v[132:135], a[52:55]
  v_mfma_f32_16x16x32_bf16 a[56:59], v[44:47], v[136:139], a[56:59]
  v_mfma_f32_16x16x32_bf16 a[60:63], v[44:47], v[140:143], a[60:63]
  global_load_dwordx4 v[40:43], v180, s[68:69] offset:0
  global_load_dwordx4 v[44:47], v180, s[70:71] offset:0
  ds_read_b128 v[128:131], v1 offset:12288
  ds_read_b128 v[132:135], v1 offset:28672
  ds_read_b128 v[136:139], v1 offset:45056
  ds_read_b128 v[140:143], v1 offset:61440
  s_waitcnt vmcnt(28) lgkmcnt(8)
  v_mfma_f32_16x16x32_bf16 a[32:35], v[48:51], v[144:147], a[32:35]
  v_mfma_f32_16x16x32_bf16 a[36:39], v[48:51], v[148:151], a[36:39]
  v_mfma_f32_16x16x32_bf16 a[40:43], v[48:51], v[152:155], a[40:43]
  v_mfma_f32_16x16x32_bf16 a[44:47], v[48:51], v[156:159], a[44:47]
  v_mfma_f32_16x16x32_bf16 a[48:51], v[52:55], v[144:147], a[48:51]
  v_mfma_f32_16x16x32_bf16 a[52:55], v[52:55], v[148:151], a[52:55]
  v_mfma_f32_16x16x32_bf16 a[56:59], v[52:55], v[152:155], a[56:59]
  v_mfma_f32_16x16x32_bf16 a[60:63], v[52:55], v[156:159], a[60:63]
  global_load_dwordx4 v[48:51], v180, s[68:69] offset:1024
  global_load_dwordx4 v[52:55], v180, s[70:71] offset:1024
  ds_read_b128 v[144:147], v1 offset:13312
  ds_read_b128 v[148:151], v1 offset:29696
  ds_read_b128 v[152:155], v1 offset:46080
  ds_read_b128 v[156:159], v1 offset:62464
  s_waitcnt vmcnt(28) lgkmcnt(8)
  v_mfma_f32_16x16x32_bf16 a[32:35], v[56:59], v[112:115], a[32:35]
  v_mfma_f32_16x16x32_bf16 a[36:39], v[56:59], v[116:119], a[36:39]
  v_mfma_f32_16x16x32_bf16 a[40:43], v[56:59], v[120:123], a[40:43]
  v_mfma_f32_16x16x32_bf16 a[44:47], v[56:59], v[124:127], a[44:47]
  v_mfma_f32_16x16x32_bf16 a[48:51], v[60:63], v[112:115], a[48:51]
  v_mfma_f32_16x16x32_bf16 a[52:55], v[60:63], v[116:119], a[52:55]
  v_mfma_f32_16x16x32_bf16 a[56:59], v[60:63], v[120:123], a[56:59]
  v_mfma_f32_16x16x32_bf16 a[60:63], v[60:63], v[124:127], a[60:63]
  global_load_dwordx4 v[56:59], v180, s[68:69] offset:2048
  global_load_dwordx4 v[60:63], v180, s[70:71] offset:2048
  ds_read_b128 v[112:115], v1 offset:14336
  ds_read_b128 v[116:119], v1 offset:30720
  ds_read_b128 v[120:123], v1 offset:47104
  ds_read_b128 v[124:127], v1 offset:63488
  s_waitcnt vmcnt(28) lgkmcnt(8)
  v_mfma_f32_16x16x32_bf16 a[32:35], v[64:67], v[128:131], a[32:35]
  v_mfma_f32_16x16x32_bf16 a[36:39], v[64:67], v[132:135], a[36:39]
  v_mfma_f32_16x16x32_bf16 a[40:43], v[64:67], v[136:139], a[40:43]
  v_mfma_f32_16x16x32_bf16 a[44:47], v[64:67], v[140:143], a[44:47]
  v_mfma_f32_16x16x32_bf16 a[48:51], v[68:71], v[128:131], a[48:51]
  v_mfma_f32_16x16x32_bf16 a[52:55], v[68:71], v[132:135], a[52:55]
  v_mfma_f32_16x16x32_bf16 a[56:59], v[68:71], v[136:139], a[56:59]
  v_mfma_f32_16x16x32_bf16 a[60:63], v[68:71], v[140:143], a[60:63]
  global_load_dwordx4 v[64:67], v180, s[68:69] offset:3072
  global_load_dwordx4 v[68:71], v180, s[70:71] offset:3072
  ds_read_b128 v[128:131], v1 offset:15360
  ds_read_b128 v[132:135], v1 offset:31744
  ds_read_b128 v[136:139], v1 offset:48128
  ds_read_b128 v[140:143], v1 offset:64512
  s_waitcnt vmcnt(20) lgkmcnt(8)
  v_mfma_f32_16x16x32_bf16 a[32:35], v[72:75], v[144:147], a[32:35]
  v_mfma_f32_16x16x32_bf16 a[36:39], v[72:75], v[148:151], a[36:39]
  v_mfma_f32_16x16x32_bf16 a[40:43], v[72:75], v[152:155], a[40:43]
  v_mfma_f32_16x16x32_bf16 a[44:47], v[72:75], v[156:159], a[44:47]
  v_mfma_f32_16x16x32_bf16 a[48:51], v[76:79], v[144:147], a[48:51]
  v_mfma_f32_16x16x32_bf16 a[52:55], v[76:79], v[148:151], a[52:55]
  v_mfma_f32_16x16x32_bf16 a[56:59], v[76:79], v[152:155], a[56:59]
  v_mfma_f32_16x16x32_bf16 a[60:63], v[76:79], v[156:159], a[60:63]
  global_load_dwordx4 v[72:75], v181, s[68:69] offset:0
  global_load_dwordx4 v[76:79], v181, s[70:71] offset:0
  ds_read_b128 v[144:147], v1 offset:0
  ds_read_b128 v[148:151], v1 offset:16384
  ds_read_b128 v[152:155], v1 offset:32768
  ds_read_b128 v[156:159], v1 offset:49152
  s_waitcnt vmcnt(20) lgkmcnt(8)
  v_mfma_f32_16x16x32_bf16 a[32:35], v[80:83], v[112:115], a[32:35]
  v_mfma_f32_16x16x32_bf16 a[36:39], v[80:83], v[116:119], a[36:39]
  v_mfma_f32_16x16x32_bf16 a[40:43], v[80:83], v[120:123], a[40:43]
  v_mfma_f32_16x16x32_bf16 a[44:47], v[80:83], v[124:127], a[44:47]
  v_mfma_f32_16x16x32_bf16 a[48:51], v[84:87], v[112:115], a[48:51]
  v_mfma_f32_16x16x32_bf16 a[52:55], v[84:87], v[116:119], a[52:55]
  v_mfma_f32_16x16x32_bf16 a[56:59], v[84:87], v[120:123], a[56:59]
  v_mfma_f32_16x16x32_bf16 a[60:63], v[84:87], v[124:127], a[60:63]
  global_load_dwordx4 v[80:83], v181, s[68:69] offset:1024
  global_load_dwordx4 v[84:87], v181, s[70:71] offset:1024
  ds_read_b128 v[112:115], v1 offset:1024
  ds_read_b128 v[116:119], v1 offset:17408
  ds_read_b128 v[120:123], v1 offset:33792
  ds_read_b128 v[124:127], v1 offset:50176
  s_waitcnt vmcnt(20) lgkmcnt(8)
  v_mfma_f32_16x16x32_bf16 a[32:35], v[88:91], v[128:131], a[32:35]
  v_mfma_f32_16x16x32_bf16 a[36:39], v[88:91], v[132:135], a[36:39]
  v_mfma_f32_16x16x32_bf16 a[40:43], v[88:91], v[136:139], a[40:43]
  v_mfma_f32_16x16x32_bf16 a[44:47], v[88:91], v[140:143], a[44:47]
  v_mfma_f32_16x16x32_bf16 a[48:51], v[92:95], v[128:131], a[48:51]
  v_mfma_f32_16x16x32_bf16 a[52:55], v[92:95], v[132:135], a[52:55]
  v_mfma_f32_16x16x32_bf16 a[56:59], v[92:95], v[136:139], a[56:59]
  v_mfma_f32_16x16x32_bf16 a[60:63], v[92:95], v[140:143], a[60:63]
  global_load_dwordx4 v[88:91], v181, s[68:69] offset:2048
  global_load_dwordx4 v[92:95], v181, s[70:71] offset:2048
  ds_read_b128 v[128:131], v1 offset:2048
  ds_read_b128 v[132:135], v1 offset:18432
  ds_read_b128 v[136:139], v1 offset:34816
  ds_read_b128 v[140:143], v1 offset:51200
  s_waitcnt vmcnt(20) lgkmcnt(8)
  v_mfma_f32_16x16x32_bf16 a[0:3], v[96:99], v[144:147], 0
  v_mfma_f32_16x16x32_bf16 a[4:7], v[96:99], v[148:151], 0
  v_mfma_f32_16x16x32_bf16 a[8:11], v[96:99], v[152:155], 0
  v_mfma_f32_16x16x32_bf16 a[12:15], v[96:99], v[156:159], 0
  v_mfma_f32_16x16x32_bf16 a[16:19], v[100:103], v[144:147], 0
  v_mfma_f32_16x16x32_bf16 a[20:23], v[100:103], v[148:151], 0
  v_mfma_f32_16x16x32_bf16 a[24:27], v[100:103], v[152:155], 0
  v_mfma_f32_16x16x32_bf16 a[28:31], v[100:103], v[156:159], 0
  global_load_dwordx4 v[96:99], v181, s[68:69] offset:3072
  global_load_dwordx4 v[100:103], v181, s[70:71] offset:3072
  ds_read_b128 v[144:147], v1 offset:3072
  ds_read_b128 v[148:151], v1 offset:19456
  ds_read_b128 v[152:155], v1 offset:35840
  ds_read_b128 v[156:159], v1 offset:52224
  s_waitcnt vmcnt(20) lgkmcnt(8)
  v_mfma_f32_16x16x32_bf16 a[0:3], v[16:19], v[112:115], a[0:3]
  v_mfma_f32_16x16x32_bf16 a[4:7], v[16:19], v[116:119], a[4:7]
  v_mfma_f32_16x16x32_bf16 a[8:11], v[16:19], v[120:123], a[8:11]
  v_mfma_f32_16x16x32_bf16 a[12:15], v[16:19], v[124:127], a[12:15]
  v_mfma_f32_16x16x32_bf16 a[16:19], v[20:23], v[112:115], a[16:19]
  v_mfma_f32_16x16x32_bf16 a[20:23], v[20:23], v[116:119], a[20:23]
  v_mfma_f32_16x16x32_bf16 a[24:27], v[20:23], v[120:123], a[24:27]
  v_mfma_f32_16x16x32_bf16 a[28:31], v[20:23], v[124:127], a[28:31]
  global_load_dwordx4 v[16:19], v182, s[68:69] offset:0
  global_load_dwordx4 v[20:23], v182, s[70:71] offset:0
  ds_read_b128 v[112:115], v1 offset:4096
  ds_read_b128 v[116:119], v1 offset:20480
  ds_read_b128 v[120:123], v1 offset:36864
  ds_read_b128 v[124:127], v1 offset:53248
  s_waitcnt vmcnt(20) lgkmcnt(8)
  v_mfma_f32_16x16x32_bf16 a[0:3], v[24:27], v[128:131], a[0:3]
  v_mfma_f32_16x16x32_bf16 a[4:7], v[24:27], v[132:135], a[4:7]
  v_mfma_f32_16x16x32_bf16 a[8:11], v[24:27], v[136:139], a[8:11]
  v_mfma_f32_16x16x32_bf16 a[12:15], v[24:27], v[140:143], a[12:15]
  v_mfma_f32_16x16x32_bf16 a[16:19], v[28:31], v[128:131], a[16:19]
  v_mfma_f32_16x16x32_bf16 a[20:23], v[28:31], v[132:135], a[20:23]
  v_mfma_f32_16x16x32_bf16 a[24:27], v[28:31], v[136:139], a[24:27]
  v_mfma_f32_16x16x32_bf16 a[28:31], v[28:31], v[140:143], a[28:31]
  global_store_dwordx4 v176, a[32:35], s[12:13] offset:128 sc1
  global_store_dwordx4 v177, a[36:39], s[12:13] offset:128 sc1
  global_store_dwordx4 v178, a[40:43], s[12:13] offset:128 sc1
  global_store_dwordx4 v179, a[44:47], s[12:13] offset:128 sc1
  global_store_dwordx4 v176, a[48:51], s[12:13] offset:192 sc1
  global_store_dwordx4 v177, a[52:55], s[12:13] offset:192 sc1
  global_store_dwordx4 v178, a[56:59], s[12:13] offset:192 sc1
  global_store_dwordx4 v179, a[60:63], s[12:13] offset:192 sc1
  global_load_dwordx4 v[24:27], v182, s[68:69] offset:1024
  global_load_dwordx4 v[28:31], v182, s[70:71] offset:1024
  ds_read_b128 v[128:131], v1 offset:5120
  ds_read_b128 v[132:135], v1 offset:21504
  ds_read_b128 v[136:139], v1 offset:37888
  ds_read_b128 v[140:143], v1 offset:54272
  s_waitcnt vmcnt(28) lgkmcnt(8)
  v_mfma_f32_16x16x32_bf16 a[0:3], v[32:35], v[144:147], a[0:3]
  v_mfma_f32_16x16x32_bf16 a[4:7], v[32:35], v[148:151], a[4:7]
  v_mfma_f32_16x16x32_bf16 a[8:11], v[32:35], v[152:155], a[8:11]
  v_mfma_f32_16x16x32_bf16 a[12:15], v[32:35], v[156:159], a[12:15]
  v_mfma_f32_16x16x32_bf16 a[16:19], v[36:39], v[144:147], a[16:19]
  v_mfma_f32_16x16x32_bf16 a[20:23], v[36:39], v[148:151], a[20:23]
  v_mfma_f32_16x16x32_bf16 a[24:27], v[36:39], v[152:155], a[24:27]
  v_mfma_f32_16x16x32_bf16 a[28:31], v[36:39], v[156:159], a[28:31]
  global_load_dwordx4 v[32:35], v182, s[68:69] offset:2048
  global_load_dwordx4 v[36:39], v182, s[70:71] offset:2048
  ds_read_b128 v[144:147], v1 offset:6144
  ds_read_b128 v[148:151], v1 offset:22528
  ds_read_b128 v[152:155], v1 offset:38912
  ds_read_b128 v[156:159], v1 offset:55296
  s_waitcnt vmcnt(28) lgkmcnt(8)
  v_mfma_f32_16x16x32_bf16 a[0:3], v[40:43], v[112:115], a[0:3]
  v_mfma_f32_16x16x32_bf16 a[4:7], v[40:43], v[116:119], a[4:7]
  v_mfma_f32_16x16x32_bf16 a[8:11], v[40:43], v[120:123], a[8:11]
  v_mfma_f32_16x16x32_bf16 a[12:15], v[40:43], v[124:127], a[12:15]
  v_mfma_f32_16x16x32_bf16 a[16:19], v[44:47], v[112:115], a[16:19]
  v_mfma_f32_16x16x32_bf16 a[20:23], v[44:47], v[116:119], a[20:23]
  v_mfma_f32_16x16x32_bf16 a[24:27], v[44:47], v[120:123], a[24:27]
  v_mfma_f32_16x16x32_bf16 a[28:31], v[44:47], v[124:127], a[28:31]
  global_load_dwordx4 v[40:43], v182, s[68:69] offset:3072
  global_load_dwordx4 v[44:47], v182, s[70:71] offset:3072
  ds_read_b128 v[112:115], v1 offset:7168
  ds_read_b128 v[116:119], v1 offset:23552
  ds_read_b128 v[120:123], v1 offset:39936
  ds_read_b128 v[124:127], v1 offset:56320
  s_waitcnt vmcnt(28) lgkmcnt(8)
  v_mfma_f32_16x16x32_bf16 a[0:3], v[48:51], v[128:131], a[0:3]
  v_mfma_f32_16x16x32_bf16 a[4:7], v[48:51], v[132:135], a[4:7]
  v_mfma_f32_16x16x32_bf16 a[8:11], v[48:51], v[136:139], a[8:11]
  v_mfma_f32_16x16x32_bf16 a[12:15], v[48:51], v[140:143], a[12:15]
  v_mfma_f32_16x16x32_bf16 a[16:19], v[52:55], v[128:131], a[16:19]
  v_mfma_f32_16x16x32_bf16 a[20:23], v[52:55], v[132:135], a[20:23]
  v_mfma_f32_16x16x32_bf16 a[24:27], v[52:55], v[136:139], a[24:27]
  v_mfma_f32_16x16x32_bf16 a[28:31], v[52:55], v[140:143], a[28:31]
  global_load_dwordx4 v[48:51], v1, s[72:73] offset:0
  global_load_dwordx4 v[52:55], v1, s[74:75] offset:0
  ds_read_b128 v[128:131], v1 offset:8192
  ds_read_b128 v[132:135], v1 offset:24576
  ds_read_b128 v[136:139], v1 offset:40960
  ds_read_b128 v[140:143], v1 offset:57344
  s_waitcnt vmcnt(28) lgkmcnt(8)
  v_mfma_f32_16x16x32_bf16 a[0:3], v[56:59], v[144:147], a[0:3]
  v_mfma_f32_16x16x32_bf16 a[4:7], v[56:59], v[148:151], a[4:7]
  v_mfma_f32_16x16x32_bf16 a[8:11], v[56:59], v[152:155], a[8:11]
  v_mfma_f32_16x16x32_bf16 a[12:15], v[56:59], v[156:159], a[12:15]
  v_mfma_f32_16x16x32_bf16 a[16:19], v[60:63], v[144:147], a[16:19]
  v_mfma_f32_16x16x32_bf16 a[20:23], v[60:63], v[148:151], a[20:23]
  v_mfma_f32_16x16x32_bf16 a[24:27], v[60:63], v[152:155], a[24:27]
  v_mfma_f32_16x16x32_bf16 a[28:31], v[60:63], v[156:159], a[28:31]
  global_load_dwordx4 v[56:59], v1, s[72:73] offset:1024
  global_load_dwordx4 v[60:63], v1, s[74:75] offset:1024
  ds_read_b128 v[144:147], v1 offset:9216
  ds_read_b128 v[148:151], v1 offset:25600
  ds_read_b128 v[152:155], v1 offset:41984
  ds_read_b128 v[156:159], v1 offset:58368
  s_waitcnt vmcnt(28) lgkmcnt(8)
  v_mfma_f32_16x16x32_bf16 a[0:3], v[64:67], v[112:115], a[0:3]
  v_mfma_f32_16x16x32_bf16 a[4:7], v[64:67], v[116:119], a[4:7]
  v_mfma_f32_16x16x32_bf16 a[8:11], v[64:67], v[120:123], a[8:11]
  v_mfma_f32_16x16x32_bf16 a[12:15], v[64:67], v[124:127], a[12:15]
  v_mfma_f32_16x16x32_bf16 a[16:19], v[68:71], v[112:115], a[16:19]
  v_mfma_f32_16x16x32_bf16 a[20:23], v[68:71], v[116:119], a[20:23]
  v_mfma_f32_16x16x32_bf16 a[24:27], v[68:71], v[120:123], a[24:27]
  v_mfma_f32_16x16x32_bf16 a[28:31], v[68:71], v[124:127], a[28:31]
  global_load_dwordx4 v[64:67], v1, s[72:73] offset:2048
  global_load_dwordx4 v[68:71], v1, s[74:75] offset:2048
  ds_read_b128 v[112:115], v1 offset:10240
  ds_read_b128 v[116:119], v1 offset:26624
  ds_read_b128 v[120:123], v1 offset:43008
  ds_read_b128 v[124:127], v1 offset:59392
  s_waitcnt vmcnt(28) lgkmcnt(8)
  v_mfma_f32_16x16x32_bf16 a[0:3], v[72:75], v[128:131], a[0:3]
  v_mfma_f32_16x16x32_bf16 a[4:7], v[72:75], v[132:135], a[4:7]
  v_mfma_f32_16x16x32_bf16 a[8:11], v[72:75], v[136:139], a[8:11]
  v_mfma_f32_16x16x32_bf16 a[12:15], v[72:75], v[140:143], a[12:15]
  v_mfma_f32_16x16x32_bf16 a[16:19], v[76:79], v[128:131], a[16:19]
  v_mfma_f32_16x16x32_bf16 a[20:23], v[76:79], v[132:135], a[20:23]
  v_mfma_f32_16x16x32_bf16 a[24:27], v[76:79], v[136:139], a[24:27]
  v_mfma_f32_16x16x32_bf16 a[28:31], v[76:79], v[140:143], a[28:31]
  global_load_dwordx4 v[72:75], v1, s[72:73] offset:3072
  global_load_dwordx4 v[76:79], v1, s[74:75] offset:3072
  ds_read_b128 v[128:131], v1 offset:11264
  ds_read_b128 v[132:135], v1 offset:27648
  ds_read_b128 v[136:139], v1 offset:44032
  ds_read_b128 v[140:143], v1 offset:60416
  s_waitcnt vmcnt(28) lgkmcnt(8)
  v_mfma_f32_16x16x32_bf16 a[0:3], v[80:83], v[144:147], a[0:3]
  v_mfma_f32_16x16x32_bf16 a[4:7], v[80:83], v[148:151], a[4:7]
  v_mfma_f32_16x16x32_bf16 a[8:11], v[80:83], v[152:155], a[8:11]
  v_mfma_f32_16x16x32_bf16 a[12:15], v[80:83], v[156:159], a[12:15]
  v_mfma_f32_16x16x32_bf16 a[16:19], v[84:87], v[144:147], a[16:19]
  v_mfma_f32_16x16x32_bf16 a[20:23], v[84:87], v[148:151], a[20:23]
  v_mfma_f32_16x16x32_bf16 a[24:27], v[84:87], v[152:155], a[24:27]
  v_mfma_f32_16x16x32_bf16 a[28:31], v[84:87], v[156:159], a[28:31]
  global_load_dwordx4 v[80:83], v180, s[72:73] offset:0
  global_load_dwordx4 v[84:87], v180, s[74:75] offset:0
  ds_read_b128 v[144:147], v1 offset:12288
  ds_read_b128 v[148:151], v1 offset:28672
  ds_read_b128 v[152:155], v1 offset:45056
  ds_read_b128 v[156:159], v1 offset:61440
  s_waitcnt vmcnt(28) lgkmcnt(8)
  v_mfma_f32_16x16x32_bf16 a[0:3], v[88:91], v[112:115], a[0:3]
  v_mfma_f32_16x16x32_bf16 a[4:7], v[88:91], v[116:119], a[4:7]
  v_mfma_f32_16x16x32_bf16 a[8:11], v[88:91], v[120:123], a[8:11]
  v_mfma_f32_16x16x32_bf16 a[12:15], v[88:91], v[124:127], a[12:15]
  v_mfma_f32_16x16x32_bf16 a[16:19], v[92:95], v[112:115], a[16:19]
  v_mfma_f32_16x16x32_bf16 a[20:23], v[92:95], v[116:119], a[20:23]
  v_mfma_f32_16x16x32_bf16 a[24:27], v[92:95], v[120:123], a[24:27]
  v_mfma_f32_16x16x32_bf16 a[28:31], v[92:95], v[124:127], a[28:31]
  global_load_dwordx4 v[88:91], v180, s[72:73] offset:1024
  global_load_dwordx4 v[92:95], v180, s[74:75] offset:1024
  ds_read_b128 v[112:115], v1 offset:13312
  ds_read_b128 v[116:119], v1 offset:29696
  ds_read_b128 v[120:123], v1 offset:46080
  ds_read_b128 v[124:127], v1 offset:62464
  s_waitcnt vmcnt(28) lgkmcnt(8)
  v_mfma_f32_16x16x32_bf16 a[0:3], v[96:99], v[128:131], a[0:3]
  v_mfma_f32_16x16x32_bf16 a[4:7], v[96:99], v[132:135], a[4:7]
  v_mfma_f32_16x16x32_bf16 a[8:11], v[96:99], v[136:139], a[8:11]
  v_mfma_f32_16x16x32_bf16 a[12:15], v[96:99], v[140:143], a[12:15]
  v_mfma_f32_16x16x32_bf16 a[16:19], v[100:103], v[128:131], a[16:19]
  v_mfma_f32_16x16x32_bf16 a[20:23], v[100:103], v[132:135], a[20:23]
  v_mfma_f32_16x16x32_bf16 a[24:27], v[100:103], v[136:139], a[24:27]
  v_mfma_f32_16x16x32_bf16 a[28:31], v[100:103], v[140:143], a[28:31]
  global_load_dwordx4 v[96:99], v180, s[72:73] offset:2048
  global_load_dwordx4 v[100:103], v180, s[74:75] offset:2048
  ds_read_b128 v[128:131], v1 offset:14336
  ds_read_b128 v[132:135], v1 offset:30720
  ds_read_b128 v[136:139], v1 offset:47104
  ds_read_b128 v[140:143], v1 offset:63488
  s_waitcnt vmcnt(28) lgkmcnt(8)
  v_mfma_f32_16x16x32_bf16 a[0:3], v[16:19], v[144:147], a[0:3]
  v_mfma_f32_16x16x32_bf16 a[4:7], v[16:19], v[148:151], a[4:7]
  v_mfma_f32_16x16x32_bf16 a[8:11], v[16:19], v[152:155], a[8:11]
  v_mfma_f32_16x16x32_bf16 a[12:15], v[16:19], v[156:159], a[12:15]
  v_mfma_f32_16x16x32_bf16 a[16:19], v[20:23], v[144:147], a[16:19]
  v_mfma_f32_16x16x32_bf16 a[20:23], v[20:23], v[148:151], a[20:23]
  v_mfma_f32_16x16x32_bf16 a[24:27], v[20:23], v[152:155], a[24:27]
  v_mfma_f32_16x16x32_bf16 a[28:31], v[20:23], v[156:159], a[28:31]
  global_load_dwordx4 v[16:19], v180, s[72:73] offset:3072
  global_load_dwordx4 v[20:23], v180, s[74:75] offset:3072
  ds_read_b128 v[144:147], v1 offset:15360
  ds_read_b128 v[148:151], v1 offset:31744
  ds_read_b128 v[152:155], v1 offset:48128
  ds_read_b128 v[156:159], v1 offset:64512
  s_waitcnt vmcnt(20) lgkmcnt(8)
  v_mfma_f32_16x16x32_bf16 a[0:3], v[24:27], v[112:115], a[0:3]
  v_mfma_f32_16x16x32_bf16 a[4:7], v[24:27], v[116:119], a[4:7]
  v_mfma_f32_16x16x32_bf16 a[8:11], v[24:27], v[120:123], a[8:11]
  v_mfma_f32_16x16x32_bf16 a[12:15], v[24:27], v[124:127], a[12:15]
  v_mfma_f32_16x16x32_bf16 a[16:19], v[28:31], v[112:115], a[16:19]
  v_mfma_f32_16x16x32_bf16 a[20:23], v[28:31], v[116:119], a[20:23]
  v_mfma_f32_16x16x32_bf16 a[24:27], v[28:31], v[120:123], a[24:27]
  v_mfma_f32_16x16x32_bf16 a[28:31], v[28:31], v[124:127], a[28:31]
  global_load_dwordx4 v[24:27], v181, s[72:73] offset:0
  global_load_dwordx4 v[28:31], v181, s[74:75] offset:0
  ds_read_b128 v[112:115], v1 offset:0
  ds_read_b128 v[116:119], v1 offset:16384
  ds_read_b128 v[120:123], v1 offset:32768
  ds_read_b128 v[124:127], v1 offset:49152
  s_waitcnt vmcnt(20) lgkmcnt(8)
  v_mfma_f32_16x16x32_bf16 a[0:3], v[32:35], v[128:131], a[0:3]
  v_mfma_f32_16x16x32_bf16 a[4:7], v[32:35], v[132:135], a[4:7]
  v_mfma_f32_16x16x32_bf16 a[8:11], v[32:35], v[136:139], a[8:11]
  v_mfma_f32_16x16x32_bf16 a[12:15], v[32:35], v[140:143], a[12:15]
  v_mfma_f32_16x16x32_bf16 a[16:19], v[36:39], v[128:131], a[16:19]
  v_mfma_f32_16x16x32_bf16 a[20:23], v[36:39], v[132:135], a[20:23]
  v_mfma_f32_16x16x32_bf16 a[24:27], v[36:39], v[136:139], a[24:27]
  v_mfma_f32_16x16x32_bf16 a[28:31], v[36:39], v[140:143], a[28:31]
  global_load_dwordx4 v[32:35], v181, s[72:73] offset:1024
  global_load_dwordx4 v[36:39], v181, s[74:75] offset:1024
  ds_read_b128 v[128:131], v1 offset:1024
  ds_read_b128 v[132:135], v1 offset:17408
  ds_read_b128 v[136:139], v1 offset:33792
  ds_read_b128 v[140:143], v1 offset:50176
  s_waitcnt vmcnt(20) lgkmcnt(8)
  v_mfma_f32_16x16x32_bf16 a[0:3], v[40:43], v[144:147], a[0:3]
  v_mfma_f32_16x16x32_bf16 a[4:7], v[40:43], v[148:151], a[4:7]
  v_mfma_f32_16x16x32_bf16 a[8:11], v[40:43], v[152:155], a[8:11]
  v_mfma_f32_16x16x32_bf16 a[12:15], v[40:43], v[156:159], a[12:15]
  v_mfma_f32_16x16x32_bf16 a[16:19], v[44:47], v[144:147], a[16:19]
  v_mfma_f32_16x16x32_bf16 a[20:23], v[44:47], v[148:151], a[20:23]
  v_mfma_f32_16x16x32_bf16 a[24:27], v[44:47], v[152:155], a[24:27]
  v_mfma_f32_16x16x32_bf16 a[28:31], v[44:47], v[156:159], a[28:31]
  global_load_dwordx4 v[40:43], v181, s[72:73] offset:2048
  global_load_dwordx4 v[44:47], v181, s[74:75] offset:2048
  ds_read_b128 v[144:147], v1 offset:2048
  ds_read_b128 v[148:151], v1 offset:18432
  ds_read_b128 v[152:155], v1 offset:34816
  ds_read_b128 v[156:159], v1 offset:51200
  s_waitcnt vmcnt(20) lgkmcnt(8)
  v_mfma_f32_16x16x32_bf16 a[32:35], v[48:51], v[112:115], 0
  v_mfma_f32_16x16x32_bf16 a[36:39], v[48:51], v[116:119], 0
  v_mfma_f32_16x16x32_bf16 a[40:43], v[48:51], v[120:123], 0
  v_mfma_f32_16x16x32_bf16 a[44:47], v[48:51], v[124:127], 0
  v_mfma_f32_16x16x32_bf16 a[48:51], v[52:55], v[112:115], 0
  v_mfma_f32_16x16x32_bf16 a[52:55], v[52:55], v[116:119], 0
  v_mfma_f32_16x16x32_bf16 a[56:59], v[52:55], v[120:123], 0
  v_mfma_f32_16x16x32_bf16 a[60:63], v[52:55], v[124:127], 0
  global_load_dwordx4 v[48:51], v181, s[72:73] offset:3072
  global_load_dwordx4 v[52:55], v181, s[74:75] offset:3072
  ds_read_b128 v[112:115], v1 offset:3072
  ds_read_b128 v[116:119], v1 offset:19456
  ds_read_b128 v[120:123], v1 offset:35840
  ds_read_b128 v[124:127], v1 offset:52224
  s_waitcnt vmcnt(20) lgkmcnt(8)
  v_mfma_f32_16x16x32_bf16 a[32:35], v[56:59], v[128:131], a[32:35]
  v_mfma_f32_16x16x32_bf16 a[36:39], v[56:59], v[132:135], a[36:39]
  v_mfma_f32_16x16x32_bf16 a[40:43], v[56:59], v[136:139], a[40:43]
  v_mfma_f32_16x16x32_bf16 a[44:47], v[56:59], v[140:143], a[44:47]
  v_mfma_f32_16x16x32_bf16 a[48:51], v[60:63], v[128:131], a[48:51]
  v_mfma_f32_16x16x32_bf16 a[52:55], v[60:63], v[132:135], a[52:55]
  v_mfma_f32_16x16x32_bf16 a[56:59], v[60:63], v[136:139], a[56:59]
  v_mfma_f32_16x16x32_bf16 a[60:63], v[60:63], v[140:143], a[60:63]
  global_load_dwordx4 v[56:59], v182, s[72:73] offset:0
  global_load_dwordx4 v[60:63], v182, s[74:75] offset:0
  ds_read_b128 v[128:131], v1 offset:4096
  ds_read_b128 v[132:135], v1 offset:20480
  ds_read_b128 v[136:139], v1 offset:36864
  ds_read_b128 v[140:143], v1 offset:53248
  s_waitcnt vmcnt(20) lgkmcnt(8)
  v_mfma_f32_16x16x32_bf16 a[32:35], v[64:67], v[144:147], a[32:35]
  v_mfma_f32_16x16x32_bf16 a[36:39], v[64:67], v[148:151], a[36:39]
  v_mfma_f32_16x16x32_bf16 a[40:43], v[64:67], v[152:155], a[40:43]
  v_mfma_f32_16x16x32_bf16 a[44:47], v[64:67], v[156:159], a[44:47]
  v_mfma_f32_16x16x32_bf16 a[48:51], v[68:71], v[144:147], a[48:51]
  v_mfma_f32_16x16x32_bf16 a[52:55], v[68:71], v[148:151], a[52:55]
  v_mfma_f32_16x16x32_bf16 a[56:59], v[68:71], v[152:155], a[56:59]
  v_mfma_f32_16x16x32_bf16 a[60:63], v[68:71], v[156:159], a[60:63]
  global_store_dwordx4 v176, a[0:3], s[12:13] offset:256 sc1
  global_store_dwordx4 v177, a[4:7], s[12:13] offset:256 sc1
  global_store_dwordx4 v178, a[8:11], s[12:13] offset:256 sc1
  global_store_dwordx4 v179, a[12:15], s[12:13] offset:256 sc1
  global_store_dwordx4 v176, a[16:19], s[12:13] offset:320 sc1
  global_store_dwordx4 v177, a[20:23], s[12:13] offset:320 sc1
  global_store_dwordx4 v178, a[24:27], s[12:13] offset:320 sc1
  global_store_dwordx4 v179, a[28:31], s[12:13] offset:320 sc1
  global_load_dwordx4 v[64:67], v182, s[72:73] offset:1024
  global_load_dwordx4 v[68:71], v182, s[74:75] offset:1024
  ds_read_b128 v[144:147], v1 offset:5120
  ds_read_b128 v[148:151], v1 offset:21504
  ds_read_b128 v[152:155], v1 offset:37888
  ds_read_b128 v[156:159], v1 offset:54272
  s_waitcnt vmcnt(28) lgkmcnt(8)
  v_mfma_f32_16x16x32_bf16 a[32:35], v[72:75], v[112:115], a[32:35]
  v_mfma_f32_16x16x32_bf16 a[36:39], v[72:75], v[116:119], a[36:39]
  v_mfma_f32_16x16x32_bf16 a[40:43], v[72:75], v[120:123], a[40:43]
  v_mfma_f32_16x16x32_bf16 a[44:47], v[72:75], v[124:127], a[44:47]
  v_mfma_f32_16x16x32_bf16 a[48:51], v[76:79], v[112:115], a[48:51]
  v_mfma_f32_16x16x32_bf16 a[52:55], v[76:79], v[116:119], a[52:55]
  v_mfma_f32_16x16x32_bf16 a[56:59], v[76:79], v[120:123], a[56:59]
  v_mfma_f32_16x16x32_bf16 a[60:63], v[76:79], v[124:127], a[60:63]
  global_load_dwordx4 v[72:75], v182, s[72:73] offset:2048
  global_load_dwordx4 v[76:79], v182, s[74:75] offset:2048
  ds_read_b128 v[112:115], v1 offset:6144
  ds_read_b128 v[116:119], v1 offset:22528
  ds_read_b128 v[120:123], v1 offset:38912
  ds_read_b128 v[124:127], v1 offset:55296
  s_waitcnt vmcnt(28) lgkmcnt(8)
  v_mfma_f32_16x16x32_bf16 a[32:35], v[80:83], v[128:131], a[32:35]
  v_mfma_f32_16x16x32_bf16 a[36:39], v[80:83], v[132:135], a[36:39]
  v_mfma_f32_16x16x32_bf16 a[40:43], v[80:83], v[136:139], a[40:43]
  v_mfma_f32_16x16x32_bf16 a[44:47], v[80:83], v[140:143], a[44:47]
  v_mfma_f32_16x16x32_bf16 a[48:51], v[84:87], v[128:131], a[48:51]
  v_mfma_f32_16x16x32_bf16 a[52:55], v[84:87], v[132:135], a[52:55]
  v_mfma_f32_16x16x32_bf16 a[56:59], v[84:87], v[136:139], a[56:59]
  v_mfma_f32_16x16x32_bf16 a[60:63], v[84:87], v[140:143], a[60:63]
  global_load_dwordx4 v[80:83], v182, s[72:73] offset:3072
  global_load_dwordx4 v[84:87], v182, s[74:75] offset:3072
  ds_read_b128 v[128:131], v1 offset:7168
  ds_read_b128 v[132:135], v1 offset:23552
  ds_read_b128 v[136:139], v1 offset:39936
  ds_read_b128 v[140:143], v1 offset:56320
  s_waitcnt vmcnt(28) lgkmcnt(8)
  v_mfma_f32_16x16x32_bf16 a[32:35], v[88:91], v[144:147], a[32:35]
  v_mfma_f32_16x16x32_bf16 a[36:39], v[88:91], v[148:151], a[36:39]
  v_mfma_f32_16x16x32_bf16 a[40:43], v[88:91], v[152:155], a[40:43]
  v_mfma_f32_16x16x32_bf16 a[44:47], v[88:91], v[156:159], a[44:47]
  v_mfma_f32_16x16x32_bf16 a[48:51], v[92:95], v[144:147], a[48:51]
  v_mfma_f32_16x16x32_bf16 a[52:55], v[92:95], v[148:151], a[52:55]
  v_mfma_f32_16x16x32_bf16 a[56:59], v[92:95], v[152:155], a[56:59]
  v_mfma_f32_16x16x32_bf16 a[60:63], v[92:95], v[156:159], a[60:63]
  global_load_dwordx4 v[88:91], v1, s[76:77] offset:0
  global_load_dwordx4 v[92:95], v1, s[78:79] offset:0
  ds_read_b128 v[144:147], v1 offset:8192
  ds_read_b128 v[148:151], v1 offset:24576
  ds_read_b128 v[152:155], v1 offset:40960
  ds_read_b128 v[156:159], v1 offset:57344
  s_waitcnt vmcnt(28) lgkmcnt(8)
  v_mfma_f32_16x16x32_bf16 a[32:35], v[96:99], v[112:115], a[32:35]
  v_mfma_f32_16x16x32_bf16 a[36:39], v[96:99], v[116:119], a[36:39]
  v_mfma_f32_16x16x32_bf16 a[40:43], v[96:99], v[120:123], a[40:43]
  v_mfma_f32_16x16x32_bf16 a[44:47], v[96:99], v[124:127], a[44:47]
  v_mfma_f32_16x16x32_bf16 a[48:51], v[100:103], v[112:115], a[48:51]
  v_mfma_f32_16x16x32_bf16 a[52:55], v[100:103], v[116:119], a[52:55]
  v_mfma_f32_16x16x32_bf16 a[56:59], v[100:103], v[120:123], a[56:59]
  v_mfma_f32_16x16x32_bf16 a[60:63], v[100:103], v[124:127], a[60:63]
  global_load_dwordx4 v[96:99], v1, s[76:77] offset:1024
  global_load_dwordx4 v[100:103], v1, s[78:79] offset:1024
  ds_read_b128 v[112:115], v1 offset:9216
  ds_read_b128 v[116:119], v1 offset:25600
  ds_read_b128 v[120:123], v1 offset:41984
  ds_read_b128 v[124:127], v1 offset:58368
  s_waitcnt vmcnt(28) lgkmcnt(8)
  v_mfma_f32_16x16x32_bf16 a[32:35], v[16:19], v[128:131], a[32:35]
  v_mfma_f32_16x16x32_bf16 a[36:39], v[16:19], v[132:135], a[36:39]
  v_mfma_f32_16x16x32_bf16 a[40:43], v[16:19], v[136:139], a[40:43]
  v_mfma_f32_16x16x32_bf16 a[44:47], v[16:19], v[140:143], a[44:47]
  v_mfma_f32_16x16x32_bf16 a[48:51], v[20:23], v[128:131], a[48:51]
  v_mfma_f32_16x16x32_bf16 a[52:55], v[20:23], v[132:135], a[52:55]
  v_mfma_f32_16x16x32_bf16 a[56:59], v[20:23], v[136:139], a[56:59]
  v_mfma_f32_16x16x32_bf16 a[60:63], v[20:23], v[140:143], a[60:63]
  global_load_dwordx4 v[16:19], v1, s[76:77] offset:2048
  global_load_dwordx4 v[20:23], v1, s[78:79] offset:2048
  ds_read_b128 v[128:131], v1 offset:10240
  ds_read_b128 v[132:135], v1 offset:26624
  ds_read_b128 v[136:139], v1 offset:43008
  ds_read_b128 v[140:143], v1 offset:59392
  s_waitcnt vmcnt(28) lgkmcnt(8)
  v_mfma_f32_16x16x32_bf16 a[32:35], v[24:27], v[144:147], a[32:35]
  v_mfma_f32_16x16x32_bf16 a[36:39], v[24:27], v[148:151], a[36:39]
  v_mfma_f32_16x16x32_bf16 a[40:43], v[24:27], v[152:155], a[40:43]
  v_mfma_f32_16x16x32_bf16 a[44:47], v[24:27], v[156:159], a[44:47]
  v_mfma_f32_16x16x32_bf16 a[48:51], v[28:31], v[144:147], a[48:51]
  v_mfma_f32_16x16x32_bf16 a[52:55], v[28:31], v[148:151], a[52:55]
  v_mfma_f32_16x16x32_bf16 a[56:59], v[28:31], v[152:155], a[56:59]
  v_mfma_f32_16x16x32_bf16 a[60:63], v[28:31], v[156:159], a[60:63]
  global_load_dwordx4 v[24:27], v1, s[76:77] offset:3072
  global_load_dwordx4 v[28:31], v1, s[78:79] offset:3072
  ds_read_b128 v[144:147], v1 offset:11264
  ds_read_b128 v[148:151], v1 offset:27648
  ds_read_b128 v[152:155], v1 offset:44032
  ds_read_b128 v[156:159], v1 offset:60416
  s_waitcnt vmcnt(28) lgkmcnt(8)
  v_mfma_f32_16x16x32_bf16 a[32:35], v[32:35], v[112:115], a[32:35]
  v_mfma_f32_16x16x32_bf16 a[36:39], v[32:35], v[116:119], a[36:39]
  v_mfma_f32_16x16x32_bf16 a[40:43], v[32:35], v[120:123], a[40:43]
  v_mfma_f32_16x16x32_bf16 a[44:47], v[32:35], v[124:127], a[44:47]
  v_mfma_f32_16x16x32_bf16 a[48:51], v[36:39], v[112:115], a[48:51]
  v_mfma_f32_16x16x32_bf16 a[52:55], v[36:39], v[116:119], a[52:55]
  v_mfma_f32_16x16x32_bf16 a[56:59], v[36:39], v[120:123], a[56:59]
  v_mfma_f32_16x16x32_bf16 a[60:63], v[36:39], v[124:127], a[60:63]
  global_load_dwordx4 v[32:35], v180, s[76:77] offset:0
  global_load_dwordx4 v[36:39], v180, s[78:79] offset:0
  ds_read_b128 v[112:115], v1 offset:12288
  ds_read_b128 v[116:119], v1 offset:28672
  ds_read_b128 v[120:123], v1 offset:45056
  ds_read_b128 v[124:127], v1 offset:61440
  s_waitcnt vmcnt(28) lgkmcnt(8)
  v_mfma_f32_16x16x32_bf16 a[32:35], v[40:43], v[128:131], a[32:35]
  v_mfma_f32_16x16x32_bf16 a[36:39], v[40:43], v[132:135], a[36:39]
  v_mfma_f32_16x16x32_bf16 a[40:43], v[40:43], v[136:139], a[40:43]
  v_mfma_f32_16x16x32_bf16 a[44:47], v[40:43], v[140:143], a[44:47]
  v_mfma_f32_16x16x32_bf16 a[48:51], v[44:47], v[128:131], a[48:51]
  v_mfma_f32_16x16x32_bf16 a[52:55], v[44:47], v[132:135], a[52:55]
  v_mfma_f32_16x16x32_bf16 a[56:59], v[44:47], v[136:139], a[56:59]
  v_mfma_f32_16x16x32_bf16 a[60:63], v[44:47], v[140:143], a[60:63]
  global_load_dwordx4 v[40:43], v180, s[76:77] offset:1024
  global_load_dwordx4 v[44:47], v180, s[78:79] offset:1024
  ds_read_b128 v[128:131], v1 offset:13312
  ds_read_b128 v[132:135], v1 offset:29696
  ds_read_b128 v[136:139], v1 offset:46080
  ds_read_b128 v[140:143], v1 offset:62464
  s_waitcnt vmcnt(28) lgkmcnt(8)
  v_mfma_f32_16x16x32_bf16 a[32:35], v[48:51], v[144:147], a[32:35]
  v_mfma_f32_16x16x32_bf16 a[36:39], v[48:51], v[148:151], a[36:39]
  v_mfma_f32_16x16x32_bf16 a[40:43], v[48:51], v[152:155], a[40:43]
  v_mfma_f32_16x16x32_bf16 a[44:47], v[48:51], v[156:159], a[44:47]
  v_mfma_f32_16x16x32_bf16 a[48:51], v[52:55], v[144:147], a[48:51]
  v_mfma_f32_16x16x32_bf16 a[52:55], v[52:55], v[148:151], a[52:55]
  v_mfma_f32_16x16x32_bf16 a[56:59], v[52:55], v[152:155], a[56:59]
  v_mfma_f32_16x16x32_bf16 a[60:63], v[52:55], v[156:159], a[60:63]
  global_load_dwordx4 v[48:51], v180, s[76:77] offset:2048
  global_load_dwordx4 v[52:55], v180, s[78:79] offset:2048
  ds_read_b128 v[144:147], v1 offset:14336
  ds_read_b128 v[148:151], v1 offset:30720
  ds_read_b128 v[152:155], v1 offset:47104
  ds_read_b128 v[156:159], v1 offset:63488
  s_waitcnt vmcnt(28) lgkmcnt(8)
  v_mfma_f32_16x16x32_bf16 a[32:35], v[56:59], v[112:115], a[32:35]
  v_mfma_f32_16x16x32_bf16 a[36:39], v[56:59], v[116:119], a[36:39]
  v_mfma_f32_16x16x32_bf16 a[40:43], v[56:59], v[120:123], a[40:43]
  v_mfma_f32_16x16x32_bf16 a[44:47], v[56:59], v[124:127], a[44:47]
  v_mfma_f32_16x16x32_bf16 a[48:51], v[60:63], v[112:115], a[48:51]
  v_mfma_f32_16x16x32_bf16 a[52:55], v[60:63], v[116:119], a[52:55]
  v_mfma_f32_16x16x32_bf16 a[56:59], v[60:63], v[120:123], a[56:59]
  v_mfma_f32_16x16x32_bf16 a[60:63], v[60:63], v[124:127], a[60:63]
  global_load_dwordx4 v[56:59], v180, s[76:77] offset:3072
  global_load_dwordx4 v[60:63], v180, s[78:79] offset:3072
  ds_read_b128 v[112:115], v1 offset:15360
  ds_read_b128 v[116:119], v1 offset:31744
  ds_read_b128 v[120:123], v1 offset:48128
  ds_read_b128 v[124:127], v1 offset:64512
  s_waitcnt vmcnt(20) lgkmcnt(8)
  v_mfma_f32_16x16x32_bf16 a[32:35], v[64:67], v[128:131], a[32:35]
  v_mfma_f32_16x16x32_bf16 a[36:39], v[64:67], v[132:135], a[36:39]
  v_mfma_f32_16x16x32_bf16 a[40:43], v[64:67], v[136:139], a[40:43]
  v_mfma_f32_16x16x32_bf16 a[44:47], v[64:67], v[140:143], a[44:47]
  v_mfma_f32_16x16x32_bf16 a[48:51], v[68:71], v[128:131], a[48:51]
  v_mfma_f32_16x16x32_bf16 a[52:55], v[68:71], v[132:135], a[52:55]
  v_mfma_f32_16x16x32_bf16 a[56:59], v[68:71], v[136:139], a[56:59]
  v_mfma_f32_16x16x32_bf16 a[60:63], v[68:71], v[140:143], a[60:63]
  global_load_dwordx4 v[64:67], v181, s[76:77] offset:0
  global_load_dwordx4 v[68:71], v181, s[78:79] offset:0
  ds_read_b128 v[128:131], v1 offset:0
  ds_read_b128 v[132:135], v1 offset:16384
  ds_read_b128 v[136:139], v1 offset:32768
  ds_read_b128 v[140:143], v1 offset:49152
  s_waitcnt vmcnt(20) lgkmcnt(8)
  v_mfma_f32_16x16x32_bf16 a[32:35], v[72:75], v[144:147], a[32:35]
  v_mfma_f32_16x16x32_bf16 a[36:39], v[72:75], v[148:151], a[36:39]
  v_mfma_f32_16x16x32_bf16 a[40:43], v[72:75], v[152:155], a[40:43]
  v_mfma_f32_16x16x32_bf16 a[44:47], v[72:75], v[156:159], a[44:47]
  v_mfma_f32_16x16x32_bf16 a[48:51], v[76:79], v[144:147], a[48:51]
  v_mfma_f32_16x16x32_bf16 a[52:55], v[76:79], v[148:151], a[52:55]
  v_mfma_f32_16x16x32_bf16 a[56:59], v[76:79], v[152:155], a[56:59]
  v_mfma_f32_16x16x32_bf16 a[60:63], v[76:79], v[156:159], a[60:63]
  global_load_dwordx4 v[72:75], v181, s[76:77] offset:1024
  global_load_dwordx4 v[76:79], v181, s[78:79] offset:1024
  ds_read_b128 v[144:147], v1 offset:1024
  ds_read_b128 v[148:151], v1 offset:17408
  ds_read_b128 v[152:155], v1 offset:33792
  ds_read_b128 v[156:159], v1 offset:50176
  s_waitcnt vmcnt(20) lgkmcnt(8)
  v_mfma_f32_16x16x32_bf16 a[32:35], v[80:83], v[112:115], a[32:35]
  v_mfma_f32_16x16x32_bf16 a[36:39], v[80:83], v[116:119], a[36:39]
  v_mfma_f32_16x16x32_bf16 a[40:43], v[80:83], v[120:123], a[40:43]
  v_mfma_f32_16x16x32_bf16 a[44:47], v[80:83], v[124:127], a[44:47]
  v_mfma_f32_16x16x32_bf16 a[48:51], v[84:87], v[112:115], a[48:51]
  v_mfma_f32_16x16x32_bf16 a[52:55], v[84:87], v[116:119], a[52:55]
  v_mfma_f32_16x16x32_bf16 a[56:59], v[84:87], v[120:123], a[56:59]
  v_mfma_f32_16x16x32_bf16 a[60:63], v[84:87], v[124:127], a[60:63]
  global_load_dwordx4 v[80:83], v181, s[76:77] offset:2048
  global_load_dwordx4 v[84:87], v181, s[78:79] offset:2048
  ds_read_b128 v[112:115], v1 offset:2048
  ds_read_b128 v[116:119], v1 offset:18432
  ds_read_b128 v[120:123], v1 offset:34816
  ds_read_b128 v[124:127], v1 offset:51200
  s_waitcnt vmcnt(20) lgkmcnt(8)
  v_mfma_f32_16x16x32_bf16 a[0:3], v[88:91], v[128:131], 0
  v_mfma_f32_16x16x32_bf16 a[4:7], v[88:91], v[132:135], 0
  v_mfma_f32_16x16x32_bf16 a[8:11], v[88:91], v[136:139], 0
  v_mfma_f32_16x16x32_bf16 a[12:15], v[88:91], v[140:143], 0
  v_mfma_f32_16x16x32_bf16 a[16:19], v[92:95], v[128:131], 0
  v_mfma_f32_16x16x32_bf16 a[20:23], v[92:95], v[132:135], 0
  v_mfma_f32_16x16x32_bf16 a[24:27], v[92:95], v[136:139], 0
  v_mfma_f32_16x16x32_bf16 a[28:31], v[92:95], v[140:143], 0
  global_load_dwordx4 v[88:91], v181, s[76:77] offset:3072
  global_load_dwordx4 v[92:95], v181, s[78:79] offset:3072
  ds_read_b128 v[128:131], v1 offset:3072
  ds_read_b128 v[132:135], v1 offset:19456
  ds_read_b128 v[136:139], v1 offset:35840
  ds_read_b128 v[140:143], v1 offset:52224
  s_waitcnt vmcnt(20) lgkmcnt(8)
  v_mfma_f32_16x16x32_bf16 a[0:3], v[96:99], v[144:147], a[0:3]
  v_mfma_f32_16x16x32_bf16 a[4:7], v[96:99], v[148:151], a[4:7]
  v_mfma_f32_16x16x32_bf16 a[8:11], v[96:99], v[152:155], a[8:11]
  v_mfma_f32_16x16x32_bf16 a[12:15], v[96:99], v[156:159], a[12:15]
  v_mfma_f32_16x16x32_bf16 a[16:19], v[100:103], v[144:147], a[16:19]
  v_mfma_f32_16x16x32_bf16 a[20:23], v[100:103], v[148:151], a[20:23]
  v_mfma_f32_16x16x32_bf16 a[24:27], v[100:103], v[152:155], a[24:27]
  v_mfma_f32_16x16x32_bf16 a[28:31], v[100:103], v[156:159], a[28:31]
  global_load_dwordx4 v[96:99], v182, s[76:77] offset:0
  global_load_dwordx4 v[100:103], v182, s[78:79] offset:0
  ds_read_b128 v[144:147], v1 offset:4096
  ds_read_b128 v[148:151], v1 offset:20480
  ds_read_b128 v[152:155], v1 offset:36864
  ds_read_b128 v[156:159], v1 offset:53248
  s_waitcnt vmcnt(20) lgkmcnt(8)
  v_mfma_f32_16x16x32_bf16 a[0:3], v[16:19], v[112:115], a[0:3]
  v_mfma_f32_16x16x32_bf16 a[4:7], v[16:19], v[116:119], a[4:7]
  v_mfma_f32_16x16x32_bf16 a[8:11], v[16:19], v[120:123], a[8:11]
  v_mfma_f32_16x16x32_bf16 a[12:15], v[16:19], v[124:127], a[12:15]
  v_mfma_f32_16x16x32_bf16 a[16:19], v[20:23], v[112:115], a[16:19]
  v_mfma_f32_16x16x32_bf16 a[20:23], v[20:23], v[116:119], a[20:23]
  v_mfma_f32_16x16x32_bf16 a[24:27], v[20:23], v[120:123], a[24:27]
  v_mfma_f32_16x16x32_bf16 a[28:31], v[20:23], v[124:127], a[28:31]
  global_store_dwordx4 v176, a[32:35], s[12:13] offset:384 sc1
  global_store_dwordx4 v177, a[36:39], s[12:13] offset:384 sc1
  global_store_dwordx4 v178, a[40:43], s[12:13] offset:384 sc1
  global_store_dwordx4 v179, a[44:47], s[12:13] offset:384 sc1
  global_store_dwordx4 v176, a[48:51], s[12:13] offset:448 sc1
  global_store_dwordx4 v177, a[52:55], s[12:13] offset:448 sc1
  global_store_dwordx4 v178, a[56:59], s[12:13] offset:448 sc1
  global_store_dwordx4 v179, a[60:63], s[12:13] offset:448 sc1
  global_load_dwordx4 v[16:19], v182, s[76:77] offset:1024
  global_load_dwordx4 v[20:23], v182, s[78:79] offset:1024
  ds_read_b128 v[112:115], v1 offset:5120
  ds_read_b128 v[116:119], v1 offset:21504
  ds_read_b128 v[120:123], v1 offset:37888
  ds_read_b128 v[124:127], v1 offset:54272
  s_waitcnt vmcnt(28) lgkmcnt(8)
  v_mfma_f32_16x16x32_bf16 a[0:3], v[24:27], v[128:131], a[0:3]
  v_mfma_f32_16x16x32_bf16 a[4:7], v[24:27], v[132:135], a[4:7]
  v_mfma_f32_16x16x32_bf16 a[8:11], v[24:27], v[136:139], a[8:11]
  v_mfma_f32_16x16x32_bf16 a[12:15], v[24:27], v[140:143], a[12:15]
  v_mfma_f32_16x16x32_bf16 a[16:19], v[28:31], v[128:131], a[16:19]
  v_mfma_f32_16x16x32_bf16 a[20:23], v[28:31], v[132:135], a[20:23]
  v_mfma_f32_16x16x32_bf16 a[24:27], v[28:31], v[136:139], a[24:27]
  v_mfma_f32_16x16x32_bf16 a[28:31], v[28:31], v[140:143], a[28:31]
  global_load_dwordx4 v[24:27], v182, s[76:77] offset:2048
  global_load_dwordx4 v[28:31], v182, s[78:79] offset:2048
  ds_read_b128 v[128:131], v1 offset:6144
  ds_read_b128 v[132:135], v1 offset:22528
  ds_read_b128 v[136:139], v1 offset:38912
  ds_read_b128 v[140:143], v1 offset:55296
  s_waitcnt vmcnt(28) lgkmcnt(8)
  v_mfma_f32_16x16x32_bf16 a[0:3], v[32:35], v[144:147], a[0:3]
  v_mfma_f32_16x16x32_bf16 a[4:7], v[32:35], v[148:151], a[4:7]
  v_mfma_f32_16x16x32_bf16 a[8:11], v[32:35], v[152:155], a[8:11]
  v_mfma_f32_16x16x32_bf16 a[12:15], v[32:35], v[156:159], a[12:15]
  v_mfma_f32_16x16x32_bf16 a[16:19], v[36:39], v[144:147], a[16:19]
  v_mfma_f32_16x16x32_bf16 a[20:23], v[36:39], v[148:151], a[20:23]
  v_mfma_f32_16x16x32_bf16 a[24:27], v[36:39], v[152:155], a[24:27]
  v_mfma_f32_16x16x32_bf16 a[28:31], v[36:39], v[156:159], a[28:31]
  global_load_dwordx4 v[32:35], v182, s[76:77] offset:3072
  global_load_dwordx4 v[36:39], v182, s[78:79] offset:3072
  ds_read_b128 v[144:147], v1 offset:7168
  ds_read_b128 v[148:151], v1 offset:23552
  ds_read_b128 v[152:155], v1 offset:39936
  ds_read_b128 v[156:159], v1 offset:56320
  s_waitcnt vmcnt(28) lgkmcnt(8)
  v_mfma_f32_16x16x32_bf16 a[0:3], v[40:43], v[112:115], a[0:3]
  v_mfma_f32_16x16x32_bf16 a[4:7], v[40:43], v[116:119], a[4:7]
  v_mfma_f32_16x16x32_bf16 a[8:11], v[40:43], v[120:123], a[8:11]
  v_mfma_f32_16x16x32_bf16 a[12:15], v[40:43], v[124:127], a[12:15]
  v_mfma_f32_16x16x32_bf16 a[16:19], v[44:47], v[112:115], a[16:19]
  v_mfma_f32_16x16x32_bf16 a[20:23], v[44:47], v[116:119], a[20:23]
  v_mfma_f32_16x16x32_bf16 a[24:27], v[44:47], v[120:123], a[24:27]
  v_mfma_f32_16x16x32_bf16 a[28:31], v[44:47], v[124:127], a[28:31]
  ds_read_b128 v[112:115], v1 offset:8192
  ds_read_b128 v[116:119], v1 offset:24576
  ds_read_b128 v[120:123], v1 offset:40960
  ds_read_b128 v[124:127], v1 offset:57344
  s_waitcnt vmcnt(26) lgkmcnt(8)
  v_mfma_f32_16x16x32_bf16 a[0:3], v[48:51], v[128:131], a[0:3]
  v_mfma_f32_16x16x32_bf16 a[4:7], v[48:51], v[132:135], a[4:7]
  v_mfma_f32_16x16x32_bf16 a[8:11], v[48:51], v[136:139], a[8:11]
  v_mfma_f32_16x16x32_bf16 a[12:15], v[48:51], v[140:143], a[12:15]
  v_mfma_f32_16x16x32_bf16 a[16:19], v[52:55], v[128:131], a[16:19]
  v_mfma_f32_16x16x32_bf16 a[20:23], v[52:55], v[132:135], a[20:23]
  v_mfma_f32_16x16x32_bf16 a[24:27], v[52:55], v[136:139], a[24:27]
  v_mfma_f32_16x16x32_bf16 a[28:31], v[52:55], v[140:143], a[28:31]
  ds_read_b128 v[128:131], v1 offset:9216
  ds_read_b128 v[132:135], v1 offset:25600
  ds_read_b128 v[136:139], v1 offset:41984
  ds_read_b128 v[140:143], v1 offset:58368
  s_waitcnt vmcnt(24) lgkmcnt(8)
  v_mfma_f32_16x16x32_bf16 a[0:3], v[56:59], v[144:147], a[0:3]
  v_mfma_f32_16x16x32_bf16 a[4:7], v[56:59], v[148:151], a[4:7]
  v_mfma_f32_16x16x32_bf16 a[8:11], v[56:59], v[152:155], a[8:11]
  v_mfma_f32_16x16x32_bf16 a[12:15], v[56:59], v[156:159], a[12:15]
  v_mfma_f32_16x16x32_bf16 a[16:19], v[60:63], v[144:147], a[16:19]
  v_mfma_f32_16x16x32_bf16 a[20:23], v[60:63], v[148:151], a[20:23]
  v_mfma_f32_16x16x32_bf16 a[24:27], v[60:63], v[152:155], a[24:27]
  v_mfma_f32_16x16x32_bf16 a[28:31], v[60:63], v[156:159], a[28:31]
  ds_read_b128 v[144:147], v1 offset:10240
  ds_read_b128 v[148:151], v1 offset:26624
  ds_read_b128 v[152:155], v1 offset:43008
  ds_read_b128 v[156:159], v1 offset:59392
  s_waitcnt vmcnt(22) lgkmcnt(8)
  v_mfma_f32_16x16x32_bf16 a[0:3], v[64:67], v[112:115], a[0:3]
  v_mfma_f32_16x16x32_bf16 a[4:7], v[64:67], v[116:119], a[4:7]
  v_mfma_f32_16x16x32_bf16 a[8:11], v[64:67], v[120:123], a[8:11]
  v_mfma_f32_16x16x32_bf16 a[12:15], v[64:67], v[124:127], a[12:15]
  v_mfma_f32_16x16x32_bf16 a[16:19], v[68:71], v[112:115], a[16:19]
  v_mfma_f32_16x16x32_bf16 a[20:23], v[68:71], v[116:119], a[20:23]
  v_mfma_f32_16x16x32_bf16 a[24:27], v[68:71], v[120:123], a[24:27]
  v_mfma_f32_16x16x32_bf16 a[28:31], v[68:71], v[124:127], a[28:31]
  ds_read_b128 v[112:115], v1 offset:11264
  ds_read_b128 v[116:119], v1 offset:27648
  ds_read_b128 v[120:123], v1 offset:44032
  ds_read_b128 v[124:127], v1 offset:60416
  s_waitcnt vmcnt(20) lgkmcnt(8)
  v_mfma_f32_16x16x32_bf16 a[0:3], v[72:75], v[128:131], a[0:3]
  v_mfma_f32_16x16x32_bf16 a[4:7], v[72:75], v[132:135], a[4:7]
  v_mfma_f32_16x16x32_bf16 a[8:11], v[72:75], v[136:139], a[8:11]
  v_mfma_f32_16x16x32_bf16 a[12:15], v[72:75], v[140:143], a[12:15]
  v_mfma_f32_16x16x32_bf16 a[16:19], v[76:79], v[128:131], a[16:19]
  v_mfma_f32_16x16x32_bf16 a[20:23], v[76:79], v[132:135], a[20:23]
  v_mfma_f32_16x16x32_bf16 a[24:27], v[76:79], v[136:139], a[24:27]
  v_mfma_f32_16x16x32_bf16 a[28:31], v[76:79], v[140:143], a[28:31]
  ds_read_b128 v[128:131], v1 offset:12288
  ds_read_b128 v[132:135], v1 offset:28672
  ds_read_b128 v[136:139], v1 offset:45056
  ds_read_b128 v[140:143], v1 offset:61440
  s_waitcnt vmcnt(18) lgkmcnt(8)
  v_mfma_f32_16x16x32_bf16 a[0:3], v[80:83], v[144:147], a[0:3]
  v_mfma_f32_16x16x32_bf16 a[4:7], v[80:83], v[148:151], a[4:7]
  v_mfma_f32_16x16x32_bf16 a[8:11], v[80:83], v[152:155], a[8:11]
  v_mfma_f32_16x16x32_bf16 a[12:15], v[80:83], v[156:159], a[12:15]
  v_mfma_f32_16x16x32_bf16 a[16:19], v[84:87], v[144:147], a[16:19]
  v_mfma_f32_16x16x32_bf16 a[20:23], v[84:87], v[148:151], a[20:23]
  v_mfma_f32_16x16x32_bf16 a[24:27], v[84:87], v[152:155], a[24:27]
  v_mfma_f32_16x16x32_bf16 a[28:31], v[84:87], v[156:159], a[28:31]
  ds_read_b128 v[144:147], v1 offset:13312
  ds_read_b128 v[148:151], v1 offset:29696
  ds_read_b128 v[152:155], v1 offset:46080
  ds_read_b128 v[156:159], v1 offset:62464
  s_waitcnt vmcnt(16) lgkmcnt(8)
  v_mfma_f32_16x16x32_bf16 a[0:3], v[88:91], v[112:115], a[0:3]
  v_mfma_f32_16x16x32_bf16 a[4:7], v[88:91], v[116:119], a[4:7]
  v_mfma_f32_16x16x32_bf16 a[8:11], v[88:91], v[120:123], a[8:11]
  v_mfma_f32_16x16x32_bf16 a[12:15], v[88:91], v[124:127], a[12:15]
  v_mfma_f32_16x16x32_bf16 a[16:19], v[92:95], v[112:115], a[16:19]
  v_mfma_f32_16x16x32_bf16 a[20:23], v[92:95], v[116:119], a[20:23]
  v_mfma_f32_16x16x32_bf16 a[24:27], v[92:95], v[120:123], a[24:27]
  v_mfma_f32_16x16x32_bf16 a[28:31], v[92:95], v[124:127], a[28:31]
  ds_read_b128 v[112:115], v1 offset:14336
  ds_read_b128 v[116:119], v1 offset:30720
  ds_read_b128 v[120:123], v1 offset:47104
  ds_read_b128 v[124:127], v1 offset:63488
  s_waitcnt vmcnt(14) lgkmcnt(8)
  v_mfma_f32_16x16x32_bf16 a[0:3], v[96:99], v[128:131], a[0:3]
  v_mfma_f32_16x16x32_bf16 a[4:7], v[96:99], v[132:135], a[4:7]
  v_mfma_f32_16x16x32_bf16 a[8:11], v[96:99], v[136:139], a[8:11]
  v_mfma_f32_16x16x32_bf16 a[12:15], v[96:99], v[140:143], a[12:15]
  v_mfma_f32_16x16x32_bf16 a[16:19], v[100:103], v[128:131], a[16:19]
  v_mfma_f32_16x16x32_bf16 a[20:23], v[100:103], v[132:135], a[20:23]
  v_mfma_f32_16x16x32_bf16 a[24:27], v[100:103], v[136:139], a[24:27]
  v_mfma_f32_16x16x32_bf16 a[28:31], v[100:103], v[140:143], a[28:31]
  ds_read_b128 v[128:131], v1 offset:15360
  ds_read_b128 v[132:135], v1 offset:31744
  ds_read_b128 v[136:139], v1 offset:48128
  ds_read_b128 v[140:143], v1 offset:64512
  s_waitcnt vmcnt(4) lgkmcnt(8)
  v_mfma_f32_16x16x32_bf16 a[0:3], v[16:19], v[144:147], a[0:3]
  v_mfma_f32_16x16x32_bf16 a[4:7], v[16:19], v[148:151], a[4:7]
  v_mfma_f32_16x16x32_bf16 a[8:11], v[16:19], v[152:155], a[8:11]
  v_mfma_f32_16x16x32_bf16 a[12:15], v[16:19], v[156:159], a[12:15]
  v_mfma_f32_16x16x32_bf16 a[16:19], v[20:23], v[144:147], a[16:19]
  v_mfma_f32_16x16x32_bf16 a[20:23], v[20:23], v[148:151], a[20:23]
  v_mfma_f32_16x16x32_bf16 a[24:27], v[20:23], v[152:155], a[24:27]
  v_mfma_f32_16x16x32_bf16 a[28:31], v[20:23], v[156:159], a[28:31]
  s_waitcnt vmcnt(2) lgkmcnt(4)
  v_mfma_f32_16x16x32_bf16 a[0:3], v[24:27], v[112:115], a[0:3]
  v_mfma_f32_16x16x32_bf16 a[4:7], v[24:27], v[116:119], a[4:7]
  v_mfma_f32_16x16x32_bf16 a[8:11], v[24:27], v[120:123], a[8:11]
  v_mfma_f32_16x16x32_bf16 a[12:15], v[24:27], v[124:127], a[12:15]
  v_mfma_f32_16x16x32_bf16 a[16:19], v[28:31], v[112:115], a[16:19]
  v_mfma_f32_16x16x32_bf16 a[20:23], v[28:31], v[116:119], a[20:23]
  v_mfma_f32_16x16x32_bf16 a[24:27], v[28:31], v[120:123], a[24:27]
  v_mfma_f32_16x16x32_bf16 a[28:31], v[28:31], v[124:127], a[28:31]
  s_waitcnt vmcnt(0) lgkmcnt(0)
  v_mfma_f32_16x16x32_bf16 a[0:3], v[32:35], v[128:131], a[0:3]
  v_mfma_f32_16x16x32_bf16 a[4:7], v[32:35], v[132:135], a[4:7]
  v_mfma_f32_16x16x32_bf16 a[8:11], v[32:35], v[136:139], a[8:11]
  v_mfma_f32_16x16x32_bf16 a[12:15], v[32:35], v[140:143], a[12:15]
  v_mfma_f32_16x16x32_bf16 a[16:19], v[36:39], v[128:131], a[16:19]
  v_mfma_f32_16x16x32_bf16 a[20:23], v[36:39], v[132:135], a[20:23]
  v_mfma_f32_16x16x32_bf16 a[24:27], v[36:39], v[136:139], a[24:27]
  v_mfma_f32_16x16x32_bf16 a[28:31], v[36:39], v[140:143], a[28:31]
  s_nop 7
  s_nop 1
  global_store_dwordx4 v176, a[0:3], s[12:13] offset:512 sc1
  global_store_dwordx4 v177, a[4:7], s[12:13] offset:512 sc1
  global_store_dwordx4 v178, a[8:11], s[12:13] offset:512 sc1
  global_store_dwordx4 v179, a[12:15], s[12:13] offset:512 sc1
  global_store_dwordx4 v176, a[16:19], s[12:13] offset:576 sc1
  global_store_dwordx4 v177, a[20:23], s[12:13] offset:576 sc1
  global_store_dwordx4 v178, a[24:27], s[12:13] offset:576 sc1
  global_store_dwordx4 v179, a[28:31], s[12:13] offset:576 sc1
  s_waitcnt vmcnt(0)
  s_barrier
  s_lshl_b32 s10, s45, 2
  s_add_u32 s10, s10, 0x8c00380
  s_add_u32 s14, s6, s10
  s_addc_u32 s15, s7, 0
  v_mov_b32 v12, 0
  s_cmp_lg_u32 s8, 0
  s_cbranch_scc1 bawl_wait
  v_mov_b32 v13, 1
  s_mov_b64 s[56:57], exec
  s_mov_b64 exec, 1
  global_atomic_add v12, v13, s[14:15]
  s_mov_b32 s58, 0
bawl_poll:
  s_sleep 2
  global_load_dword v14, v12, s[14:15] sc1
  s_waitcnt vmcnt(0)
  v_readfirstlane_b32 s10, v14
  s_add_u32 s58, s58, 1
  s_cmp_gt_u32 s58, 100000
  s_cbranch_scc1 bawl_pdone
  s_cmp_lt_u32 s10, 8
  s_cbranch_scc1 bawl_poll
bawl_pdone:
  s_mov_b64 exec, s[56:57]
bawl_wait:
  s_barrier
  v_lshrrev_b32 v10, 5, v0
  v_and_b32 v11, 31, v0
  s_lshl_b32 s10, s44, 3
  v_add_u32 v10, s10, v10
  v_mul_u32_u24 v12, 2560, v10
  v_lshl_add_u32 v12, v11, 4, v12
  s_mul_i32 s10, s45, 1310720
  s_add_u32 s10, s10, 0xd000000
  s_add_u32 s12, s6, s10
  s_addc_u32 s13, s7, 0
  s_lshl_b32 s10, s45, 6
  v_add_u32 v13, s10, v10
  v_mul_u32_u24 v14, 0x500, v13
  v_lshl_add_u32 v14, v11, 3, v14
  global_load_dwordx2 v[180:181], v14, s[4:5] offset:0
  global_load_dwordx2 v[182:183], v14, s[4:5] offset:256
  global_load_dwordx2 v[184:185], v14, s[4:5] offset:512
  global_load_dwordx2 v[186:187], v14, s[4:5] offset:768
  global_load_dwordx2 v[188:189], v14, s[4:5] offset:1024
  global_load_dwordx4 v[16:19], v12, s[12:13] offset:0 sc1
  global_load_dwordx4 v[20:23], v12, s[12:13] offset:512 sc1
  global_load_dwordx4 v[24:27], v12, s[12:13] offset:1024 sc1
  global_load_dwordx4 v[28:31], v12, s[12:13] offset:1536 sc1
  global_load_dwordx4 v[32:35], v12, s[12:13] offset:2048 sc1
  s_add_u32 s12, s12, 163840
  s_addc_u32 s13, s13, 0
  global_load_dwordx4 v[36:39], v12, s[12:13] offset:0 sc1
  global_load_dwordx4 v[40:43], v12, s[12:13] offset:512 sc1
  global_load_dwordx4 v[44:47], v12, s[12:13] offset:1024 sc1
  global_load_dwordx4 v[48:51], v12, s[12:13] offset:1536 sc1
  global_load_dwordx4 v[52:55], v12, s[12:13] offset:2048 sc1
  s_add_u32 s12, s12, 163840
  s_addc_u32 s13, s13, 0
  global_load_dwordx4 v[56:59], v12, s[12:13] offset:0 sc1
  global_load_dwordx4 v[60:63], v12, s[12:13] offset:512 sc1
  global_load_dwordx4 v[64:67], v12, s[12:13] offset:1024 sc1
  global_load_dwordx4 v[68:71], v12, s[12:13] offset:1536 sc1
  global_load_dwordx4 v[72:75], v12, s[12:13] offset:2048 sc1
  s_add_u32 s12, s12, 163840
  s_addc_u32 s13, s13, 0
  global_load_dwordx4 v[76:79], v12, s[12:13] offset:0 sc1
  global_load_dwordx4 v[80:83], v12, s[12:13] offset:512 sc1
  global_load_dwordx4 v[84:87], v12, s[12:13] offset:1024 sc1
  global_load_dwordx4 v[88:91], v12, s[12:13] offset:1536 sc1
  global_load_dwordx4 v[92:95], v12, s[12:13] offset:2048 sc1
  s_add_u32 s12, s12, 163840
  s_addc_u32 s13, s13, 0
  global_load_dwordx4 v[96:99], v12, s[12:13] offset:0 sc1
  global_load_dwordx4 v[100:103], v12, s[12:13] offset:512 sc1
  global_load_dwordx4 v[104:107], v12, s[12:13] offset:1024 sc1
  global_load_dwordx4 v[108:111], v12, s[12:13] offset:1536 sc1
  global_load_dwordx4 v[112:115], v12, s[12:13] offset:2048 sc1
  s_add_u32 s12, s12, 163840
  s_addc_u32 s13, s13, 0
  global_load_dwordx4 v[116:119], v12, s[12:13] offset:0 sc1
  global_load_dwordx4 v[120:123], v12, s[12:13] offset:512 sc1
  global_load_dwordx4 v[124:127], v12, s[12:13] offset:1024 sc1
  global_load_dwordx4 v[128:131], v12, s[12:13] offset:1536 sc1
  global_load_dwordx4 v[132:135], v12, s[12:13] offset:2048 sc1
  s_add_u32 s12, s12, 163840
  s_addc_u32 s13, s13, 0
  global_load_dwordx4 v[136:139], v12, s[12:13] offset:0 sc1
  global_load_dwordx4 v[140:143], v12, s[12:13] offset:512 sc1
  global_load_dwordx4 v[144:147], v12, s[12:13] offset:1024 sc1
  global_load_dwordx4 v[148:151], v12, s[12:13] offset:1536 sc1
  global_load_dwordx4 v[152:155], v12, s[12:13] offset:2048 sc1
  s_add_u32 s12, s12, 163840
  s_addc_u32 s13, s13, 0
  global_load_dwordx4 v[156:159], v12, s[12:13] offset:0 sc1
  global_load_dwordx4 v[160:163], v12, s[12:13] offset:512 sc1
  global_load_dwordx4 v[164:167], v12, s[12:13] offset:1024 sc1
  global_load_dwordx4 v[168:171], v12, s[12:13] offset:1536 sc1
  global_load_dwordx4 v[172:175], v12, s[12:13] offset:2048 sc1
  s_add_u32 s12, s12, 163840
  s_addc_u32 s13, s13, 0
  s_waitcnt vmcnt(30)
  v_pk_add_f32 v[16:17], v[16:17], v[36:37]
  v_pk_add_f32 v[18:19], v[18:19], v[38:39]
  v_pk_add_f32 v[20:21], v[20:21], v[40:41]
  v_pk_add_f32 v[22:23], v[22:23], v[42:43]
  v_pk_add_f32 v[24:25], v[24:25], v[44:45]
  v_pk_add_f32 v[26:27], v[26:27], v[46:47]
  v_pk_add_f32 v[28:29], v[28:29], v[48:49]
  v_pk_add_f32 v[30:31], v[30:31], v[50:51]
  v_pk_add_f32 v[32:33], v[32:33], v[52:53]
  v_pk_add_f32 v[34:35], v[34:35], v[54:55]
  s_waitcnt vmcnt(25)
  v_pk_add_f32 v[16:17], v[16:17], v[56:57]
  v_pk_add_f32 v[18:19], v[18:19], v[58:59]
  v_pk_add_f32 v[20:21], v[20:21], v[60:61]
  v_pk_add_f32 v[22:23], v[22:23], v[62:63]
  v_pk_add_f32 v[24:25], v[24:25], v[64:65]
  v_pk_add_f32 v[26:27], v[26:27], v[66:67]
  v_pk_add_f32 v[28:29], v[28:29], v[68:69]
  v_pk_add_f32 v[30:31], v[30:31], v[70:71]
  v_pk_add_f32 v[32:33], v[32:33], v[72:73]
  v_pk_add_f32 v[34:35], v[34:35], v[74:75]
  s_waitcnt vmcnt(20)
  v_pk_add_f32 v[16:17], v[16:17], v[76:77]
  v_pk_add_f32 v[18:19], v[18:19], v[78:79]
  v_pk_add_f32 v[20:21], v[20:21], v[80:81]
  v_pk_add_f32 v[22:23], v[22:23], v[82:83]
  v_pk_add_f32 v[24:25], v[24:25], v[84:85]
  v_pk_add_f32 v[26:27], v[26:27], v[86:87]
  v_pk_add_f32 v[28:29], v[28:29], v[88:89]
  v_pk_add_f32 v[30:31], v[30:31], v[90:91]
  v_pk_add_f32 v[32:33], v[32:33], v[92:93]
  v_pk_add_f32 v[34:35], v[34:35], v[94:95]
  s_waitcnt vmcnt(15)
  v_pk_add_f32 v[16:17], v[16:17], v[96:97]
  v_pk_add_f32 v[18:19], v[18:19], v[98:99]
  v_pk_add_f32 v[20:21], v[20:21], v[100:101]
  v_pk_add_f32 v[22:23], v[22:23], v[102:103]
  v_pk_add_f32 v[24:25], v[24:25], v[104:105]
  v_pk_add_f32 v[26:27], v[26:27], v[106:107]
  v_pk_add_f32 v[28:29], v[28:29], v[108:109]
  v_pk_add_f32 v[30:31], v[30:31], v[110:111]
  v_pk_add_f32 v[32:33], v[32:33], v[112:113]
  v_pk_add_f32 v[34:35], v[34:35], v[114:115]
  s_waitcnt vmcnt(10)
  v_pk_add_f32 v[16:17], v[16:17], v[116:117]
  v_pk_add_f32 v[18:19], v[18:19], v[118:119]
  v_pk_add_f32 v[20:21], v[20:21], v[120:121]
  v_pk_add_f32 v[22:23], v[22:23], v[122:123]
  v_pk_add_f32 v[24:25], v[24:25], v[124:125]
  v_pk_add_f32 v[26:27], v[26:27], v[126:127]
  v_pk_add_f32 v[28:29], v[28:29], v[128:129]
  v_pk_add_f32 v[30:31], v[30:31], v[130:131]
  v_pk_add_f32 v[32:33], v[32:33], v[132:133]
  v_pk_add_f32 v[34:35], v[34:35], v[134:135]
  s_waitcnt vmcnt(5)
  v_pk_add_f32 v[16:17], v[16:17], v[136:137]
  v_pk_add_f32 v[18:19], v[18:19], v[138:139]
  v_pk_add_f32 v[20:21], v[20:21], v[140:141]
  v_pk_add_f32 v[22:23], v[22:23], v[142:143]
  v_pk_add_f32 v[24:25], v[24:25], v[144:145]
  v_pk_add_f32 v[26:27], v[26:27], v[146:147]
  v_pk_add_f32 v[28:29], v[28:29], v[148:149]
  v_pk_add_f32 v[30:31], v[30:31], v[150:151]
  v_pk_add_f32 v[32:33], v[32:33], v[152:153]
  v_pk_add_f32 v[34:35], v[34:35], v[154:155]
  s_waitcnt vmcnt(0)
  v_pk_add_f32 v[16:17], v[16:17], v[156:157]
  v_pk_add_f32 v[18:19], v[18:19], v[158:159]
  v_pk_add_f32 v[20:21], v[20:21], v[160:161]
  v_pk_add_f32 v[22:23], v[22:23], v[162:163]
  v_pk_add_f32 v[24:25], v[24:25], v[164:165]
  v_pk_add_f32 v[26:27], v[26:27], v[166:167]
  v_pk_add_f32 v[28:29], v[28:29], v[168:169]
  v_pk_add_f32 v[30:31], v[30:31], v[170:171]
  v_pk_add_f32 v[32:33], v[32:33], v[172:173]
  v_pk_add_f32 v[34:35], v[34:35], v[174:175]
  s_add_u32 s16, s6, 0x7000000
  s_addc_u32 s17, s7, 0
  v_cvt_pk_bf16_f32 v40, v16, v17
  v_cvt_pk_bf16_f32 v41, v18, v19
  v_lshlrev_b32 v16, 16, v40
  v_and_b32 v17, s54, v40
  v_lshlrev_b32 v18, 16, v41
  v_and_b32 v19, s54, v41
  v_lshlrev_b32 v42, 16, v180
  v_and_b32 v43, s54, v180
  v_lshlrev_b32 v44, 16, v181
  v_and_b32 v45, s54, v181
  v_add_f32 v16, v16, v42
  v_add_f32 v17, v17, v43
  v_add_f32 v18, v18, v44
  v_add_f32 v19, v19, v45
  v_cvt_pk_bf16_f32 v50, v16, v17
  v_cvt_pk_bf16_f32 v51, v18, v19
  v_lshlrev_b32 v16, 16, v50
  v_and_b32 v17, s54, v50
  v_lshlrev_b32 v18, 16, v51
  v_and_b32 v19, s54, v51
  global_store_dwordx2 v14, v[50:51], s[16:17] offset:0 sc1
  v_cvt_pk_bf16_f32 v40, v20, v21
  v_cvt_pk_bf16_f32 v41, v22, v23
  v_lshlrev_b32 v20, 16, v40
  v_and_b32 v21, s54, v40
  v_lshlrev_b32 v22, 16, v41
  v_and_b32 v23, s54, v41
  v_lshlrev_b32 v42, 16, v182
  v_and_b32 v43, s54, v182
  v_lshlrev_b32 v44, 16, v183
  v_and_b32 v45, s54, v183
  v_add_f32 v20, v20, v42
  v_add_f32 v21, v21, v43
  v_add_f32 v22, v22, v44
  v_add_f32 v23, v23, v45
  v_cvt_pk_bf16_f32 v52, v20, v21
  v_cvt_pk_bf16_f32 v53, v22, v23
  v_lshlrev_b32 v20, 16, v52
  v_and_b32 v21, s54, v52
  v_lshlrev_b32 v22, 16, v53
  v_and_b32 v23, s54, v53
  global_store_dwordx2 v14, v[52:53], s[16:17] offset:256 sc1
  v_cvt_pk_bf16_f32 v40, v24, v25
  v_cvt_pk_bf16_f32 v41, v26, v27
  v_lshlrev_b32 v24, 16, v40
  v_and_b32 v25, s54, v40
  v_lshlrev_b32 v26, 16, v41
  v_and_b32 v27, s54, v41
  v_lshlrev_b32 v42, 16, v184
  v_and_b32 v43, s54, v184
  v_lshlrev_b32 v44, 16, v185
  v_and_b32 v45, s54, v185
  v_add_f32 v24, v24, v42
  v_add_f32 v25, v25, v43
  v_add_f32 v26, v26, v44
  v_add_f32 v27, v27, v45
  v_cvt_pk_bf16_f32 v54, v24, v25
  v_cvt_pk_bf16_f32 v55, v26, v27
  v_lshlrev_b32 v24, 16, v54
  v_and_b32 v25, s54, v54
  v_lshlrev_b32 v26, 16, v55
  v_and_b32 v27, s54, v55
  global_store_dwordx2 v14, v[54:55], s[16:17] offset:512 sc1
  v_cvt_pk_bf16_f32 v40, v28, v29
  v_cvt_pk_bf16_f32 v41, v30, v31
  v_lshlrev_b32 v28, 16, v40
  v_and_b32 v29, s54, v40
  v_lshlrev_b32 v30, 16, v41
  v_and_b32 v31, s54, v41
  v_lshlrev_b32 v42, 16, v186
  v_and_b32 v43, s54, v186
  v_lshlrev_b32 v44, 16, v187
  v_and_b32 v45, s54, v187
  v_add_f32 v28, v28, v42
  v_add_f32 v29, v29, v43
  v_add_f32 v30, v30, v44
  v_add_f32 v31, v31, v45
  v_cvt_pk_bf16_f32 v56, v28, v29
  v_cvt_pk_bf16_f32 v57, v30, v31
  v_lshlrev_b32 v28, 16, v56
  v_and_b32 v29, s54, v56
  v_lshlrev_b32 v30, 16, v57
  v_and_b32 v31, s54, v57
  global_store_dwordx2 v14, v[56:57], s[16:17] offset:768 sc1
  v_cvt_pk_bf16_f32 v40, v32, v33
  v_cvt_pk_bf16_f32 v41, v34, v35
  v_lshlrev_b32 v32, 16, v40
  v_and_b32 v33, s54, v40
  v_lshlrev_b32 v34, 16, v41
  v_and_b32 v35, s54, v41
  v_lshlrev_b32 v42, 16, v188
  v_and_b32 v43, s54, v188
  v_lshlrev_b32 v44, 16, v189
  v_and_b32 v45, s54, v189
  v_add_f32 v32, v32, v42
  v_add_f32 v33, v33, v43
  v_add_f32 v34, v34, v44
  v_add_f32 v35, v35, v45
  v_cvt_pk_bf16_f32 v58, v32, v33
  v_cvt_pk_bf16_f32 v59, v34, v35
  v_lshlrev_b32 v32, 16, v58
  v_and_b32 v33, s54, v58
  v_lshlrev_b32 v34, 16, v59
  v_and_b32 v35, s54, v59
  global_store_dwordx2 v14, v[58:59], s[16:17] offset:1024 sc1
  v_add_f32 v60, v16, v17
  v_add_f32 v60, v60, v18
  v_add_f32 v60, v60, v19
  v_add_f32 v60, v60, v20
  v_add_f32 v60, v60, v21
  v_add_f32 v60, v60, v22
  v_add_f32 v60, v60, v23
  v_add_f32 v60, v60, v24
  v_add_f32 v60, v60, v25
  v_add_f32 v60, v60, v26
  v_add_f32 v60, v60, v27
  v_add_f32 v60, v60, v28
  v_add_f32 v60, v60, v29
  v_add_f32 v60, v60, v30
  v_add_f32 v60, v60, v31
  v_add_f32 v60, v60, v32
  v_add_f32 v60, v60, v33
  v_add_f32 v60, v60, v34
  v_add_f32 v60, v60, v35
  s_nop 1
  v_add_f32_dpp v60, v60, v60 quad_perm:[1,0,3,2] row_mask:0xf bank_mask:0xf
  s_nop 1
  v_add_f32_dpp v60, v60, v60 quad_perm:[2,3,0,1] row_mask:0xf bank_mask:0xf
  s_nop 1
  v_add_f32_dpp v60, v60, v60 row_ror:4 row_mask:0xf bank_mask:0xf
  s_nop 1
  v_add_f32_dpp v60, v60, v60 row_ror:8 row_mask:0xf bank_mask:0xf
  s_nop 1
  v_mov_b32 v61, v60
  s_nop 1
  v_permlane16_swap_b32 v60, v61
  v_add_f32 v60, v60, v61
  v_mul_f32 v60, 0x3acccccd, v60
  v_mov_b32 v62, 0
  v_sub_f32 v63, v16, v60
  v_fmac_f32 v62, v63, v63
  v_sub_f32 v63, v17, v60
  v_fmac_f32 v62, v63, v63
  v_sub_f32 v63, v18, v60
  v_fmac_f32 v62, v63, v63
  v_sub_f32 v63, v19, v60
  v_fmac_f32 v62, v63, v63
  v_sub_f32 v63, v20, v60
  v_fmac_f32 v62, v63, v63
  v_sub_f32 v63, v21, v60
  v_fmac_f32 v62, v63, v63
  v_sub_f32 v63, v22, v60
  v_fmac_f32 v62, v63, v63
  v_sub_f32 v63, v23, v60
  v_fmac_f32 v62, v63, v63
  v_sub_f32 v63, v24, v60
  v_fmac_f32 v62, v63, v63
  v_sub_f32 v63, v25, v60
  v_fmac_f32 v62, v63, v63
  v_sub_f32 v63, v26, v60
  v_fmac_f32 v62, v63, v63
  v_sub_f32 v63, v27, v60
  v_fmac_f32 v62, v63, v63
  v_sub_f32 v63, v28, v60
  v_fmac_f32 v62, v63, v63
  v_sub_f32 v63, v29, v60
  v_fmac_f32 v62, v63, v63
  v_sub_f32 v63, v30, v60
  v_fmac_f32 v62, v63, v63
  v_sub_f32 v63, v31, v60
  v_fmac_f32 v62, v63, v63
  v_sub_f32 v63, v32, v60
  v_fmac_f32 v62, v63, v63
  v_sub_f32 v63, v33, v60
  v_fmac_f32 v62, v63, v63
  v_sub_f32 v63, v34, v60
  v_fmac_f32 v62, v63, v63
  v_sub_f32 v63, v35, v60
  v_fmac_f32 v62, v63, v63
  s_nop 1
  v_add_f32_dpp v62, v62, v62 quad_perm:[1,0,3,2] row_mask:0xf bank_mask:0xf
  s_nop 1
  v_add_f32_dpp v62, v62, v62 quad_perm:[2,3,0,1] row_mask:0xf bank_mask:0xf
  s_nop 1
  v_add_f32_dpp v62, v62, v62 row_ror:4 row_mask:0xf bank_mask:0xf
  s_nop 1
  v_add_f32_dpp v62, v62, v62 row_ror:8 row_mask:0xf bank_mask:0xf
  s_nop 1
  v_mov_b32 v61, v62
  s_nop 1
  v_permlane16_swap_b32 v62, v61
  v_add_f32 v62, v62, v61
  v_mul_f32 v62, 0x3acccccd, v62
  v_cvt_pk_bf16_f32 v64, v60, v62
  v_lshlrev_b32 v60, 16, v64
  v_and_b32 v62, s54, v64
  v_add_f32 v62, 0x3727c5ac, v62
  v_cvt_pk_bf16_f32 v64, v62, v62
  v_lshlrev_b32 v62, 16, v64
  v_sqrt_f32 v62, v62
  s_nop 0
  v_cvt_pk_bf16_f32 v64, v62, v62
  v_lshlrev_b32 v62, 16, v64
  v_rcp_f32 v63, v62
  s_nop 0
  v_fma_f32 v64, -v62, v63, 1.0
  v_fma_f32 v63, v64, v63, v63
  v_lshrrev_b32 v65, 4, v13
  v_mul_u32_u24 v65, 20480, v65
  v_and_b32 v66, 15, v13
  v_lshl_add_u32 v65, v66, 4, v65
  v_lshrrev_b32 v66, 3, v11
  v_lshl_add_u32 v65, v66, 10, v65
  v_bfe_u32 v66, v11, 1, 2
  v_lshl_add_u32 v65, v66, 8, v65
  v_and_b32 v66, 1, v11
  v_lshl_add_u32 v65, v66, 3, v65
  s_add_u32 s18, s6, 0x7400000
  s_addc_u32 s19, s7, 0
  v_sub_f32 v16, v16, v60
  v_sub_f32 v17, v17, v60
  v_sub_f32 v18, v18, v60
  v_sub_f32 v19, v19, v60
  v_cvt_pk_bf16_f32 v40, v16, v17
  v_cvt_pk_bf16_f32 v41, v18, v19
  v_lshlrev_b32 v16, 16, v40
  v_and_b32 v17, s54, v40
  v_lshlrev_b32 v18, 16, v41
  v_and_b32 v19, s54, v41
  v_mul_f32 v16, v16, v63
  v_mul_f32 v17, v17, v63
  v_mul_f32 v18, v18, v63
  v_mul_f32 v19, v19, v63
  v_cvt_pk_bf16_f32 v70, v16, v17
  v_cvt_pk_bf16_f32 v71, v18, v19
  global_store_dwordx2 v65, v[70:71], s[18:19] sc1
  v_add_u32 v65, 0x1000, v65
  v_sub_f32 v20, v20, v60
  v_sub_f32 v21, v21, v60
  v_sub_f32 v22, v22, v60
  v_sub_f32 v23, v23, v60
  v_cvt_pk_bf16_f32 v40, v20, v21
  v_cvt_pk_bf16_f32 v41, v22, v23
  v_lshlrev_b32 v20, 16, v40
  v_and_b32 v21, s54, v40
  v_lshlrev_b32 v22, 16, v41
  v_and_b32 v23, s54, v41
  v_mul_f32 v20, v20, v63
  v_mul_f32 v21, v21, v63
  v_mul_f32 v22, v22, v63
  v_mul_f32 v23, v23, v63
  v_cvt_pk_bf16_f32 v72, v20, v21
  v_cvt_pk_bf16_f32 v73, v22, v23
  global_store_dwordx2 v65, v[72:73], s[18:19] sc1
  v_add_u32 v65, 0x1000, v65
  v_sub_f32 v24, v24, v60
  v_sub_f32 v25, v25, v60
  v_sub_f32 v26, v26, v60
  v_sub_f32 v27, v27, v60
  v_cvt_pk_bf16_f32 v40, v24, v25
  v_cvt_pk_bf16_f32 v41, v26, v27
  v_lshlrev_b32 v24, 16, v40
  v_and_b32 v25, s54, v40
  v_lshlrev_b32 v26, 16, v41
  v_and_b32 v27, s54, v41
  v_mul_f32 v24, v24, v63
  v_mul_f32 v25, v25, v63
  v_mul_f32 v26, v26, v63
  v_mul_f32 v27, v27, v63
  v_cvt_pk_bf16_f32 v74, v24, v25
  v_cvt_pk_bf16_f32 v75, v26, v27
  global_store_dwordx2 v65, v[74:75], s[18:19] sc1
  v_add_u32 v65, 0x1000, v65
  v_sub_f32 v28, v28, v60
  v_sub_f32 v29, v29, v60
  v_sub_f32 v30, v30, v60
  v_sub_f32 v31, v31, v60
  v_cvt_pk_bf16_f32 v40, v28, v29
  v_cvt_pk_bf16_f32 v41, v30, v31
  v_lshlrev_b32 v28, 16, v40
  v_and_b32 v29, s54, v40
  v_lshlrev_b32 v30, 16, v41
  v_and_b32 v31, s54, v41
  v_mul_f32 v28, v28, v63
  v_mul_f32 v29, v29, v63
  v_mul_f32 v30, v30, v63
  v_mul_f32 v31, v31, v63
  v_cvt_pk_bf16_f32 v76, v28, v29
  v_cvt_pk_bf16_f32 v77, v30, v31
  global_store_dwordx2 v65, v[76:77], s[18:19] sc1
  v_add_u32 v65, 0x1000, v65
  v_sub_f32 v32, v32, v60
  v_sub_f32 v33, v33, v60
  v_sub_f32 v34, v34, v60
  v_sub_f32 v35, v35, v60
  v_cvt_pk_bf16_f32 v40, v32, v33
  v_cvt_pk_bf16_f32 v41, v34, v35
  v_lshlrev_b32 v32, 16, v40
  v_and_b32 v33, s54, v40
  v_lshlrev_b32 v34, 16, v41
  v_and_b32 v35, s54, v41
  v_mul_f32 v32, v32, v63
  v_mul_f32 v33, v33, v63
  v_mul_f32 v34, v34, v63
  v_mul_f32 v35, v35, v63
  v_cvt_pk_bf16_f32 v78, v32, v33
  v_cvt_pk_bf16_f32 v79, v34, v35
  global_store_dwordx2 v65, v[78:79], s[18:19] sc1
  v_add_u32 v65, 0x1000, v65
  s_lshr_b32 s95, s96, 1
  s_lshl_b32 s95, s95, 2
  s_add_u32 s95, s95, 128
  s_waitcnt vmcnt(0)
  s_barrier
  s_cmp_lg_u32 s99, 0
  s_cbranch_scc1 dyn_loop
  s_load_dwordx2 s[6:7], s[0:1], 104
  s_waitcnt lgkmcnt(0)
  s_add_u32 s12, s6, 0x8c00400
  s_addc_u32 s13, s7, 0
  v_mov_b32 v8, s95
  v_mov_b32 v9, 1
  s_mov_b64 s[56:57], exec
  s_mov_b64 exec, 1
  global_atomic_add v8, v9, s[12:13]
  s_mov_b64 exec, s[56:57]
  s_branch dyn_loop
chain_done:
  s_endpgm
.globl awl_kernel
.p2align 8
.type awl_kernel,@function
awl_kernel:
  s_cmp_ge_u32 s2, 64
  s_cbranch_scc1 awl_done
  s_and_b32 s44, s2, 7
  s_lshr_b32 s45, s2, 3
  s_add_u32 s45, s45, 24
  s_load_dwordx2 s[6:7], s[0:1], 104
  s_load_dwordx2 s[4:5], s[0:1], 0
  v_lshrrev_b32 v2, 6, v0
  v_and_b32 v3, 63, v0
  s_nop 0
  v_readfirstlane_b32 s8, v2
  v_lshlrev_b32 v1, 4, v3
  v_lshlrev_b32 v7, 3, v3
  v_and_b32 v4, 15, v3
  v_lshrrev_b32 v5, 4, v3
  v_add_u32 v6, 0x1000, v1
  s_mov_b32 s52, 0x3db504f3
  s_mov_b32 s53, 0x3fb8aa3b
  s_mov_b32 s54, 0xffff0000
  v_mov_b32 v8, 0xff800000
  v_lshlrev_b32 v9, 2, v5
  s_waitcnt lgkmcnt(0)
  s_mul_i32 s10, s8, 1290
  s_lshl_b32 s11, s44, 4
  s_add_u32 s10, s10, s11
  s_lshl_b32 s10, s10, 10
  s_add_u32 s10, s10, 0x1180000
  s_add_u32 s60, s6, s10
  s_addc_u32 s61, s7, 0
  s_add_u32 s62, s60, 132096
  s_addc_u32 s63, s61, 0
  s_add_u32 s64, s62, 132096
  s_addc_u32 s65, s63, 0
  s_add_u32 s66, s64, 132096
  s_addc_u32 s67, s65, 0
  s_add_u32 s68, s66, 132096
  s_addc_u32 s69, s67, 0
  s_add_u32 s70, s68, 132096
  s_addc_u32 s71, s69, 0
  s_add_u32 s72, s70, 132096
  s_addc_u32 s73, s71, 0
  s_add_u32 s74, s72, 132096
  s_addc_u32 s75, s73, 0
  s_add_u32 s76, s74, 132096
  s_addc_u32 s77, s75, 0
  s_add_u32 s78, s76, 132096
  s_addc_u32 s79, s77, 0
  s_lshl_b32 s41, s44, 2
  s_add_u32 s41, s41, s8
  s_lshl_b32 s40, s45, 1
  s_lshl_b32 s42, s8, 12
  s_lshl_b32 s9, s40, 5
  s_add_u32 s9, s9, s41
  s_lshl_b32 s10, s9, 13
  s_add_u32 s11, s10, 0x2000000
  s_add_u32 s12, s6, s11
  s_addc_u32 s13, s7, 0
  s_add_u32 s11, s10, 0x3000000
  s_add_u32 s14, s6, s11
  s_addc_u32 s15, s7, 0
  s_add_u32 s11, s10, 0x4000000
  s_add_u32 s16, s6, s11
  s_addc_u32 s17, s7, 0
  s_lshl_b32 s10, s9, 12
  s_add_u32 s11, s10, 0xc000000
  s_add_u32 s18, s6, s11
  s_addc_u32 s19, s7, 0
  s_add_u32 s11, s10, 0xc800000
  s_add_u32 s20, s6, s11
  s_addc_u32 s21, s7, 0
  global_load_dwordx4 v[16:19], v1, s[12:13] offset:0
  global_load_dwordx4 v[48:51], v1, s[14:15] offset:0
  global_load_dwordx4 v[20:23], v1, s[12:13] offset:1024
  global_load_dwordx4 v[52:55], v1, s[14:15] offset:1024
  global_load_dwordx4 v[24:27], v1, s[12:13] offset:2048
  global_load_dwordx4 v[56:59], v1, s[14:15] offset:2048
  global_load_dwordx4 v[28:31], v1, s[12:13] offset:3072
  global_load_dwordx4 v[60:63], v1, s[14:15] offset:3072
  global_load_dwordx4 v[32:35], v6, s[12:13] offset:0
  global_load_dwordx4 v[64:67], v6, s[14:15] offset:0
  global_load_dwordx4 v[36:39], v6, s[12:13] offset:1024
  global_load_dwordx4 v[68:71], v6, s[14:15] offset:1024
  global_load_dwordx4 v[40:43], v6, s[12:13] offset:2048
  global_load_dwordx4 v[72:75], v6, s[14:15] offset:2048
  global_load_dwordx4 v[44:47], v6, s[12:13] offset:3072
  global_load_dwordx4 v[76:79], v6, s[14:15] offset:3072
  global_load_dwordx4 v[80:83], v1, s[18:19] offset:0
  global_load_dwordx4 v[84:87], v1, s[18:19] offset:1024
  global_load_dwordx4 v[88:91], v1, s[18:19] offset:2048
  global_load_dwordx4 v[92:95], v1, s[18:19] offset:3072
  global_load_dwordx4 v[96:99], v1, s[16:17] offset:0
  global_load_dwordx4 v[100:103], v1, s[16:17] offset:1024
  global_load_dwordx4 v[104:107], v1, s[16:17] offset:2048
  global_load_dwordx4 v[108:111], v1, s[16:17] offset:3072
  global_load_dwordx4 v[112:115], v6, s[16:17] offset:0
  global_load_dwordx4 v[116:119], v6, s[16:17] offset:1024
  global_load_dwordx4 v[120:123], v6, s[16:17] offset:2048
  global_load_dwordx4 v[124:127], v6, s[16:17] offset:3072
  global_load_dwordx2 v[128:129], v7, s[20:21] offset:0
  global_load_dwordx2 v[130:131], v7, s[20:21] offset:512
  global_load_dwordx2 v[132:133], v7, s[20:21] offset:1024
  global_load_dwordx2 v[134:135], v7, s[20:21] offset:1536
  global_load_dwordx2 v[136:137], v7, s[20:21] offset:2048
  global_load_dwordx2 v[138:139], v7, s[20:21] offset:2560
  global_load_dwordx2 v[140:141], v7, s[20:21] offset:3072
  global_load_dwordx2 v[142:143], v7, s[20:21] offset:3584
  s_add_u32 s40, s40, 1
  s_lshl_b32 s9, s40, 5
  s_add_u32 s9, s9, s41
  s_lshl_b32 s10, s9, 13
  s_add_u32 s11, s10, 0x2000000
  s_add_u32 s12, s6, s11
  s_addc_u32 s13, s7, 0
  s_add_u32 s11, s10, 0x3000000
  s_add_u32 s14, s6, s11
  s_addc_u32 s15, s7, 0
  s_add_u32 s11, s10, 0x4000000
  s_add_u32 s16, s6, s11
  s_addc_u32 s17, s7, 0
  s_lshl_b32 s10, s9, 12
  s_add_u32 s11, s10, 0xc000000
  s_add_u32 s18, s6, s11
  s_addc_u32 s19, s7, 0
  s_add_u32 s11, s10, 0xc800000
  s_add_u32 s20, s6, s11
  s_addc_u32 s21, s7, 0
  global_load_dwordx4 a[0:3], v1, s[12:13] offset:0
  global_load_dwordx4 a[32:35], v1, s[14:15] offset:0
  global_load_dwordx4 a[4:7], v1, s[12:13] offset:1024
  global_load_dwordx4 a[36:39], v1, s[14:15] offset:1024
  global_load_dwordx4 a[8:11], v1, s[12:13] offset:2048
  global_load_dwordx4 a[40:43], v1, s[14:15] offset:2048
  global_load_dwordx4 a[12:15], v1, s[12:13] offset:3072
  global_load_dwordx4 a[44:47], v1, s[14:15] offset:3072
  global_load_dwordx4 a[16:19], v6, s[12:13] offset:0
  global_load_dwordx4 a[48:51], v6, s[14:15] offset:0
  global_load_dwordx4 a[20:23], v6, s[12:13] offset:1024
  global_load_dwordx4 a[52:55], v6, s[14:15] offset:1024
  global_load_dwordx4 a[24:27], v6, s[12:13] offset:2048
  global_load_dwordx4 a[56:59], v6, s[14:15] offset:2048
  global_load_dwordx4 a[28:31], v6, s[12:13] offset:3072
  global_load_dwordx4 a[60:63], v6, s[14:15] offset:3072
  global_load_dwordx4 a[64:67], v1, s[18:19] offset:0
  global_load_dwordx4 a[68:71], v1, s[18:19] offset:1024
  global_load_dwordx4 a[72:75], v1, s[18:19] offset:2048
  global_load_dwordx4 a[76:79], v1, s[18:19] offset:3072
  global_load_dwordx4 a[80:83], v1, s[16:17] offset:0
  global_load_dwordx4 a[84:87], v1, s[16:17] offset:1024
  global_load_dwordx4 a[88:91], v1, s[16:17] offset:2048
  global_load_dwordx4 a[92:95], v1, s[16:17] offset:3072
  global_load_dwordx4 a[96:99], v6, s[16:17] offset:0
  global_load_dwordx4 a[100:103], v6, s[16:17] offset:1024
  global_load_dwordx4 a[104:107], v6, s[16:17] offset:2048
  global_load_dwordx4 a[108:111], v6, s[16:17] offset:3072
  global_load_dwordx2 a[112:113], v7, s[20:21] offset:0
  global_load_dwordx2 a[114:115], v7, s[20:21] offset:512
  global_load_dwordx2 a[116:117], v7, s[20:21] offset:1024
  global_load_dwordx2 a[118:119], v7, s[20:21] offset:1536
  global_load_dwordx2 a[120:121], v7, s[20:21] offset:2048
  global_load_dwordx2 a[122:123], v7, s[20:21] offset:2560
  global_load_dwordx2 a[124:125], v7, s[20:21] offset:3072
  global_load_dwordx2 a[126:127], v7, s[20:21] offset:3584
  s_waitcnt vmcnt(52)
  v_mfma_f32_16x16x32_bf16 v[144:147], v[80:83], v[16:19], 0
  v_mfma_f32_16x16x32_bf16 v[148:151], v[48:51], v[16:19], 0
  v_mfma_f32_16x16x32_bf16 v[152:155], v[80:83], v[20:23], 0
  v_mfma_f32_16x16x32_bf16 v[156:159], v[48:51], v[20:23], 0
  v_mfma_f32_16x16x32_bf16 v[160:163], v[52:55], v[20:23], 0
  v_mfma_f32_16x16x32_bf16 v[144:147], v[84:87], v[24:27], v[144:147]
  v_mfma_f32_16x16x32_bf16 v[148:151], v[56:59], v[24:27], v[148:151]
  v_mfma_f32_16x16x32_bf16 v[152:155], v[84:87], v[28:31], v[152:155]
  v_mfma_f32_16x16x32_bf16 v[156:159], v[56:59], v[28:31], v[156:159]
  v_mfma_f32_16x16x32_bf16 v[160:163], v[60:63], v[28:31], v[160:163]
  v_mfma_f32_16x16x32_bf16 v[144:147], v[88:91], v[32:35], v[144:147]
  v_mfma_f32_16x16x32_bf16 v[148:151], v[64:67], v[32:35], v[148:151]
  v_mfma_f32_16x16x32_bf16 v[152:155], v[88:91], v[36:39], v[152:155]
  v_mfma_f32_16x16x32_bf16 v[156:159], v[64:67], v[36:39], v[156:159]
  v_mfma_f32_16x16x32_bf16 v[160:163], v[68:71], v[36:39], v[160:163]
  v_mfma_f32_16x16x32_bf16 v[144:147], v[92:95], v[40:43], v[144:147]
  v_mfma_f32_16x16x32_bf16 v[148:151], v[72:75], v[40:43], v[148:151]
  v_mfma_f32_16x16x32_bf16 v[152:155], v[92:95], v[44:47], v[152:155]
  v_mfma_f32_16x16x32_bf16 v[156:159], v[72:75], v[44:47], v[156:159]
  v_mfma_f32_16x16x32_bf16 v[160:163], v[76:79], v[44:47], v[160:163]
  s_nop 7
  v_cvt_pk_bf16_f32 v10, v144, v145
  v_lshlrev_b32 v144, 16, v10
  v_and_b32 v145, s54, v10
  v_mul_f32 v144, s52, v144
  v_mul_f32 v145, s52, v145
  v_cvt_pk_bf16_f32 v10, v144, v145
  v_lshlrev_b32 v144, 16, v10
  v_and_b32 v145, s54, v10
  v_cvt_pk_bf16_f32 v10, v146, v147
  v_lshlrev_b32 v146, 16, v10
  v_and_b32 v147, s54, v10
  v_mul_f32 v146, s52, v146
  v_mul_f32 v147, s52, v147
  v_cvt_pk_bf16_f32 v10, v146, v147
  v_lshlrev_b32 v146, 16, v10
  v_and_b32 v147, s54, v10
  v_cvt_pk_bf16_f32 v10, v148, v149
  v_lshlrev_b32 v148, 16, v10
  v_and_b32 v149, s54, v10
  v_mul_f32 v148, s52, v148
  v_mul_f32 v149, s52, v149
  v_cvt_pk_bf16_f32 v10, v148, v149
  v_lshlrev_b32 v148, 16, v10
  v_and_b32 v149, s54, v10
  v_cvt_pk_bf16_f32 v10, v150, v151
  v_lshlrev_b32 v150, 16, v10
  v_and_b32 v151, s54, v10
  v_mul_f32 v150, s52, v150
  v_mul_f32 v151, s52, v151
  v_cvt_pk_bf16_f32 v10, v150, v151
  v_lshlrev_b32 v150, 16, v10
  v_and_b32 v151, s54, v10
  v_cvt_pk_bf16_f32 v10, v152, v153
  v_lshlrev_b32 v152, 16, v10
  v_and_b32 v153, s54, v10
  v_mul_f32 v152, s52, v152
  v_mul_f32 v153, s52, v153
  v_cvt_pk_bf16_f32 v10, v152, v153
  v_lshlrev_b32 v152, 16, v10
  v_and_b32 v153, s54, v10
  v_cvt_pk_bf16_f32 v10, v154, v155
  v_lshlrev_b32 v154, 16, v10
  v_and_b32 v155, s54, v10
  v_mul_f32 v154, s52, v154
  v_mul_f32 v155, s52, v155
  v_cvt_pk_bf16_f32 v10, v154, v155
  v_lshlrev_b32 v154, 16, v10
  v_and_b32 v155, s54, v10
  v_cvt_pk_bf16_f32 v10, v156, v157
  v_lshlrev_b32 v156, 16, v10
  v_and_b32 v157, s54, v10
  v_mul_f32 v156, s52, v156
  v_mul_f32 v157, s52, v157
  v_cvt_pk_bf16_f32 v10, v156, v157
  v_lshlrev_b32 v156, 16, v10
  v_and_b32 v157, s54, v10
  v_cvt_pk_bf16_f32 v10, v158, v159
  v_lshlrev_b32 v158, 16, v10
  v_and_b32 v159, s54, v10
  v_mul_f32 v158, s52, v158
  v_mul_f32 v159, s52, v159
  v_cvt_pk_bf16_f32 v10, v158, v159
  v_lshlrev_b32 v158, 16, v10
  v_and_b32 v159, s54, v10
  v_cvt_pk_bf16_f32 v10, v160, v161
  v_lshlrev_b32 v160, 16, v10
  v_and_b32 v161, s54, v10
  v_mul_f32 v160, s52, v160
  v_mul_f32 v161, s52, v161
  v_cvt_pk_bf16_f32 v10, v160, v161
  v_lshlrev_b32 v160, 16, v10
  v_and_b32 v161, s54, v10
  v_cvt_pk_bf16_f32 v10, v162, v163
  v_lshlrev_b32 v162, 16, v10
  v_and_b32 v163, s54, v10
  v_mul_f32 v162, s52, v162
  v_mul_f32 v163, s52, v163
  v_cvt_pk_bf16_f32 v10, v162, v163
  v_lshlrev_b32 v162, 16, v10
  v_and_b32 v163, s54, v10
  v_cmp_lt_u32 vcc, 31, v3
  s_nop 1
  v_cndmask_b32 v144, v144, v8, vcc
  v_cndmask_b32 v145, v145, v8, vcc
  v_cndmask_b32 v146, v146, v8, vcc
  v_cndmask_b32 v147, v147, v8, vcc
  v_cndmask_b32 v152, v152, v8, vcc
  v_cndmask_b32 v153, v153, v8, vcc
  v_cndmask_b32 v154, v154, v8, vcc
  v_cndmask_b32 v155, v155, v8, vcc
  v_add_u32 v10, 0, v9
  v_cmp_gt_u32 vcc, v10, v4
  s_nop 1
  v_cndmask_b32 v148, v148, v8, vcc
  v_cndmask_b32 v160, v160, v8, vcc
  v_add_u32 v10, 1, v9
  v_cmp_gt_u32 vcc, v10, v4
  s_nop 1
  v_cndmask_b32 v149, v149, v8, vcc
  v_cndmask_b32 v161, v161, v8, vcc
  v_add_u32 v10, 2, v9
  v_cmp_gt_u32 vcc, v10, v4
  s_nop 1
  v_cndmask_b32 v150, v150, v8, vcc
  v_cndmask_b32 v162, v162, v8, vcc
  v_add_u32 v10, 3, v9
  v_cmp_gt_u32 vcc, v10, v4
  s_nop 1
  v_cndmask_b32 v151, v151, v8, vcc
  v_cndmask_b32 v163, v163, v8, vcc
  v_max3_f32 v10, v144, v145, v146
  v_max3_f32 v10, v10, v147, v148
  v_max3_f32 v10, v10, v149, v150
  v_max_f32 v10, v10, v151
  s_nop 1
  v_mov_b32 v11, v10
  s_nop 1
  v_permlane16_swap_b32 v10, v11
  v_max_f32 v10, v10, v11
  s_nop 1
  v_mov_b32 v11, v10
  s_nop 1
  v_permlane32_swap_b32 v10, v11
  v_max_f32 v10, v10, v11
  v_sub_f32 v144, v144, v10
  v_mul_f32 v144, s53, v144
  v_sub_f32 v145, v145, v10
  v_mul_f32 v145, s53, v145
  v_sub_f32 v146, v146, v10
  v_mul_f32 v146, s53, v146
  v_sub_f32 v147, v147, v10
  v_mul_f32 v147, s53, v147
  v_sub_f32 v148, v148, v10
  v_mul_f32 v148, s53, v148
  v_sub_f32 v149, v149, v10
  v_mul_f32 v149, s53, v149
  v_sub_f32 v150, v150, v10
  v_mul_f32 v150, s53, v150
  v_sub_f32 v151, v151, v10
  v_mul_f32 v151, s53, v151
  v_exp_f32 v144, v144
  v_exp_f32 v145, v145
  v_exp_f32 v146, v146
  v_exp_f32 v147, v147
  v_exp_f32 v148, v148
  v_exp_f32 v149, v149
  v_exp_f32 v150, v150
  v_exp_f32 v151, v151
  s_nop 0
  v_add_f32 v10, v144, v145
  v_add_f32 v10, v10, v146
  v_add_f32 v10, v10, v147
  v_add_f32 v10, v10, v148
  v_add_f32 v10, v10, v149
  v_add_f32 v10, v10, v150
  v_add_f32 v10, v10, v151
  s_nop 1
  v_mov_b32 v11, v10
  s_nop 1
  v_permlane16_swap_b32 v10, v11
  v_add_f32 v10, v10, v11
  s_nop 1
  v_mov_b32 v11, v10
  s_nop 1
  v_permlane32_swap_b32 v10, v11
  v_add_f32 v10, v10, v11
  v_rcp_f32 v11, v10
  s_nop 0
  v_fma_f32 v12, -v10, v11, 1.0
  v_fma_f32 v11, v12, v11, v11
  v_mul_f32 v144, v144, v11
  v_mul_f32 v145, v145, v11
  v_mul_f32 v146, v146, v11
  v_mul_f32 v147, v147, v11
  v_mul_f32 v148, v148, v11
  v_mul_f32 v149, v149, v11
  v_mul_f32 v150, v150, v11
  v_mul_f32 v151, v151, v11
  v_max3_f32 v10, v152, v153, v154
  v_max3_f32 v10, v10, v155, v156
  v_max3_f32 v10, v10, v157, v158
  v_max3_f32 v10, v10, v159, v160
  v_max3_f32 v10, v10, v161, v162
  v_max_f32 v10, v10, v163
  s_nop 1
  v_mov_b32 v11, v10
  s_nop 1
  v_permlane16_swap_b32 v10, v11
  v_max_f32 v10, v10, v11
  s_nop 1
  v_mov_b32 v11, v10
  s_nop 1
  v_permlane32_swap_b32 v10, v11
  v_max_f32 v10, v10, v11
  v_sub_f32 v152, v152, v10
  v_mul_f32 v152, s53, v152
  v_sub_f32 v153, v153, v10
  v_mul_f32 v153, s53, v153
  v_sub_f32 v154, v154, v10
  v_mul_f32 v154, s53, v154
  v_sub_f32 v155, v155, v10
  v_mul_f32 v155, s53, v155
  v_sub_f32 v156, v156, v10
  v_mul_f32 v156, s53, v156
  v_sub_f32 v157, v157, v10
  v_mul_f32 v157, s53, v157
  v_sub_f32 v158, v158, v10
  v_mul_f32 v158, s53, v158
  v_sub_f32 v159, v159, v10
  v_mul_f32 v159, s53, v159
  v_sub_f32 v160, v160, v10
  v_mul_f32 v160, s53, v160
  v_sub_f32 v161, v161, v10
  v_mul_f32 v161, s53, v161
  v_sub_f32 v162, v162, v10
  v_mul_f32 v162, s53, v162
  v_sub_f32 v163, v163, v10
  v_mul_f32 v163, s53, v163
  v_exp_f32 v152, v152
  v_exp_f32 v153, v153
  v_exp_f32 v154, v154
  v_exp_f32 v155, v155
  v_exp_f32 v156, v156
  v_exp_f32 v157, v157
  v_exp_f32 v158, v158
  v_exp_f32 v159, v159
  v_exp_f32 v160, v160
  v_exp_f32 v161, v161
  v_exp_f32 v162, v162
  v_exp_f32 v163, v163
  s_nop 0
  v_add_f32 v10, v152, v153
  v_add_f32 v10, v10, v154
  v_add_f32 v10, v10, v155
  v_add_f32 v10, v10, v156
  v_add_f32 v10, v10, v157
  v_add_f32 v10, v10, v158
  v_add_f32 v10, v10, v159
  v_add_f32 v10, v10, v160
  v_add_f32 v10, v10, v161
  v_add_f32 v10, v10, v162
  v_add_f32 v10, v10, v163
  s_nop 1
  v_mov_b32 v11, v10
  s_nop 1
  v_permlane16_swap_b32 v10, v11
  v_add_f32 v10, v10, v11
  s_nop 1
  v_mov_b32 v11, v10
  s_nop 1
  v_permlane32_swap_b32 v10, v11
  v_add_f32 v10, v10, v11
  v_rcp_f32 v11, v10
  s_nop 0
  v_fma_f32 v12, -v10, v11, 1.0
  v_fma_f32 v11, v12, v11, v11
  v_mul_f32 v152, v152, v11
  v_mul_f32 v153, v153, v11
  v_mul_f32 v154, v154, v11
  v_mul_f32 v155, v155, v11
  v_mul_f32 v156, v156, v11
  v_mul_f32 v157, v157, v11
  v_mul_f32 v158, v158, v11
  v_mul_f32 v159, v159, v11
  v_mul_f32 v160, v160, v11
  v_mul_f32 v161, v161, v11
  v_mul_f32 v162, v162, v11
  v_mul_f32 v163, v163, v11
  v_cvt_pk_bf16_f32 v164, v144, v145
  v_cvt_pk_bf16_f32 v165, v146, v147
  v_cvt_pk_bf16_f32 v166, v148, v149
  v_cvt_pk_bf16_f32 v167, v150, v151
  v_mov_b32 v168, 0
  v_mov_b32 v169, 0
  v_cvt_pk_bf16_f32 v170, v152, v153
  v_cvt_pk_bf16_f32 v171, v154, v155
  v_cvt_pk_bf16_f32 v172, v156, v157
  v_cvt_pk_bf16_f32 v173, v158, v159
  v_cvt_pk_bf16_f32 v174, v160, v161
  v_cvt_pk_bf16_f32 v175, v162, v163
  s_waitcnt vmcnt(36)
  v_mfma_f32_16x16x16_bf16 v[16:19], v[128:129], v[164:165], 0
  v_mfma_f32_16x16x16_bf16 v[20:23], v[130:131], v[164:165], 0
  v_mfma_f32_16x16x16_bf16 v[24:27], v[132:133], v[164:165], 0
  v_mfma_f32_16x16x16_bf16 v[28:31], v[134:135], v[164:165], 0
  v_mfma_f32_16x16x16_bf16 v[32:35], v[136:137], v[164:165], 0
  v_mfma_f32_16x16x16_bf16 v[36:39], v[138:139], v[164:165], 0
  v_mfma_f32_16x16x16_bf16 v[40:43], v[140:141], v[164:165], 0
  v_mfma_f32_16x16x16_bf16 v[44:47], v[142:143], v[164:165], 0
  v_mfma_f32_16x16x16_bf16 v[48:51], v[128:129], v[170:171], 0
  v_mfma_f32_16x16x16_bf16 v[52:55], v[130:131], v[170:171], 0
  v_mfma_f32_16x16x16_bf16 v[56:59], v[132:133], v[170:171], 0
  v_mfma_f32_16x16x16_bf16 v[60:63], v[134:135], v[170:171], 0
  v_mfma_f32_16x16x16_bf16 v[64:67], v[136:137], v[170:171], 0
  v_mfma_f32_16x16x16_bf16 v[68:71], v[138:139], v[170:171], 0
  v_mfma_f32_16x16x16_bf16 v[72:75], v[140:141], v[170:171], 0
  v_mfma_f32_16x16x16_bf16 v[76:79], v[142:143], v[170:171], 0
  v_mfma_f32_16x16x32_bf16 v[16:19], v[96:99], v[166:169], v[16:19]
  v_mfma_f32_16x16x32_bf16 v[20:23], v[100:103], v[166:169], v[20:23]
  v_mfma_f32_16x16x32_bf16 v[24:27], v[104:107], v[166:169], v[24:27]
  v_mfma_f32_16x16x32_bf16 v[28:31], v[108:111], v[166:169], v[28:31]
  v_mfma_f32_16x16x32_bf16 v[32:35], v[112:115], v[166:169], v[32:35]
  v_mfma_f32_16x16x32_bf16 v[36:39], v[116:119], v[166:169], v[36:39]
  v_mfma_f32_16x16x32_bf16 v[40:43], v[120:123], v[166:169], v[40:43]
  v_mfma_f32_16x16x32_bf16 v[44:47], v[124:127], v[166:169], v[44:47]
  v_mfma_f32_16x16x32_bf16 v[48:51], v[96:99], v[172:175], v[48:51]
  v_mfma_f32_16x16x32_bf16 v[52:55], v[100:103], v[172:175], v[52:55]
  v_mfma_f32_16x16x32_bf16 v[56:59], v[104:107], v[172:175], v[56:59]
  v_mfma_f32_16x16x32_bf16 v[60:63], v[108:111], v[172:175], v[60:63]
  v_mfma_f32_16x16x32_bf16 v[64:67], v[112:115], v[172:175], v[64:67]
  v_mfma_f32_16x16x32_bf16 v[68:71], v[116:119], v[172:175], v[68:71]
  v_mfma_f32_16x16x32_bf16 v[72:75], v[120:123], v[172:175], v[72:75]
  v_mfma_f32_16x16x32_bf16 v[76:79], v[124:127], v[172:175], v[76:79]
  v_add_u32 v11, s42, v1
  s_nop 6
  v_cvt_pk_bf16_f32 v80, v16, v17
  v_cvt_pk_bf16_f32 v81, v18, v19
  v_cvt_pk_bf16_f32 v82, v20, v21
  v_cvt_pk_bf16_f32 v83, v22, v23
  ds_write_b128 v11, v[80:83] offset:0
  v_cvt_pk_bf16_f32 v84, v24, v25
  v_cvt_pk_bf16_f32 v85, v26, v27
  v_cvt_pk_bf16_f32 v86, v28, v29
  v_cvt_pk_bf16_f32 v87, v30, v31
  ds_write_b128 v11, v[84:87] offset:1024
  v_cvt_pk_bf16_f32 v88, v32, v33
  v_cvt_pk_bf16_f32 v89, v34, v35
  v_cvt_pk_bf16_f32 v90, v36, v37
  v_cvt_pk_bf16_f32 v91, v38, v39
  ds_write_b128 v11, v[88:91] offset:2048
  v_cvt_pk_bf16_f32 v92, v40, v41
  v_cvt_pk_bf16_f32 v93, v42, v43
  v_cvt_pk_bf16_f32 v94, v44, v45
  v_cvt_pk_bf16_f32 v95, v46, v47
  ds_write_b128 v11, v[92:95] offset:3072
  s_waitcnt lgkmcnt(0)
  v_cvt_pk_bf16_f32 v80, v48, v49
  v_cvt_pk_bf16_f32 v81, v50, v51
  v_cvt_pk_bf16_f32 v82, v52, v53
  v_cvt_pk_bf16_f32 v83, v54, v55
  ds_write_b128 v11, v[80:83] offset:16384
  v_cvt_pk_bf16_f32 v84, v56, v57
  v_cvt_pk_bf16_f32 v85, v58, v59
  v_cvt_pk_bf16_f32 v86, v60, v61
  v_cvt_pk_bf16_f32 v87, v62, v63
  ds_write_b128 v11, v[84:87] offset:17408
  v_cvt_pk_bf16_f32 v88, v64, v65
  v_cvt_pk_bf16_f32 v89, v66, v67
  v_cvt_pk_bf16_f32 v90, v68, v69
  v_cvt_pk_bf16_f32 v91, v70, v71
  ds_write_b128 v11, v[88:91] offset:18432
  v_cvt_pk_bf16_f32 v92, v72, v73
  v_cvt_pk_bf16_f32 v93, v74, v75
  v_cvt_pk_bf16_f32 v94, v76, v77
  v_cvt_pk_bf16_f32 v95, v78, v79
  ds_write_b128 v11, v[92:95] offset:19456
  s_waitcnt lgkmcnt(0)
  s_add_u32 s42, s42, 32768
  s_waitcnt vmcnt(16)
  v_mfma_f32_16x16x32_bf16 v[144:147], a[64:67], a[0:3], 0
  v_mfma_f32_16x16x32_bf16 v[148:151], a[32:35], a[0:3], 0
  v_mfma_f32_16x16x32_bf16 v[152:155], a[64:67], a[4:7], 0
  v_mfma_f32_16x16x32_bf16 v[156:159], a[32:35], a[4:7], 0
  v_mfma_f32_16x16x32_bf16 v[160:163], a[36:39], a[4:7], 0
  v_mfma_f32_16x16x32_bf16 v[144:147], a[68:71], a[8:11], v[144:147]
  v_mfma_f32_16x16x32_bf16 v[148:151], a[40:43], a[8:11], v[148:151]
  v_mfma_f32_16x16x32_bf16 v[152:155], a[68:71], a[12:15], v[152:155]
  v_mfma_f32_16x16x32_bf16 v[156:159], a[40:43], a[12:15], v[156:159]
  v_mfma_f32_16x16x32_bf16 v[160:163], a[44:47], a[12:15], v[160:163]
  v_mfma_f32_16x16x32_bf16 v[144:147], a[72:75], a[16:19], v[144:147]
  v_mfma_f32_16x16x32_bf16 v[148:151], a[48:51], a[16:19], v[148:151]
  v_mfma_f32_16x16x32_bf16 v[152:155], a[72:75], a[20:23], v[152:155]
  v_mfma_f32_16x16x32_bf16 v[156:159], a[48:51], a[20:23], v[156:159]
  v_mfma_f32_16x16x32_bf16 v[160:163], a[52:55], a[20:23], v[160:163]
  v_mfma_f32_16x16x32_bf16 v[144:147], a[76:79], a[24:27], v[144:147]
  v_mfma_f32_16x16x32_bf16 v[148:151], a[56:59], a[24:27], v[148:151]
  v_mfma_f32_16x16x32_bf16 v[152:155], a[76:79], a[28:31], v[152:155]
  v_mfma_f32_16x16x32_bf16 v[156:159], a[56:59], a[28:31], v[156:159]
  v_mfma_f32_16x16x32_bf16 v[160:163], a[60:63], a[28:31], v[160:163]
  s_nop 7
  v_cvt_pk_bf16_f32 v10, v144, v145
  v_lshlrev_b32 v144, 16, v10
  v_and_b32 v145, s54, v10
  v_mul_f32 v144, s52, v144
  v_mul_f32 v145, s52, v145
  v_cvt_pk_bf16_f32 v10, v144, v145
  v_lshlrev_b32 v144, 16, v10
  v_and_b32 v145, s54, v10
  v_cvt_pk_bf16_f32 v10, v146, v147
  v_lshlrev_b32 v146, 16, v10
  v_and_b32 v147, s54, v10
  v_mul_f32 v146, s52, v146
  v_mul_f32 v147, s52, v147
  v_cvt_pk_bf16_f32 v10, v146, v147
  v_lshlrev_b32 v146, 16, v10
  v_and_b32 v147, s54, v10
  v_cvt_pk_bf16_f32 v10, v148, v149
  v_lshlrev_b32 v148, 16, v10
  v_and_b32 v149, s54, v10
  v_mul_f32 v148, s52, v148
  v_mul_f32 v149, s52, v149
  v_cvt_pk_bf16_f32 v10, v148, v149
  v_lshlrev_b32 v148, 16, v10
  v_and_b32 v149, s54, v10
  v_cvt_pk_bf16_f32 v10, v150, v151
  v_lshlrev_b32 v150, 16, v10
  v_and_b32 v151, s54, v10
  v_mul_f32 v150, s52, v150
  v_mul_f32 v151, s52, v151
  v_cvt_pk_bf16_f32 v10, v150, v151
  v_lshlrev_b32 v150, 16, v10
  v_and_b32 v151, s54, v10
  v_cvt_pk_bf16_f32 v10, v152, v153
  v_lshlrev_b32 v152, 16, v10
  v_and_b32 v153, s54, v10
  v_mul_f32 v152, s52, v152
  v_mul_f32 v153, s52, v153
  v_cvt_pk_bf16_f32 v10, v152, v153
  v_lshlrev_b32 v152, 16, v10
  v_and_b32 v153, s54, v10
  v_cvt_pk_bf16_f32 v10, v154, v155
  v_lshlrev_b32 v154, 16, v10
  v_and_b32 v155, s54, v10
  v_mul_f32 v154, s52, v154
  v_mul_f32 v155, s52, v155
  v_cvt_pk_bf16_f32 v10, v154, v155
  v_lshlrev_b32 v154, 16, v10
  v_and_b32 v155, s54, v10
  v_cvt_pk_bf16_f32 v10, v156, v157
  v_lshlrev_b32 v156, 16, v10
  v_and_b32 v157, s54, v10
  v_mul_f32 v156, s52, v156
  v_mul_f32 v157, s52, v157
  v_cvt_pk_bf16_f32 v10, v156, v157
  v_lshlrev_b32 v156, 16, v10
  v_and_b32 v157, s54, v10
  v_cvt_pk_bf16_f32 v10, v158, v159
  v_lshlrev_b32 v158, 16, v10
  v_and_b32 v159, s54, v10
  v_mul_f32 v158, s52, v158
  v_mul_f32 v159, s52, v159
  v_cvt_pk_bf16_f32 v10, v158, v159
  v_lshlrev_b32 v158, 16, v10
  v_and_b32 v159, s54, v10
  v_cvt_pk_bf16_f32 v10, v160, v161
  v_lshlrev_b32 v160, 16, v10
  v_and_b32 v161, s54, v10
  v_mul_f32 v160, s52, v160
  v_mul_f32 v161, s52, v161
  v_cvt_pk_bf16_f32 v10, v160, v161
  v_lshlrev_b32 v160, 16, v10
  v_and_b32 v161, s54, v10
  v_cvt_pk_bf16_f32 v10, v162, v163
  v_lshlrev_b32 v162, 16, v10
  v_and_b32 v163, s54, v10
  v_mul_f32 v162, s52, v162
  v_mul_f32 v163, s52, v163
  v_cvt_pk_bf16_f32 v10, v162, v163
  v_lshlrev_b32 v162, 16, v10
  v_and_b32 v163, s54, v10
  v_cmp_lt_u32 vcc, 31, v3
  s_nop 1
  v_cndmask_b32 v144, v144, v8, vcc
  v_cndmask_b32 v145, v145, v8, vcc
  v_cndmask_b32 v146, v146, v8, vcc
  v_cndmask_b32 v147, v147, v8, vcc
  v_cndmask_b32 v152, v152, v8, vcc
  v_cndmask_b32 v153, v153, v8, vcc
  v_cndmask_b32 v154, v154, v8, vcc
  v_cndmask_b32 v155, v155, v8, vcc
  v_add_u32 v10, 0, v9
  v_cmp_gt_u32 vcc, v10, v4
  s_nop 1
  v_cndmask_b32 v148, v148, v8, vcc
  v_cndmask_b32 v160, v160, v8, vcc
  v_add_u32 v10, 1, v9
  v_cmp_gt_u32 vcc, v10, v4
  s_nop 1
  v_cndmask_b32 v149, v149, v8, vcc
  v_cndmask_b32 v161, v161, v8, vcc
  v_add_u32 v10, 2, v9
  v_cmp_gt_u32 vcc, v10, v4
  s_nop 1
  v_cndmask_b32 v150, v150, v8, vcc
  v_cndmask_b32 v162, v162, v8, vcc
  v_add_u32 v10, 3, v9
  v_cmp_gt_u32 vcc, v10, v4
  s_nop 1
  v_cndmask_b32 v151, v151, v8, vcc
  v_cndmask_b32 v163, v163, v8, vcc
  v_max3_f32 v10, v144, v145, v146
  v_max3_f32 v10, v10, v147, v148
  v_max3_f32 v10, v10, v149, v150
  v_max_f32 v10, v10, v151
  s_nop 1
  v_mov_b32 v11, v10
  s_nop 1
  v_permlane16_swap_b32 v10, v11
  v_max_f32 v10, v10, v11
  s_nop 1
  v_mov_b32 v11, v10
  s_nop 1
  v_permlane32_swap_b32 v10, v11
  v_max_f32 v10, v10, v11
  v_sub_f32 v144, v144, v10
  v_mul_f32 v144, s53, v144
  v_sub_f32 v145, v145, v10
  v_mul_f32 v145, s53, v145
  v_sub_f32 v146, v146, v10
  v_mul_f32 v146, s53, v146
  v_sub_f32 v147, v147, v10
  v_mul_f32 v147, s53, v147
  v_sub_f32 v148, v148, v10
  v_mul_f32 v148, s53, v148
  v_sub_f32 v149, v149, v10
  v_mul_f32 v149, s53, v149
  v_sub_f32 v150, v150, v10
  v_mul_f32 v150, s53, v150
  v_sub_f32 v151, v151, v10
  v_mul_f32 v151, s53, v151
  v_exp_f32 v144, v144
  v_exp_f32 v145, v145
  v_exp_f32 v146, v146
  v_exp_f32 v147, v147
  v_exp_f32 v148, v148
  v_exp_f32 v149, v149
  v_exp_f32 v150, v150
  v_exp_f32 v151, v151
  s_nop 0
  v_add_f32 v10, v144, v145
  v_add_f32 v10, v10, v146
  v_add_f32 v10, v10, v147
  v_add_f32 v10, v10, v148
  v_add_f32 v10, v10, v149
  v_add_f32 v10, v10, v150
  v_add_f32 v10, v10, v151
  s_nop 1
  v_mov_b32 v11, v10
  s_nop 1
  v_permlane16_swap_b32 v10, v11
  v_add_f32 v10, v10, v11
  s_nop 1
  v_mov_b32 v11, v10
  s_nop 1
  v_permlane32_swap_b32 v10, v11
  v_add_f32 v10, v10, v11
  v_rcp_f32 v11, v10
  s_nop 0
  v_fma_f32 v12, -v10, v11, 1.0
  v_fma_f32 v11, v12, v11, v11
  v_mul_f32 v144, v144, v11
  v_mul_f32 v145, v145, v11
  v_mul_f32 v146, v146, v11
  v_mul_f32 v147, v147, v11
  v_mul_f32 v148, v148, v11
  v_mul_f32 v149, v149, v11
  v_mul_f32 v150, v150, v11
  v_mul_f32 v151, v151, v11
  v_max3_f32 v10, v152, v153, v154
  v_max3_f32 v10, v10, v155, v156
  v_max3_f32 v10, v10, v157, v158
  v_max3_f32 v10, v10, v159, v160
  v_max3_f32 v10, v10, v161, v162
  v_max_f32 v10, v10, v163
  s_nop 1
  v_mov_b32 v11, v10
  s_nop 1
  v_permlane16_swap_b32 v10, v11
  v_max_f32 v10, v10, v11
  s_nop 1
  v_mov_b32 v11, v10
  s_nop 1
  v_permlane32_swap_b32 v10, v11
  v_max_f32 v10, v10, v11
  v_sub_f32 v152, v152, v10
  v_mul_f32 v152, s53, v152
  v_sub_f32 v153, v153, v10
  v_mul_f32 v153, s53, v153
  v_sub_f32 v154, v154, v10
  v_mul_f32 v154, s53, v154
  v_sub_f32 v155, v155, v10
  v_mul_f32 v155, s53, v155
  v_sub_f32 v156, v156, v10
  v_mul_f32 v156, s53, v156
  v_sub_f32 v157, v157, v10
  v_mul_f32 v157, s53, v157
  v_sub_f32 v158, v158, v10
  v_mul_f32 v158, s53, v158
  v_sub_f32 v159, v159, v10
  v_mul_f32 v159, s53, v159
  v_sub_f32 v160, v160, v10
  v_mul_f32 v160, s53, v160
  v_sub_f32 v161, v161, v10
  v_mul_f32 v161, s53, v161
  v_sub_f32 v162, v162, v10
  v_mul_f32 v162, s53, v162
  v_sub_f32 v163, v163, v10
  v_mul_f32 v163, s53, v163
  v_exp_f32 v152, v152
  v_exp_f32 v153, v153
  v_exp_f32 v154, v154
  v_exp_f32 v155, v155
  v_exp_f32 v156, v156
  v_exp_f32 v157, v157
  v_exp_f32 v158, v158
  v_exp_f32 v159, v159
  v_exp_f32 v160, v160
  v_exp_f32 v161, v161
  v_exp_f32 v162, v162
  v_exp_f32 v163, v163
  s_nop 0
  v_add_f32 v10, v152, v153
  v_add_f32 v10, v10, v154
  v_add_f32 v10, v10, v155
  v_add_f32 v10, v10, v156
  v_add_f32 v10, v10, v157
  v_add_f32 v10, v10, v158
  v_add_f32 v10, v10, v159
  v_add_f32 v10, v10, v160
  v_add_f32 v10, v10, v161
  v_add_f32 v10, v10, v162
  v_add_f32 v10, v10, v163
  s_nop 1
  v_mov_b32 v11, v10
  s_nop 1
  v_permlane16_swap_b32 v10, v11
  v_add_f32 v10, v10, v11
  s_nop 1
  v_mov_b32 v11, v10
  s_nop 1
  v_permlane32_swap_b32 v10, v11
  v_add_f32 v10, v10, v11
  v_rcp_f32 v11, v10
  s_nop 0
  v_fma_f32 v12, -v10, v11, 1.0
  v_fma_f32 v11, v12, v11, v11
  v_mul_f32 v152, v152, v11
  v_mul_f32 v153, v153, v11
  v_mul_f32 v154, v154, v11
  v_mul_f32 v155, v155, v11
  v_mul_f32 v156, v156, v11
  v_mul_f32 v157, v157, v11
  v_mul_f32 v158, v158, v11
  v_mul_f32 v159, v159, v11
  v_mul_f32 v160, v160, v11
  v_mul_f32 v161, v161, v11
  v_mul_f32 v162, v162, v11
  v_mul_f32 v163, v163, v11
  v_cvt_pk_bf16_f32 v164, v144, v145
  v_cvt_pk_bf16_f32 v165, v146, v147
  v_cvt_pk_bf16_f32 v166, v148, v149
  v_cvt_pk_bf16_f32 v167, v150, v151
  v_mov_b32 v168, 0
  v_mov_b32 v169, 0
  v_cvt_pk_bf16_f32 v170, v152, v153
  v_cvt_pk_bf16_f32 v171, v154, v155
  v_cvt_pk_bf16_f32 v172, v156, v157
  v_cvt_pk_bf16_f32 v173, v158, v159
  v_cvt_pk_bf16_f32 v174, v160, v161
  v_cvt_pk_bf16_f32 v175, v162, v163
  s_waitcnt vmcnt(0)
  v_mfma_f32_16x16x16_bf16 v[16:19], a[112:113], v[164:165], 0
  v_mfma_f32_16x16x16_bf16 v[20:23], a[114:115], v[164:165], 0
  v_mfma_f32_16x16x16_bf16 v[24:27], a[116:117], v[164:165], 0
  v_mfma_f32_16x16x16_bf16 v[28:31], a[118:119], v[164:165], 0
  v_mfma_f32_16x16x16_bf16 v[32:35], a[120:121], v[164:165], 0
  v_mfma_f32_16x16x16_bf16 v[36:39], a[122:123], v[164:165], 0
  v_mfma_f32_16x16x16_bf16 v[40:43], a[124:125], v[164:165], 0
  v_mfma_f32_16x16x16_bf16 v[44:47], a[126:127], v[164:165], 0
  v_mfma_f32_16x16x16_bf16 v[48:51], a[112:113], v[170:171], 0
  v_mfma_f32_16x16x16_bf16 v[52:55], a[114:115], v[170:171], 0
  v_mfma_f32_16x16x16_bf16 v[56:59], a[116:117], v[170:171], 0
  v_mfma_f32_16x16x16_bf16 v[60:63], a[118:119], v[170:171], 0
  v_mfma_f32_16x16x16_bf16 v[64:67], a[120:121], v[170:171], 0
  v_mfma_f32_16x16x16_bf16 v[68:71], a[122:123], v[170:171], 0
  v_mfma_f32_16x16x16_bf16 v[72:75], a[124:125], v[170:171], 0
  v_mfma_f32_16x16x16_bf16 v[76:79], a[126:127], v[170:171], 0
  v_mfma_f32_16x16x32_bf16 v[16:19], a[80:83], v[166:169], v[16:19]
  v_mfma_f32_16x16x32_bf16 v[20:23], a[84:87], v[166:169], v[20:23]
  v_mfma_f32_16x16x32_bf16 v[24:27], a[88:91], v[166:169], v[24:27]
  v_mfma_f32_16x16x32_bf16 v[28:31], a[92:95], v[166:169], v[28:31]
  v_mfma_f32_16x16x32_bf16 v[32:35], a[96:99], v[166:169], v[32:35]
  v_mfma_f32_16x16x32_bf16 v[36:39], a[100:103], v[166:169], v[36:39]
  v_mfma_f32_16x16x32_bf16 v[40:43], a[104:107], v[166:169], v[40:43]
  v_mfma_f32_16x16x32_bf16 v[44:47], a[108:111], v[166:169], v[44:47]
  v_mfma_f32_16x16x32_bf16 v[48:51], a[80:83], v[172:175], v[48:51]
  v_mfma_f32_16x16x32_bf16 v[52:55], a[84:87], v[172:175], v[52:55]
  v_mfma_f32_16x16x32_bf16 v[56:59], a[88:91], v[172:175], v[56:59]
  v_mfma_f32_16x16x32_bf16 v[60:63], a[92:95], v[172:175], v[60:63]
  v_mfma_f32_16x16x32_bf16 v[64:67], a[96:99], v[172:175], v[64:67]
  v_mfma_f32_16x16x32_bf16 v[68:71], a[100:103], v[172:175], v[68:71]
  v_mfma_f32_16x16x32_bf16 v[72:75], a[104:107], v[172:175], v[72:75]
  v_mfma_f32_16x16x32_bf16 v[76:79], a[108:111], v[172:175], v[76:79]
  v_add_u32 v11, s42, v1
  s_nop 6
  v_cvt_pk_bf16_f32 v80, v16, v17
  v_cvt_pk_bf16_f32 v81, v18, v19
  v_cvt_pk_bf16_f32 v82, v20, v21
  v_cvt_pk_bf16_f32 v83, v22, v23
  ds_write_b128 v11, v[80:83] offset:0
  v_cvt_pk_bf16_f32 v84, v24, v25
  v_cvt_pk_bf16_f32 v85, v26, v27
  v_cvt_pk_bf16_f32 v86, v28, v29
  v_cvt_pk_bf16_f32 v87, v30, v31
  ds_write_b128 v11, v[84:87] offset:1024
  v_cvt_pk_bf16_f32 v88, v32, v33
  v_cvt_pk_bf16_f32 v89, v34, v35
  v_cvt_pk_bf16_f32 v90, v36, v37
  v_cvt_pk_bf16_f32 v91, v38, v39
  ds_write_b128 v11, v[88:91] offset:2048
  v_cvt_pk_bf16_f32 v92, v40, v41
  v_cvt_pk_bf16_f32 v93, v42, v43
  v_cvt_pk_bf16_f32 v94, v44, v45
  v_cvt_pk_bf16_f32 v95, v46, v47
  ds_write_b128 v11, v[92:95] offset:3072
  s_waitcnt lgkmcnt(0)
  v_cvt_pk_bf16_f32 v80, v48, v49
  v_cvt_pk_bf16_f32 v81, v50, v51
  v_cvt_pk_bf16_f32 v82, v52, v53
  v_cvt_pk_bf16_f32 v83, v54, v55
  ds_write_b128 v11, v[80:83] offset:16384
  v_cvt_pk_bf16_f32 v84, v56, v57
  v_cvt_pk_bf16_f32 v85, v58, v59
  v_cvt_pk_bf16_f32 v86, v60, v61
  v_cvt_pk_bf16_f32 v87, v62, v63
  ds_write_b128 v11, v[84:87] offset:17408
  v_cvt_pk_bf16_f32 v88, v64, v65
  v_cvt_pk_bf16_f32 v89, v66, v67
  v_cvt_pk_bf16_f32 v90, v68, v69
  v_cvt_pk_bf16_f32 v91, v70, v71
  ds_write_b128 v11, v[88:91] offset:18432
  v_cvt_pk_bf16_f32 v92, v72, v73
  v_cvt_pk_bf16_f32 v93, v74, v75
  v_cvt_pk_bf16_f32 v94, v76, v77
  v_cvt_pk_bf16_f32 v95, v78, v79
  ds_write_b128 v11, v[92:95] offset:19456
  s_waitcnt lgkmcnt(0)
  s_lshl_b32 s10, s45, 3
  s_add_u32 s10, s10, s44
  s_mul_i32 s10, s10, 163840
  s_mul_i32 s11, s8, 640
  s_add_u32 s10, s10, s11
  s_add_u32 s10, s10, 0xd000000
  s_add_u32 s12, s6, s10
  s_addc_u32 s13, s7, 0
  v_mul_u32_u24 v176, 2560, v4
  v_lshl_add_u32 v176, v5, 4, v176
  v_add_u32 v177, 40960, v176
  v_add_u32 v178, 81920, v176
  v_add_u32 v179, 122880, v176
  v_add_u32 v180, 0x1000, v1
  v_add_u32 v181, 0x2000, v1
  v_add_u32 v182, 0x3000, v1
  global_load_dwordx4 v[16:19], v1, s[60:61] offset:0
  global_load_dwordx4 v[20:23], v1, s[62:63] offset:0
  global_load_dwordx4 v[24:27], v1, s[60:61] offset:1024
  global_load_dwordx4 v[28:31], v1, s[62:63] offset:1024
  global_load_dwordx4 v[32:35], v1, s[60:61] offset:2048
  global_load_dwordx4 v[36:39], v1, s[62:63] offset:2048
  global_load_dwordx4 v[40:43], v1, s[60:61] offset:3072
  global_load_dwordx4 v[44:47], v1, s[62:63] offset:3072
  global_load_dwordx4 v[48:51], v180, s[60:61] offset:0
  global_load_dwordx4 v[52:55], v180, s[62:63] offset:0
  global_load_dwordx4 v[56:59], v180, s[60:61] offset:1024
  global_load_dwordx4 v[60:63], v180, s[62:63] offset:1024
  global_load_dwordx4 v[64:67], v180, s[60:61] offset:2048
  global_load_dwordx4 v[68:71], v180, s[62:63] offset:2048
  global_load_dwordx4 v[72:75], v180, s[60:61] offset:3072
  global_load_dwordx4 v[76:79], v180, s[62:63] offset:3072
  global_load_dwordx4 v[80:83], v181, s[60:61] offset:0
  global_load_dwordx4 v[84:87], v181, s[62:63] offset:0
  global_load_dwordx4 v[88:91], v181, s[60:61] offset:1024
  global_load_dwordx4 v[92:95], v181, s[62:63] offset:1024
  s_barrier
  ds_read_b128 v[112:115], v1 offset:0
  ds_read_b128 v[116:119], v1 offset:16384
  ds_read_b128 v[120:123], v1 offset:32768
  ds_read_b128 v[124:127], v1 offset:49152
  ds_read_b128 v[128:131], v1 offset:1024
  ds_read_b128 v[132:135], v1 offset:17408
  ds_read_b128 v[136:139], v1 offset:33792
  ds_read_b128 v[140:143], v1 offset:50176
  global_load_dwordx4 v[96:99], v181, s[60:61] offset:2048
  global_load_dwordx4 v[100:103], v181, s[62:63] offset:2048
  ds_read_b128 v[144:147], v1 offset:2048
  ds_read_b128 v[148:151], v1 offset:18432
  ds_read_b128 v[152:155], v1 offset:34816
  ds_read_b128 v[156:159], v1 offset:51200
  s_waitcnt vmcnt(20) lgkmcnt(8)
  v_mfma_f32_16x16x32_bf16 a[0:3], v[16:19], v[112:115], 0
  v_mfma_f32_16x16x32_bf16 a[4:7], v[16:19], v[116:119], 0
  v_mfma_f32_16x16x32_bf16 a[8:11], v[16:19], v[120:123], 0
  v_mfma_f32_16x16x32_bf16 a[12:15], v[16:19], v[124:127], 0
  v_mfma_f32_16x16x32_bf16 a[16:19], v[20:23], v[112:115], 0
  v_mfma_f32_16x16x32_bf16 a[20:23], v[20:23], v[116:119], 0
  v_mfma_f32_16x16x32_bf16 a[24:27], v[20:23], v[120:123], 0
  v_mfma_f32_16x16x32_bf16 a[28:31], v[20:23], v[124:127], 0
  global_load_dwordx4 v[16:19], v181, s[60:61] offset:3072
  global_load_dwordx4 v[20:23], v181, s[62:63] offset:3072
  ds_read_b128 v[112:115], v1 offset:3072
  ds_read_b128 v[116:119], v1 offset:19456
  ds_read_b128 v[120:123], v1 offset:35840
  ds_read_b128 v[124:127], v1 offset:52224
  s_waitcnt vmcnt(20) lgkmcnt(8)
  v_mfma_f32_16x16x32_bf16 a[0:3], v[24:27], v[128:131], a[0:3]
  v_mfma_f32_16x16x32_bf16 a[4:7], v[24:27], v[132:135], a[4:7]
  v_mfma_f32_16x16x32_bf16 a[8:11], v[24:27], v[136:139], a[8:11]
  v_mfma_f32_16x16x32_bf16 a[12:15], v[24:27], v[140:143], a[12:15]
  v_mfma_f32_16x16x32_bf16 a[16:19], v[28:31], v[128:131], a[16:19]
  v_mfma_f32_16x16x32_bf16 a[20:23], v[28:31], v[132:135], a[20:23]
  v_mfma_f32_16x16x32_bf16 a[24:27], v[28:31], v[136:139], a[24:27]
  v_mfma_f32_16x16x32_bf16 a[28:31], v[28:31], v[140:143], a[28:31]
  global_load_dwordx4 v[24:27], v182, s[60:61] offset:0
  global_load_dwordx4 v[28:31], v182, s[62:63] offset:0
  ds_read_b128 v[128:131], v1 offset:4096
  ds_read_b128 v[132:135], v1 offset:20480
  ds_read_b128 v[136:139], v1 offset:36864
  ds_read_b128 v[140:143], v1 offset:53248
  s_waitcnt vmcnt(20) lgkmcnt(8)
  v_mfma_f32_16x16x32_bf16 a[0:3], v[32:35], v[144:147], a[0:3]
  v_mfma_f32_16x16x32_bf16 a[4:7], v[32:35], v[148:151], a[4:7]
  v_mfma_f32_16x16x32_bf16 a[8:11], v[32:35], v[152:155], a[8:11]
  v_mfma_f32_16x16x32_bf16 a[12:15], v[32:35], v[156:159], a[12:15]
  v_mfma_f32_16x16x32_bf16 a[16:19], v[36:39], v[144:147], a[16:19]
  v_mfma_f32_16x16x32_bf16 a[20:23], v[36:39], v[148:151], a[20:23]
  v_mfma_f32_16x16x32_bf16 a[24:27], v[36:39], v[152:155], a[24:27]
  v_mfma_f32_16x16x32_bf16 a[28:31], v[36:39], v[156:159], a[28:31]
  global_load_dwordx4 v[32:35], v182, s[60:61] offset:1024
  global_load_dwordx4 v[36:39], v182, s[62:63] offset:1024
  ds_read_b128 v[144:147], v1 offset:5120
  ds_read_b128 v[148:151], v1 offset:21504
  ds_read_b128 v[152:155], v1 offset:37888
  ds_read_b128 v[156:159], v1 offset:54272
  s_waitcnt vmcnt(20) lgkmcnt(8)
  v_mfma_f32_16x16x32_bf16 a[0:3], v[40:43], v[112:115], a[0:3]
  v_mfma_f32_16x16x32_bf16 a[4:7], v[40:43], v[116:119], a[4:7]
  v_mfma_f32_16x16x32_bf16 a[8:11], v[40:43], v[120:123], a[8:11]
  v_mfma_f32_16x16x32_bf16 a[12:15], v[40:43], v[124:127], a[12:15]
  v_mfma_f32_16x16x32_bf16 a[16:19], v[44:47], v[112:115], a[16:19]
  v_mfma_f32_16x16x32_bf16 a[20:23], v[44:47], v[116:119], a[20:23]
  v_mfma_f32_16x16x32_bf16 a[24:27], v[44:47], v[120:123], a[24:27]
  v_mfma_f32_16x16x32_bf16 a[28:31], v[44:47], v[124:127], a[28:31]
  global_load_dwordx4 v[40:43], v182, s[60:61] offset:2048
  global_load_dwordx4 v[44:47], v182, s[62:63] offset:2048
  ds_read_b128 v[112:115], v1 offset:6144
  ds_read_b128 v[116:119], v1 offset:22528
  ds_read_b128 v[120:123], v1 offset:38912
  ds_read_b128 v[124:127], v1 offset:55296
  s_waitcnt vmcnt(20) lgkmcnt(8)
  v_mfma_f32_16x16x32_bf16 a[0:3], v[48:51], v[128:131], a[0:3]
  v_mfma_f32_16x16x32_bf16 a[4:7], v[48:51], v[132:135], a[4:7]
  v_mfma_f32_16x16x32_bf16 a[8:11], v[48:51], v[136:139], a[8:11]
  v_mfma_f32_16x16x32_bf16 a[12:15], v[48:51], v[140:143], a[12:15]
  v_mfma_f32_16x16x32_bf16 a[16:19], v[52:55], v[128:131], a[16:19]
  v_mfma_f32_16x16x32_bf16 a[20:23], v[52:55], v[132:135], a[20:23]
  v_mfma_f32_16x16x32_bf16 a[24:27], v[52:55], v[136:139], a[24:27]
  v_mfma_f32_16x16x32_bf16 a[28:31], v[52:55], v[140:143], a[28:31]
  global_load_dwordx4 v[48:51], v182, s[60:61] offset:3072
  global_load_dwordx4 v[52:55], v182, s[62:63] offset:3072
  ds_read_b128 v[128:131], v1 offset:7168
  ds_read_b128 v[132:135], v1 offset:23552
  ds_read_b128 v[136:139], v1 offset:39936
  ds_read_b128 v[140:143], v1 offset:56320
  s_waitcnt vmcnt(20) lgkmcnt(8)
  v_mfma_f32_16x16x32_bf16 a[0:3], v[56:59], v[144:147], a[0:3]
  v_mfma_f32_16x16x32_bf16 a[4:7], v[56:59], v[148:151], a[4:7]
  v_mfma_f32_16x16x32_bf16 a[8:11], v[56:59], v[152:155], a[8:11]
  v_mfma_f32_16x16x32_bf16 a[12:15], v[56:59], v[156:159], a[12:15]
  v_mfma_f32_16x16x32_bf16 a[16:19], v[60:63], v[144:147], a[16:19]
  v_mfma_f32_16x16x32_bf16 a[20:23], v[60:63], v[148:151], a[20:23]
  v_mfma_f32_16x16x32_bf16 a[24:27], v[60:63], v[152:155], a[24:27]
  v_mfma_f32_16x16x32_bf16 a[28:31], v[60:63], v[156:159], a[28:31]
  global_load_dwordx4 v[56:59], v1, s[64:65] offset:0
  global_load_dwordx4 v[60:63], v1, s[66:67] offset:0
  ds_read_b128 v[144:147], v1 offset:8192
  ds_read_b128 v[148:151], v1 offset:24576
  ds_read_b128 v[152:155], v1 offset:40960
  ds_read_b128 v[156:159], v1 offset:57344
  s_waitcnt vmcnt(20) lgkmcnt(8)
  v_mfma_f32_16x16x32_bf16 a[0:3], v[64:67], v[112:115], a[0:3]
  v_mfma_f32_16x16x32_bf16 a[4:7], v[64:67], v[116:119], a[4:7]
  v_mfma_f32_16x16x32_bf16 a[8:11], v[64:67], v[120:123], a[8:11]
  v_mfma_f32_16x16x32_bf16 a[12:15], v[64:67], v[124:127], a[12:15]
  v_mfma_f32_16x16x32_bf16 a[16:19], v[68:71], v[112:115], a[16:19]
  v_mfma_f32_16x16x32_bf16 a[20:23], v[68:71], v[116:119], a[20:23]
  v_mfma_f32_16x16x32_bf16 a[24:27], v[68:71], v[120:123], a[24:27]
  v_mfma_f32_16x16x32_bf16 a[28:31], v[68:71], v[124:127], a[28:31]
  global_load_dwordx4 v[64:67], v1, s[64:65] offset:1024
  global_load_dwordx4 v[68:71], v1, s[66:67] offset:1024
  ds_read_b128 v[112:115], v1 offset:9216
  ds_read_b128 v[116:119], v1 offset:25600
  ds_read_b128 v[120:123], v1 offset:41984
  ds_read_b128 v[124:127], v1 offset:58368
  s_waitcnt vmcnt(20) lgkmcnt(8)
  v_mfma_f32_16x16x32_bf16 a[0:3], v[72:75], v[128:131], a[0:3]
  v_mfma_f32_16x16x32_bf16 a[4:7], v[72:75], v[132:135], a[4:7]
  v_mfma_f32_16x16x32_bf16 a[8:11], v[72:75], v[136:139], a[8:11]
  v_mfma_f32_16x16x32_bf16 a[12:15], v[72:75], v[140:143], a[12:15]
  v_mfma_f32_16x16x32_bf16 a[16:19], v[76:79], v[128:131], a[16:19]
  v_mfma_f32_16x16x32_bf16 a[20:23], v[76:79], v[132:135], a[20:23]
  v_mfma_f32_16x16x32_bf16 a[24:27], v[76:79], v[136:139], a[24:27]
  v_mfma_f32_16x16x32_bf16 a[28:31], v[76:79], v[140:143], a[28:31]
  global_load_dwordx4 v[72:75], v1, s[64:65] offset:2048
  global_load_dwordx4 v[76:79], v1, s[66:67] offset:2048
  ds_read_b128 v[128:131], v1 offset:10240
  ds_read_b128 v[132:135], v1 offset:26624
  ds_read_b128 v[136:139], v1 offset:43008
  ds_read_b128 v[140:143], v1 offset:59392
  s_waitcnt vmcnt(20) lgkmcnt(8)
  v_mfma_f32_16x16x32_bf16 a[0:3], v[80:83], v[144:147], a[0:3]
  v_mfma_f32_16x16x32_bf16 a[4:7], v[80:83], v[148:151], a[4:7]
  v_mfma_f32_16x16x32_bf16 a[8:11], v[80:83], v[152:155], a[8:11]
  v_mfma_f32_16x16x32_bf16 a[12:15], v[80:83], v[156:159], a[12:15]
  v_mfma_f32_16x16x32_bf16 a[16:19], v[84:87], v[144:147], a[16:19]
  v_mfma_f32_16x16x32_bf16 a[20:23], v[84:87], v[148:151], a[20:23]
  v_mfma_f32_16x16x32_bf16 a[24:27], v[84:87], v[152:155], a[24:27]
  v_mfma_f32_16x16x32_bf16 a[28:31], v[84:87], v[156:159], a[28:31]
  global_load_dwordx4 v[80:83], v1, s[64:65] offset:3072
  global_load_dwordx4 v[84:87], v1, s[66:67] offset:3072
  ds_read_b128 v[144:147], v1 offset:11264
  ds_read_b128 v[148:151], v1 offset:27648
  ds_read_b128 v[152:155], v1 offset:44032
  ds_read_b128 v[156:159], v1 offset:60416
  s_waitcnt vmcnt(20) lgkmcnt(8)
  v_mfma_f32_16x16x32_bf16 a[0:3], v[88:91], v[112:115], a[0:3]
  v_mfma_f32_16x16x32_bf16 a[4:7], v[88:91], v[116:119], a[4:7]
  v_mfma_f32_16x16x32_bf16 a[8:11], v[88:91], v[120:123], a[8:11]
  v_mfma_f32_16x16x32_bf16 a[12:15], v[88:91], v[124:127], a[12:15]
  v_mfma_f32_16x16x32_bf16 a[16:19], v[92:95], v[112:115], a[16:19]
  v_mfma_f32_16x16x32_bf16 a[20:23], v[92:95], v[116:119], a[20:23]
  v_mfma_f32_16x16x32_bf16 a[24:27], v[92:95], v[120:123], a[24:27]
  v_mfma_f32_16x16x32_bf16 a[28:31], v[92:95], v[124:127], a[28:31]
  global_load_dwordx4 v[88:91], v180, s[64:65] offset:0
  global_load_dwordx4 v[92:95], v180, s[66:67] offset:0
  ds_read_b128 v[112:115], v1 offset:12288
  ds_read_b128 v[116:119], v1 offset:28672
  ds_read_b128 v[120:123], v1 offset:45056
  ds_read_b128 v[124:127], v1 offset:61440
  s_waitcnt vmcnt(20) lgkmcnt(8)
  v_mfma_f32_16x16x32_bf16 a[0:3], v[96:99], v[128:131], a[0:3]
  v_mfma_f32_16x16x32_bf16 a[4:7], v[96:99], v[132:135], a[4:7]
  v_mfma_f32_16x16x32_bf16 a[8:11], v[96:99], v[136:139], a[8:11]
  v_mfma_f32_16x16x32_bf16 a[12:15], v[96:99], v[140:143], a[12:15]
  v_mfma_f32_16x16x32_bf16 a[16:19], v[100:103], v[128:131], a[16:19]
  v_mfma_f32_16x16x32_bf16 a[20:23], v[100:103], v[132:135], a[20:23]
  v_mfma_f32_16x16x32_bf16 a[24:27], v[100:103], v[136:139], a[24:27]
  v_mfma_f32_16x16x32_bf16 a[28:31], v[100:103], v[140:143], a[28:31]
  global_load_dwordx4 v[96:99], v180, s[64:65] offset:1024
  global_load_dwordx4 v[100:103], v180, s[66:67] offset:1024
  ds_read_b128 v[128:131], v1 offset:13312
  ds_read_b128 v[132:135], v1 offset:29696
  ds_read_b128 v[136:139], v1 offset:46080
  ds_read_b128 v[140:143], v1 offset:62464
  s_waitcnt vmcnt(20) lgkmcnt(8)
  v_mfma_f32_16x16x32_bf16 a[0:3], v[16:19], v[144:147], a[0:3]
  v_mfma_f32_16x16x32_bf16 a[4:7], v[16:19], v[148:151], a[4:7]
  v_mfma_f32_16x16x32_bf16 a[8:11], v[16:19], v[152:155], a[8:11]
  v_mfma_f32_16x16x32_bf16 a[12:15], v[16:19], v[156:159], a[12:15]
  v_mfma_f32_16x16x32_bf16 a[16:19], v[20:23], v[144:147], a[16:19]
  v_mfma_f32_16x16x32_bf16 a[20:23], v[20:23], v[148:151], a[20:23]
  v_mfma_f32_16x16x32_bf16 a[24:27], v[20:23], v[152:155], a[24:27]
  v_mfma_f32_16x16x32_bf16 a[28:31], v[20:23], v[156:159], a[28:31]
  global_load_dwordx4 v[16:19], v180, s[64:65] offset:2048
  global_load_dwordx4 v[20:23], v180, s[66:67] offset:2048
  ds_read_b128 v[144:147], v1 offset:14336
  ds_read_b128 v[148:151], v1 offset:30720
  ds_read_b128 v[152:155], v1 offset:47104
  ds_read_b128 v[156:159], v1 offset:63488
  s_waitcnt vmcnt(20) lgkmcnt(8)
  v_mfma_f32_16x16x32_bf16 a[0:3], v[24:27], v[112:115], a[0:3]
  v_mfma_f32_16x16x32_bf16 a[4:7], v[24:27], v[116:119], a[4:7]
  v_mfma_f32_16x16x32_bf16 a[8:11], v[24:27], v[120:123], a[8:11]
  v_mfma_f32_16x16x32_bf16 a[12:15], v[24:27], v[124:127], a[12:15]
  v_mfma_f32_16x16x32_bf16 a[16:19], v[28:31], v[112:115], a[16:19]
  v_mfma_f32_16x16x32_bf16 a[20:23], v[28:31], v[116:119], a[20:23]
  v_mfma_f32_16x16x32_bf16 a[24:27], v[28:31], v[120:123], a[24:27]
  v_mfma_f32_16x16x32_bf16 a[28:31], v[28:31], v[124:127], a[28:31]
  global_load_dwordx4 v[24:27], v180, s[64:65] offset:3072
  global_load_dwordx4 v[28:31], v180, s[66:67] offset:3072
  ds_read_b128 v[112:115], v1 offset:15360
  ds_read_b128 v[116:119], v1 offset:31744
  ds_read_b128 v[120:123], v1 offset:48128
  ds_read_b128 v[124:127], v1 offset:64512
  s_waitcnt vmcnt(20) lgkmcnt(8)
  v_mfma_f32_16x16x32_bf16 a[0:3], v[32:35], v[128:131], a[0:3]
  v_mfma_f32_16x16x32_bf16 a[4:7], v[32:35], v[132:135], a[4:7]
  v_mfma_f32_16x16x32_bf16 a[8:11], v[32:35], v[136:139], a[8:11]
  v_mfma_f32_16x16x32_bf16 a[12:15], v[32:35], v[140:143], a[12:15]
  v_mfma_f32_16x16x32_bf16 a[16:19], v[36:39], v[128:131], a[16:19]
  v_mfma_f32_16x16x32_bf16 a[20:23], v[36:39], v[132:135], a[20:23]
  v_mfma_f32_16x16x32_bf16 a[24:27], v[36:39], v[136:139], a[24:27]
  v_mfma_f32_16x16x32_bf16 a[28:31], v[36:39], v[140:143], a[28:31]
  global_load_dwordx4 v[32:35], v181, s[64:65] offset:0
  global_load_dwordx4 v[36:39], v181, s[66:67] offset:0
  ds_read_b128 v[128:131], v1 offset:0
  ds_read_b128 v[132:135], v1 offset:16384
  ds_read_b128 v[136:139], v1 offset:32768
  ds_read_b128 v[140:143], v1 offset:49152
  s_waitcnt vmcnt(20) lgkmcnt(8)
  v_mfma_f32_16x16x32_bf16 a[0:3], v[40:43], v[144:147], a[0:3]
  v_mfma_f32_16x16x32_bf16 a[4:7], v[40:43], v[148:151], a[4:7]
  v_mfma_f32_16x16x32_bf16 a[8:11], v[40:43], v[152:155], a[8:11]
  v_mfma_f32_16x16x32_bf16 a[12:15], v[40:43], v[156:159], a[12:15]
  v_mfma_f32_16x16x32_bf16 a[16:19], v[44:47], v[144:147], a[16:19]
  v_mfma_f32_16x16x32_bf16 a[20:23], v[44:47], v[148:151], a[20:23]
  v_mfma_f32_16x16x32_bf16 a[24:27], v[44:47], v[152:155], a[24:27]
  v_mfma_f32_16x16x32_bf16 a[28:31], v[44:47], v[156:159], a[28:31]
  global_load_dwordx4 v[40:43], v181, s[64:65] offset:1024
  global_load_dwordx4 v[44:47], v181, s[66:67] offset:1024
  ds_read_b128 v[144:147], v1 offset:1024
  ds_read_b128 v[148:151], v1 offset:17408
  ds_read_b128 v[152:155], v1 offset:33792
  ds_read_b128 v[156:159], v1 offset:50176
  s_waitcnt vmcnt(20) lgkmcnt(8)
  v_mfma_f32_16x16x32_bf16 a[0:3], v[48:51], v[112:115], a[0:3]
  v_mfma_f32_16x16x32_bf16 a[4:7], v[48:51], v[116:119], a[4:7]
  v_mfma_f32_16x16x32_bf16 a[8:11], v[48:51], v[120:123], a[8:11]
  v_mfma_f32_16x16x32_bf16 a[12:15], v[48:51], v[124:127], a[12:15]
  v_mfma_f32_16x16x32_bf16 a[16:19], v[52:55], v[112:115], a[16:19]
  v_mfma_f32_16x16x32_bf16 a[20:23], v[52:55], v[116:119], a[20:23]
  v_mfma_f32_16x16x32_bf16 a[24:27], v[52:55], v[120:123], a[24:27]
  v_mfma_f32_16x16x32_bf16 a[28:31], v[52:55], v[124:127], a[28:31]
  global_load_dwordx4 v[48:51], v181, s[64:65] offset:2048
  global_load_dwordx4 v[52:55], v181, s[66:67] offset:2048
  ds_read_b128 v[112:115], v1 offset:2048
  ds_read_b128 v[116:119], v1 offset:18432
  ds_read_b128 v[120:123], v1 offset:34816
  ds_read_b128 v[124:127], v1 offset:51200
  s_waitcnt vmcnt(20) lgkmcnt(8)
  v_mfma_f32_16x16x32_bf16 a[32:35], v[56:59], v[128:131], 0
  v_mfma_f32_16x16x32_bf16 a[36:39], v[56:59], v[132:135], 0
  v_mfma_f32_16x16x32_bf16 a[40:43], v[56:59], v[136:139], 0
  v_mfma_f32_16x16x32_bf16 a[44:47], v[56:59], v[140:143], 0
  v_mfma_f32_16x16x32_bf16 a[48:51], v[60:63], v[128:131], 0
  v_mfma_f32_16x16x32_bf16 a[52:55], v[60:63], v[132:135], 0
  v_mfma_f32_16x16x32_bf16 a[56:59], v[60:63], v[136:139], 0
  v_mfma_f32_16x16x32_bf16 a[60:63], v[60:63], v[140:143], 0
  global_load_dwordx4 v[56:59], v181, s[64:65] offset:3072
  global_load_dwordx4 v[60:63], v181, s[66:67] offset:3072
  ds_read_b128 v[128:131], v1 offset:3072
  ds_read_b128 v[132:135], v1 offset:19456
  ds_read_b128 v[136:139], v1 offset:35840
  ds_read_b128 v[140:143], v1 offset:52224
  s_waitcnt vmcnt(20) lgkmcnt(8)
  v_mfma_f32_16x16x32_bf16 a[32:35], v[64:67], v[144:147], a[32:35]
  v_mfma_f32_16x16x32_bf16 a[36:39], v[64:67], v[148:151], a[36:39]
  v_mfma_f32_16x16x32_bf16 a[40:43], v[64:67], v[152:155], a[40:43]
  v_mfma_f32_16x16x32_bf16 a[44:47], v[64:67], v[156:159], a[44:47]
  v_mfma_f32_16x16x32_bf16 a[48:51], v[68:71], v[144:147], a[48:51]
  v_mfma_f32_16x16x32_bf16 a[52:55], v[68:71], v[148:151], a[52:55]
  v_mfma_f32_16x16x32_bf16 a[56:59], v[68:71], v[152:155], a[56:59]
  v_mfma_f32_16x16x32_bf16 a[60:63], v[68:71], v[156:159], a[60:63]
  global_load_dwordx4 v[64:67], v182, s[64:65] offset:0
  global_load_dwordx4 v[68:71], v182, s[66:67] offset:0
  ds_read_b128 v[144:147], v1 offset:4096
  ds_read_b128 v[148:151], v1 offset:20480
  ds_read_b128 v[152:155], v1 offset:36864
  ds_read_b128 v[156:159], v1 offset:53248
  s_waitcnt vmcnt(20) lgkmcnt(8)
  v_mfma_f32_16x16x32_bf16 a[32:35], v[72:75], v[112:115], a[32:35]
  v_mfma_f32_16x16x32_bf16 a[36:39], v[72:75], v[116:119], a[36:39]
  v_mfma_f32_16x16x32_bf16 a[40:43], v[72:75], v[120:123], a[40:43]
  v_mfma_f32_16x16x32_bf16 a[44:47], v[72:75], v[124:127], a[44:47]
  v_mfma_f32_16x16x32_bf16 a[48:51], v[76:79], v[112:115], a[48:51]
  v_mfma_f32_16x16x32_bf16 a[52:55], v[76:79], v[116:119], a[52:55]
  v_mfma_f32_16x16x32_bf16 a[56:59], v[76:79], v[120:123], a[56:59]
  v_mfma_f32_16x16x32_bf16 a[60:63], v[76:79], v[124:127], a[60:63]
  global_store_dwordx4 v176, a[0:3], s[12:13] offset:0 sc1
  global_store_dwordx4 v177, a[4:7], s[12:13] offset:0 sc1
  global_store_dwordx4 v178, a[8:11], s[12:13] offset:0 sc1
  global_store_dwordx4 v179, a[12:15], s[12:13] offset:0 sc1
  global_store_dwordx4 v176, a[16:19], s[12:13] offset:64 sc1
  global_store_dwordx4 v177, a[20:23], s[12:13] offset:64 sc1
  global_store_dwordx4 v178, a[24:27], s[12:13] offset:64 sc1
  global_store_dwordx4 v179, a[28:31], s[12:13] offset:64 sc1
  global_load_dwordx4 v[72:75], v182, s[64:65] offset:1024
  global_load_dwordx4 v[76:79], v182, s[66:67] offset:1024
  ds_read_b128 v[112:115], v1 offset:5120
  ds_read_b128 v[116:119], v1 offset:21504
  ds_read_b128 v[120:123], v1 offset:37888
  ds_read_b128 v[124:127], v1 offset:54272
  s_waitcnt vmcnt(28) lgkmcnt(8)
  v_mfma_f32_16x16x32_bf16 a[32:35], v[80:83], v[128:131], a[32:35]
  v_mfma_f32_16x16x32_bf16 a[36:39], v[80:83], v[132:135], a[36:39]
  v_mfma_f32_16x16x32_bf16 a[40:43], v[80:83], v[136:139], a[40:43]
  v_mfma_f32_16x16x32_bf16 a[44:47], v[80:83], v[140:143], a[44:47]
  v_mfma_f32_16x16x32_bf16 a[48:51], v[84:87], v[128:131], a[48:51]
  v_mfma_f32_16x16x32_bf16 a[52:55], v[84:87], v[132:135], a[52:55]
  v_mfma_f32_16x16x32_bf16 a[56:59], v[84:87], v[136:139], a[56:59]
  v_mfma_f32_16x16x32_bf16 a[60:63], v[84:87], v[140:143], a[60:63]
  global_load_dwordx4 v[80:83], v182, s[64:65] offset:2048
  global_load_dwordx4 v[84:87], v182, s[66:67] offset:2048
  ds_read_b128 v[128:131], v1 offset:6144
  ds_read_b128 v[132:135], v1 offset:22528
  ds_read_b128 v[136:139], v1 offset:38912
  ds_read_b128 v[140:143], v1 offset:55296
  s_waitcnt vmcnt(28) lgkmcnt(8)
  v_mfma_f32_16x16x32_bf16 a[32:35], v[88:91], v[144:147], a[32:35]
  v_mfma_f32_16x16x32_bf16 a[36:39], v[88:91], v[148:151], a[36:39]
  v_mfma_f32_16x16x32_bf16 a[40:43], v[88:91], v[152:155], a[40:43]
  v_mfma_f32_16x16x32_bf16 a[44:47], v[88:91], v[156:159], a[44:47]
  v_mfma_f32_16x16x32_bf16 a[48:51], v[92:95], v[144:147], a[48:51]
  v_mfma_f32_16x16x32_bf16 a[52:55], v[92:95], v[148:151], a[52:55]
  v_mfma_f32_16x16x32_bf16 a[56:59], v[92:95], v[152:155], a[56:59]
  v_mfma_f32_16x16x32_bf16 a[60:63], v[92:95], v[156:159], a[60:63]
  global_load_dwordx4 v[88:91], v182, s[64:65] offset:3072
  global_load_dwordx4 v[92:95], v182, s[66:67] offset:3072
  ds_read_b128 v[144:147], v1 offset:7168
  ds_read_b128 v[148:151], v1 offset:23552
  ds_read_b128 v[152:155], v1 offset:39936
  ds_read_b128 v[156:159], v1 offset:56320
  s_waitcnt vmcnt(28) lgkmcnt(8)
  v_mfma_f32_16x16x32_bf16 a[32:35], v[96:99], v[112:115], a[32:35]
  v_mfma_f32_16x16x32_bf16 a[36:39], v[96:99], v[116:119], a[36:39]
  v_mfma_f32_16x16x32_bf16 a[40:43], v[96:99], v[120:123], a[40:43]
  v_mfma_f32_16x16x32_bf16 a[44:47], v[96:99], v[124:127], a[44:47]
  v_mfma_f32_16x16x32_bf16 a[48:51], v[100:103], v[112:115], a[48:51]
  v_mfma_f32_16x16x32_bf16 a[52:55], v[100:103], v[116:119], a[52:55]
  v_mfma_f32_16x16x32_bf16 a[56:59], v[100:103], v[120:123], a[56:59]
  v_mfma_f32_16x16x32_bf16 a[60:63], v[100:103], v[124:127], a[60:63]
  global_load_dwordx4 v[96:99], v1, s[68:69] offset:0
  global_load_dwordx4 v[100:103], v1, s[70:71] offset:0
  ds_read_b128 v[112:115], v1 offset:8192
  ds_read_b128 v[116:119], v1 offset:24576
  ds_read_b128 v[120:123], v1 offset:40960
  ds_read_b128 v[124:127], v1 offset:57344
  s_waitcnt vmcnt(28) lgkmcnt(8)
  v_mfma_f32_16x16x32_bf16 a[32:35], v[16:19], v[128:131], a[32:35]
  v_mfma_f32_16x16x32_bf16 a[36:39], v[16:19], v[132:135], a[36:39]
  v_mfma_f32_16x16x32_bf16 a[40:43], v[16:19], v[136:139], a[40:43]
  v_mfma_f32_16x16x32_bf16 a[44:47], v[16:19], v[140:143], a[44:47]
  v_mfma_f32_16x16x32_bf16 a[48:51], v[20:23], v[128:131], a[48:51]
  v_mfma_f32_16x16x32_bf16 a[52:55], v[20:23], v[132:135], a[52:55]
  v_mfma_f32_16x16x32_bf16 a[56:59], v[20:23], v[136:139], a[56:59]
  v_mfma_f32_16x16x32_bf16 a[60:63], v[20:23], v[140:143], a[60:63]
  global_load_dwordx4 v[16:19], v1, s[68:69] offset:1024
  global_load_dwordx4 v[20:23], v1, s[70:71] offset:1024
  ds_read_b128 v[128:131], v1 offset:9216
  ds_read_b128 v[132:135], v1 offset:25600
  ds_read_b128 v[136:139], v1 offset:41984
  ds_read_b128 v[140:143], v1 offset:58368
  s_waitcnt vmcnt(28) lgkmcnt(8)
  v_mfma_f32_16x16x32_bf16 a[32:35], v[24:27], v[144:147], a[32:35]
  v_mfma_f32_16x16x32_bf16 a[36:39], v[24:27], v[148:151], a[36:39]
  v_mfma_f32_16x16x32_bf16 a[40:43], v[24:27], v[152:155], a[40:43]
  v_mfma_f32_16x16x32_bf16 a[44:47], v[24:27], v[156:159], a[44:47]
  v_mfma_f32_16x16x32_bf16 a[48:51], v[28:31], v[144:147], a[48:51]
  v_mfma_f32_16x16x32_bf16 a[52:55], v[28:31], v[148:151], a[52:55]
  v_mfma_f32_16x16x32_bf16 a[56:59], v[28:31], v[152:155], a[56:59]
  v_mfma_f32_16x16x32_bf16 a[60:63], v[28:31], v[156:159], a[60:63]
  global_load_dwordx4 v[24:27], v1, s[68:69] offset:2048
  global_load_dwordx4 v[28:31], v1, s[70:71] offset:2048
  ds_read_b128 v[144:147], v1 offset:10240
  ds_read_b128 v[148:151], v1 offset:26624
  ds_read_b128 v[152:155], v1 offset:43008
  ds_read_b128 v[156:159], v1 offset:59392
  s_waitcnt vmcnt(28) lgkmcnt(8)
  v_mfma_f32_16x16x32_bf16 a[32:35], v[32:35], v[112:115], a[32:35]
  v_mfma_f32_16x16x32_bf16 a[36:39], v[32:35], v[116:119], a[36:39]
  v_mfma_f32_16x16x32_bf16 a[40:43], v[32:35], v[120:123], a[40:43]
  v_mfma_f32_16x16x32_bf16 a[44:47], v[32:35], v[124:127], a[44:47]
  v_mfma_f32_16x16x32_bf16 a[48:51], v[36:39], v[112:115], a[48:51]
  v_mfma_f32_16x16x32_bf16 a[52:55], v[36:39], v[116:119], a[52:55]
  v_mfma_f32_16x16x32_bf16 a[56:59], v[36:39], v[120:123], a[56:59]
  v_mfma_f32_16x16x32_bf16 a[60:63], v[36:39], v[124:127], a[60:63]
  global_load_dwordx4 v[32:35], v1, s[68:69] offset:3072
  global_load_dwordx4 v[36:39], v1, s[70:71] offset:3072
  ds_read_b128 v[112:115], v1 offset:11264
  ds_read_b128 v[116:119], v1 offset:27648
  ds_read_b128 v[120:123], v1 offset:44032
  ds_read_b128 v[124:127], v1 offset:60416
  s_waitcnt vmcnt(28) lgkmcnt(8)
  v_mfma_f32_16x16x32_bf16 a[32:35], v[40:43], v[128:131], a[32:35]
  v_mfma_f32_16x16x32_bf16 a[36:39], v[40:43], v[132:135], a[36:39]
  v_mfma_f32_16x16x32_bf16 a[40:43], v[40:43], v[136:139], a[40:43]
  v_mfma_f32_16x16x32_bf16 a[44:47], v[40:43], v[140:143], a[44:47]
  v_mfma_f32_16x16x32_bf16 a[48:51], v[44:47], v[128:131], a[48:51]
  v_mfma_f32_16x16x32_bf16 a[52:55], v[44:47], v[132:135], a[52:55]
  v_mfma_f32_16x16x32_bf16 a[56:59], v[44:47], v[136:139], a[56:59]
  v_mfma_f32_16x16x32_bf16 a[60:63], v[44:47], v[140:143], a[60:63]
  global_load_dwordx4 v[40:43], v180, s[68:69] offset:0
  global_load_dwordx4 v[44:47], v180, s[70:71] offset:0
  ds_read_b128 v[128:131], v1 offset:12288
  ds_read_b128 v[132:135], v1 offset:28672
  ds_read_b128 v[136:139], v1 offset:45056
  ds_read_b128 v[140:143], v1 offset:61440
  s_waitcnt vmcnt(28) lgkmcnt(8)
  v_mfma_f32_16x16x32_bf16 a[32:35], v[48:51], v[144:147], a[32:35]
  v_mfma_f32_16x16x32_bf16 a[36:39], v[48:51], v[148:151], a[36:39]
  v_mfma_f32_16x16x32_bf16 a[40:43], v[48:51], v[152:155], a[40:43]
  v_mfma_f32_16x16x32_bf16 a[44:47], v[48:51], v[156:159], a[44:47]
  v_mfma_f32_16x16x32_bf16 a[48:51], v[52:55], v[144:147], a[48:51]
  v_mfma_f32_16x16x32_bf16 a[52:55], v[52:55], v[148:151], a[52:55]
  v_mfma_f32_16x16x32_bf16 a[56:59], v[52:55], v[152:155], a[56:59]
  v_mfma_f32_16x16x32_bf16 a[60:63], v[52:55], v[156:159], a[60:63]
  global_load_dwordx4 v[48:51], v180, s[68:69] offset:1024
  global_load_dwordx4 v[52:55], v180, s[70:71] offset:1024
  ds_read_b128 v[144:147], v1 offset:13312
  ds_read_b128 v[148:151], v1 offset:29696
  ds_read_b128 v[152:155], v1 offset:46080
  ds_read_b128 v[156:159], v1 offset:62464
  s_waitcnt vmcnt(28) lgkmcnt(8)
  v_mfma_f32_16x16x32_bf16 a[32:35], v[56:59], v[112:115], a[32:35]
  v_mfma_f32_16x16x32_bf16 a[36:39], v[56:59], v[116:119], a[36:39]
  v_mfma_f32_16x16x32_bf16 a[40:43], v[56:59], v[120:123], a[40:43]
  v_mfma_f32_16x16x32_bf16 a[44:47], v[56:59], v[124:127], a[44:47]
  v_mfma_f32_16x16x32_bf16 a[48:51], v[60:63], v[112:115], a[48:51]
  v_mfma_f32_16x16x32_bf16 a[52:55], v[60:63], v[116:119], a[52:55]
  v_mfma_f32_16x16x32_bf16 a[56:59], v[60:63], v[120:123], a[56:59]
  v_mfma_f32_16x16x32_bf16 a[60:63], v[60:63], v[124:127], a[60:63]
  global_load_dwordx4 v[56:59], v180, s[68:69] offset:2048
  global_load_dwordx4 v[60:63], v180, s[70:71] offset:2048
  ds_read_b128 v[112:115], v1 offset:14336
  ds_read_b128 v[116:119], v1 offset:30720
  ds_read_b128 v[120:123], v1 offset:47104
  ds_read_b128 v[124:127], v1 offset:63488
  s_waitcnt vmcnt(28) lgkmcnt(8)
  v_mfma_f32_16x16x32_bf16 a[32:35], v[64:67], v[128:131], a[32:35]
  v_mfma_f32_16x16x32_bf16 a[36:39], v[64:67], v[132:135], a[36:39]
  v_mfma_f32_16x16x32_bf16 a[40:43], v[64:67], v[136:139], a[40:43]
  v_mfma_f32_16x16x32_bf16 a[44:47], v[64:67], v[140:143], a[44:47]
  v_mfma_f32_16x16x32_bf16 a[48:51], v[68:71], v[128:131], a[48:51]
  v_mfma_f32_16x16x32_bf16 a[52:55], v[68:71], v[132:135], a[52:55]
  v_mfma_f32_16x16x32_bf16 a[56:59], v[68:71], v[136:139], a[56:59]
  v_mfma_f32_16x16x32_bf16 a[60:63], v[68:71], v[140:143], a[60:63]
  global_load_dwordx4 v[64:67], v180, s[68:69] offset:3072
  global_load_dwordx4 v[68:71], v180, s[70:71] offset:3072
  ds_read_b128 v[128:131], v1 offset:15360
  ds_read_b128 v[132:135], v1 offset:31744
  ds_read_b128 v[136:139], v1 offset:48128
  ds_read_b128 v[140:143], v1 offset:64512
  s_waitcnt vmcnt(20) lgkmcnt(8)
  v_mfma_f32_16x16x32_bf16 a[32:35], v[72:75], v[144:147], a[32:35]
  v_mfma_f32_16x16x32_bf16 a[36:39], v[72:75], v[148:151], a[36:39]
  v_mfma_f32_16x16x32_bf16 a[40:43], v[72:75], v[152:155], a[40:43]
  v_mfma_f32_16x16x32_bf16 a[44:47], v[72:75], v[156:159], a[44:47]
  v_mfma_f32_16x16x32_bf16 a[48:51], v[76:79], v[144:147], a[48:51]
  v_mfma_f32_16x16x32_bf16 a[52:55], v[76:79], v[148:151], a[52:55]
  v_mfma_f32_16x16x32_bf16 a[56:59], v[76:79], v[152:155], a[56:59]
  v_mfma_f32_16x16x32_bf16 a[60:63], v[76:79], v[156:159], a[60:63]
  global_load_dwordx4 v[72:75], v181, s[68:69] offset:0
  global_load_dwordx4 v[76:79], v181, s[70:71] offset:0
  ds_read_b128 v[144:147], v1 offset:0
  ds_read_b128 v[148:151], v1 offset:16384
  ds_read_b128 v[152:155], v1 offset:32768
  ds_read_b128 v[156:159], v1 offset:49152
  s_waitcnt vmcnt(20) lgkmcnt(8)
  v_mfma_f32_16x16x32_bf16 a[32:35], v[80:83], v[112:115], a[32:35]
  v_mfma_f32_16x16x32_bf16 a[36:39], v[80:83], v[116:119], a[36:39]
  v_mfma_f32_16x16x32_bf16 a[40:43], v[80:83], v[120:123], a[40:43]
  v_mfma_f32_16x16x32_bf16 a[44:47], v[80:83], v[124:127], a[44:47]
  v_mfma_f32_16x16x32_bf16 a[48:51], v[84:87], v[112:115], a[48:51]
  v_mfma_f32_16x16x32_bf16 a[52:55], v[84:87], v[116:119], a[52:55]
  v_mfma_f32_16x16x32_bf16 a[56:59], v[84:87], v[120:123], a[56:59]
  v_mfma_f32_16x16x32_bf16 a[60:63], v[84:87], v[124:127], a[60:63]
  global_load_dwordx4 v[80:83], v181, s[68:69] offset:1024
  global_load_dwordx4 v[84:87], v181, s[70:71] offset:1024
  ds_read_b128 v[112:115], v1 offset:1024
  ds_read_b128 v[116:119], v1 offset:17408
  ds_read_b128 v[120:123], v1 offset:33792
  ds_read_b128 v[124:127], v1 offset:50176
  s_waitcnt vmcnt(20) lgkmcnt(8)
  v_mfma_f32_16x16x32_bf16 a[32:35], v[88:91], v[128:131], a[32:35]
  v_mfma_f32_16x16x32_bf16 a[36:39], v[88:91], v[132:135], a[36:39]
  v_mfma_f32_16x16x32_bf16 a[40:43], v[88:91], v[136:139], a[40:43]
  v_mfma_f32_16x16x32_bf16 a[44:47], v[88:91], v[140:143], a[44:47]
  v_mfma_f32_16x16x32_bf16 a[48:51], v[92:95], v[128:131], a[48:51]
  v_mfma_f32_16x16x32_bf16 a[52:55], v[92:95], v[132:135], a[52:55]
  v_mfma_f32_16x16x32_bf16 a[56:59], v[92:95], v[136:139], a[56:59]
  v_mfma_f32_16x16x32_bf16 a[60:63], v[92:95], v[140:143], a[60:63]
  global_load_dwordx4 v[88:91], v181, s[68:69] offset:2048
  global_load_dwordx4 v[92:95], v181, s[70:71] offset:2048
  ds_read_b128 v[128:131], v1 offset:2048
  ds_read_b128 v[132:135], v1 offset:18432
  ds_read_b128 v[136:139], v1 offset:34816
  ds_read_b128 v[140:143], v1 offset:51200
  s_waitcnt vmcnt(20) lgkmcnt(8)
  v_mfma_f32_16x16x32_bf16 a[0:3], v[96:99], v[144:147], 0
  v_mfma_f32_16x16x32_bf16 a[4:7], v[96:99], v[148:151], 0
  v_mfma_f32_16x16x32_bf16 a[8:11], v[96:99], v[152:155], 0
  v_mfma_f32_16x16x32_bf16 a[12:15], v[96:99], v[156:159], 0
  v_mfma_f32_16x16x32_bf16 a[16:19], v[100:103], v[144:147], 0
  v_mfma_f32_16x16x32_bf16 a[20:23], v[100:103], v[148:151], 0
  v_mfma_f32_16x16x32_bf16 a[24:27], v[100:103], v[152:155], 0
  v_mfma_f32_16x16x32_bf16 a[28:31], v[100:103], v[156:159], 0
  global_load_dwordx4 v[96:99], v181, s[68:69] offset:3072
  global_load_dwordx4 v[100:103], v181, s[70:71] offset:3072
  ds_read_b128 v[144:147], v1 offset:3072
  ds_read_b128 v[148:151], v1 offset:19456
  ds_read_b128 v[152:155], v1 offset:35840
  ds_read_b128 v[156:159], v1 offset:52224
  s_waitcnt vmcnt(20) lgkmcnt(8)
  v_mfma_f32_16x16x32_bf16 a[0:3], v[16:19], v[112:115], a[0:3]
  v_mfma_f32_16x16x32_bf16 a[4:7], v[16:19], v[116:119], a[4:7]
  v_mfma_f32_16x16x32_bf16 a[8:11], v[16:19], v[120:123], a[8:11]
  v_mfma_f32_16x16x32_bf16 a[12:15], v[16:19], v[124:127], a[12:15]
  v_mfma_f32_16x16x32_bf16 a[16:19], v[20:23], v[112:115], a[16:19]
  v_mfma_f32_16x16x32_bf16 a[20:23], v[20:23], v[116:119], a[20:23]
  v_mfma_f32_16x16x32_bf16 a[24:27], v[20:23], v[120:123], a[24:27]
  v_mfma_f32_16x16x32_bf16 a[28:31], v[20:23], v[124:127], a[28:31]
  global_load_dwordx4 v[16:19], v182, s[68:69] offset:0
  global_load_dwordx4 v[20:23], v182, s[70:71] offset:0
  ds_read_b128 v[112:115], v1 offset:4096
  ds_read_b128 v[116:119], v1 offset:20480
  ds_read_b128 v[120:123], v1 offset:36864
  ds_read_b128 v[124:127], v1 offset:53248
  s_waitcnt vmcnt(20) lgkmcnt(8)
  v_mfma_f32_16x16x32_bf16 a[0:3], v[24:27], v[128:131], a[0:3]
  v_mfma_f32_16x16x32_bf16 a[4:7], v[24:27], v[132:135], a[4:7]
  v_mfma_f32_16x16x32_bf16 a[8:11], v[24:27], v[136:139], a[8:11]
  v_mfma_f32_16x16x32_bf16 a[12:15], v[24:27], v[140:143], a[12:15]
  v_mfma_f32_16x16x32_bf16 a[16:19], v[28:31], v[128:131], a[16:19]
  v_mfma_f32_16x16x32_bf16 a[20:23], v[28:31], v[132:135], a[20:23]
  v_mfma_f32_16x16x32_bf16 a[24:27], v[28:31], v[136:139], a[24:27]
  v_mfma_f32_16x16x32_bf16 a[28:31], v[28:31], v[140:143], a[28:31]
  global_store_dwordx4 v176, a[32:35], s[12:13] offset:128 sc1
  global_store_dwordx4 v177, a[36:39], s[12:13] offset:128 sc1
  global_store_dwordx4 v178, a[40:43], s[12:13] offset:128 sc1
  global_store_dwordx4 v179, a[44:47], s[12:13] offset:128 sc1
  global_store_dwordx4 v176, a[48:51], s[12:13] offset:192 sc1
  global_store_dwordx4 v177, a[52:55], s[12:13] offset:192 sc1
  global_store_dwordx4 v178, a[56:59], s[12:13] offset:192 sc1
  global_store_dwordx4 v179, a[60:63], s[12:13] offset:192 sc1
  global_load_dwordx4 v[24:27], v182, s[68:69] offset:1024
  global_load_dwordx4 v[28:31], v182, s[70:71] offset:1024
  ds_read_b128 v[128:131], v1 offset:5120
  ds_read_b128 v[132:135], v1 offset:21504
  ds_read_b128 v[136:139], v1 offset:37888
  ds_read_b128 v[140:143], v1 offset:54272
  s_waitcnt vmcnt(28) lgkmcnt(8)
  v_mfma_f32_16x16x32_bf16 a[0:3], v[32:35], v[144:147], a[0:3]
  v_mfma_f32_16x16x32_bf16 a[4:7], v[32:35], v[148:151], a[4:7]
  v_mfma_f32_16x16x32_bf16 a[8:11], v[32:35], v[152:155], a[8:11]
  v_mfma_f32_16x16x32_bf16 a[12:15], v[32:35], v[156:159], a[12:15]
  v_mfma_f32_16x16x32_bf16 a[16:19], v[36:39], v[144:147], a[16:19]
  v_mfma_f32_16x16x32_bf16 a[20:23], v[36:39], v[148:151], a[20:23]
  v_mfma_f32_16x16x32_bf16 a[24:27], v[36:39], v[152:155], a[24:27]
  v_mfma_f32_16x16x32_bf16 a[28:31], v[36:39], v[156:159], a[28:31]
  global_load_dwordx4 v[32:35], v182, s[68:69] offset:2048
  global_load_dwordx4 v[36:39], v182, s[70:71] offset:2048
  ds_read_b128 v[144:147], v1 offset:6144
  ds_read_b128 v[148:151], v1 offset:22528
  ds_read_b128 v[152:155], v1 offset:38912
  ds_read_b128 v[156:159], v1 offset:55296
  s_waitcnt vmcnt(28) lgkmcnt(8)
  v_mfma_f32_16x16x32_bf16 a[0:3], v[40:43], v[112:115], a[0:3]
  v_mfma_f32_16x16x32_bf16 a[4:7], v[40:43], v[116:119], a[4:7]
  v_mfma_f32_16x16x32_bf16 a[8:11], v[40:43], v[120:123], a[8:11]
  v_mfma_f32_16x16x32_bf16 a[12:15], v[40:43], v[124:127], a[12:15]
  v_mfma_f32_16x16x32_bf16 a[16:19], v[44:47], v[112:115], a[16:19]
  v_mfma_f32_16x16x32_bf16 a[20:23], v[44:47], v[116:119], a[20:23]
  v_mfma_f32_16x16x32_bf16 a[24:27], v[44:47], v[120:123], a[24:27]
  v_mfma_f32_16x16x32_bf16 a[28:31], v[44:47], v[124:127], a[28:31]
  global_load_dwordx4 v[40:43], v182, s[68:69] offset:3072
  global_load_dwordx4 v[44:47], v182, s[70:71] offset:3072
  ds_read_b128 v[112:115], v1 offset:7168
  ds_read_b128 v[116:119], v1 offset:23552
  ds_read_b128 v[120:123], v1 offset:39936
  ds_read_b128 v[124:127], v1 offset:56320
  s_waitcnt vmcnt(28) lgkmcnt(8)
  v_mfma_f32_16x16x32_bf16 a[0:3], v[48:51], v[128:131], a[0:3]
  v_mfma_f32_16x16x32_bf16 a[4:7], v[48:51], v[132:135], a[4:7]
  v_mfma_f32_16x16x32_bf16 a[8:11], v[48:51], v[136:139], a[8:11]
  v_mfma_f32_16x16x32_bf16 a[12:15], v[48:51], v[140:143], a[12:15]
  v_mfma_f32_16x16x32_bf16 a[16:19], v[52:55], v[128:131], a[16:19]
  v_mfma_f32_16x16x32_bf16 a[20:23], v[52:55], v[132:135], a[20:23]
  v_mfma_f32_16x16x32_bf16 a[24:27], v[52:55], v[136:139], a[24:27]
  v_mfma_f32_16x16x32_bf16 a[28:31], v[52:55], v[140:143], a[28:31]
  global_load_dwordx4 v[48:51], v1, s[72:73] offset:0
  global_load_dwordx4 v[52:55], v1, s[74:75] offset:0
  ds_read_b128 v[128:131], v1 offset:8192
  ds_read_b128 v[132:135], v1 offset:24576
  ds_read_b128 v[136:139], v1 offset:40960
  ds_read_b128 v[140:143], v1 offset:57344
  s_waitcnt vmcnt(28) lgkmcnt(8)
  v_mfma_f32_16x16x32_bf16 a[0:3], v[56:59], v[144:147], a[0:3]
  v_mfma_f32_16x16x32_bf16 a[4:7], v[56:59], v[148:151], a[4:7]
  v_mfma_f32_16x16x32_bf16 a[8:11], v[56:59], v[152:155], a[8:11]
  v_mfma_f32_16x16x32_bf16 a[12:15], v[56:59], v[156:159], a[12:15]
  v_mfma_f32_16x16x32_bf16 a[16:19], v[60:63], v[144:147], a[16:19]
  v_mfma_f32_16x16x32_bf16 a[20:23], v[60:63], v[148:151], a[20:23]
  v_mfma_f32_16x16x32_bf16 a[24:27], v[60:63], v[152:155], a[24:27]
  v_mfma_f32_16x16x32_bf16 a[28:31], v[60:63], v[156:159], a[28:31]
  global_load_dwordx4 v[56:59], v1, s[72:73] offset:1024
  global_load_dwordx4 v[60:63], v1, s[74:75] offset:1024
  ds_read_b128 v[144:147], v1 offset:9216
  ds_read_b128 v[148:151], v1 offset:25600
  ds_read_b128 v[152:155], v1 offset:41984
  ds_read_b128 v[156:159], v1 offset:58368
  s_waitcnt vmcnt(28) lgkmcnt(8)
  v_mfma_f32_16x16x32_bf16 a[0:3], v[64:67], v[112:115], a[0:3]
  v_mfma_f32_16x16x32_bf16 a[4:7], v[64:67], v[116:119], a[4:7]
  v_mfma_f32_16x16x32_bf16 a[8:11], v[64:67], v[120:123], a[8:11]
  v_mfma_f32_16x16x32_bf16 a[12:15], v[64:67], v[124:127], a[12:15]
  v_mfma_f32_16x16x32_bf16 a[16:19], v[68:71], v[112:115], a[16:19]
  v_mfma_f32_16x16x32_bf16 a[20:23], v[68:71], v[116:119], a[20:23]
  v_mfma_f32_16x16x32_bf16 a[24:27], v[68:71], v[120:123], a[24:27]
  v_mfma_f32_16x16x32_bf16 a[28:31], v[68:71], v[124:127], a[28:31]
  global_load_dwordx4 v[64:67], v1, s[72:73] offset:2048
  global_load_dwordx4 v[68:71], v1, s[74:75] offset:2048
  ds_read_b128 v[112:115], v1 offset:10240
  ds_read_b128 v[116:119], v1 offset:26624
  ds_read_b128 v[120:123], v1 offset:43008
  ds_read_b128 v[124:127], v1 offset:59392
  s_waitcnt vmcnt(28) lgkmcnt(8)
  v_mfma_f32_16x16x32_bf16 a[0:3], v[72:75], v[128:131], a[0:3]
  v_mfma_f32_16x16x32_bf16 a[4:7], v[72:75], v[132:135], a[4:7]
  v_mfma_f32_16x16x32_bf16 a[8:11], v[72:75], v[136:139], a[8:11]
  v_mfma_f32_16x16x32_bf16 a[12:15], v[72:75], v[140:143], a[12:15]
  v_mfma_f32_16x16x32_bf16 a[16:19], v[76:79], v[128:131], a[16:19]
  v_mfma_f32_16x16x32_bf16 a[20:23], v[76:79], v[132:135], a[20:23]
  v_mfma_f32_16x16x32_bf16 a[24:27], v[76:79], v[136:139], a[24:27]
  v_mfma_f32_16x16x32_bf16 a[28:31], v[76:79], v[140:143], a[28:31]
  global_load_dwordx4 v[72:75], v1, s[72:73] offset:3072
  global_load_dwordx4 v[76:79], v1, s[74:75] offset:3072
  ds_read_b128 v[128:131], v1 offset:11264
  ds_read_b128 v[132:135], v1 offset:27648
  ds_read_b128 v[136:139], v1 offset:44032
  ds_read_b128 v[140:143], v1 offset:60416
  s_waitcnt vmcnt(28) lgkmcnt(8)
  v_mfma_f32_16x16x32_bf16 a[0:3], v[80:83], v[144:147], a[0:3]
  v_mfma_f32_16x16x32_bf16 a[4:7], v[80:83], v[148:151], a[4:7]
  v_mfma_f32_16x16x32_bf16 a[8:11], v[80:83], v[152:155], a[8:11]
  v_mfma_f32_16x16x32_bf16 a[12:15], v[80:83], v[156:159], a[12:15]
  v_mfma_f32_16x16x32_bf16 a[16:19], v[84:87], v[144:147], a[16:19]
  v_mfma_f32_16x16x32_bf16 a[20:23], v[84:87], v[148:151], a[20:23]
  v_mfma_f32_16x16x32_bf16 a[24:27], v[84:87], v[152:155], a[24:27]
  v_mfma_f32_16x16x32_bf16 a[28:31], v[84:87], v[156:159], a[28:31]
  global_load_dwordx4 v[80:83], v180, s[72:73] offset:0
  global_load_dwordx4 v[84:87], v180, s[74:75] offset:0
  ds_read_b128 v[144:147], v1 offset:12288
  ds_read_b128 v[148:151], v1 offset:28672
  ds_read_b128 v[152:155], v1 offset:45056
  ds_read_b128 v[156:159], v1 offset:61440
  s_waitcnt vmcnt(28) lgkmcnt(8)
  v_mfma_f32_16x16x32_bf16 a[0:3], v[88:91], v[112:115], a[0:3]
  v_mfma_f32_16x16x32_bf16 a[4:7], v[88:91], v[116:119], a[4:7]
  v_mfma_f32_16x16x32_bf16 a[8:11], v[88:91], v[120:123], a[8:11]
  v_mfma_f32_16x16x32_bf16 a[12:15], v[88:91], v[124:127], a[12:15]
  v_mfma_f32_16x16x32_bf16 a[16:19], v[92:95], v[112:115], a[16:19]
  v_mfma_f32_16x16x32_bf16 a[20:23], v[92:95], v[116:119], a[20:23]
  v_mfma_f32_16x16x32_bf16 a[24:27], v[92:95], v[120:123], a[24:27]
  v_mfma_f32_16x16x32_bf16 a[28:31], v[92:95], v[124:127], a[28:31]
  global_load_dwordx4 v[88:91], v180, s[72:73] offset:1024
  global_load_dwordx4 v[92:95], v180, s[74:75] offset:1024
  ds_read_b128 v[112:115], v1 offset:13312
  ds_read_b128 v[116:119], v1 offset:29696
  ds_read_b128 v[120:123], v1 offset:46080
  ds_read_b128 v[124:127], v1 offset:62464
  s_waitcnt vmcnt(28) lgkmcnt(8)
  v_mfma_f32_16x16x32_bf16 a[0:3], v[96:99], v[128:131], a[0:3]
  v_mfma_f32_16x16x32_bf16 a[4:7], v[96:99], v[132:135], a[4:7]
  v_mfma_f32_16x16x32_bf16 a[8:11], v[96:99], v[136:139], a[8:11]
  v_mfma_f32_16x16x32_bf16 a[12:15], v[96:99], v[140:143], a[12:15]
  v_mfma_f32_16x16x32_bf16 a[16:19], v[100:103], v[128:131], a[16:19]
  v_mfma_f32_16x16x32_bf16 a[20:23], v[100:103], v[132:135], a[20:23]
  v_mfma_f32_16x16x32_bf16 a[24:27], v[100:103], v[136:139], a[24:27]
  v_mfma_f32_16x16x32_bf16 a[28:31], v[100:103], v[140:143], a[28:31]
  global_load_dwordx4 v[96:99], v180, s[72:73] offset:2048
  global_load_dwordx4 v[100:103], v180, s[74:75] offset:2048
  ds_read_b128 v[128:131], v1 offset:14336
  ds_read_b128 v[132:135], v1 offset:30720
  ds_read_b128 v[136:139], v1 offset:47104
  ds_read_b128 v[140:143], v1 offset:63488
  s_waitcnt vmcnt(28) lgkmcnt(8)
  v_mfma_f32_16x16x32_bf16 a[0:3], v[16:19], v[144:147], a[0:3]
  v_mfma_f32_16x16x32_bf16 a[4:7], v[16:19], v[148:151], a[4:7]
  v_mfma_f32_16x16x32_bf16 a[8:11], v[16:19], v[152:155], a[8:11]
  v_mfma_f32_16x16x32_bf16 a[12:15], v[16:19], v[156:159], a[12:15]
  v_mfma_f32_16x16x32_bf16 a[16:19], v[20:23], v[144:147], a[16:19]
  v_mfma_f32_16x16x32_bf16 a[20:23], v[20:23], v[148:151], a[20:23]
  v_mfma_f32_16x16x32_bf16 a[24:27], v[20:23], v[152:155], a[24:27]
  v_mfma_f32_16x16x32_bf16 a[28:31], v[20:23], v[156:159], a[28:31]
  global_load_dwordx4 v[16:19], v180, s[72:73] offset:3072
  global_load_dwordx4 v[20:23], v180, s[74:75] offset:3072
  ds_read_b128 v[144:147], v1 offset:15360
  ds_read_b128 v[148:151], v1 offset:31744
  ds_read_b128 v[152:155], v1 offset:48128
  ds_read_b128 v[156:159], v1 offset:64512
  s_waitcnt vmcnt(20) lgkmcnt(8)
  v_mfma_f32_16x16x32_bf16 a[0:3], v[24:27], v[112:115], a[0:3]
  v_mfma_f32_16x16x32_bf16 a[4:7], v[24:27], v[116:119], a[4:7]
  v_mfma_f32_16x16x32_bf16 a[8:11], v[24:27], v[120:123], a[8:11]
  v_mfma_f32_16x16x32_bf16 a[12:15], v[24:27], v[124:127], a[12:15]
  v_mfma_f32_16x16x32_bf16 a[16:19], v[28:31], v[112:115], a[16:19]
  v_mfma_f32_16x16x32_bf16 a[20:23], v[28:31], v[116:119], a[20:23]
  v_mfma_f32_16x16x32_bf16 a[24:27], v[28:31], v[120:123], a[24:27]
  v_mfma_f32_16x16x32_bf16 a[28:31], v[28:31], v[124:127], a[28:31]
  global_load_dwordx4 v[24:27], v181, s[72:73] offset:0
  global_load_dwordx4 v[28:31], v181, s[74:75] offset:0
  ds_read_b128 v[112:115], v1 offset:0
  ds_read_b128 v[116:119], v1 offset:16384
  ds_read_b128 v[120:123], v1 offset:32768
  ds_read_b128 v[124:127], v1 offset:49152
  s_waitcnt vmcnt(20) lgkmcnt(8)
  v_mfma_f32_16x16x32_bf16 a[0:3], v[32:35], v[128:131], a[0:3]
  v_mfma_f32_16x16x32_bf16 a[4:7], v[32:35], v[132:135], a[4:7]
  v_mfma_f32_16x16x32_bf16 a[8:11], v[32:35], v[136:139], a[8:11]
  v_mfma_f32_16x16x32_bf16 a[12:15], v[32:35], v[140:143], a[12:15]
  v_mfma_f32_16x16x32_bf16 a[16:19], v[36:39], v[128:131], a[16:19]
  v_mfma_f32_16x16x32_bf16 a[20:23], v[36:39], v[132:135], a[20:23]
  v_mfma_f32_16x16x32_bf16 a[24:27], v[36:39], v[136:139], a[24:27]
  v_mfma_f32_16x16x32_bf16 a[28:31], v[36:39], v[140:143], a[28:31]
  global_load_dwordx4 v[32:35], v181, s[72:73] offset:1024
  global_load_dwordx4 v[36:39], v181, s[74:75] offset:1024
  ds_read_b128 v[128:131], v1 offset:1024
  ds_read_b128 v[132:135], v1 offset:17408
  ds_read_b128 v[136:139], v1 offset:33792
  ds_read_b128 v[140:143], v1 offset:50176
  s_waitcnt vmcnt(20) lgkmcnt(8)
  v_mfma_f32_16x16x32_bf16 a[0:3], v[40:43], v[144:147], a[0:3]
  v_mfma_f32_16x16x32_bf16 a[4:7], v[40:43], v[148:151], a[4:7]
  v_mfma_f32_16x16x32_bf16 a[8:11], v[40:43], v[152:155], a[8:11]
  v_mfma_f32_16x16x32_bf16 a[12:15], v[40:43], v[156:159], a[12:15]
  v_mfma_f32_16x16x32_bf16 a[16:19], v[44:47], v[144:147], a[16:19]
  v_mfma_f32_16x16x32_bf16 a[20:23], v[44:47], v[148:151], a[20:23]
  v_mfma_f32_16x16x32_bf16 a[24:27], v[44:47], v[152:155], a[24:27]
  v_mfma_f32_16x16x32_bf16 a[28:31], v[44:47], v[156:159], a[28:31]
  global_load_dwordx4 v[40:43], v181, s[72:73] offset:2048
  global_load_dwordx4 v[44:47], v181, s[74:75] offset:2048
  ds_read_b128 v[144:147], v1 offset:2048
  ds_read_b128 v[148:151], v1 offset:18432
  ds_read_b128 v[152:155], v1 offset:34816
  ds_read_b128 v[156:159], v1 offset:51200
  s_waitcnt vmcnt(20) lgkmcnt(8)
  v_mfma_f32_16x16x32_bf16 a[32:35], v[48:51], v[112:115], 0
  v_mfma_f32_16x16x32_bf16 a[36:39], v[48:51], v[116:119], 0
  v_mfma_f32_16x16x32_bf16 a[40:43], v[48:51], v[120:123], 0
  v_mfma_f32_16x16x32_bf16 a[44:47], v[48:51], v[124:127], 0
  v_mfma_f32_16x16x32_bf16 a[48:51], v[52:55], v[112:115], 0
  v_mfma_f32_16x16x32_bf16 a[52:55], v[52:55], v[116:119], 0
  v_mfma_f32_16x16x32_bf16 a[56:59], v[52:55], v[120:123], 0
  v_mfma_f32_16x16x32_bf16 a[60:63], v[52:55], v[124:127], 0
  global_load_dwordx4 v[48:51], v181, s[72:73] offset:3072
  global_load_dwordx4 v[52:55], v181, s[74:75] offset:3072
  ds_read_b128 v[112:115], v1 offset:3072
  ds_read_b128 v[116:119], v1 offset:19456
  ds_read_b128 v[120:123], v1 offset:35840
  ds_read_b128 v[124:127], v1 offset:52224
  s_waitcnt vmcnt(20) lgkmcnt(8)
  v_mfma_f32_16x16x32_bf16 a[32:35], v[56:59], v[128:131], a[32:35]
  v_mfma_f32_16x16x32_bf16 a[36:39], v[56:59], v[132:135], a[36:39]
  v_mfma_f32_16x16x32_bf16 a[40:43], v[56:59], v[136:139], a[40:43]
  v_mfma_f32_16x16x32_bf16 a[44:47], v[56:59], v[140:143], a[44:47]
  v_mfma_f32_16x16x32_bf16 a[48:51], v[60:63], v[128:131], a[48:51]
  v_mfma_f32_16x16x32_bf16 a[52:55], v[60:63], v[132:135], a[52:55]
  v_mfma_f32_16x16x32_bf16 a[56:59], v[60:63], v[136:139], a[56:59]
  v_mfma_f32_16x16x32_bf16 a[60:63], v[60:63], v[140:143], a[60:63]
  global_load_dwordx4 v[56:59], v182, s[72:73] offset:0
  global_load_dwordx4 v[60:63], v182, s[74:75] offset:0
  ds_read_b128 v[128:131], v1 offset:4096
  ds_read_b128 v[132:135], v1 offset:20480
  ds_read_b128 v[136:139], v1 offset:36864
  ds_read_b128 v[140:143], v1 offset:53248
  s_waitcnt vmcnt(20) lgkmcnt(8)
  v_mfma_f32_16x16x32_bf16 a[32:35], v[64:67], v[144:147], a[32:35]
  v_mfma_f32_16x16x32_bf16 a[36:39], v[64:67], v[148:151], a[36:39]
  v_mfma_f32_16x16x32_bf16 a[40:43], v[64:67], v[152:155], a[40:43]
  v_mfma_f32_16x16x32_bf16 a[44:47], v[64:67], v[156:159], a[44:47]
  v_mfma_f32_16x16x32_bf16 a[48:51], v[68:71], v[144:147], a[48:51]
  v_mfma_f32_16x16x32_bf16 a[52:55], v[68:71], v[148:151], a[52:55]
  v_mfma_f32_16x16x32_bf16 a[56:59], v[68:71], v[152:155], a[56:59]
  v_mfma_f32_16x16x32_bf16 a[60:63], v[68:71], v[156:159], a[60:63]
  global_store_dwordx4 v176, a[0:3], s[12:13] offset:256 sc1
  global_store_dwordx4 v177, a[4:7], s[12:13] offset:256 sc1
  global_store_dwordx4 v178, a[8:11], s[12:13] offset:256 sc1
  global_store_dwordx4 v179, a[12:15], s[12:13] offset:256 sc1
  global_store_dwordx4 v176, a[16:19], s[12:13] offset:320 sc1
  global_store_dwordx4 v177, a[20:23], s[12:13] offset:320 sc1
  global_store_dwordx4 v178, a[24:27], s[12:13] offset:320 sc1
  global_store_dwordx4 v179, a[28:31], s[12:13] offset:320 sc1
  global_load_dwordx4 v[64:67], v182, s[72:73] offset:1024
  global_load_dwordx4 v[68:71], v182, s[74:75] offset:1024
  ds_read_b128 v[144:147], v1 offset:5120
  ds_read_b128 v[148:151], v1 offset:21504
  ds_read_b128 v[152:155], v1 offset:37888
  ds_read_b128 v[156:159], v1 offset:54272
  s_waitcnt vmcnt(28) lgkmcnt(8)
  v_mfma_f32_16x16x32_bf16 a[32:35], v[72:75], v[112:115], a[32:35]
  v_mfma_f32_16x16x32_bf16 a[36:39], v[72:75], v[116:119], a[36:39]
  v_mfma_f32_16x16x32_bf16 a[40:43], v[72:75], v[120:123], a[40:43]
  v_mfma_f32_16x16x32_bf16 a[44:47], v[72:75], v[124:127], a[44:47]
  v_mfma_f32_16x16x32_bf16 a[48:51], v[76:79], v[112:115], a[48:51]
  v_mfma_f32_16x16x32_bf16 a[52:55], v[76:79], v[116:119], a[52:55]
  v_mfma_f32_16x16x32_bf16 a[56:59], v[76:79], v[120:123], a[56:59]
  v_mfma_f32_16x16x32_bf16 a[60:63], v[76:79], v[124:127], a[60:63]
  global_load_dwordx4 v[72:75], v182, s[72:73] offset:2048
  global_load_dwordx4 v[76:79], v182, s[74:75] offset:2048
  ds_read_b128 v[112:115], v1 offset:6144
  ds_read_b128 v[116:119], v1 offset:22528
  ds_read_b128 v[120:123], v1 offset:38912
  ds_read_b128 v[124:127], v1 offset:55296
  s_waitcnt vmcnt(28) lgkmcnt(8)
  v_mfma_f32_16x16x32_bf16 a[32:35], v[80:83], v[128:131], a[32:35]
  v_mfma_f32_16x16x32_bf16 a[36:39], v[80:83], v[132:135], a[36:39]
  v_mfma_f32_16x16x32_bf16 a[40:43], v[80:83], v[136:139], a[40:43]
  v_mfma_f32_16x16x32_bf16 a[44:47], v[80:83], v[140:143], a[44:47]
  v_mfma_f32_16x16x32_bf16 a[48:51], v[84:87], v[128:131], a[48:51]
  v_mfma_f32_16x16x32_bf16 a[52:55], v[84:87], v[132:135], a[52:55]
  v_mfma_f32_16x16x32_bf16 a[56:59], v[84:87], v[136:139], a[56:59]
  v_mfma_f32_16x16x32_bf16 a[60:63], v[84:87], v[140:143], a[60:63]
  global_load_dwordx4 v[80:83], v182, s[72:73] offset:3072
  global_load_dwordx4 v[84:87], v182, s[74:75] offset:3072
  ds_read_b128 v[128:131], v1 offset:7168
  ds_read_b128 v[132:135], v1 offset:23552
  ds_read_b128 v[136:139], v1 offset:39936
  ds_read_b128 v[140:143], v1 offset:56320
  s_waitcnt vmcnt(28) lgkmcnt(8)
  v_mfma_f32_16x16x32_bf16 a[32:35], v[88:91], v[144:147], a[32:35]
  v_mfma_f32_16x16x32_bf16 a[36:39], v[88:91], v[148:151], a[36:39]
  v_mfma_f32_16x16x32_bf16 a[40:43], v[88:91], v[152:155], a[40:43]
  v_mfma_f32_16x16x32_bf16 a[44:47], v[88:91], v[156:159], a[44:47]
  v_mfma_f32_16x16x32_bf16 a[48:51], v[92:95], v[144:147], a[48:51]
  v_mfma_f32_16x16x32_bf16 a[52:55], v[92:95], v[148:151], a[52:55]
  v_mfma_f32_16x16x32_bf16 a[56:59], v[92:95], v[152:155], a[56:59]
  v_mfma_f32_16x16x32_bf16 a[60:63], v[92:95], v[156:159], a[60:63]
  global_load_dwordx4 v[88:91], v1, s[76:77] offset:0
  global_load_dwordx4 v[92:95], v1, s[78:79] offset:0
  ds_read_b128 v[144:147], v1 offset:8192
  ds_read_b128 v[148:151], v1 offset:24576
  ds_read_b128 v[152:155], v1 offset:40960
  ds_read_b128 v[156:159], v1 offset:57344
  s_waitcnt vmcnt(28) lgkmcnt(8)
  v_mfma_f32_16x16x32_bf16 a[32:35], v[96:99], v[112:115], a[32:35]
  v_mfma_f32_16x16x32_bf16 a[36:39], v[96:99], v[116:119], a[36:39]
  v_mfma_f32_16x16x32_bf16 a[40:43], v[96:99], v[120:123], a[40:43]
  v_mfma_f32_16x16x32_bf16 a[44:47], v[96:99], v[124:127], a[44:47]
  v_mfma_f32_16x16x32_bf16 a[48:51], v[100:103], v[112:115], a[48:51]
  v_mfma_f32_16x16x32_bf16 a[52:55], v[100:103], v[116:119], a[52:55]
  v_mfma_f32_16x16x32_bf16 a[56:59], v[100:103], v[120:123], a[56:59]
  v_mfma_f32_16x16x32_bf16 a[60:63], v[100:103], v[124:127], a[60:63]
  global_load_dwordx4 v[96:99], v1, s[76:77] offset:1024
  global_load_dwordx4 v[100:103], v1, s[78:79] offset:1024
  ds_read_b128 v[112:115], v1 offset:9216
  ds_read_b128 v[116:119], v1 offset:25600
  ds_read_b128 v[120:123], v1 offset:41984
  ds_read_b128 v[124:127], v1 offset:58368
  s_waitcnt vmcnt(28) lgkmcnt(8)
  v_mfma_f32_16x16x32_bf16 a[32:35], v[16:19], v[128:131], a[32:35]
  v_mfma_f32_16x16x32_bf16 a[36:39], v[16:19], v[132:135], a[36:39]
  v_mfma_f32_16x16x32_bf16 a[40:43], v[16:19], v[136:139], a[40:43]
  v_mfma_f32_16x16x32_bf16 a[44:47], v[16:19], v[140:143], a[44:47]
  v_mfma_f32_16x16x32_bf16 a[48:51], v[20:23], v[128:131], a[48:51]
  v_mfma_f32_16x16x32_bf16 a[52:55], v[20:23], v[132:135], a[52:55]
  v_mfma_f32_16x16x32_bf16 a[56:59], v[20:23], v[136:139], a[56:59]
  v_mfma_f32_16x16x32_bf16 a[60:63], v[20:23], v[140:143], a[60:63]
  global_load_dwordx4 v[16:19], v1, s[76:77] offset:2048
  global_load_dwordx4 v[20:23], v1, s[78:79] offset:2048
  ds_read_b128 v[128:131], v1 offset:10240
  ds_read_b128 v[132:135], v1 offset:26624
  ds_read_b128 v[136:139], v1 offset:43008
  ds_read_b128 v[140:143], v1 offset:59392
  s_waitcnt vmcnt(28) lgkmcnt(8)
  v_mfma_f32_16x16x32_bf16 a[32:35], v[24:27], v[144:147], a[32:35]
  v_mfma_f32_16x16x32_bf16 a[36:39], v[24:27], v[148:151], a[36:39]
  v_mfma_f32_16x16x32_bf16 a[40:43], v[24:27], v[152:155], a[40:43]
  v_mfma_f32_16x16x32_bf16 a[44:47], v[24:27], v[156:159], a[44:47]
  v_mfma_f32_16x16x32_bf16 a[48:51], v[28:31], v[144:147], a[48:51]
  v_mfma_f32_16x16x32_bf16 a[52:55], v[28:31], v[148:151], a[52:55]
  v_mfma_f32_16x16x32_bf16 a[56:59], v[28:31], v[152:155], a[56:59]
  v_mfma_f32_16x16x32_bf16 a[60:63], v[28:31], v[156:159], a[60:63]
  global_load_dwordx4 v[24:27], v1, s[76:77] offset:3072
  global_load_dwordx4 v[28:31], v1, s[78:79] offset:3072
  ds_read_b128 v[144:147], v1 offset:11264
  ds_read_b128 v[148:151], v1 offset:27648
  ds_read_b128 v[152:155], v1 offset:44032
  ds_read_b128 v[156:159], v1 offset:60416
  s_waitcnt vmcnt(28) lgkmcnt(8)
  v_mfma_f32_16x16x32_bf16 a[32:35], v[32:35], v[112:115], a[32:35]
  v_mfma_f32_16x16x32_bf16 a[36:39], v[32:35], v[116:119], a[36:39]
  v_mfma_f32_16x16x32_bf16 a[40:43], v[32:35], v[120:123], a[40:43]
  v_mfma_f32_16x16x32_bf16 a[44:47], v[32:35], v[124:127], a[44:47]
  v_mfma_f32_16x16x32_bf16 a[48:51], v[36:39], v[112:115], a[48:51]
  v_mfma_f32_16x16x32_bf16 a[52:55], v[36:39], v[116:119], a[52:55]
  v_mfma_f32_16x16x32_bf16 a[56:59], v[36:39], v[120:123], a[56:59]
  v_mfma_f32_16x16x32_bf16 a[60:63], v[36:39], v[124:127], a[60:63]
  global_load_dwordx4 v[32:35], v180, s[76:77] offset:0
  global_load_dwordx4 v[36:39], v180, s[78:79] offset:0
  ds_read_b128 v[112:115], v1 offset:12288
  ds_read_b128 v[116:119], v1 offset:28672
  ds_read_b128 v[120:123], v1 offset:45056
  ds_read_b128 v[124:127], v1 offset:61440
  s_waitcnt vmcnt(28) lgkmcnt(8)
  v_mfma_f32_16x16x32_bf16 a[32:35], v[40:43], v[128:131], a[32:35]
  v_mfma_f32_16x16x32_bf16 a[36:39], v[40:43], v[132:135], a[36:39]
  v_mfma_f32_16x16x32_bf16 a[40:43], v[40:43], v[136:139], a[40:43]
  v_mfma_f32_16x16x32_bf16 a[44:47], v[40:43], v[140:143], a[44:47]
  v_mfma_f32_16x16x32_bf16 a[48:51], v[44:47], v[128:131], a[48:51]
  v_mfma_f32_16x16x32_bf16 a[52:55], v[44:47], v[132:135], a[52:55]
  v_mfma_f32_16x16x32_bf16 a[56:59], v[44:47], v[136:139], a[56:59]
  v_mfma_f32_16x16x32_bf16 a[60:63], v[44:47], v[140:143], a[60:63]
  global_load_dwordx4 v[40:43], v180, s[76:77] offset:1024
  global_load_dwordx4 v[44:47], v180, s[78:79] offset:1024
  ds_read_b128 v[128:131], v1 offset:13312
  ds_read_b128 v[132:135], v1 offset:29696
  ds_read_b128 v[136:139], v1 offset:46080
  ds_read_b128 v[140:143], v1 offset:62464
  s_waitcnt vmcnt(28) lgkmcnt(8)
  v_mfma_f32_16x16x32_bf16 a[32:35], v[48:51], v[144:147], a[32:35]
  v_mfma_f32_16x16x32_bf16 a[36:39], v[48:51], v[148:151], a[36:39]
  v_mfma_f32_16x16x32_bf16 a[40:43], v[48:51], v[152:155], a[40:43]
  v_mfma_f32_16x16x32_bf16 a[44:47], v[48:51], v[156:159], a[44:47]
  v_mfma_f32_16x16x32_bf16 a[48:51], v[52:55], v[144:147], a[48:51]
  v_mfma_f32_16x16x32_bf16 a[52:55], v[52:55], v[148:151], a[52:55]
  v_mfma_f32_16x16x32_bf16 a[56:59], v[52:55], v[152:155], a[56:59]
  v_mfma_f32_16x16x32_bf16 a[60:63], v[52:55], v[156:159], a[60:63]
  global_load_dwordx4 v[48:51], v180, s[76:77] offset:2048
  global_load_dwordx4 v[52:55], v180, s[78:79] offset:2048
  ds_read_b128 v[144:147], v1 offset:14336
  ds_read_b128 v[148:151], v1 offset:30720
  ds_read_b128 v[152:155], v1 offset:47104
  ds_read_b128 v[156:159], v1 offset:63488
  s_waitcnt vmcnt(28) lgkmcnt(8)
  v_mfma_f32_16x16x32_bf16 a[32:35], v[56:59], v[112:115], a[32:35]
  v_mfma_f32_16x16x32_bf16 a[36:39], v[56:59], v[116:119], a[36:39]
  v_mfma_f32_16x16x32_bf16 a[40:43], v[56:59], v[120:123], a[40:43]
  v_mfma_f32_16x16x32_bf16 a[44:47], v[56:59], v[124:127], a[44:47]
  v_mfma_f32_16x16x32_bf16 a[48:51], v[60:63], v[112:115], a[48:51]
  v_mfma_f32_16x16x32_bf16 a[52:55], v[60:63], v[116:119], a[52:55]
  v_mfma_f32_16x16x32_bf16 a[56:59], v[60:63], v[120:123], a[56:59]
  v_mfma_f32_16x16x32_bf16 a[60:63], v[60:63], v[124:127], a[60:63]
  global_load_dwordx4 v[56:59], v180, s[76:77] offset:3072
  global_load_dwordx4 v[60:63], v180, s[78:79] offset:3072
  ds_read_b128 v[112:115], v1 offset:15360
  ds_read_b128 v[116:119], v1 offset:31744
  ds_read_b128 v[120:123], v1 offset:48128
  ds_read_b128 v[124:127], v1 offset:64512
  s_waitcnt vmcnt(20) lgkmcnt(8)
  v_mfma_f32_16x16x32_bf16 a[32:35], v[64:67], v[128:131], a[32:35]
  v_mfma_f32_16x16x32_bf16 a[36:39], v[64:67], v[132:135], a[36:39]
  v_mfma_f32_16x16x32_bf16 a[40:43], v[64:67], v[136:139], a[40:43]
  v_mfma_f32_16x16x32_bf16 a[44:47], v[64:67], v[140:143], a[44:47]
  v_mfma_f32_16x16x32_bf16 a[48:51], v[68:71], v[128:131], a[48:51]
  v_mfma_f32_16x16x32_bf16 a[52:55], v[68:71], v[132:135], a[52:55]
  v_mfma_f32_16x16x32_bf16 a[56:59], v[68:71], v[136:139], a[56:59]
  v_mfma_f32_16x16x32_bf16 a[60:63], v[68:71], v[140:143], a[60:63]
  global_load_dwordx4 v[64:67], v181, s[76:77] offset:0
  global_load_dwordx4 v[68:71], v181, s[78:79] offset:0
  ds_read_b128 v[128:131], v1 offset:0
  ds_read_b128 v[132:135], v1 offset:16384
  ds_read_b128 v[136:139], v1 offset:32768
  ds_read_b128 v[140:143], v1 offset:49152
  s_waitcnt vmcnt(20) lgkmcnt(8)
  v_mfma_f32_16x16x32_bf16 a[32:35], v[72:75], v[144:147], a[32:35]
  v_mfma_f32_16x16x32_bf16 a[36:39], v[72:75], v[148:151], a[36:39]
  v_mfma_f32_16x16x32_bf16 a[40:43], v[72:75], v[152:155], a[40:43]
  v_mfma_f32_16x16x32_bf16 a[44:47], v[72:75], v[156:159], a[44:47]
  v_mfma_f32_16x16x32_bf16 a[48:51], v[76:79], v[144:147], a[48:51]
  v_mfma_f32_16x16x32_bf16 a[52:55], v[76:79], v[148:151], a[52:55]
  v_mfma_f32_16x16x32_bf16 a[56:59], v[76:79], v[152:155], a[56:59]
  v_mfma_f32_16x16x32_bf16 a[60:63], v[76:79], v[156:159], a[60:63]
  global_load_dwordx4 v[72:75], v181, s[76:77] offset:1024
  global_load_dwordx4 v[76:79], v181, s[78:79] offset:1024
  ds_read_b128 v[144:147], v1 offset:1024
  ds_read_b128 v[148:151], v1 offset:17408
  ds_read_b128 v[152:155], v1 offset:33792
  ds_read_b128 v[156:159], v1 offset:50176
  s_waitcnt vmcnt(20) lgkmcnt(8)
  v_mfma_f32_16x16x32_bf16 a[32:35], v[80:83], v[112:115], a[32:35]
  v_mfma_f32_16x16x32_bf16 a[36:39], v[80:83], v[116:119], a[36:39]
  v_mfma_f32_16x16x32_bf16 a[40:43], v[80:83], v[120:123], a[40:43]
  v_mfma_f32_16x16x32_bf16 a[44:47], v[80:83], v[124:127], a[44:47]
  v_mfma_f32_16x16x32_bf16 a[48:51], v[84:87], v[112:115], a[48:51]
  v_mfma_f32_16x16x32_bf16 a[52:55], v[84:87], v[116:119], a[52:55]
  v_mfma_f32_16x16x32_bf16 a[56:59], v[84:87], v[120:123], a[56:59]
  v_mfma_f32_16x16x32_bf16 a[60:63], v[84:87], v[124:127], a[60:63]
  global_load_dwordx4 v[80:83], v181, s[76:77] offset:2048
  global_load_dwordx4 v[84:87], v181, s[78:79] offset:2048
  ds_read_b128 v[112:115], v1 offset:2048
  ds_read_b128 v[116:119], v1 offset:18432
  ds_read_b128 v[120:123], v1 offset:34816
  ds_read_b128 v[124:127], v1 offset:51200
  s_waitcnt vmcnt(20) lgkmcnt(8)
  v_mfma_f32_16x16x32_bf16 a[0:3], v[88:91], v[128:131], 0
  v_mfma_f32_16x16x32_bf16 a[4:7], v[88:91], v[132:135], 0
  v_mfma_f32_16x16x32_bf16 a[8:11], v[88:91], v[136:139], 0
  v_mfma_f32_16x16x32_bf16 a[12:15], v[88:91], v[140:143], 0
  v_mfma_f32_16x16x32_bf16 a[16:19], v[92:95], v[128:131], 0
  v_mfma_f32_16x16x32_bf16 a[20:23], v[92:95], v[132:135], 0
  v_mfma_f32_16x16x32_bf16 a[24:27], v[92:95], v[136:139], 0
  v_mfma_f32_16x16x32_bf16 a[28:31], v[92:95], v[140:143], 0
  global_load_dwordx4 v[88:91], v181, s[76:77] offset:3072
  global_load_dwordx4 v[92:95], v181, s[78:79] offset:3072
  ds_read_b128 v[128:131], v1 offset:3072
  ds_read_b128 v[132:135], v1 offset:19456
  ds_read_b128 v[136:139], v1 offset:35840
  ds_read_b128 v[140:143], v1 offset:52224
  s_waitcnt vmcnt(20) lgkmcnt(8)
  v_mfma_f32_16x16x32_bf16 a[0:3], v[96:99], v[144:147], a[0:3]
  v_mfma_f32_16x16x32_bf16 a[4:7], v[96:99], v[148:151], a[4:7]
  v_mfma_f32_16x16x32_bf16 a[8:11], v[96:99], v[152:155], a[8:11]
  v_mfma_f32_16x16x32_bf16 a[12:15], v[96:99], v[156:159], a[12:15]
  v_mfma_f32_16x16x32_bf16 a[16:19], v[100:103], v[144:147], a[16:19]
  v_mfma_f32_16x16x32_bf16 a[20:23], v[100:103], v[148:151], a[20:23]
  v_mfma_f32_16x16x32_bf16 a[24:27], v[100:103], v[152:155], a[24:27]
  v_mfma_f32_16x16x32_bf16 a[28:31], v[100:103], v[156:159], a[28:31]
  global_load_dwordx4 v[96:99], v182, s[76:77] offset:0
  global_load_dwordx4 v[100:103], v182, s[78:79] offset:0
  ds_read_b128 v[144:147], v1 offset:4096
  ds_read_b128 v[148:151], v1 offset:20480
  ds_read_b128 v[152:155], v1 offset:36864
  ds_read_b128 v[156:159], v1 offset:53248
  s_waitcnt vmcnt(20) lgkmcnt(8)
  v_mfma_f32_16x16x32_bf16 a[0:3], v[16:19], v[112:115], a[0:3]
  v_mfma_f32_16x16x32_bf16 a[4:7], v[16:19], v[116:119], a[4:7]
  v_mfma_f32_16x16x32_bf16 a[8:11], v[16:19], v[120:123], a[8:11]
  v_mfma_f32_16x16x32_bf16 a[12:15], v[16:19], v[124:127], a[12:15]
  v_mfma_f32_16x16x32_bf16 a[16:19], v[20:23], v[112:115], a[16:19]
  v_mfma_f32_16x16x32_bf16 a[20:23], v[20:23], v[116:119], a[20:23]
  v_mfma_f32_16x16x32_bf16 a[24:27], v[20:23], v[120:123], a[24:27]
  v_mfma_f32_16x16x32_bf16 a[28:31], v[20:23], v[124:127], a[28:31]
  global_store_dwordx4 v176, a[32:35], s[12:13] offset:384 sc1
  global_store_dwordx4 v177, a[36:39], s[12:13] offset:384 sc1
  global_store_dwordx4 v178, a[40:43], s[12:13] offset:384 sc1
  global_store_dwordx4 v179, a[44:47], s[12:13] offset:384 sc1
  global_store_dwordx4 v176, a[48:51], s[12:13] offset:448 sc1
  global_store_dwordx4 v177, a[52:55], s[12:13] offset:448 sc1
  global_store_dwordx4 v178, a[56:59], s[12:13] offset:448 sc1
  global_store_dwordx4 v179, a[60:63], s[12:13] offset:448 sc1
  global_load_dwordx4 v[16:19], v182, s[76:77] offset:1024
  global_load_dwordx4 v[20:23], v182, s[78:79] offset:1024
  ds_read_b128 v[112:115], v1 offset:5120
  ds_read_b128 v[116:119], v1 offset:21504
  ds_read_b128 v[120:123], v1 offset:37888
  ds_read_b128 v[124:127], v1 offset:54272
  s_waitcnt vmcnt(28) lgkmcnt(8)
  v_mfma_f32_16x16x32_bf16 a[0:3], v[24:27], v[128:131], a[0:3]
  v_mfma_f32_16x16x32_bf16 a[4:7], v[24:27], v[132:135], a[4:7]
  v_mfma_f32_16x16x32_bf16 a[8:11], v[24:27], v[136:139], a[8:11]
  v_mfma_f32_16x16x32_bf16 a[12:15], v[24:27], v[140:143], a[12:15]
  v_mfma_f32_16x16x32_bf16 a[16:19], v[28:31], v[128:131], a[16:19]
  v_mfma_f32_16x16x32_bf16 a[20:23], v[28:31], v[132:135], a[20:23]
  v_mfma_f32_16x16x32_bf16 a[24:27], v[28:31], v[136:139], a[24:27]
  v_mfma_f32_16x16x32_bf16 a[28:31], v[28:31], v[140:143], a[28:31]
  global_load_dwordx4 v[24:27], v182, s[76:77] offset:2048
  global_load_dwordx4 v[28:31], v182, s[78:79] offset:2048
  ds_read_b128 v[128:131], v1 offset:6144
  ds_read_b128 v[132:135], v1 offset:22528
  ds_read_b128 v[136:139], v1 offset:38912
  ds_read_b128 v[140:143], v1 offset:55296
  s_waitcnt vmcnt(28) lgkmcnt(8)
  v_mfma_f32_16x16x32_bf16 a[0:3], v[32:35], v[144:147], a[0:3]
  v_mfma_f32_16x16x32_bf16 a[4:7], v[32:35], v[148:151], a[4:7]
  v_mfma_f32_16x16x32_bf16 a[8:11], v[32:35], v[152:155], a[8:11]
  v_mfma_f32_16x16x32_bf16 a[12:15], v[32:35], v[156:159], a[12:15]
  v_mfma_f32_16x16x32_bf16 a[16:19], v[36:39], v[144:147], a[16:19]
  v_mfma_f32_16x16x32_bf16 a[20:23], v[36:39], v[148:151], a[20:23]
  v_mfma_f32_16x16x32_bf16 a[24:27], v[36:39], v[152:155], a[24:27]
  v_mfma_f32_16x16x32_bf16 a[28:31], v[36:39], v[156:159], a[28:31]
  global_load_dwordx4 v[32:35], v182, s[76:77] offset:3072
  global_load_dwordx4 v[36:39], v182, s[78:79] offset:3072
  ds_read_b128 v[144:147], v1 offset:7168
  ds_read_b128 v[148:151], v1 offset:23552
  ds_read_b128 v[152:155], v1 offset:39936
  ds_read_b128 v[156:159], v1 offset:56320
  s_waitcnt vmcnt(28) lgkmcnt(8)
  v_mfma_f32_16x16x32_bf16 a[0:3], v[40:43], v[112:115], a[0:3]
  v_mfma_f32_16x16x32_bf16 a[4:7], v[40:43], v[116:119], a[4:7]
  v_mfma_f32_16x16x32_bf16 a[8:11], v[40:43], v[120:123], a[8:11]
  v_mfma_f32_16x16x32_bf16 a[12:15], v[40:43], v[124:127], a[12:15]
  v_mfma_f32_16x16x32_bf16 a[16:19], v[44:47], v[112:115], a[16:19]
  v_mfma_f32_16x16x32_bf16 a[20:23], v[44:47], v[116:119], a[20:23]
  v_mfma_f32_16x16x32_bf16 a[24:27], v[44:47], v[120:123], a[24:27]
  v_mfma_f32_16x16x32_bf16 a[28:31], v[44:47], v[124:127], a[28:31]
  ds_read_b128 v[112:115], v1 offset:8192
  ds_read_b128 v[116:119], v1 offset:24576
  ds_read_b128 v[120:123], v1 offset:40960
  ds_read_b128 v[124:127], v1 offset:57344
  s_waitcnt vmcnt(26) lgkmcnt(8)
  v_mfma_f32_16x16x32_bf16 a[0:3], v[48:51], v[128:131], a[0:3]
  v_mfma_f32_16x16x32_bf16 a[4:7], v[48:51], v[132:135], a[4:7]
  v_mfma_f32_16x16x32_bf16 a[8:11], v[48:51], v[136:139], a[8:11]
  v_mfma_f32_16x16x32_bf16 a[12:15], v[48:51], v[140:143], a[12:15]
  v_mfma_f32_16x16x32_bf16 a[16:19], v[52:55], v[128:131], a[16:19]
  v_mfma_f32_16x16x32_bf16 a[20:23], v[52:55], v[132:135], a[20:23]
  v_mfma_f32_16x16x32_bf16 a[24:27], v[52:55], v[136:139], a[24:27]
  v_mfma_f32_16x16x32_bf16 a[28:31], v[52:55], v[140:143], a[28:31]
  ds_read_b128 v[128:131], v1 offset:9216
  ds_read_b128 v[132:135], v1 offset:25600
  ds_read_b128 v[136:139], v1 offset:41984
  ds_read_b128 v[140:143], v1 offset:58368
  s_waitcnt vmcnt(24) lgkmcnt(8)
  v_mfma_f32_16x16x32_bf16 a[0:3], v[56:59], v[144:147], a[0:3]
  v_mfma_f32_16x16x32_bf16 a[4:7], v[56:59], v[148:151], a[4:7]
  v_mfma_f32_16x16x32_bf16 a[8:11], v[56:59], v[152:155], a[8:11]
  v_mfma_f32_16x16x32_bf16 a[12:15], v[56:59], v[156:159], a[12:15]
  v_mfma_f32_16x16x32_bf16 a[16:19], v[60:63], v[144:147], a[16:19]
  v_mfma_f32_16x16x32_bf16 a[20:23], v[60:63], v[148:151], a[20:23]
  v_mfma_f32_16x16x32_bf16 a[24:27], v[60:63], v[152:155], a[24:27]
  v_mfma_f32_16x16x32_bf16 a[28:31], v[60:63], v[156:159], a[28:31]
  ds_read_b128 v[144:147], v1 offset:10240
  ds_read_b128 v[148:151], v1 offset:26624
  ds_read_b128 v[152:155], v1 offset:43008
  ds_read_b128 v[156:159], v1 offset:59392
  s_waitcnt vmcnt(22) lgkmcnt(8)
  v_mfma_f32_16x16x32_bf16 a[0:3], v[64:67], v[112:115], a[0:3]
  v_mfma_f32_16x16x32_bf16 a[4:7], v[64:67], v[116:119], a[4:7]
  v_mfma_f32_16x16x32_bf16 a[8:11], v[64:67], v[120:123], a[8:11]
  v_mfma_f32_16x16x32_bf16 a[12:15], v[64:67], v[124:127], a[12:15]
  v_mfma_f32_16x16x32_bf16 a[16:19], v[68:71], v[112:115], a[16:19]
  v_mfma_f32_16x16x32_bf16 a[20:23], v[68:71], v[116:119], a[20:23]
  v_mfma_f32_16x16x32_bf16 a[24:27], v[68:71], v[120:123], a[24:27]
  v_mfma_f32_16x16x32_bf16 a[28:31], v[68:71], v[124:127], a[28:31]
  ds_read_b128 v[112:115], v1 offset:11264
  ds_read_b128 v[116:119], v1 offset:27648
  ds_read_b128 v[120:123], v1 offset:44032
  ds_read_b128 v[124:127], v1 offset:60416
  s_waitcnt vmcnt(20) lgkmcnt(8)
  v_mfma_f32_16x16x32_bf16 a[0:3], v[72:75], v[128:131], a[0:3]
  v_mfma_f32_16x16x32_bf16 a[4:7], v[72:75], v[132:135], a[4:7]
  v_mfma_f32_16x16x32_bf16 a[8:11], v[72:75], v[136:139], a[8:11]
  v_mfma_f32_16x16x32_bf16 a[12:15], v[72:75], v[140:143], a[12:15]
  v_mfma_f32_16x16x32_bf16 a[16:19], v[76:79], v[128:131], a[16:19]
  v_mfma_f32_16x16x32_bf16 a[20:23], v[76:79], v[132:135], a[20:23]
  v_mfma_f32_16x16x32_bf16 a[24:27], v[76:79], v[136:139], a[24:27]
  v_mfma_f32_16x16x32_bf16 a[28:31], v[76:79], v[140:143], a[28:31]
  ds_read_b128 v[128:131], v1 offset:12288
  ds_read_b128 v[132:135], v1 offset:28672
  ds_read_b128 v[136:139], v1 offset:45056
  ds_read_b128 v[140:143], v1 offset:61440
  s_waitcnt vmcnt(18) lgkmcnt(8)
  v_mfma_f32_16x16x32_bf16 a[0:3], v[80:83], v[144:147], a[0:3]
  v_mfma_f32_16x16x32_bf16 a[4:7], v[80:83], v[148:151], a[4:7]
  v_mfma_f32_16x16x32_bf16 a[8:11], v[80:83], v[152:155], a[8:11]
  v_mfma_f32_16x16x32_bf16 a[12:15], v[80:83], v[156:159], a[12:15]
  v_mfma_f32_16x16x32_bf16 a[16:19], v[84:87], v[144:147], a[16:19]
  v_mfma_f32_16x16x32_bf16 a[20:23], v[84:87], v[148:151], a[20:23]
  v_mfma_f32_16x16x32_bf16 a[24:27], v[84:87], v[152:155], a[24:27]
  v_mfma_f32_16x16x32_bf16 a[28:31], v[84:87], v[156:159], a[28:31]
  ds_read_b128 v[144:147], v1 offset:13312
  ds_read_b128 v[148:151], v1 offset:29696
  ds_read_b128 v[152:155], v1 offset:46080
  ds_read_b128 v[156:159], v1 offset:62464
  s_waitcnt vmcnt(16) lgkmcnt(8)
  v_mfma_f32_16x16x32_bf16 a[0:3], v[88:91], v[112:115], a[0:3]
  v_mfma_f32_16x16x32_bf16 a[4:7], v[88:91], v[116:119], a[4:7]
  v_mfma_f32_16x16x32_bf16 a[8:11], v[88:91], v[120:123], a[8:11]
  v_mfma_f32_16x16x32_bf16 a[12:15], v[88:91], v[124:127], a[12:15]
  v_mfma_f32_16x16x32_bf16 a[16:19], v[92:95], v[112:115], a[16:19]
  v_mfma_f32_16x16x32_bf16 a[20:23], v[92:95], v[116:119], a[20:23]
  v_mfma_f32_16x16x32_bf16 a[24:27], v[92:95], v[120:123], a[24:27]
  v_mfma_f32_16x16x32_bf16 a[28:31], v[92:95], v[124:127], a[28:31]
  ds_read_b128 v[112:115], v1 offset:14336
  ds_read_b128 v[116:119], v1 offset:30720
  ds_read_b128 v[120:123], v1 offset:47104
  ds_read_b128 v[124:127], v1 offset:63488
  s_waitcnt vmcnt(14) lgkmcnt(8)
  v_mfma_f32_16x16x32_bf16 a[0:3], v[96:99], v[128:131], a[0:3]
  v_mfma_f32_16x16x32_bf16 a[4:7], v[96:99], v[132:135], a[4:7]
  v_mfma_f32_16x16x32_bf16 a[8:11], v[96:99], v[136:139], a[8:11]
  v_mfma_f32_16x16x32_bf16 a[12:15], v[96:99], v[140:143], a[12:15]
  v_mfma_f32_16x16x32_bf16 a[16:19], v[100:103], v[128:131], a[16:19]
  v_mfma_f32_16x16x32_bf16 a[20:23], v[100:103], v[132:135], a[20:23]
  v_mfma_f32_16x16x32_bf16 a[24:27], v[100:103], v[136:139], a[24:27]
  v_mfma_f32_16x16x32_bf16 a[28:31], v[100:103], v[140:143], a[28:31]
  ds_read_b128 v[128:131], v1 offset:15360
  ds_read_b128 v[132:135], v1 offset:31744
  ds_read_b128 v[136:139], v1 offset:48128
  ds_read_b128 v[140:143], v1 offset:64512
  s_waitcnt vmcnt(4) lgkmcnt(8)
  v_mfma_f32_16x16x32_bf16 a[0:3], v[16:19], v[144:147], a[0:3]
  v_mfma_f32_16x16x32_bf16 a[4:7], v[16:19], v[148:151], a[4:7]
  v_mfma_f32_16x16x32_bf16 a[8:11], v[16:19], v[152:155], a[8:11]
  v_mfma_f32_16x16x32_bf16 a[12:15], v[16:19], v[156:159], a[12:15]
  v_mfma_f32_16x16x32_bf16 a[16:19], v[20:23], v[144:147], a[16:19]
  v_mfma_f32_16x16x32_bf16 a[20:23], v[20:23], v[148:151], a[20:23]
  v_mfma_f32_16x16x32_bf16 a[24:27], v[20:23], v[152:155], a[24:27]
  v_mfma_f32_16x16x32_bf16 a[28:31], v[20:23], v[156:159], a[28:31]
  s_waitcnt vmcnt(2) lgkmcnt(4)
  v_mfma_f32_16x16x32_bf16 a[0:3], v[24:27], v[112:115], a[0:3]
  v_mfma_f32_16x16x32_bf16 a[4:7], v[24:27], v[116:119], a[4:7]
  v_mfma_f32_16x16x32_bf16 a[8:11], v[24:27], v[120:123], a[8:11]
  v_mfma_f32_16x16x32_bf16 a[12:15], v[24:27], v[124:127], a[12:15]
  v_mfma_f32_16x16x32_bf16 a[16:19], v[28:31], v[112:115], a[16:19]
  v_mfma_f32_16x16x32_bf16 a[20:23], v[28:31], v[116:119], a[20:23]
  v_mfma_f32_16x16x32_bf16 a[24:27], v[28:31], v[120:123], a[24:27]
  v_mfma_f32_16x16x32_bf16 a[28:31], v[28:31], v[124:127], a[28:31]
  s_waitcnt vmcnt(0) lgkmcnt(0)
  v_mfma_f32_16x16x32_bf16 a[0:3], v[32:35], v[128:131], a[0:3]
  v_mfma_f32_16x16x32_bf16 a[4:7], v[32:35], v[132:135], a[4:7]
  v_mfma_f32_16x16x32_bf16 a[8:11], v[32:35], v[136:139], a[8:11]
  v_mfma_f32_16x16x32_bf16 a[12:15], v[32:35], v[140:143], a[12:15]
  v_mfma_f32_16x16x32_bf16 a[16:19], v[36:39], v[128:131], a[16:19]
  v_mfma_f32_16x16x32_bf16 a[20:23], v[36:39], v[132:135], a[20:23]
  v_mfma_f32_16x16x32_bf16 a[24:27], v[36:39], v[136:139], a[24:27]
  v_mfma_f32_16x16x32_bf16 a[28:31], v[36:39], v[140:143], a[28:31]
  s_nop 7
  s_nop 1
  global_store_dwordx4 v176, a[0:3], s[12:13] offset:512 sc1
  global_store_dwordx4 v177, a[4:7], s[12:13] offset:512 sc1
  global_store_dwordx4 v178, a[8:11], s[12:13] offset:512 sc1
  global_store_dwordx4 v179, a[12:15], s[12:13] offset:512 sc1
  global_store_dwordx4 v176, a[16:19], s[12:13] offset:576 sc1
  global_store_dwordx4 v177, a[20:23], s[12:13] offset:576 sc1
  global_store_dwordx4 v178, a[24:27], s[12:13] offset:576 sc1
  global_store_dwordx4 v179, a[28:31], s[12:13] offset:576 sc1
  s_waitcnt vmcnt(0)
  s_barrier
  s_lshl_b32 s10, s45, 2
  s_add_u32 s10, s10, 0x8c00380
  s_add_u32 s14, s6, s10
  s_addc_u32 s15, s7, 0
  v_mov_b32 v12, 0
  s_cmp_lg_u32 s8, 0
  s_cbranch_scc1 awl_wait
  v_mov_b32 v13, 1
  s_mov_b64 s[56:57], exec
  s_mov_b64 exec, 1
  global_atomic_add v12, v13, s[14:15]
  s_mov_b32 s58, 0
awl_poll:
  s_sleep 2
  global_load_dword v14, v12, s[14:15] sc1
  s_waitcnt vmcnt(0)
  v_readfirstlane_b32 s10, v14
  s_add_u32 s58, s58, 1
  s_cmp_gt_u32 s58, 100000
  s_cbranch_scc1 awl_pdone
  s_cmp_lt_u32 s10, 8
  s_cbranch_scc1 awl_poll
awl_pdone:
  s_mov_b64 exec, s[56:57]
awl_wait:
  s_barrier
  v_lshrrev_b32 v10, 5, v0
  v_and_b32 v11, 31, v0
  s_lshl_b32 s10, s44, 3
  v_add_u32 v10, s10, v10
  v_mul_u32_u24 v12, 2560, v10
  v_lshl_add_u32 v12, v11, 4, v12
  s_mul_i32 s10, s45, 1310720
  s_add_u32 s10, s10, 0xd000000
  s_add_u32 s12, s6, s10
  s_addc_u32 s13, s7, 0
  s_lshl_b32 s10, s45, 6
  v_add_u32 v13, s10, v10
  v_mul_u32_u24 v14, 0x500, v13
  v_lshl_add_u32 v14, v11, 3, v14
  global_load_dwordx2 v[180:181], v14, s[4:5] offset:0
  global_load_dwordx2 v[182:183], v14, s[4:5] offset:256
  global_load_dwordx2 v[184:185], v14, s[4:5] offset:512
  global_load_dwordx2 v[186:187], v14, s[4:5] offset:768
  global_load_dwordx2 v[188:189], v14, s[4:5] offset:1024
  global_load_dwordx4 v[16:19], v12, s[12:13] offset:0 sc1
  global_load_dwordx4 v[20:23], v12, s[12:13] offset:512 sc1
  global_load_dwordx4 v[24:27], v12, s[12:13] offset:1024 sc1
  global_load_dwordx4 v[28:31], v12, s[12:13] offset:1536 sc1
  global_load_dwordx4 v[32:35], v12, s[12:13] offset:2048 sc1
  s_add_u32 s12, s12, 163840
  s_addc_u32 s13, s13, 0
  global_load_dwordx4 v[36:39], v12, s[12:13] offset:0 sc1
  global_load_dwordx4 v[40:43], v12, s[12:13] offset:512 sc1
  global_load_dwordx4 v[44:47], v12, s[12:13] offset:1024 sc1
  global_load_dwordx4 v[48:51], v12, s[12:13] offset:1536 sc1
  global_load_dwordx4 v[52:55], v12, s[12:13] offset:2048 sc1
  s_add_u32 s12, s12, 163840
  s_addc_u32 s13, s13, 0
  global_load_dwordx4 v[56:59], v12, s[12:13] offset:0 sc1
  global_load_dwordx4 v[60:63], v12, s[12:13] offset:512 sc1
  global_load_dwordx4 v[64:67], v12, s[12:13] offset:1024 sc1
  global_load_dwordx4 v[68:71], v12, s[12:13] offset:1536 sc1
  global_load_dwordx4 v[72:75], v12, s[12:13] offset:2048 sc1
  s_add_u32 s12, s12, 163840
  s_addc_u32 s13, s13, 0
  global_load_dwordx4 v[76:79], v12, s[12:13] offset:0 sc1
  global_load_dwordx4 v[80:83], v12, s[12:13] offset:512 sc1
  global_load_dwordx4 v[84:87], v12, s[12:13] offset:1024 sc1
  global_load_dwordx4 v[88:91], v12, s[12:13] offset:1536 sc1
  global_load_dwordx4 v[92:95], v12, s[12:13] offset:2048 sc1
  s_add_u32 s12, s12, 163840
  s_addc_u32 s13, s13, 0
  global_load_dwordx4 v[96:99], v12, s[12:13] offset:0 sc1
  global_load_dwordx4 v[100:103], v12, s[12:13] offset:512 sc1
  global_load_dwordx4 v[104:107], v12, s[12:13] offset:1024 sc1
  global_load_dwordx4 v[108:111], v12, s[12:13] offset:1536 sc1
  global_load_dwordx4 v[112:115], v12, s[12:13] offset:2048 sc1
  s_add_u32 s12, s12, 163840
  s_addc_u32 s13, s13, 0
  global_load_dwordx4 v[116:119], v12, s[12:13] offset:0 sc1
  global_load_dwordx4 v[120:123], v12, s[12:13] offset:512 sc1
  global_load_dwordx4 v[124:127], v12, s[12:13] offset:1024 sc1
  global_load_dwordx4 v[128:131], v12, s[12:13] offset:1536 sc1
  global_load_dwordx4 v[132:135], v12, s[12:13] offset:2048 sc1
  s_add_u32 s12, s12, 163840
  s_addc_u32 s13, s13, 0
  global_load_dwordx4 v[136:139], v12, s[12:13] offset:0 sc1
  global_load_dwordx4 v[140:143], v12, s[12:13] offset:512 sc1
  global_load_dwordx4 v[144:147], v12, s[12:13] offset:1024 sc1
  global_load_dwordx4 v[148:151], v12, s[12:13] offset:1536 sc1
  global_load_dwordx4 v[152:155], v12, s[12:13] offset:2048 sc1
  s_add_u32 s12, s12, 163840
  s_addc_u32 s13, s13, 0
  global_load_dwordx4 v[156:159], v12, s[12:13] offset:0 sc1
  global_load_dwordx4 v[160:163], v12, s[12:13] offset:512 sc1
  global_load_dwordx4 v[164:167], v12, s[12:13] offset:1024 sc1
  global_load_dwordx4 v[168:171], v12, s[12:13] offset:1536 sc1
  global_load_dwordx4 v[172:175], v12, s[12:13] offset:2048 sc1
  s_add_u32 s12, s12, 163840
  s_addc_u32 s13, s13, 0
  s_waitcnt vmcnt(30)
  v_pk_add_f32 v[16:17], v[16:17], v[36:37]
  v_pk_add_f32 v[18:19], v[18:19], v[38:39]
  v_pk_add_f32 v[20:21], v[20:21], v[40:41]
  v_pk_add_f32 v[22:23], v[22:23], v[42:43]
  v_pk_add_f32 v[24:25], v[24:25], v[44:45]
  v_pk_add_f32 v[26:27], v[26:27], v[46:47]
  v_pk_add_f32 v[28:29], v[28:29], v[48:49]
  v_pk_add_f32 v[30:31], v[30:31], v[50:51]
  v_pk_add_f32 v[32:33], v[32:33], v[52:53]
  v_pk_add_f32 v[34:35], v[34:35], v[54:55]
  s_waitcnt vmcnt(25)
  v_pk_add_f32 v[16:17], v[16:17], v[56:57]
  v_pk_add_f32 v[18:19], v[18:19], v[58:59]
  v_pk_add_f32 v[20:21], v[20:21], v[60:61]
  v_pk_add_f32 v[22:23], v[22:23], v[62:63]
  v_pk_add_f32 v[24:25], v[24:25], v[64:65]
  v_pk_add_f32 v[26:27], v[26:27], v[66:67]
  v_pk_add_f32 v[28:29], v[28:29], v[68:69]
  v_pk_add_f32 v[30:31], v[30:31], v[70:71]
  v_pk_add_f32 v[32:33], v[32:33], v[72:73]
  v_pk_add_f32 v[34:35], v[34:35], v[74:75]
  s_waitcnt vmcnt(20)
  v_pk_add_f32 v[16:17], v[16:17], v[76:77]
  v_pk_add_f32 v[18:19], v[18:19], v[78:79]
  v_pk_add_f32 v[20:21], v[20:21], v[80:81]
  v_pk_add_f32 v[22:23], v[22:23], v[82:83]
  v_pk_add_f32 v[24:25], v[24:25], v[84:85]
  v_pk_add_f32 v[26:27], v[26:27], v[86:87]
  v_pk_add_f32 v[28:29], v[28:29], v[88:89]
  v_pk_add_f32 v[30:31], v[30:31], v[90:91]
  v_pk_add_f32 v[32:33], v[32:33], v[92:93]
  v_pk_add_f32 v[34:35], v[34:35], v[94:95]
  s_waitcnt vmcnt(15)
  v_pk_add_f32 v[16:17], v[16:17], v[96:97]
  v_pk_add_f32 v[18:19], v[18:19], v[98:99]
  v_pk_add_f32 v[20:21], v[20:21], v[100:101]
  v_pk_add_f32 v[22:23], v[22:23], v[102:103]
  v_pk_add_f32 v[24:25], v[24:25], v[104:105]
  v_pk_add_f32 v[26:27], v[26:27], v[106:107]
  v_pk_add_f32 v[28:29], v[28:29], v[108:109]
  v_pk_add_f32 v[30:31], v[30:31], v[110:111]
  v_pk_add_f32 v[32:33], v[32:33], v[112:113]
  v_pk_add_f32 v[34:35], v[34:35], v[114:115]
  s_waitcnt vmcnt(10)
  v_pk_add_f32 v[16:17], v[16:17], v[116:117]
  v_pk_add_f32 v[18:19], v[18:19], v[118:119]
  v_pk_add_f32 v[20:21], v[20:21], v[120:121]
  v_pk_add_f32 v[22:23], v[22:23], v[122:123]
  v_pk_add_f32 v[24:25], v[24:25], v[124:125]
  v_pk_add_f32 v[26:27], v[26:27], v[126:127]
  v_pk_add_f32 v[28:29], v[28:29], v[128:129]
  v_pk_add_f32 v[30:31], v[30:31], v[130:131]
  v_pk_add_f32 v[32:33], v[32:33], v[132:133]
  v_pk_add_f32 v[34:35], v[34:35], v[134:135]
  s_waitcnt vmcnt(5)
  v_pk_add_f32 v[16:17], v[16:17], v[136:137]
  v_pk_add_f32 v[18:19], v[18:19], v[138:139]
  v_pk_add_f32 v[20:21], v[20:21], v[140:141]
  v_pk_add_f32 v[22:23], v[22:23], v[142:143]
  v_pk_add_f32 v[24:25], v[24:25], v[144:145]
  v_pk_add_f32 v[26:27], v[26:27], v[146:147]
  v_pk_add_f32 v[28:29], v[28:29], v[148:149]
  v_pk_add_f32 v[30:31], v[30:31], v[150:151]
  v_pk_add_f32 v[32:33], v[32:33], v[152:153]
  v_pk_add_f32 v[34:35], v[34:35], v[154:155]
  s_waitcnt vmcnt(0)
  v_pk_add_f32 v[16:17], v[16:17], v[156:157]
  v_pk_add_f32 v[18:19], v[18:19], v[158:159]
  v_pk_add_f32 v[20:21], v[20:21], v[160:161]
  v_pk_add_f32 v[22:23], v[22:23], v[162:163]
  v_pk_add_f32 v[24:25], v[24:25], v[164:165]
  v_pk_add_f32 v[26:27], v[26:27], v[166:167]
  v_pk_add_f32 v[28:29], v[28:29], v[168:169]
  v_pk_add_f32 v[30:31], v[30:31], v[170:171]
  v_pk_add_f32 v[32:33], v[32:33], v[172:173]
  v_pk_add_f32 v[34:35], v[34:35], v[174:175]
  s_add_u32 s16, s6, 0x7000000
  s_addc_u32 s17, s7, 0
  v_cvt_pk_bf16_f32 v40, v16, v17
  v_cvt_pk_bf16_f32 v41, v18, v19
  v_lshlrev_b32 v16, 16, v40
  v_and_b32 v17, s54, v40
  v_lshlrev_b32 v18, 16, v41
  v_and_b32 v19, s54, v41
  v_lshlrev_b32 v42, 16, v180
  v_and_b32 v43, s54, v180
  v_lshlrev_b32 v44, 16, v181
  v_and_b32 v45, s54, v181
  v_add_f32 v16, v16, v42
  v_add_f32 v17, v17, v43
  v_add_f32 v18, v18, v44
  v_add_f32 v19, v19, v45
  v_cvt_pk_bf16_f32 v50, v16, v17
  v_cvt_pk_bf16_f32 v51, v18, v19
  v_lshlrev_b32 v16, 16, v50
  v_and_b32 v17, s54, v50
  v_lshlrev_b32 v18, 16, v51
  v_and_b32 v19, s54, v51
  global_store_dwordx2 v14, v[50:51], s[16:17] offset:0
  v_cvt_pk_bf16_f32 v40, v20, v21
  v_cvt_pk_bf16_f32 v41, v22, v23
  v_lshlrev_b32 v20, 16, v40
  v_and_b32 v21, s54, v40
  v_lshlrev_b32 v22, 16, v41
  v_and_b32 v23, s54, v41
  v_lshlrev_b32 v42, 16, v182
  v_and_b32 v43, s54, v182
  v_lshlrev_b32 v44, 16, v183
  v_and_b32 v45, s54, v183
  v_add_f32 v20, v20, v42
  v_add_f32 v21, v21, v43
  v_add_f32 v22, v22, v44
  v_add_f32 v23, v23, v45
  v_cvt_pk_bf16_f32 v52, v20, v21
  v_cvt_pk_bf16_f32 v53, v22, v23
  v_lshlrev_b32 v20, 16, v52
  v_and_b32 v21, s54, v52
  v_lshlrev_b32 v22, 16, v53
  v_and_b32 v23, s54, v53
  global_store_dwordx2 v14, v[52:53], s[16:17] offset:256
  v_cvt_pk_bf16_f32 v40, v24, v25
  v_cvt_pk_bf16_f32 v41, v26, v27
  v_lshlrev_b32 v24, 16, v40
  v_and_b32 v25, s54, v40
  v_lshlrev_b32 v26, 16, v41
  v_and_b32 v27, s54, v41
  v_lshlrev_b32 v42, 16, v184
  v_and_b32 v43, s54, v184
  v_lshlrev_b32 v44, 16, v185
  v_and_b32 v45, s54, v185
  v_add_f32 v24, v24, v42
  v_add_f32 v25, v25, v43
  v_add_f32 v26, v26, v44
  v_add_f32 v27, v27, v45
  v_cvt_pk_bf16_f32 v54, v24, v25
  v_cvt_pk_bf16_f32 v55, v26, v27
  v_lshlrev_b32 v24, 16, v54
  v_and_b32 v25, s54, v54
  v_lshlrev_b32 v26, 16, v55
  v_and_b32 v27, s54, v55
  global_store_dwordx2 v14, v[54:55], s[16:17] offset:512
  v_cvt_pk_bf16_f32 v40, v28, v29
  v_cvt_pk_bf16_f32 v41, v30, v31
  v_lshlrev_b32 v28, 16, v40
  v_and_b32 v29, s54, v40
  v_lshlrev_b32 v30, 16, v41
  v_and_b32 v31, s54, v41
  v_lshlrev_b32 v42, 16, v186
  v_and_b32 v43, s54, v186
  v_lshlrev_b32 v44, 16, v187
  v_and_b32 v45, s54, v187
  v_add_f32 v28, v28, v42
  v_add_f32 v29, v29, v43
  v_add_f32 v30, v30, v44
  v_add_f32 v31, v31, v45
  v_cvt_pk_bf16_f32 v56, v28, v29
  v_cvt_pk_bf16_f32 v57, v30, v31
  v_lshlrev_b32 v28, 16, v56
  v_and_b32 v29, s54, v56
  v_lshlrev_b32 v30, 16, v57
  v_and_b32 v31, s54, v57
  global_store_dwordx2 v14, v[56:57], s[16:17] offset:768
  v_cvt_pk_bf16_f32 v40, v32, v33
  v_cvt_pk_bf16_f32 v41, v34, v35
  v_lshlrev_b32 v32, 16, v40
  v_and_b32 v33, s54, v40
  v_lshlrev_b32 v34, 16, v41
  v_and_b32 v35, s54, v41
  v_lshlrev_b32 v42, 16, v188
  v_and_b32 v43, s54, v188
  v_lshlrev_b32 v44, 16, v189
  v_and_b32 v45, s54, v189
  v_add_f32 v32, v32, v42
  v_add_f32 v33, v33, v43
  v_add_f32 v34, v34, v44
  v_add_f32 v35, v35, v45
  v_cvt_pk_bf16_f32 v58, v32, v33
  v_cvt_pk_bf16_f32 v59, v34, v35
  v_lshlrev_b32 v32, 16, v58
  v_and_b32 v33, s54, v58
  v_lshlrev_b32 v34, 16, v59
  v_and_b32 v35, s54, v59
  global_store_dwordx2 v14, v[58:59], s[16:17] offset:1024
  v_add_f32 v60, v16, v17
  v_add_f32 v60, v60, v18
  v_add_f32 v60, v60, v19
  v_add_f32 v60, v60, v20
  v_add_f32 v60, v60, v21
  v_add_f32 v60, v60, v22
  v_add_f32 v60, v60, v23
  v_add_f32 v60, v60, v24
  v_add_f32 v60, v60, v25
  v_add_f32 v60, v60, v26
  v_add_f32 v60, v60, v27
  v_add_f32 v60, v60, v28
  v_add_f32 v60, v60, v29
  v_add_f32 v60, v60, v30
  v_add_f32 v60, v60, v31
  v_add_f32 v60, v60, v32
  v_add_f32 v60, v60, v33
  v_add_f32 v60, v60, v34
  v_add_f32 v60, v60, v35
  s_nop 1
  v_add_f32_dpp v60, v60, v60 quad_perm:[1,0,3,2] row_mask:0xf bank_mask:0xf
  s_nop 1
  v_add_f32_dpp v60, v60, v60 quad_perm:[2,3,0,1] row_mask:0xf bank_mask:0xf
  s_nop 1
  v_add_f32_dpp v60, v60, v60 row_ror:4 row_mask:0xf bank_mask:0xf
  s_nop 1
  v_add_f32_dpp v60, v60, v60 row_ror:8 row_mask:0xf bank_mask:0xf
  s_nop 1
  v_mov_b32 v61, v60
  s_nop 1
  v_permlane16_swap_b32 v60, v61
  v_add_f32 v60, v60, v61
  v_mul_f32 v60, 0x3acccccd, v60
  v_mov_b32 v62, 0
  v_sub_f32 v63, v16, v60
  v_fmac_f32 v62, v63, v63
  v_sub_f32 v63, v17, v60
  v_fmac_f32 v62, v63, v63
  v_sub_f32 v63, v18, v60
  v_fmac_f32 v62, v63, v63
  v_sub_f32 v63, v19, v60
  v_fmac_f32 v62, v63, v63
  v_sub_f32 v63, v20, v60
  v_fmac_f32 v62, v63, v63
  v_sub_f32 v63, v21, v60
  v_fmac_f32 v62, v63, v63
  v_sub_f32 v63, v22, v60
  v_fmac_f32 v62, v63, v63
  v_sub_f32 v63, v23, v60
  v_fmac_f32 v62, v63, v63
  v_sub_f32 v63, v24, v60
  v_fmac_f32 v62, v63, v63
  v_sub_f32 v63, v25, v60
  v_fmac_f32 v62, v63, v63
  v_sub_f32 v63, v26, v60
  v_fmac_f32 v62, v63, v63
  v_sub_f32 v63, v27, v60
  v_fmac_f32 v62, v63, v63
  v_sub_f32 v63, v28, v60
  v_fmac_f32 v62, v63, v63
  v_sub_f32 v63, v29, v60
  v_fmac_f32 v62, v63, v63
  v_sub_f32 v63, v30, v60
  v_fmac_f32 v62, v63, v63
  v_sub_f32 v63, v31, v60
  v_fmac_f32 v62, v63, v63
  v_sub_f32 v63, v32, v60
  v_fmac_f32 v62, v63, v63
  v_sub_f32 v63, v33, v60
  v_fmac_f32 v62, v63, v63
  v_sub_f32 v63, v34, v60
  v_fmac_f32 v62, v63, v63
  v_sub_f32 v63, v35, v60
  v_fmac_f32 v62, v63, v63
  s_nop 1
  v_add_f32_dpp v62, v62, v62 quad_perm:[1,0,3,2] row_mask:0xf bank_mask:0xf
  s_nop 1
  v_add_f32_dpp v62, v62, v62 quad_perm:[2,3,0,1] row_mask:0xf bank_mask:0xf
  s_nop 1
  v_add_f32_dpp v62, v62, v62 row_ror:4 row_mask:0xf bank_mask:0xf
  s_nop 1
  v_add_f32_dpp v62, v62, v62 row_ror:8 row_mask:0xf bank_mask:0xf
  s_nop 1
  v_mov_b32 v61, v62
  s_nop 1
  v_permlane16_swap_b32 v62, v61
  v_add_f32 v62, v62, v61
  v_mul_f32 v62, 0x3acccccd, v62
  v_cvt_pk_bf16_f32 v64, v60, v62
  v_lshlrev_b32 v60, 16, v64
  v_and_b32 v62, s54, v64
  v_add_f32 v62, 0x3727c5ac, v62
  v_cvt_pk_bf16_f32 v64, v62, v62
  v_lshlrev_b32 v62, 16, v64
  v_sqrt_f32 v62, v62
  s_nop 0
  v_cvt_pk_bf16_f32 v64, v62, v62
  v_lshlrev_b32 v62, 16, v64
  v_rcp_f32 v63, v62
  s_nop 0
  v_fma_f32 v64, -v62, v63, 1.0
  v_fma_f32 v63, v64, v63, v63
  v_lshrrev_b32 v65, 4, v13
  v_mul_u32_u24 v65, 20480, v65
  v_and_b32 v66, 15, v13
  v_lshl_add_u32 v65, v66, 4, v65
  v_lshrrev_b32 v66, 3, v11
  v_lshl_add_u32 v65, v66, 10, v65
  v_bfe_u32 v66, v11, 1, 2
  v_lshl_add_u32 v65, v66, 8, v65
  v_and_b32 v66, 1, v11
  v_lshl_add_u32 v65, v66, 3, v65
  s_add_u32 s18, s6, 0x7400000
  s_addc_u32 s19, s7, 0
  v_sub_f32 v16, v16, v60
  v_sub_f32 v17, v17, v60
  v_sub_f32 v18, v18, v60
  v_sub_f32 v19, v19, v60
  v_cvt_pk_bf16_f32 v40, v16, v17
  v_cvt_pk_bf16_f32 v41, v18, v19
  v_lshlrev_b32 v16, 16, v40
  v_and_b32 v17, s54, v40
  v_lshlrev_b32 v18, 16, v41
  v_and_b32 v19, s54, v41
  v_mul_f32 v16, v16, v63
  v_mul_f32 v17, v17, v63
  v_mul_f32 v18, v18, v63
  v_mul_f32 v19, v19, v63
  v_cvt_pk_bf16_f32 v70, v16, v17
  v_cvt_pk_bf16_f32 v71, v18, v19
  global_store_dwordx2 v65, v[70:71], s[18:19]
  v_add_u32 v65, 0x1000, v65
  v_sub_f32 v20, v20, v60
  v_sub_f32 v21, v21, v60
  v_sub_f32 v22, v22, v60
  v_sub_f32 v23, v23, v60
  v_cvt_pk_bf16_f32 v40, v20, v21
  v_cvt_pk_bf16_f32 v41, v22, v23
  v_lshlrev_b32 v20, 16, v40
  v_and_b32 v21, s54, v40
  v_lshlrev_b32 v22, 16, v41
  v_and_b32 v23, s54, v41
  v_mul_f32 v20, v20, v63
  v_mul_f32 v21, v21, v63
  v_mul_f32 v22, v22, v63
  v_mul_f32 v23, v23, v63
  v_cvt_pk_bf16_f32 v72, v20, v21
  v_cvt_pk_bf16_f32 v73, v22, v23
  global_store_dwordx2 v65, v[72:73], s[18:19]
  v_add_u32 v65, 0x1000, v65
  v_sub_f32 v24, v24, v60
  v_sub_f32 v25, v25, v60
  v_sub_f32 v26, v26, v60
  v_sub_f32 v27, v27, v60
  v_cvt_pk_bf16_f32 v40, v24, v25
  v_cvt_pk_bf16_f32 v41, v26, v27
  v_lshlrev_b32 v24, 16, v40
  v_and_b32 v25, s54, v40
  v_lshlrev_b32 v26, 16, v41
  v_and_b32 v27, s54, v41
  v_mul_f32 v24, v24, v63
  v_mul_f32 v25, v25, v63
  v_mul_f32 v26, v26, v63
  v_mul_f32 v27, v27, v63
  v_cvt_pk_bf16_f32 v74, v24, v25
  v_cvt_pk_bf16_f32 v75, v26, v27
  global_store_dwordx2 v65, v[74:75], s[18:19]
  v_add_u32 v65, 0x1000, v65
  v_sub_f32 v28, v28, v60
  v_sub_f32 v29, v29, v60
  v_sub_f32 v30, v30, v60
  v_sub_f32 v31, v31, v60
  v_cvt_pk_bf16_f32 v40, v28, v29
  v_cvt_pk_bf16_f32 v41, v30, v31
  v_lshlrev_b32 v28, 16, v40
  v_and_b32 v29, s54, v40
  v_lshlrev_b32 v30, 16, v41
  v_and_b32 v31, s54, v41
  v_mul_f32 v28, v28, v63
  v_mul_f32 v29, v29, v63
  v_mul_f32 v30, v30, v63
  v_mul_f32 v31, v31, v63
  v_cvt_pk_bf16_f32 v76, v28, v29
  v_cvt_pk_bf16_f32 v77, v30, v31
  global_store_dwordx2 v65, v[76:77], s[18:19]
  v_add_u32 v65, 0x1000, v65
  v_sub_f32 v32, v32, v60
  v_sub_f32 v33, v33, v60
  v_sub_f32 v34, v34, v60
  v_sub_f32 v35, v35, v60
  v_cvt_pk_bf16_f32 v40, v32, v33
  v_cvt_pk_bf16_f32 v41, v34, v35
  v_lshlrev_b32 v32, 16, v40
  v_and_b32 v33, s54, v40
  v_lshlrev_b32 v34, 16, v41
  v_and_b32 v35, s54, v41
  v_mul_f32 v32, v32, v63
  v_mul_f32 v33, v33, v63
  v_mul_f32 v34, v34, v63
  v_mul_f32 v35, v35, v63
  v_cvt_pk_bf16_f32 v78, v32, v33
  v_cvt_pk_bf16_f32 v79, v34, v35
  global_store_dwordx2 v65, v[78:79], s[18:19]
  v_add_u32 v65, 0x1000, v65
awl_done:
  s_endpgm
.globl ffn1_kernel
.p2align 8
.type ffn1_kernel,@function
ffn1_kernel:
  s_cmp_ge_u32 s2, 108
  s_cbranch_scc1 ffn1_kernel_done
  s_load_dwordx2 s[6:7], s[0:1], 104
  s_load_dwordx2 s[4:5], s[0:1], 0
  s_load_dwordx2 s[8:9], s[0:1], 88
  v_lshrrev_b32 v5, 6, v0
  v_and_b32 v6, 63, v0
  s_nop 0
  v_readfirstlane_b32 s22, v5
  v_lshlrev_b32 v1, 4, v6
  s_mul_i32 s21, s2, 16384
  s_lshr_b32 s21, s21, 16
  s_mul_i32 s14, s21, 4
  s_sub_u32 s20, s2, s14
  s_add_u32 s20, s20, 12
  s_mov_b32 s19, 0
  s_waitcnt lgkmcnt(0)
  s_lshr_b32 s23, s22, 1
  s_and_b32 s24, s22, 1
  s_add_u32 s25, s22, 0
  s_mul_i32 s26, s20, 8
  s_add_u32 s26, s26, s25
  s_mul_i32 s26, s26, 20480
  s_add_u32 s26, s26, 0x7400000
  s_mul_i32 s27, s21, 8
  s_add_u32 s27, s27, s25
  s_sub_u32 s27, s27, 8
  s_mul_i32 s27, s27, 20480
  s_add_u32 s27, s27, 0x1700000
  s_cmp_lt_u32 s25, 8
  s_cselect_b32 s26, s26, s27
  s_add_u32 s40, s6, s26
  s_addc_u32 s41, s7, 0
  s_add_u32 s25, s22, 4
  s_mul_i32 s26, s20, 8
  s_add_u32 s26, s26, s25
  s_mul_i32 s26, s26, 20480
  s_add_u32 s26, s26, 0x7400000
  s_mul_i32 s27, s21, 8
  s_add_u32 s27, s27, s25
  s_sub_u32 s27, s27, 8
  s_mul_i32 s27, s27, 20480
  s_add_u32 s27, s27, 0x1700000
  s_cmp_lt_u32 s25, 8
  s_cselect_b32 s26, s26, s27
  s_add_u32 s42, s6, s26
  s_addc_u32 s43, s7, 0
  s_add_u32 s25, s22, 8
  s_mul_i32 s26, s20, 8
  s_add_u32 s26, s26, s25
  s_mul_i32 s26, s26, 20480
  s_add_u32 s26, s26, 0x7400000
  s_mul_i32 s27, s21, 8
  s_add_u32 s27, s27, s25
  s_sub_u32 s27, s27, 8
  s_mul_i32 s27, s27, 20480
  s_add_u32 s27, s27, 0x1700000
  s_cmp_lt_u32 s25, 8
  s_cselect_b32 s26, s26, s27
  s_add_u32 s44, s6, s26
  s_addc_u32 s45, s7, 0
  s_add_u32 s25, s22, 12
  s_mul_i32 s26, s20, 8
  s_add_u32 s26, s26, s25
  s_mul_i32 s26, s26, 20480
  s_add_u32 s26, s26, 0x7400000
  s_mul_i32 s27, s21, 8
  s_add_u32 s27, s27, s25
  s_sub_u32 s27, s27, 8
  s_mul_i32 s27, s27, 20480
  s_add_u32 s27, s27, 0x1700000
  s_cmp_lt_u32 s25, 8
  s_cselect_b32 s26, s26, s27
  s_add_u32 s46, s6, s26
  s_addc_u32 s47, s7, 0
  s_mul_i32 s28, s22, 1024
  s_mul_i32 s25, s19, 0
  v_add_u32 v2, s25, v1
  s_mul_i32 s29, s23, 4096
  s_mul_i32 s30, s24, 4096
  s_add_u32 s30, s30, 8192
  s_mov_b32 s31, 0
  s_mov_b32 s32, 0
  s_add_u32 s33, s32, s28
  s_add_u32 m0, s33, 0
  s_nop 0
  global_load_lds_dwordx4 v2, s[40:41]
  s_add_u32 m0, s33, 4096
  s_nop 0
  global_load_lds_dwordx4 v2, s[42:43]
  s_add_u32 m0, s33, 8192
  s_nop 0
  global_load_lds_dwordx4 v2, s[44:45]
  s_add_u32 m0, s33, 12288
  s_nop 0
  global_load_lds_dwordx4 v2, s[46:47]
  v_add_u32 v2, 1024, v2
  s_add_u32 s32, s32, 16384
  s_cmp_ge_u32 s32, 65536
  s_cselect_b32 s32, 0, s32
  s_add_u32 s33, s32, s28
  s_add_u32 m0, s33, 0
  s_nop 0
  global_load_lds_dwordx4 v2, s[40:41]
  s_add_u32 m0, s33, 4096
  s_nop 0
  global_load_lds_dwordx4 v2, s[42:43]
  s_add_u32 m0, s33, 8192
  s_nop 0
  global_load_lds_dwordx4 v2, s[44:45]
  s_add_u32 m0, s33, 12288
  s_nop 0
  global_load_lds_dwordx4 v2, s[46:47]
  v_add_u32 v2, 1024, v2
  s_add_u32 s32, s32, 16384
  s_cmp_ge_u32 s32, 65536
  s_cselect_b32 s32, 0, s32
  s_add_u32 s33, s32, s28
  s_add_u32 m0, s33, 0
  s_nop 0
  global_load_lds_dwordx4 v2, s[40:41]
  s_add_u32 m0, s33, 4096
  s_nop 0
  global_load_lds_dwordx4 v2, s[42:43]
  s_add_u32 m0, s33, 8192
  s_nop 0
  global_load_lds_dwordx4 v2, s[44:45]
  s_add_u32 m0, s33, 12288
  s_nop 0
  global_load_lds_dwordx4 v2, s[46:47]
  v_add_u32 v2, 1024, v2
  s_add_u32 s32, s32, 16384
  s_cmp_ge_u32 s32, 65536
  s_cselect_b32 s32, 0, s32
  s_add_u32 s33, s32, s28
  s_add_u32 m0, s33, 0
  s_nop 0
  global_load_lds_dwordx4 v2, s[40:41]
  s_add_u32 m0, s33, 4096
  s_nop 0
  global_load_lds_dwordx4 v2, s[42:43]
  s_add_u32 m0, s33, 8192
  s_nop 0
  global_load_lds_dwordx4 v2, s[44:45]
  s_add_u32 m0, s33, 12288
  s_nop 0
  global_load_lds_dwordx4 v2, s[46:47]
  v_add_u32 v2, 1024, v2
  s_add_u32 s32, s32, 16384
  s_cmp_ge_u32 s32, 65536
  s_cselect_b32 s32, 0, s32
  v_accvgpr_write_b32 a0, 0
  v_accvgpr_write_b32 a1, 0
  v_accvgpr_write_b32 a2, 0
  v_accvgpr_write_b32 a3, 0
  v_accvgpr_write_b32 a4, 0
  v_accvgpr_write_b32 a5, 0
  v_accvgpr_write_b32 a6, 0
  v_accvgpr_write_b32 a7, 0
  v_accvgpr_write_b32 a8, 0
  v_accvgpr_write_b32 a9, 0
  v_accvgpr_write_b32 a10, 0
  v_accvgpr_write_b32 a11, 0
  v_accvgpr_write_b32 a12, 0
  v_accvgpr_write_b32 a13, 0
  v_accvgpr_write_b32 a14, 0
  v_accvgpr_write_b32 a15, 0
  v_accvgpr_write_b32 a16, 0
  v_accvgpr_write_b32 a17, 0
  v_accvgpr_write_b32 a18, 0
  v_accvgpr_write_b32 a19, 0
  v_accvgpr_write_b32 a20, 0
  v_accvgpr_write_b32 a21, 0
  v_accvgpr_write_b32 a22, 0
  v_accvgpr_write_b32 a23, 0
  v_accvgpr_write_b32 a24, 0
  v_accvgpr_write_b32 a25, 0
  v_accvgpr_write_b32 a26, 0
  v_accvgpr_write_b32 a27, 0
  v_accvgpr_write_b32 a28, 0
  v_accvgpr_write_b32 a29, 0
  v_accvgpr_write_b32 a30, 0
  v_accvgpr_write_b32 a31, 0
  v_accvgpr_write_b32 a32, 0
  v_accvgpr_write_b32 a33, 0
  v_accvgpr_write_b32 a34, 0
  v_accvgpr_write_b32 a35, 0
  v_accvgpr_write_b32 a36, 0
  v_accvgpr_write_b32 a37, 0
  v_accvgpr_write_b32 a38, 0
  v_accvgpr_write_b32 a39, 0
  v_accvgpr_write_b32 a40, 0
  v_accvgpr_write_b32 a41, 0
  v_accvgpr_write_b32 a42, 0
  v_accvgpr_write_b32 a43, 0
  v_accvgpr_write_b32 a44, 0
  v_accvgpr_write_b32 a45, 0
  v_accvgpr_write_b32 a46, 0
  v_accvgpr_write_b32 a47, 0
  v_accvgpr_write_b32 a48, 0
  v_accvgpr_write_b32 a49, 0
  v_accvgpr_write_b32 a50, 0
  v_accvgpr_write_b32 a51, 0
  v_accvgpr_write_b32 a52, 0
  v_accvgpr_write_b32 a53, 0
  v_accvgpr_write_b32 a54, 0
  v_accvgpr_write_b32 a55, 0
  v_accvgpr_write_b32 a56, 0
  v_accvgpr_write_b32 a57, 0
  v_accvgpr_write_b32 a58, 0
  v_accvgpr_write_b32 a59, 0
  v_accvgpr_write_b32 a60, 0
  v_accvgpr_write_b32 a61, 0
  v_accvgpr_write_b32 a62, 0
  v_accvgpr_write_b32 a63, 0
  s_waitcnt vmcnt(12)
  s_barrier
  s_add_u32 s34, s31, s29
  s_add_u32 s35, s31, s30
  v_add_u32 v3, s34, v1
  v_add_u32 v4, s35, v1
  ds_read_b128 v[8:11], v4 offset:0
  ds_read_b128 v[12:15], v4 offset:1024
  ds_read_b128 v[16:19], v4 offset:2048
  ds_read_b128 v[20:23], v4 offset:3072
  ds_read_b128 v[24:27], v3 offset:0
  ds_read_b128 v[28:31], v3 offset:1024
  ds_read_b128 v[32:35], v3 offset:2048
  ds_read_b128 v[36:39], v3 offset:3072
  s_add_u32 s31, s31, 16384
  s_cmp_ge_u32 s31, 65536
  s_cselect_b32 s31, 0, s31
  s_mov_b32 s36, 0
ffn1_kernel_loop:
  s_waitcnt vmcnt(8) lgkmcnt(0)
  s_barrier
  v_mfma_f32_16x16x32_bf16 a[0:3], v[8:11], v[24:27], a[0:3]
  s_add_u32 s34, s31, s29
  s_add_u32 s35, s31, s30
  v_add_u32 v3, s34, v1
  v_add_u32 v4, s35, v1
  v_mfma_f32_16x16x32_bf16 a[4:7], v[12:15], v[24:27], a[4:7]
  ds_read_b128 v[40:43], v4 offset:0
  v_mfma_f32_16x16x32_bf16 a[8:11], v[16:19], v[24:27], a[8:11]
  ds_read_b128 v[44:47], v4 offset:1024
  v_mfma_f32_16x16x32_bf16 a[12:15], v[20:23], v[24:27], a[12:15]
  ds_read_b128 v[48:51], v4 offset:2048
  v_mfma_f32_16x16x32_bf16 a[16:19], v[8:11], v[28:31], a[16:19]
  ds_read_b128 v[52:55], v4 offset:3072
  v_mfma_f32_16x16x32_bf16 a[20:23], v[12:15], v[28:31], a[20:23]
  ds_read_b128 v[56:59], v3 offset:0
  v_mfma_f32_16x16x32_bf16 a[24:27], v[16:19], v[28:31], a[24:27]
  ds_read_b128 v[60:63], v3 offset:1024
  v_mfma_f32_16x16x32_bf16 a[28:31], v[20:23], v[28:31], a[28:31]
  ds_read_b128 v[64:67], v3 offset:2048
  v_mfma_f32_16x16x32_bf16 a[32:35], v[8:11], v[32:35], a[32:35]
  ds_read_b128 v[68:71], v3 offset:3072
  v_mfma_f32_16x16x32_bf16 a[36:39], v[12:15], v[32:35], a[36:39]
  s_add_u32 s31, s31, 16384
  s_cmp_ge_u32 s31, 65536
  s_cselect_b32 s31, 0, s31
  v_mfma_f32_16x16x32_bf16 a[40:43], v[16:19], v[32:35], a[40:43]
  s_add_u32 s33, s32, s28
  v_mfma_f32_16x16x32_bf16 a[44:47], v[20:23], v[32:35], a[44:47]
  s_add_u32 m0, s33, 0
  s_nop 0
  global_load_lds_dwordx4 v2, s[40:41]
  v_mfma_f32_16x16x32_bf16 a[48:51], v[8:11], v[36:39], a[48:51]
  s_add_u32 m0, s33, 4096
  s_nop 0
  global_load_lds_dwordx4 v2, s[42:43]
  v_mfma_f32_16x16x32_bf16 a[52:55], v[12:15], v[36:39], a[52:55]
  s_add_u32 m0, s33, 8192
  s_nop 0
  global_load_lds_dwordx4 v2, s[44:45]
  v_mfma_f32_16x16x32_bf16 a[56:59], v[16:19], v[36:39], a[56:59]
  s_add_u32 m0, s33, 12288
  s_nop 0
  global_load_lds_dwordx4 v2, s[46:47]
  v_mfma_f32_16x16x32_bf16 a[60:63], v[20:23], v[36:39], a[60:63]
  v_add_u32 v2, 1024, v2
  s_add_u32 s32, s32, 16384
  s_cmp_ge_u32 s32, 65536
  s_cselect_b32 s32, 0, s32
  s_waitcnt vmcnt(8) lgkmcnt(0)
  s_barrier
  v_mfma_f32_16x16x32_bf16 a[0:3], v[40:43], v[56:59], a[0:3]
  s_add_u32 s34, s31, s29
  s_add_u32 s35, s31, s30
  v_add_u32 v3, s34, v1
  v_add_u32 v4, s35, v1
  v_mfma_f32_16x16x32_bf16 a[4:7], v[44:47], v[56:59], a[4:7]
  ds_read_b128 v[8:11], v4 offset:0
  v_mfma_f32_16x16x32_bf16 a[8:11], v[48:51], v[56:59], a[8:11]
  ds_read_b128 v[12:15], v4 offset:1024
  v_mfma_f32_16x16x32_bf16 a[12:15], v[52:55], v[56:59], a[12:15]
  ds_read_b128 v[16:19], v4 offset:2048
  v_mfma_f32_16x16x32_bf16 a[16:19], v[40:43], v[60:63], a[16:19]
  ds_read_b128 v[20:23], v4 offset:3072
  v_mfma_f32_16x16x32_bf16 a[20:23], v[44:47], v[60:63], a[20:23]
  ds_read_b128 v[24:27], v3 offset:0
  v_mfma_f32_16x16x32_bf16 a[24:27], v[48:51], v[60:63], a[24:27]
  ds_read_b128 v[28:31], v3 offset:1024
  v_mfma_f32_16x16x32_bf16 a[28:31], v[52:55], v[60:63], a[28:31]
  ds_read_b128 v[32:35], v3 offset:2048
  v_mfma_f32_16x16x32_bf16 a[32:35], v[40:43], v[64:67], a[32:35]
  ds_read_b128 v[36:39], v3 offset:3072
  v_mfma_f32_16x16x32_bf16 a[36:39], v[44:47], v[64:67], a[36:39]
  s_add_u32 s31, s31, 16384
  s_cmp_ge_u32 s31, 65536
  s_cselect_b32 s31, 0, s31
  v_mfma_f32_16x16x32_bf16 a[40:43], v[48:51], v[64:67], a[40:43]
  s_add_u32 s33, s32, s28
  v_mfma_f32_16x16x32_bf16 a[44:47], v[52:55], v[64:67], a[44:47]
  s_add_u32 m0, s33, 0
  s_nop 0
  global_load_lds_dwordx4 v2, s[40:41]
  v_mfma_f32_16x16x32_bf16 a[48:51], v[40:43], v[68:71], a[48:51]
  s_add_u32 m0, s33, 4096
  s_nop 0
  global_load_lds_dwordx4 v2, s[42:43]
  v_mfma_f32_16x16x32_bf16 a[52:55], v[44:47], v[68:71], a[52:55]
  s_add_u32 m0, s33, 8192
  s_nop 0
  global_load_lds_dwordx4 v2, s[44:45]
  v_mfma_f32_16x16x32_bf16 a[56:59], v[48:51], v[68:71], a[56:59]
  s_add_u32 m0, s33, 12288
  s_nop 0
  global_load_lds_dwordx4 v2, s[46:47]
  v_mfma_f32_16x16x32_bf16 a[60:63], v[52:55], v[68:71], a[60:63]
  v_add_u32 v2, 1024, v2
  s_add_u32 s32, s32, 16384
  s_cmp_ge_u32 s32, 65536
  s_cselect_b32 s32, 0, s32
  s_add_u32 s36, s36, 2
  s_cmp_lt_u32 s36, 16
  s_cbranch_scc1 ffn1_kernel_loop
  s_waitcnt vmcnt(8) lgkmcnt(0)
  s_barrier
  v_mfma_f32_16x16x32_bf16 a[0:3], v[8:11], v[24:27], a[0:3]
  s_add_u32 s34, s31, s29
  s_add_u32 s35, s31, s30
  v_add_u32 v3, s34, v1
  v_add_u32 v4, s35, v1
  v_mfma_f32_16x16x32_bf16 a[4:7], v[12:15], v[24:27], a[4:7]
  ds_read_b128 v[40:43], v4 offset:0
  v_mfma_f32_16x16x32_bf16 a[8:11], v[16:19], v[24:27], a[8:11]
  v_mfma_f32_16x16x32_bf16 a[12:15], v[20:23], v[24:27], a[12:15]
  ds_read_b128 v[44:47], v4 offset:1024
  v_mfma_f32_16x16x32_bf16 a[16:19], v[8:11], v[28:31], a[16:19]
  ds_read_b128 v[48:51], v4 offset:2048
  v_mfma_f32_16x16x32_bf16 a[20:23], v[12:15], v[28:31], a[20:23]
  v_mfma_f32_16x16x32_bf16 a[24:27], v[16:19], v[28:31], a[24:27]
  ds_read_b128 v[52:55], v4 offset:3072
  v_mfma_f32_16x16x32_bf16 a[28:31], v[20:23], v[28:31], a[28:31]
  v_mfma_f32_16x16x32_bf16 a[32:35], v[8:11], v[32:35], a[32:35]
  ds_read_b128 v[56:59], v3 offset:0
  v_mfma_f32_16x16x32_bf16 a[36:39], v[12:15], v[32:35], a[36:39]
  ds_read_b128 v[60:63], v3 offset:1024
  v_mfma_f32_16x16x32_bf16 a[40:43], v[16:19], v[32:35], a[40:43]
  v_mfma_f32_16x16x32_bf16 a[44:47], v[20:23], v[32:35], a[44:47]
  ds_read_b128 v[64:67], v3 offset:2048
  v_mfma_f32_16x16x32_bf16 a[48:51], v[8:11], v[36:39], a[48:51]
  ds_read_b128 v[68:71], v3 offset:3072
  v_mfma_f32_16x16x32_bf16 a[52:55], v[12:15], v[36:39], a[52:55]
  v_mfma_f32_16x16x32_bf16 a[56:59], v[16:19], v[36:39], a[56:59]
  s_add_u32 s31, s31, 16384
  s_cmp_ge_u32 s31, 65536
  s_cselect_b32 s31, 0, s31
  v_mfma_f32_16x16x32_bf16 a[60:63], v[20:23], v[36:39], a[60:63]
  s_waitcnt vmcnt(4) lgkmcnt(0)
  s_barrier
  v_mfma_f32_16x16x32_bf16 a[0:3], v[40:43], v[56:59], a[0:3]
  s_add_u32 s34, s31, s29
  s_add_u32 s35, s31, s30
  v_add_u32 v3, s34, v1
  v_add_u32 v4, s35, v1
  v_mfma_f32_16x16x32_bf16 a[4:7], v[44:47], v[56:59], a[4:7]
  ds_read_b128 v[8:11], v4 offset:0
  v_mfma_f32_16x16x32_bf16 a[8:11], v[48:51], v[56:59], a[8:11]
  v_mfma_f32_16x16x32_bf16 a[12:15], v[52:55], v[56:59], a[12:15]
  ds_read_b128 v[12:15], v4 offset:1024
  v_mfma_f32_16x16x32_bf16 a[16:19], v[40:43], v[60:63], a[16:19]
  ds_read_b128 v[16:19], v4 offset:2048
  v_mfma_f32_16x16x32_bf16 a[20:23], v[44:47], v[60:63], a[20:23]
  v_mfma_f32_16x16x32_bf16 a[24:27], v[48:51], v[60:63], a[24:27]
  ds_read_b128 v[20:23], v4 offset:3072
  v_mfma_f32_16x16x32_bf16 a[28:31], v[52:55], v[60:63], a[28:31]
  v_mfma_f32_16x16x32_bf16 a[32:35], v[40:43], v[64:67], a[32:35]
  ds_read_b128 v[24:27], v3 offset:0
  v_mfma_f32_16x16x32_bf16 a[36:39], v[44:47], v[64:67], a[36:39]
  ds_read_b128 v[28:31], v3 offset:1024
  v_mfma_f32_16x16x32_bf16 a[40:43], v[48:51], v[64:67], a[40:43]
  v_mfma_f32_16x16x32_bf16 a[44:47], v[52:55], v[64:67], a[44:47]
  ds_read_b128 v[32:35], v3 offset:2048
  v_mfma_f32_16x16x32_bf16 a[48:51], v[40:43], v[68:71], a[48:51]
  ds_read_b128 v[36:39], v3 offset:3072
  v_mfma_f32_16x16x32_bf16 a[52:55], v[44:47], v[68:71], a[52:55]
  v_mfma_f32_16x16x32_bf16 a[56:59], v[48:51], v[68:71], a[56:59]
  s_add_u32 s31, s31, 16384
  s_cmp_ge_u32 s31, 65536
  s_cselect_b32 s31, 0, s31
  v_mfma_f32_16x16x32_bf16 a[60:63], v[52:55], v[68:71], a[60:63]
  s_waitcnt vmcnt(0) lgkmcnt(0)
  s_barrier
  v_mfma_f32_16x16x32_bf16 a[0:3], v[8:11], v[24:27], a[0:3]
  s_add_u32 s34, s31, s29
  s_add_u32 s35, s31, s30
  v_add_u32 v3, s34, v1
  v_add_u32 v4, s35, v1
  v_mfma_f32_16x16x32_bf16 a[4:7], v[12:15], v[24:27], a[4:7]
  ds_read_b128 v[40:43], v4 offset:0
  v_mfma_f32_16x16x32_bf16 a[8:11], v[16:19], v[24:27], a[8:11]
  v_mfma_f32_16x16x32_bf16 a[12:15], v[20:23], v[24:27], a[12:15]
  ds_read_b128 v[44:47], v4 offset:1024
  v_mfma_f32_16x16x32_bf16 a[16:19], v[8:11], v[28:31], a[16:19]
  ds_read_b128 v[48:51], v4 offset:2048
  v_mfma_f32_16x16x32_bf16 a[20:23], v[12:15], v[28:31], a[20:23]
  v_mfma_f32_16x16x32_bf16 a[24:27], v[16:19], v[28:31], a[24:27]
  ds_read_b128 v[52:55], v4 offset:3072
  v_mfma_f32_16x16x32_bf16 a[28:31], v[20:23], v[28:31], a[28:31]
  v_mfma_f32_16x16x32_bf16 a[32:35], v[8:11], v[32:35], a[32:35]
  ds_read_b128 v[56:59], v3 offset:0
  v_mfma_f32_16x16x32_bf16 a[36:39], v[12:15], v[32:35], a[36:39]
  ds_read_b128 v[60:63], v3 offset:1024
  v_mfma_f32_16x16x32_bf16 a[40:43], v[16:19], v[32:35], a[40:43]
  v_mfma_f32_16x16x32_bf16 a[44:47], v[20:23], v[32:35], a[44:47]
  ds_read_b128 v[64:67], v3 offset:2048
  v_mfma_f32_16x16x32_bf16 a[48:51], v[8:11], v[36:39], a[48:51]
  ds_read_b128 v[68:71], v3 offset:3072
  v_mfma_f32_16x16x32_bf16 a[52:55], v[12:15], v[36:39], a[52:55]
  v_mfma_f32_16x16x32_bf16 a[56:59], v[16:19], v[36:39], a[56:59]
  s_add_u32 s31, s31, 16384
  s_cmp_ge_u32 s31, 65536
  s_cselect_b32 s31, 0, s31
  v_mfma_f32_16x16x32_bf16 a[60:63], v[20:23], v[36:39], a[60:63]
  s_waitcnt lgkmcnt(0)
  v_mfma_f32_16x16x32_bf16 a[0:3], v[40:43], v[56:59], a[0:3]
  v_mfma_f32_16x16x32_bf16 a[4:7], v[44:47], v[56:59], a[4:7]
  v_mfma_f32_16x16x32_bf16 a[8:11], v[48:51], v[56:59], a[8:11]
  v_mfma_f32_16x16x32_bf16 a[12:15], v[52:55], v[56:59], a[12:15]
  v_mfma_f32_16x16x32_bf16 a[16:19], v[40:43], v[60:63], a[16:19]
  v_mfma_f32_16x16x32_bf16 a[20:23], v[44:47], v[60:63], a[20:23]
  v_mfma_f32_16x16x32_bf16 a[24:27], v[48:51], v[60:63], a[24:27]
  v_mfma_f32_16x16x32_bf16 a[28:31], v[52:55], v[60:63], a[28:31]
  v_mfma_f32_16x16x32_bf16 a[32:35], v[40:43], v[64:67], a[32:35]
  v_mfma_f32_16x16x32_bf16 a[36:39], v[44:47], v[64:67], a[36:39]
  v_mfma_f32_16x16x32_bf16 a[40:43], v[48:51], v[64:67], a[40:43]
  v_mfma_f32_16x16x32_bf16 a[44:47], v[52:55], v[64:67], a[44:47]
  v_mfma_f32_16x16x32_bf16 a[48:51], v[40:43], v[68:71], a[48:51]
  v_mfma_f32_16x16x32_bf16 a[52:55], v[44:47], v[68:71], a[52:55]
  v_mfma_f32_16x16x32_bf16 a[56:59], v[48:51], v[68:71], a[56:59]
  v_mfma_f32_16x16x32_bf16 a[60:63], v[52:55], v[68:71], a[60:63]
  s_nop 7
  s_nop 3
  s_lshl_b32 s10, s20, 3
  s_lshl_b32 s11, s23, 2
  s_add_u32 s10, s10, s11
  s_mul_i32 s10, s10, 54
  s_lshl_b32 s11, s21, 1
  s_add_u32 s10, s10, s11
  s_add_u32 s10, s10, s24
  s_lshl_b32 s10, s10, 10
  s_add_u32 s10, s10, 0x7800000
  s_add_u32 s14, s6, s10
  s_addc_u32 s15, s7, 0
  s_mov_b32 s54, 0xffff0000
  v_accvgpr_read_b32 v8, a0
  v_accvgpr_read_b32 v12, a8
  v_accvgpr_read_b32 v9, a1
  v_accvgpr_read_b32 v13, a9
  v_accvgpr_read_b32 v10, a2
  v_accvgpr_read_b32 v14, a10
  v_accvgpr_read_b32 v11, a3
  v_accvgpr_read_b32 v15, a11
  v_cvt_pk_bf16_f32 v16, v8, v9
  v_cvt_pk_bf16_f32 v17, v10, v11
  v_cvt_pk_bf16_f32 v18, v12, v13
  v_cvt_pk_bf16_f32 v19, v14, v15
  v_lshlrev_b32 v8, 16, v16
  v_and_b32 v9, s54, v16
  v_lshlrev_b32 v10, 16, v17
  v_and_b32 v11, s54, v17
  v_lshlrev_b32 v12, 16, v18
  v_and_b32 v13, s54, v18
  v_lshlrev_b32 v14, 16, v19
  v_and_b32 v15, s54, v19
  v_max_f32 v8, 0, v8
  v_max_f32 v9, 0, v9
  v_max_f32 v10, 0, v10
  v_max_f32 v11, 0, v11
  v_mul_f32 v8, v8, v12
  v_mul_f32 v9, v9, v13
  v_mul_f32 v10, v10, v14
  v_mul_f32 v11, v11, v15
  v_cvt_pk_bf16_f32 v20, v8, v9
  v_cvt_pk_bf16_f32 v21, v10, v11
  v_accvgpr_read_b32 v8, a4
  v_accvgpr_read_b32 v12, a12
  v_accvgpr_read_b32 v9, a5
  v_accvgpr_read_b32 v13, a13
  v_accvgpr_read_b32 v10, a6
  v_accvgpr_read_b32 v14, a14
  v_accvgpr_read_b32 v11, a7
  v_accvgpr_read_b32 v15, a15
  v_cvt_pk_bf16_f32 v16, v8, v9
  v_cvt_pk_bf16_f32 v17, v10, v11
  v_cvt_pk_bf16_f32 v18, v12, v13
  v_cvt_pk_bf16_f32 v19, v14, v15
  v_lshlrev_b32 v8, 16, v16
  v_and_b32 v9, s54, v16
  v_lshlrev_b32 v10, 16, v17
  v_and_b32 v11, s54, v17
  v_lshlrev_b32 v12, 16, v18
  v_and_b32 v13, s54, v18
  v_lshlrev_b32 v14, 16, v19
  v_and_b32 v15, s54, v19
  v_max_f32 v8, 0, v8
  v_max_f32 v9, 0, v9
  v_max_f32 v10, 0, v10
  v_max_f32 v11, 0, v11
  v_mul_f32 v8, v8, v12
  v_mul_f32 v9, v9, v13
  v_mul_f32 v10, v10, v14
  v_mul_f32 v11, v11, v15
  v_cvt_pk_bf16_f32 v22, v8, v9
  v_cvt_pk_bf16_f32 v23, v10, v11
  global_store_dwordx4 v1, v[20:23], s[14:15]
  s_add_u32 s14, s14, 55296
  s_addc_u32 s15, s15, 0
  v_accvgpr_read_b32 v8, a16
  v_accvgpr_read_b32 v12, a24
  v_accvgpr_read_b32 v9, a17
  v_accvgpr_read_b32 v13, a25
  v_accvgpr_read_b32 v10, a18
  v_accvgpr_read_b32 v14, a26
  v_accvgpr_read_b32 v11, a19
  v_accvgpr_read_b32 v15, a27
  v_cvt_pk_bf16_f32 v16, v8, v9
  v_cvt_pk_bf16_f32 v17, v10, v11
  v_cvt_pk_bf16_f32 v18, v12, v13
  v_cvt_pk_bf16_f32 v19, v14, v15
  v_lshlrev_b32 v8, 16, v16
  v_and_b32 v9, s54, v16
  v_lshlrev_b32 v10, 16, v17
  v_and_b32 v11, s54, v17
  v_lshlrev_b32 v12, 16, v18
  v_and_b32 v13, s54, v18
  v_lshlrev_b32 v14, 16, v19
  v_and_b32 v15, s54, v19
  v_max_f32 v8, 0, v8
  v_max_f32 v9, 0, v9
  v_max_f32 v10, 0, v10
  v_max_f32 v11, 0, v11
  v_mul_f32 v8, v8, v12
  v_mul_f32 v9, v9, v13
  v_mul_f32 v10, v10, v14
  v_mul_f32 v11, v11, v15
  v_cvt_pk_bf16_f32 v24, v8, v9
  v_cvt_pk_bf16_f32 v25, v10, v11
  v_accvgpr_read_b32 v8, a20
  v_accvgpr_read_b32 v12, a28
  v_accvgpr_read_b32 v9, a21
  v_accvgpr_read_b32 v13, a29
  v_accvgpr_read_b32 v10, a22
  v_accvgpr_read_b32 v14, a30
  v_accvgpr_read_b32 v11, a23
  v_accvgpr_read_b32 v15, a31
  v_cvt_pk_bf16_f32 v16, v8, v9
  v_cvt_pk_bf16_f32 v17, v10, v11
  v_cvt_pk_bf16_f32 v18, v12, v13
  v_cvt_pk_bf16_f32 v19, v14, v15
  v_lshlrev_b32 v8, 16, v16
  v_and_b32 v9, s54, v16
  v_lshlrev_b32 v10, 16, v17
  v_and_b32 v11, s54, v17
  v_lshlrev_b32 v12, 16, v18
  v_and_b32 v13, s54, v18
  v_lshlrev_b32 v14, 16, v19
  v_and_b32 v15, s54, v19
  v_max_f32 v8, 0, v8
  v_max_f32 v9, 0, v9
  v_max_f32 v10, 0, v10
  v_max_f32 v11, 0, v11
  v_mul_f32 v8, v8, v12
  v_mul_f32 v9, v9, v13
  v_mul_f32 v10, v10, v14
  v_mul_f32 v11, v11, v15
  v_cvt_pk_bf16_f32 v26, v8, v9
  v_cvt_pk_bf16_f32 v27, v10, v11
  global_store_dwordx4 v1, v[24:27], s[14:15]
  s_add_u32 s14, s14, 55296
  s_addc_u32 s15, s15, 0
  v_accvgpr_read_b32 v8, a32
  v_accvgpr_read_b32 v12, a40
  v_accvgpr_read_b32 v9, a33
  v_accvgpr_read_b32 v13, a41
  v_accvgpr_read_b32 v10, a34
  v_accvgpr_read_b32 v14, a42
  v_accvgpr_read_b32 v11, a35
  v_accvgpr_read_b32 v15, a43
  v_cvt_pk_bf16_f32 v16, v8, v9
  v_cvt_pk_bf16_f32 v17, v10, v11
  v_cvt_pk_bf16_f32 v18, v12, v13
  v_cvt_pk_bf16_f32 v19, v14, v15
  v_lshlrev_b32 v8, 16, v16
  v_and_b32 v9, s54, v16
  v_lshlrev_b32 v10, 16, v17
  v_and_b32 v11, s54, v17
  v_lshlrev_b32 v12, 16, v18
  v_and_b32 v13, s54, v18
  v_lshlrev_b32 v14, 16, v19
  v_and_b32 v15, s54, v19
  v_max_f32 v8, 0, v8
  v_max_f32 v9, 0, v9
  v_max_f32 v10, 0, v10
  v_max_f32 v11, 0, v11
  v_mul_f32 v8, v8, v12
  v_mul_f32 v9, v9, v13
  v_mul_f32 v10, v10, v14
  v_mul_f32 v11, v11, v15
  v_cvt_pk_bf16_f32 v20, v8, v9
  v_cvt_pk_bf16_f32 v21, v10, v11
  v_accvgpr_read_b32 v8, a36
  v_accvgpr_read_b32 v12, a44
  v_accvgpr_read_b32 v9, a37
  v_accvgpr_read_b32 v13, a45
  v_accvgpr_read_b32 v10, a38
  v_accvgpr_read_b32 v14, a46
  v_accvgpr_read_b32 v11, a39
  v_accvgpr_read_b32 v15, a47
  v_cvt_pk_bf16_f32 v16, v8, v9
  v_cvt_pk_bf16_f32 v17, v10, v11
  v_cvt_pk_bf16_f32 v18, v12, v13
  v_cvt_pk_bf16_f32 v19, v14, v15
  v_lshlrev_b32 v8, 16, v16
  v_and_b32 v9, s54, v16
  v_lshlrev_b32 v10, 16, v17
  v_and_b32 v11, s54, v17
  v_lshlrev_b32 v12, 16, v18
  v_and_b32 v13, s54, v18
  v_lshlrev_b32 v14, 16, v19
  v_and_b32 v15, s54, v19
  v_max_f32 v8, 0, v8
  v_max_f32 v9, 0, v9
  v_max_f32 v10, 0, v10
  v_max_f32 v11, 0, v11
  v_mul_f32 v8, v8, v12
  v_mul_f32 v9, v9, v13
  v_mul_f32 v10, v10, v14
  v_mul_f32 v11, v11, v15
  v_cvt_pk_bf16_f32 v22, v8, v9
  v_cvt_pk_bf16_f32 v23, v10, v11
  global_store_dwordx4 v1, v[20:23], s[14:15]
  s_add_u32 s14, s14, 55296
  s_addc_u32 s15, s15, 0
  v_accvgpr_read_b32 v8, a48
  v_accvgpr_read_b32 v12, a56
  v_accvgpr_read_b32 v9, a49
  v_accvgpr_read_b32 v13, a57
  v_accvgpr_read_b32 v10, a50
  v_accvgpr_read_b32 v14, a58
  v_accvgpr_read_b32 v11, a51
  v_accvgpr_read_b32 v15, a59
  v_cvt_pk_bf16_f32 v16, v8, v9
  v_cvt_pk_bf16_f32 v17, v10, v11
  v_cvt_pk_bf16_f32 v18, v12, v13
  v_cvt_pk_bf16_f32 v19, v14, v15
  v_lshlrev_b32 v8, 16, v16
  v_and_b32 v9, s54, v16
  v_lshlrev_b32 v10, 16, v17
  v_and_b32 v11, s54, v17
  v_lshlrev_b32 v12, 16, v18
  v_and_b32 v13, s54, v18
  v_lshlrev_b32 v14, 16, v19
  v_and_b32 v15, s54, v19
  v_max_f32 v8, 0, v8
  v_max_f32 v9, 0, v9
  v_max_f32 v10, 0, v10
  v_max_f32 v11, 0, v11
  v_mul_f32 v8, v8, v12
  v_mul_f32 v9, v9, v13
  v_mul_f32 v10, v10, v14
  v_mul_f32 v11, v11, v15
  v_cvt_pk_bf16_f32 v24, v8, v9
  v_cvt_pk_bf16_f32 v25, v10, v11
  v_accvgpr_read_b32 v8, a52
  v_accvgpr_read_b32 v12, a60
  v_accvgpr_read_b32 v9, a53
  v_accvgpr_read_b32 v13, a61
  v_accvgpr_read_b32 v10, a54
  v_accvgpr_read_b32 v14, a62
  v_accvgpr_read_b32 v11, a55
  v_accvgpr_read_b32 v15, a63
  v_cvt_pk_bf16_f32 v16, v8, v9
  v_cvt_pk_bf16_f32 v17, v10, v11
  v_cvt_pk_bf16_f32 v18, v12, v13
  v_cvt_pk_bf16_f32 v19, v14, v15
  v_lshlrev_b32 v8, 16, v16
  v_and_b32 v9, s54, v16
  v_lshlrev_b32 v10, 16, v17
  v_and_b32 v11, s54, v17
  v_lshlrev_b32 v12, 16, v18
  v_and_b32 v13, s54, v18
  v_lshlrev_b32 v14, 16, v19
  v_and_b32 v15, s54, v19
  v_max_f32 v8, 0, v8
  v_max_f32 v9, 0, v9
  v_max_f32 v10, 0, v10
  v_max_f32 v11, 0, v11
  v_mul_f32 v8, v8, v12
  v_mul_f32 v9, v9, v13
  v_mul_f32 v10, v10, v14
  v_mul_f32 v11, v11, v15
  v_cvt_pk_bf16_f32 v26, v8, v9
  v_cvt_pk_bf16_f32 v27, v10, v11
  global_store_dwordx4 v1, v[24:27], s[14:15]
  s_add_u32 s14, s14, 55296
  s_addc_u32 s15, s15, 0
ffn1_kernel_done:
  s_endpgm
.globl ffn2_kernel
.p2align 8
.type ffn2_kernel,@function
ffn2_kernel:
  s_cmp_ge_u32 s2, 60
  s_cbranch_scc1 ffn2_kernel_done
  s_load_dwordx2 s[6:7], s[0:1], 104
  s_load_dwordx2 s[4:5], s[0:1], 0
  s_load_dwordx2 s[8:9], s[0:1], 88
  v_lshrrev_b32 v5, 6, v0
  v_and_b32 v6, 63, v0
  s_nop 0
  v_readfirstlane_b32 s22, v5
  v_lshlrev_b32 v1, 4, v6
  s_mul_i32 s13, s2, 16384
  s_lshr_b32 s13, s13, 16
  s_mul_i32 s14, s13, 4
  s_sub_u32 s20, s2, s14
  s_add_u32 s20, s20, 12
  s_mul_i32 s19, s13, 52429
  s_lshr_b32 s19, s19, 18
  s_mul_i32 s14, s19, 5
  s_sub_u32 s21, s13, s14
  s_waitcnt lgkmcnt(0)
  s_lshr_b32 s23, s22, 1
  s_and_b32 s24, s22, 1
  s_add_u32 s25, s22, 0
  s_mul_i32 s26, s20, 8
  s_add_u32 s26, s26, s25
  s_mul_i32 s26, s26, 55296
  s_add_u32 s26, s26, 0x7800000
  s_mul_i32 s27, s21, 8
  s_add_u32 s27, s27, s25
  s_sub_u32 s27, s27, 8
  s_mul_i32 s27, s27, 55296
  s_add_u32 s27, s27, 0x1b40000
  s_cmp_lt_u32 s25, 8
  s_cselect_b32 s26, s26, s27
  s_add_u32 s40, s6, s26
  s_addc_u32 s41, s7, 0
  s_add_u32 s25, s22, 4
  s_mul_i32 s26, s20, 8
  s_add_u32 s26, s26, s25
  s_mul_i32 s26, s26, 55296
  s_add_u32 s26, s26, 0x7800000
  s_mul_i32 s27, s21, 8
  s_add_u32 s27, s27, s25
  s_sub_u32 s27, s27, 8
  s_mul_i32 s27, s27, 55296
  s_add_u32 s27, s27, 0x1b40000
  s_cmp_lt_u32 s25, 8
  s_cselect_b32 s26, s26, s27
  s_add_u32 s42, s6, s26
  s_addc_u32 s43, s7, 0
  s_add_u32 s25, s22, 8
  s_mul_i32 s26, s20, 8
  s_add_u32 s26, s26, s25
  s_mul_i32 s26, s26, 55296
  s_add_u32 s26, s26, 0x7800000
  s_mul_i32 s27, s21, 8
  s_add_u32 s27, s27, s25
  s_sub_u32 s27, s27, 8
  s_mul_i32 s27, s27, 55296
  s_add_u32 s27, s27, 0x1b40000
  s_cmp_lt_u32 s25, 8
  s_cselect_b32 s26, s26, s27
  s_add_u32 s44, s6, s26
  s_addc_u32 s45, s7, 0
  s_add_u32 s25, s22, 12
  s_mul_i32 s26, s20, 8
  s_add_u32 s26, s26, s25
  s_mul_i32 s26, s26, 55296
  s_add_u32 s26, s26, 0x7800000
  s_mul_i32 s27, s21, 8
  s_add_u32 s27, s27, s25
  s_sub_u32 s27, s27, 8
  s_mul_i32 s27, s27, 55296
  s_add_u32 s27, s27, 0x1b40000
  s_cmp_lt_u32 s25, 8
  s_cselect_b32 s26, s26, s27
  s_add_u32 s46, s6, s26
  s_addc_u32 s47, s7, 0
  s_mul_i32 s28, s22, 1024
  s_mul_i32 s25, s19, 18432
  v_add_u32 v2, s25, v1
  s_mul_i32 s29, s23, 4096
  s_mul_i32 s30, s24, 4096
  s_add_u32 s30, s30, 8192
  s_mov_b32 s31, 0
  s_mov_b32 s32, 0
  s_add_u32 s33, s32, s28
  s_add_u32 m0, s33, 0
  s_nop 0
  global_load_lds_dwordx4 v2, s[40:41]
  s_add_u32 m0, s33, 4096
  s_nop 0
  global_load_lds_dwordx4 v2, s[42:43]
  s_add_u32 m0, s33, 8192
  s_nop 0
  global_load_lds_dwordx4 v2, s[44:45]
  s_add_u32 m0, s33, 12288
  s_nop 0
  global_load_lds_dwordx4 v2, s[46:47]
  v_add_u32 v2, 1024, v2
  s_add_u32 s32, s32, 16384
  s_cmp_ge_u32 s32, 65536
  s_cselect_b32 s32, 0, s32
  s_add_u32 s33, s32, s28
  s_add_u32 m0, s33, 0
  s_nop 0
  global_load_lds_dwordx4 v2, s[40:41]
  s_add_u32 m0, s33, 4096
  s_nop 0
  global_load_lds_dwordx4 v2, s[42:43]
  s_add_u32 m0, s33, 8192
  s_nop 0
  global_load_lds_dwordx4 v2, s[44:45]
  s_add_u32 m0, s33, 12288
  s_nop 0
  global_load_lds_dwordx4 v2, s[46:47]
  v_add_u32 v2, 1024, v2
  s_add_u32 s32, s32, 16384
  s_cmp_ge_u32 s32, 65536
  s_cselect_b32 s32, 0, s32
  s_add_u32 s33, s32, s28
  s_add_u32 m0, s33, 0
  s_nop 0
  global_load_lds_dwordx4 v2, s[40:41]
  s_add_u32 m0, s33, 4096
  s_nop 0
  global_load_lds_dwordx4 v2, s[42:43]
  s_add_u32 m0, s33, 8192
  s_nop 0
  global_load_lds_dwordx4 v2, s[44:45]
  s_add_u32 m0, s33, 12288
  s_nop 0
  global_load_lds_dwordx4 v2, s[46:47]
  v_add_u32 v2, 1024, v2
  s_add_u32 s32, s32, 16384
  s_cmp_ge_u32 s32, 65536
  s_cselect_b32 s32, 0, s32
  s_add_u32 s33, s32, s28
  s_add_u32 m0, s33, 0
  s_nop 0
  global_load_lds_dwordx4 v2, s[40:41]
  s_add_u32 m0, s33, 4096
  s_nop 0
  global_load_lds_dwordx4 v2, s[42:43]
  s_add_u32 m0, s33, 8192
  s_nop 0
  global_load_lds_dwordx4 v2, s[44:45]
  s_add_u32 m0, s33, 12288
  s_nop 0
  global_load_lds_dwordx4 v2, s[46:47]
  v_add_u32 v2, 1024, v2
  s_add_u32 s32, s32, 16384
  s_cmp_ge_u32 s32, 65536
  s_cselect_b32 s32, 0, s32
  v_accvgpr_write_b32 a0, 0
  v_accvgpr_write_b32 a1, 0
  v_accvgpr_write_b32 a2, 0
  v_accvgpr_write_b32 a3, 0
  v_accvgpr_write_b32 a4, 0
  v_accvgpr_write_b32 a5, 0
  v_accvgpr_write_b32 a6, 0
  v_accvgpr_write_b32 a7, 0
  v_accvgpr_write_b32 a8, 0
  v_accvgpr_write_b32 a9, 0
  v_accvgpr_write_b32 a10, 0
  v_accvgpr_write_b32 a11, 0
  v_accvgpr_write_b32 a12, 0
  v_accvgpr_write_b32 a13, 0
  v_accvgpr_write_b32 a14, 0
  v_accvgpr_write_b32 a15, 0
  v_accvgpr_write_b32 a16, 0
  v_accvgpr_write_b32 a17, 0
  v_accvgpr_write_b32 a18, 0
  v_accvgpr_write_b32 a19, 0
  v_accvgpr_write_b32 a20, 0
  v_accvgpr_write_b32 a21, 0
  v_accvgpr_write_b32 a22, 0
  v_accvgpr_write_b32 a23, 0
  v_accvgpr_write_b32 a24, 0
  v_accvgpr_write_b32 a25, 0
  v_accvgpr_write_b32 a26, 0
  v_accvgpr_write_b32 a27, 0
  v_accvgpr_write_b32 a28, 0
  v_accvgpr_write_b32 a29, 0
  v_accvgpr_write_b32 a30, 0
  v_accvgpr_write_b32 a31, 0
  v_accvgpr_write_b32 a32, 0
  v_accvgpr_write_b32 a33, 0
  v_accvgpr_write_b32 a34, 0
  v_accvgpr_write_b32 a35, 0
  v_accvgpr_write_b32 a36, 0
  v_accvgpr_write_b32 a37, 0
  v_accvgpr_write_b32 a38, 0
  v_accvgpr_write_b32 a39, 0
  v_accvgpr_write_b32 a40, 0
  v_accvgpr_write_b32 a41, 0
  v_accvgpr_write_b32 a42, 0
  v_accvgpr_write_b32 a43, 0
  v_accvgpr_write_b32 a44, 0
  v_accvgpr_write_b32 a45, 0
  v_accvgpr_write_b32 a46, 0
  v_accvgpr_write_b32 a47, 0
  v_accvgpr_write_b32 a48, 0
  v_accvgpr_write_b32 a49, 0
  v_accvgpr_write_b32 a50, 0
  v_accvgpr_write_b32 a51, 0
  v_accvgpr_write_b32 a52, 0
  v_accvgpr_write_b32 a53, 0
  v_accvgpr_write_b32 a54, 0
  v_accvgpr_write_b32 a55, 0
  v_accvgpr_write_b32 a56, 0
  v_accvgpr_write_b32 a57, 0
  v_accvgpr_write_b32 a58, 0
  v_accvgpr_write_b32 a59, 0
  v_accvgpr_write_b32 a60, 0
  v_accvgpr_write_b32 a61, 0
  v_accvgpr_write_b32 a62, 0
  v_accvgpr_write_b32 a63, 0
  s_waitcnt vmcnt(12)
  s_barrier
  s_add_u32 s34, s31, s29
  s_add_u32 s35, s31, s30
  v_add_u32 v3, s34, v1
  v_add_u32 v4, s35, v1
  ds_read_b128 v[8:11], v4 offset:0
  ds_read_b128 v[12:15], v4 offset:1024
  ds_read_b128 v[16:19], v4 offset:2048
  ds_read_b128 v[20:23], v4 offset:3072
  ds_read_b128 v[24:27], v3 offset:0
  ds_read_b128 v[28:31], v3 offset:1024
  ds_read_b128 v[32:35], v3 offset:2048
  ds_read_b128 v[36:39], v3 offset:3072
  s_add_u32 s31, s31, 16384
  s_cmp_ge_u32 s31, 65536
  s_cselect_b32 s31, 0, s31
  s_mov_b32 s36, 0
ffn2_kernel_loop:
  s_waitcnt vmcnt(8) lgkmcnt(0)
  s_barrier
  v_mfma_f32_16x16x32_bf16 a[0:3], v[8:11], v[24:27], a[0:3]
  s_add_u32 s34, s31, s29
  s_add_u32 s35, s31, s30
  v_add_u32 v3, s34, v1
  v_add_u32 v4, s35, v1
  v_mfma_f32_16x16x32_bf16 a[4:7], v[12:15], v[24:27], a[4:7]
  ds_read_b128 v[40:43], v4 offset:0
  v_mfma_f32_16x16x32_bf16 a[8:11], v[16:19], v[24:27], a[8:11]
  ds_read_b128 v[44:47], v4 offset:1024
  v_mfma_f32_16x16x32_bf16 a[12:15], v[20:23], v[24:27], a[12:15]
  ds_read_b128 v[48:51], v4 offset:2048
  v_mfma_f32_16x16x32_bf16 a[16:19], v[8:11], v[28:31], a[16:19]
  ds_read_b128 v[52:55], v4 offset:3072
  v_mfma_f32_16x16x32_bf16 a[20:23], v[12:15], v[28:31], a[20:23]
  ds_read_b128 v[56:59], v3 offset:0
  v_mfma_f32_16x16x32_bf16 a[24:27], v[16:19], v[28:31], a[24:27]
  ds_read_b128 v[60:63], v3 offset:1024
  v_mfma_f32_16x16x32_bf16 a[28:31], v[20:23], v[28:31], a[28:31]
  ds_read_b128 v[64:67], v3 offset:2048
  v_mfma_f32_16x16x32_bf16 a[32:35], v[8:11], v[32:35], a[32:35]
  ds_read_b128 v[68:71], v3 offset:3072
  v_mfma_f32_16x16x32_bf16 a[36:39], v[12:15], v[32:35], a[36:39]
  s_add_u32 s31, s31, 16384
  s_cmp_ge_u32 s31, 65536
  s_cselect_b32 s31, 0, s31
  v_mfma_f32_16x16x32_bf16 a[40:43], v[16:19], v[32:35], a[40:43]
  s_add_u32 s33, s32, s28
  v_mfma_f32_16x16x32_bf16 a[44:47], v[20:23], v[32:35], a[44:47]
  s_add_u32 m0, s33, 0
  s_nop 0
  global_load_lds_dwordx4 v2, s[40:41]
  v_mfma_f32_16x16x32_bf16 a[48:51], v[8:11], v[36:39], a[48:51]
  s_add_u32 m0, s33, 4096
  s_nop 0
  global_load_lds_dwordx4 v2, s[42:43]
  v_mfma_f32_16x16x32_bf16 a[52:55], v[12:15], v[36:39], a[52:55]
  s_add_u32 m0, s33, 8192
  s_nop 0
  global_load_lds_dwordx4 v2, s[44:45]
  v_mfma_f32_16x16x32_bf16 a[56:59], v[16:19], v[36:39], a[56:59]
  s_add_u32 m0, s33, 12288
  s_nop 0
  global_load_lds_dwordx4 v2, s[46:47]
  v_mfma_f32_16x16x32_bf16 a[60:63], v[20:23], v[36:39], a[60:63]
  v_add_u32 v2, 1024, v2
  s_add_u32 s32, s32, 16384
  s_cmp_ge_u32 s32, 65536
  s_cselect_b32 s32, 0, s32
  s_waitcnt vmcnt(8) lgkmcnt(0)
  s_barrier
  v_mfma_f32_16x16x32_bf16 a[0:3], v[40:43], v[56:59], a[0:3]
  s_add_u32 s34, s31, s29
  s_add_u32 s35, s31, s30
  v_add_u32 v3, s34, v1
  v_add_u32 v4, s35, v1
  v_mfma_f32_16x16x32_bf16 a[4:7], v[44:47], v[56:59], a[4:7]
  ds_read_b128 v[8:11], v4 offset:0
  v_mfma_f32_16x16x32_bf16 a[8:11], v[48:51], v[56:59], a[8:11]
  ds_read_b128 v[12:15], v4 offset:1024
  v_mfma_f32_16x16x32_bf16 a[12:15], v[52:55], v[56:59], a[12:15]
  ds_read_b128 v[16:19], v4 offset:2048
  v_mfma_f32_16x16x32_bf16 a[16:19], v[40:43], v[60:63], a[16:19]
  ds_read_b128 v[20:23], v4 offset:3072
  v_mfma_f32_16x16x32_bf16 a[20:23], v[44:47], v[60:63], a[20:23]
  ds_read_b128 v[24:27], v3 offset:0
  v_mfma_f32_16x16x32_bf16 a[24:27], v[48:51], v[60:63], a[24:27]
  ds_read_b128 v[28:31], v3 offset:1024
  v_mfma_f32_16x16x32_bf16 a[28:31], v[52:55], v[60:63], a[28:31]
  ds_read_b128 v[32:35], v3 offset:2048
  v_mfma_f32_16x16x32_bf16 a[32:35], v[40:43], v[64:67], a[32:35]
  ds_read_b128 v[36:39], v3 offset:3072
  v_mfma_f32_16x16x32_bf16 a[36:39], v[44:47], v[64:67], a[36:39]
  s_add_u32 s31, s31, 16384
  s_cmp_ge_u32 s31, 65536
  s_cselect_b32 s31, 0, s31
  v_mfma_f32_16x16x32_bf16 a[40:43], v[48:51], v[64:67], a[40:43]
  s_add_u32 s33, s32, s28
  v_mfma_f32_16x16x32_bf16 a[44:47], v[52:55], v[64:67], a[44:47]
  s_add_u32 m0, s33, 0
  s_nop 0
  global_load_lds_dwordx4 v2, s[40:41]
  v_mfma_f32_16x16x32_bf16 a[48:51], v[40:43], v[68:71], a[48:51]
  s_add_u32 m0, s33, 4096
  s_nop 0
  global_load_lds_dwordx4 v2, s[42:43]
  v_mfma_f32_16x16x32_bf16 a[52:55], v[44:47], v[68:71], a[52:55]
  s_add_u32 m0, s33, 8192
  s_nop 0
  global_load_lds_dwordx4 v2, s[44:45]
  v_mfma_f32_16x16x32_bf16 a[56:59], v[48:51], v[68:71], a[56:59]
  s_add_u32 m0, s33, 12288
  s_nop 0
  global_load_lds_dwordx4 v2, s[46:47]
  v_mfma_f32_16x16x32_bf16 a[60:63], v[52:55], v[68:71], a[60:63]
  v_add_u32 v2, 1024, v2
  s_add_u32 s32, s32, 16384
  s_cmp_ge_u32 s32, 65536
  s_cselect_b32 s32, 0, s32
  s_add_u32 s36, s36, 2
  s_cmp_lt_u32 s36, 14
  s_cbranch_scc1 ffn2_kernel_loop
  s_waitcnt vmcnt(8) lgkmcnt(0)
  s_barrier
  v_mfma_f32_16x16x32_bf16 a[0:3], v[8:11], v[24:27], a[0:3]
  s_add_u32 s34, s31, s29
  s_add_u32 s35, s31, s30
  v_add_u32 v3, s34, v1
  v_add_u32 v4, s35, v1
  v_mfma_f32_16x16x32_bf16 a[4:7], v[12:15], v[24:27], a[4:7]
  ds_read_b128 v[40:43], v4 offset:0
  v_mfma_f32_16x16x32_bf16 a[8:11], v[16:19], v[24:27], a[8:11]
  v_mfma_f32_16x16x32_bf16 a[12:15], v[20:23], v[24:27], a[12:15]
  ds_read_b128 v[44:47], v4 offset:1024
  v_mfma_f32_16x16x32_bf16 a[16:19], v[8:11], v[28:31], a[16:19]
  ds_read_b128 v[48:51], v4 offset:2048
  v_mfma_f32_16x16x32_bf16 a[20:23], v[12:15], v[28:31], a[20:23]
  v_mfma_f32_16x16x32_bf16 a[24:27], v[16:19], v[28:31], a[24:27]
  ds_read_b128 v[52:55], v4 offset:3072
  v_mfma_f32_16x16x32_bf16 a[28:31], v[20:23], v[28:31], a[28:31]
  v_mfma_f32_16x16x32_bf16 a[32:35], v[8:11], v[32:35], a[32:35]
  ds_read_b128 v[56:59], v3 offset:0
  v_mfma_f32_16x16x32_bf16 a[36:39], v[12:15], v[32:35], a[36:39]
  ds_read_b128 v[60:63], v3 offset:1024
  v_mfma_f32_16x16x32_bf16 a[40:43], v[16:19], v[32:35], a[40:43]
  v_mfma_f32_16x16x32_bf16 a[44:47], v[20:23], v[32:35], a[44:47]
  ds_read_b128 v[64:67], v3 offset:2048
  v_mfma_f32_16x16x32_bf16 a[48:51], v[8:11], v[36:39], a[48:51]
  ds_read_b128 v[68:71], v3 offset:3072
  v_mfma_f32_16x16x32_bf16 a[52:55], v[12:15], v[36:39], a[52:55]
  v_mfma_f32_16x16x32_bf16 a[56:59], v[16:19], v[36:39], a[56:59]
  s_add_u32 s31, s31, 16384
  s_cmp_ge_u32 s31, 65536
  s_cselect_b32 s31, 0, s31
  v_mfma_f32_16x16x32_bf16 a[60:63], v[20:23], v[36:39], a[60:63]
  s_waitcnt vmcnt(4) lgkmcnt(0)
  s_barrier
  v_mfma_f32_16x16x32_bf16 a[0:3], v[40:43], v[56:59], a[0:3]
  s_add_u32 s34, s31, s29
  s_add_u32 s35, s31, s30
  v_add_u32 v3, s34, v1
  v_add_u32 v4, s35, v1
  v_mfma_f32_16x16x32_bf16 a[4:7], v[44:47], v[56:59], a[4:7]
  ds_read_b128 v[8:11], v4 offset:0
  v_mfma_f32_16x16x32_bf16 a[8:11], v[48:51], v[56:59], a[8:11]
  v_mfma_f32_16x16x32_bf16 a[12:15], v[52:55], v[56:59], a[12:15]
  ds_read_b128 v[12:15], v4 offset:1024
  v_mfma_f32_16x16x32_bf16 a[16:19], v[40:43], v[60:63], a[16:19]
  ds_read_b128 v[16:19], v4 offset:2048
  v_mfma_f32_16x16x32_bf16 a[20:23], v[44:47], v[60:63], a[20:23]
  v_mfma_f32_16x16x32_bf16 a[24:27], v[48:51], v[60:63], a[24:27]
  ds_read_b128 v[20:23], v4 offset:3072
  v_mfma_f32_16x16x32_bf16 a[28:31], v[52:55], v[60:63], a[28:31]
  v_mfma_f32_16x16x32_bf16 a[32:35], v[40:43], v[64:67], a[32:35]
  ds_read_b128 v[24:27], v3 offset:0
  v_mfma_f32_16x16x32_bf16 a[36:39], v[44:47], v[64:67], a[36:39]
  ds_read_b128 v[28:31], v3 offset:1024
  v_mfma_f32_16x16x32_bf16 a[40:43], v[48:51], v[64:67], a[40:43]
  v_mfma_f32_16x16x32_bf16 a[44:47], v[52:55], v[64:67], a[44:47]
  ds_read_b128 v[32:35], v3 offset:2048
  v_mfma_f32_16x16x32_bf16 a[48:51], v[40:43], v[68:71], a[48:51]
  ds_read_b128 v[36:39], v3 offset:3072
  v_mfma_f32_16x16x32_bf16 a[52:55], v[44:47], v[68:71], a[52:55]
  v_mfma_f32_16x16x32_bf16 a[56:59], v[48:51], v[68:71], a[56:59]
  s_add_u32 s31, s31, 16384
  s_cmp_ge_u32 s31, 65536
  s_cselect_b32 s31, 0, s31
  v_mfma_f32_16x16x32_bf16 a[60:63], v[52:55], v[68:71], a[60:63]
  s_waitcnt vmcnt(0) lgkmcnt(0)
  s_barrier
  v_mfma_f32_16x16x32_bf16 a[0:3], v[8:11], v[24:27], a[0:3]
  s_add_u32 s34, s31, s29
  s_add_u32 s35, s31, s30
  v_add_u32 v3, s34, v1
  v_add_u32 v4, s35, v1
  v_mfma_f32_16x16x32_bf16 a[4:7], v[12:15], v[24:27], a[4:7]
  ds_read_b128 v[40:43], v4 offset:0
  v_mfma_f32_16x16x32_bf16 a[8:11], v[16:19], v[24:27], a[8:11]
  v_mfma_f32_16x16x32_bf16 a[12:15], v[20:23], v[24:27], a[12:15]
  ds_read_b128 v[44:47], v4 offset:1024
  v_mfma_f32_16x16x32_bf16 a[16:19], v[8:11], v[28:31], a[16:19]
  ds_read_b128 v[48:51], v4 offset:2048
  v_mfma_f32_16x16x32_bf16 a[20:23], v[12:15], v[28:31], a[20:23]
  v_mfma_f32_16x16x32_bf16 a[24:27], v[16:19], v[28:31], a[24:27]
  ds_read_b128 v[52:55], v4 offset:3072
  v_mfma_f32_16x16x32_bf16 a[28:31], v[20:23], v[28:31], a[28:31]
  v_mfma_f32_16x16x32_bf16 a[32:35], v[8:11], v[32:35], a[32:35]
  ds_read_b128 v[56:59], v3 offset:0
  v_mfma_f32_16x16x32_bf16 a[36:39], v[12:15], v[32:35], a[36:39]
  ds_read_b128 v[60:63], v3 offset:1024
  v_mfma_f32_16x16x32_bf16 a[40:43], v[16:19], v[32:35], a[40:43]
  v_mfma_f32_16x16x32_bf16 a[44:47], v[20:23], v[32:35], a[44:47]
  ds_read_b128 v[64:67], v3 offset:2048
  v_mfma_f32_16x16x32_bf16 a[48:51], v[8:11], v[36:39], a[48:51]
  ds_read_b128 v[68:71], v3 offset:3072
  v_mfma_f32_16x16x32_bf16 a[52:55], v[12:15], v[36:39], a[52:55]
  v_mfma_f32_16x16x32_bf16 a[56:59], v[16:19], v[36:39], a[56:59]
  s_add_u32 s31, s31, 16384
  s_cmp_ge_u32 s31, 65536
  s_cselect_b32 s31, 0, s31
  v_mfma_f32_16x16x32_bf16 a[60:63], v[20:23], v[36:39], a[60:63]
  s_waitcnt lgkmcnt(0)
  v_mfma_f32_16x16x32_bf16 a[0:3], v[40:43], v[56:59], a[0:3]
  v_mfma_f32_16x16x32_bf16 a[4:7], v[44:47], v[56:59], a[4:7]
  v_mfma_f32_16x16x32_bf16 a[8:11], v[48:51], v[56:59], a[8:11]
  v_mfma_f32_16x16x32_bf16 a[12:15], v[52:55], v[56:59], a[12:15]
  v_mfma_f32_16x16x32_bf16 a[16:19], v[40:43], v[60:63], a[16:19]
  v_mfma_f32_16x16x32_bf16 a[20:23], v[44:47], v[60:63], a[20:23]
  v_mfma_f32_16x16x32_bf16 a[24:27], v[48:51], v[60:63], a[24:27]
  v_mfma_f32_16x16x32_bf16 a[28:31], v[52:55], v[60:63], a[28:31]
  v_mfma_f32_16x16x32_bf16 a[32:35], v[40:43], v[64:67], a[32:35]
  v_mfma_f32_16x16x32_bf16 a[36:39], v[44:47], v[64:67], a[36:39]
  v_mfma_f32_16x16x32_bf16 a[40:43], v[48:51], v[64:67], a[40:43]
  v_mfma_f32_16x16x32_bf16 a[44:47], v[52:55], v[64:67], a[44:47]
  v_mfma_f32_16x16x32_bf16 a[48:51], v[40:43], v[68:71], a[48:51]
  v_mfma_f32_16x16x32_bf16 a[52:55], v[44:47], v[68:71], a[52:55]
  v_mfma_f32_16x16x32_bf16 a[56:59], v[48:51], v[68:71], a[56:59]
  v_mfma_f32_16x16x32_bf16 a[60:63], v[52:55], v[68:71], a[60:63]
  s_nop 7
  s_nop 3
  s_mul_i32 s10, s20, 5
  s_add_u32 s10, s10, s21
  s_mul_i32 s11, s10, 196608
  s_mul_i32 s12, s22, 16384
  s_add_u32 s11, s11, s12
  s_add_u32 s11, s11, 0xb000000
  s_add_u32 s14, s6, s11
  s_addc_u32 s15, s7, 0
  s_mul_i32 s12, s19, 65536
  s_add_u32 s16, s14, s12
  s_addc_u32 s17, s15, 0
  v_mov_b32 v5, v1
  global_store_dwordx4 v5, a[0:3], s[16:17] offset:0 sc1
  global_store_dwordx4 v5, a[4:7], s[16:17] offset:1024 sc1
  global_store_dwordx4 v5, a[8:11], s[16:17] offset:2048 sc1
  global_store_dwordx4 v5, a[12:15], s[16:17] offset:3072 sc1
  v_add_u32 v5, 0x1000, v5
  global_store_dwordx4 v5, a[16:19], s[16:17] offset:0 sc1
  global_store_dwordx4 v5, a[20:23], s[16:17] offset:1024 sc1
  global_store_dwordx4 v5, a[24:27], s[16:17] offset:2048 sc1
  global_store_dwordx4 v5, a[28:31], s[16:17] offset:3072 sc1
  v_add_u32 v5, 0x1000, v5
  global_store_dwordx4 v5, a[32:35], s[16:17] offset:0 sc1
  global_store_dwordx4 v5, a[36:39], s[16:17] offset:1024 sc1
  global_store_dwordx4 v5, a[40:43], s[16:17] offset:2048 sc1
  global_store_dwordx4 v5, a[44:47], s[16:17] offset:3072 sc1
  v_add_u32 v5, 0x1000, v5
  global_store_dwordx4 v5, a[48:51], s[16:17] offset:0 sc1
  global_store_dwordx4 v5, a[52:55], s[16:17] offset:1024 sc1
  global_store_dwordx4 v5, a[56:59], s[16:17] offset:2048 sc1
  global_store_dwordx4 v5, a[60:63], s[16:17] offset:3072 sc1
  v_add_u32 v5, 0x1000, v5
  s_waitcnt vmcnt(0)
  s_barrier
  s_cmp_lg_u32 s22, 0
  s_cbranch_scc1 ffn2_kernel_skw
  s_lshl_b32 s12, s10, 2
  s_add_u32 s12, s12, 0x8c00200
  s_add_u32 s16, s6, s12
  s_addc_u32 s17, s7, 0
  v_mov_b32 v8, 0
  v_mov_b32 v9, 1
  s_mov_b64 s[56:57], exec
  s_mov_b64 exec, 1
  global_atomic_add v10, v8, v9, s[16:17] sc0
  s_waitcnt vmcnt(0)
  ds_write_b32 v8, v10
  s_waitcnt lgkmcnt(0)
  s_mov_b64 exec, s[56:57]
ffn2_kernel_skw:
  s_barrier
  v_mov_b32 v8, 0
  ds_read_b32 v10, v8
  s_waitcnt lgkmcnt(0)
  s_nop 0
  v_readfirstlane_b32 s12, v10
  s_nop 3
  s_cmp_lg_u32 s12, 2
  s_cbranch_scc1 ffn2_kernel_done
  v_add_u32 v5, 0, v1
  s_add_u32 s16, s14, 0
  s_addc_u32 s17, s15, 0
  global_load_dwordx4 v[8:11], v5, s[16:17] offset:0 sc1
  global_load_dwordx4 v[12:15], v5, s[16:17] offset:1024 sc1
  global_load_dwordx4 v[16:19], v5, s[16:17] offset:2048 sc1
  global_load_dwordx4 v[20:23], v5, s[16:17] offset:3072 sc1
  s_add_u32 s16, s14, 65536
  s_addc_u32 s17, s15, 0
  global_load_dwordx4 v[24:27], v5, s[16:17] offset:0 sc1
  global_load_dwordx4 v[28:31], v5, s[16:17] offset:1024 sc1
  global_load_dwordx4 v[32:35], v5, s[16:17] offset:2048 sc1
  global_load_dwordx4 v[36:39], v5, s[16:17] offset:3072 sc1
  s_add_u32 s16, s14, 131072
  s_addc_u32 s17, s15, 0
  global_load_dwordx4 v[40:43], v5, s[16:17] offset:0 sc1
  global_load_dwordx4 v[44:47], v5, s[16:17] offset:1024 sc1
  global_load_dwordx4 v[48:51], v5, s[16:17] offset:2048 sc1
  global_load_dwordx4 v[52:55], v5, s[16:17] offset:3072 sc1
  s_waitcnt vmcnt(0)
  v_pk_add_f32 v[8:9], v[8:9], v[24:25]
  v_pk_add_f32 v[10:11], v[10:11], v[26:27]
  v_pk_add_f32 v[12:13], v[12:13], v[28:29]
  v_pk_add_f32 v[14:15], v[14:15], v[30:31]
  v_pk_add_f32 v[16:17], v[16:17], v[32:33]
  v_pk_add_f32 v[18:19], v[18:19], v[34:35]
  v_pk_add_f32 v[20:21], v[20:21], v[36:37]
  v_pk_add_f32 v[22:23], v[22:23], v[38:39]
  v_pk_add_f32 v[8:9], v[8:9], v[40:41]
  v_pk_add_f32 v[10:11], v[10:11], v[42:43]
  v_pk_add_f32 v[12:13], v[12:13], v[44:45]
  v_pk_add_f32 v[14:15], v[14:15], v[46:47]
  v_pk_add_f32 v[16:17], v[16:17], v[48:49]
  v_pk_add_f32 v[18:19], v[18:19], v[50:51]
  v_pk_add_f32 v[20:21], v[20:21], v[52:53]
  v_pk_add_f32 v[22:23], v[22:23], v[54:55]
  v_accvgpr_write_b32 a0, v8
  v_accvgpr_write_b32 a1, v9
  v_accvgpr_write_b32 a2, v10
  v_accvgpr_write_b32 a3, v11
  v_accvgpr_write_b32 a4, v12
  v_accvgpr_write_b32 a5, v13
  v_accvgpr_write_b32 a6, v14
  v_accvgpr_write_b32 a7, v15
  v_accvgpr_write_b32 a8, v16
  v_accvgpr_write_b32 a9, v17
  v_accvgpr_write_b32 a10, v18
  v_accvgpr_write_b32 a11, v19
  v_accvgpr_write_b32 a12, v20
  v_accvgpr_write_b32 a13, v21
  v_accvgpr_write_b32 a14, v22
  v_accvgpr_write_b32 a15, v23
  v_add_u32 v5, 4096, v1
  s_add_u32 s16, s14, 0
  s_addc_u32 s17, s15, 0
  global_load_dwordx4 v[8:11], v5, s[16:17] offset:0 sc1
  global_load_dwordx4 v[12:15], v5, s[16:17] offset:1024 sc1
  global_load_dwordx4 v[16:19], v5, s[16:17] offset:2048 sc1
  global_load_dwordx4 v[20:23], v5, s[16:17] offset:3072 sc1
  s_add_u32 s16, s14, 65536
  s_addc_u32 s17, s15, 0
  global_load_dwordx4 v[24:27], v5, s[16:17] offset:0 sc1
  global_load_dwordx4 v[28:31], v5, s[16:17] offset:1024 sc1
  global_load_dwordx4 v[32:35], v5, s[16:17] offset:2048 sc1
  global_load_dwordx4 v[36:39], v5, s[16:17] offset:3072 sc1
  s_add_u32 s16, s14, 131072
  s_addc_u32 s17, s15, 0
  global_load_dwordx4 v[40:43], v5, s[16:17] offset:0 sc1
  global_load_dwordx4 v[44:47], v5, s[16:17] offset:1024 sc1
  global_load_dwordx4 v[48:51], v5, s[16:17] offset:2048 sc1
  global_load_dwordx4 v[52:55], v5, s[16:17] offset:3072 sc1
  s_waitcnt vmcnt(0)
  v_pk_add_f32 v[8:9], v[8:9], v[24:25]
  v_pk_add_f32 v[10:11], v[10:11], v[26:27]
  v_pk_add_f32 v[12:13], v[12:13], v[28:29]
  v_pk_add_f32 v[14:15], v[14:15], v[30:31]
  v_pk_add_f32 v[16:17], v[16:17], v[32:33]
  v_pk_add_f32 v[18:19], v[18:19], v[34:35]
  v_pk_add_f32 v[20:21], v[20:21], v[36:37]
  v_pk_add_f32 v[22:23], v[22:23], v[38:39]
  v_pk_add_f32 v[8:9], v[8:9], v[40:41]
  v_pk_add_f32 v[10:11], v[10:11], v[42:43]
  v_pk_add_f32 v[12:13], v[12:13], v[44:45]
  v_pk_add_f32 v[14:15], v[14:15], v[46:47]
  v_pk_add_f32 v[16:17], v[16:17], v[48:49]
  v_pk_add_f32 v[18:19], v[18:19], v[50:51]
  v_pk_add_f32 v[20:21], v[20:21], v[52:53]
  v_pk_add_f32 v[22:23], v[22:23], v[54:55]
  v_accvgpr_write_b32 a16, v8
  v_accvgpr_write_b32 a17, v9
  v_accvgpr_write_b32 a18, v10
  v_accvgpr_write_b32 a19, v11
  v_accvgpr_write_b32 a20, v12
  v_accvgpr_write_b32 a21, v13
  v_accvgpr_write_b32 a22, v14
  v_accvgpr_write_b32 a23, v15
  v_accvgpr_write_b32 a24, v16
  v_accvgpr_write_b32 a25, v17
  v_accvgpr_write_b32 a26, v18
  v_accvgpr_write_b32 a27, v19
  v_accvgpr_write_b32 a28, v20
  v_accvgpr_write_b32 a29, v21
  v_accvgpr_write_b32 a30, v22
  v_accvgpr_write_b32 a31, v23
  v_add_u32 v5, 8192, v1
  s_add_u32 s16, s14, 0
  s_addc_u32 s17, s15, 0
  global_load_dwordx4 v[8:11], v5, s[16:17] offset:0 sc1
  global_load_dwordx4 v[12:15], v5, s[16:17] offset:1024 sc1
  global_load_dwordx4 v[16:19], v5, s[16:17] offset:2048 sc1
  global_load_dwordx4 v[20:23], v5, s[16:17] offset:3072 sc1
  s_add_u32 s16, s14, 65536
  s_addc_u32 s17, s15, 0
  global_load_dwordx4 v[24:27], v5, s[16:17] offset:0 sc1
  global_load_dwordx4 v[28:31], v5, s[16:17] offset:1024 sc1
  global_load_dwordx4 v[32:35], v5, s[16:17] offset:2048 sc1
  global_load_dwordx4 v[36:39], v5, s[16:17] offset:3072 sc1
  s_add_u32 s16, s14, 131072
  s_addc_u32 s17, s15, 0
  global_load_dwordx4 v[40:43], v5, s[16:17] offset:0 sc1
  global_load_dwordx4 v[44:47], v5, s[16:17] offset:1024 sc1
  global_load_dwordx4 v[48:51], v5, s[16:17] offset:2048 sc1
  global_load_dwordx4 v[52:55], v5, s[16:17] offset:3072 sc1
  s_waitcnt vmcnt(0)
  v_pk_add_f32 v[8:9], v[8:9], v[24:25]
  v_pk_add_f32 v[10:11], v[10:11], v[26:27]
  v_pk_add_f32 v[12:13], v[12:13], v[28:29]
  v_pk_add_f32 v[14:15], v[14:15], v[30:31]
  v_pk_add_f32 v[16:17], v[16:17], v[32:33]
  v_pk_add_f32 v[18:19], v[18:19], v[34:35]
  v_pk_add_f32 v[20:21], v[20:21], v[36:37]
  v_pk_add_f32 v[22:23], v[22:23], v[38:39]
  v_pk_add_f32 v[8:9], v[8:9], v[40:41]
  v_pk_add_f32 v[10:11], v[10:11], v[42:43]
  v_pk_add_f32 v[12:13], v[12:13], v[44:45]
  v_pk_add_f32 v[14:15], v[14:15], v[46:47]
  v_pk_add_f32 v[16:17], v[16:17], v[48:49]
  v_pk_add_f32 v[18:19], v[18:19], v[50:51]
  v_pk_add_f32 v[20:21], v[20:21], v[52:53]
  v_pk_add_f32 v[22:23], v[22:23], v[54:55]
  v_accvgpr_write_b32 a32, v8
  v_accvgpr_write_b32 a33, v9
  v_accvgpr_write_b32 a34, v10
  v_accvgpr_write_b32 a35, v11
  v_accvgpr_write_b32 a36, v12
  v_accvgpr_write_b32 a37, v13
  v_accvgpr_write_b32 a38, v14
  v_accvgpr_write_b32 a39, v15
  v_accvgpr_write_b32 a40, v16
  v_accvgpr_write_b32 a41, v17
  v_accvgpr_write_b32 a42, v18
  v_accvgpr_write_b32 a43, v19
  v_accvgpr_write_b32 a44, v20
  v_accvgpr_write_b32 a45, v21
  v_accvgpr_write_b32 a46, v22
  v_accvgpr_write_b32 a47, v23
  v_add_u32 v5, 12288, v1
  s_add_u32 s16, s14, 0
  s_addc_u32 s17, s15, 0
  global_load_dwordx4 v[8:11], v5, s[16:17] offset:0 sc1
  global_load_dwordx4 v[12:15], v5, s[16:17] offset:1024 sc1
  global_load_dwordx4 v[16:19], v5, s[16:17] offset:2048 sc1
  global_load_dwordx4 v[20:23], v5, s[16:17] offset:3072 sc1
  s_add_u32 s16, s14, 65536
  s_addc_u32 s17, s15, 0
  global_load_dwordx4 v[24:27], v5, s[16:17] offset:0 sc1
  global_load_dwordx4 v[28:31], v5, s[16:17] offset:1024 sc1
  global_load_dwordx4 v[32:35], v5, s[16:17] offset:2048 sc1
  global_load_dwordx4 v[36:39], v5, s[16:17] offset:3072 sc1
  s_add_u32 s16, s14, 131072
  s_addc_u32 s17, s15, 0
  global_load_dwordx4 v[40:43], v5, s[16:17] offset:0 sc1
  global_load_dwordx4 v[44:47], v5, s[16:17] offset:1024 sc1
  global_load_dwordx4 v[48:51], v5, s[16:17] offset:2048 sc1
  global_load_dwordx4 v[52:55], v5, s[16:17] offset:3072 sc1
  s_waitcnt vmcnt(0)
  v_pk_add_f32 v[8:9], v[8:9], v[24:25]
  v_pk_add_f32 v[10:11], v[10:11], v[26:27]
  v_pk_add_f32 v[12:13], v[12:13], v[28:29]
  v_pk_add_f32 v[14:15], v[14:15], v[30:31]
  v_pk_add_f32 v[16:17], v[16:17], v[32:33]
  v_pk_add_f32 v[18:19], v[18:19], v[34:35]
  v_pk_add_f32 v[20:21], v[20:21], v[36:37]
  v_pk_add_f32 v[22:23], v[22:23], v[38:39]
  v_pk_add_f32 v[8:9], v[8:9], v[40:41]
  v_pk_add_f32 v[10:11], v[10:11], v[42:43]
  v_pk_add_f32 v[12:13], v[12:13], v[44:45]
  v_pk_add_f32 v[14:15], v[14:15], v[46:47]
  v_pk_add_f32 v[16:17], v[16:17], v[48:49]
  v_pk_add_f32 v[18:19], v[18:19], v[50:51]
  v_pk_add_f32 v[20:21], v[20:21], v[52:53]
  v_pk_add_f32 v[22:23], v[22:23], v[54:55]
  v_accvgpr_write_b32 a48, v8
  v_accvgpr_write_b32 a49, v9
  v_accvgpr_write_b32 a50, v10
  v_accvgpr_write_b32 a51, v11
  v_accvgpr_write_b32 a52, v12
  v_accvgpr_write_b32 a53, v13
  v_accvgpr_write_b32 a54, v14
  v_accvgpr_write_b32 a55, v15
  v_accvgpr_write_b32 a56, v16
  v_accvgpr_write_b32 a57, v17
  v_accvgpr_write_b32 a58, v18
  v_accvgpr_write_b32 a59, v19
  v_accvgpr_write_b32 a60, v20
  v_accvgpr_write_b32 a61, v21
  v_accvgpr_write_b32 a62, v22
  v_accvgpr_write_b32 a63, v23
  s_nop 1
  s_add_u32 s14, s6, 0x7000000
  s_addc_u32 s15, s7, 0
  v_and_b32 v5, 15, v0
  v_bfe_u32 v6, v0, 4, 2
  s_mul_i32 s10, s20, 8
  s_mul_i32 s11, s23, 4
  s_add_u32 s10, s10, s11
  s_lshl_b32 s10, s10, 4
  v_add_u32 v5, s10, v5
  v_mul_u32_u24 v5, 0x500, v5
  s_mul_i32 s10, s21, 8
  s_mul_i32 s11, s24, 4
  s_add_u32 s10, s10, s11
  s_lshl_b32 s10, s10, 5
  v_lshl_add_u32 v5, v6, 3, v5
  v_add_u32 v5, s10, v5
  s_mov_b32 s54, 0xffff0000
  global_load_dwordx2 v[32:33], v5, s[14:15] offset:0
  global_load_dwordx2 v[34:35], v5, s[14:15] offset:32
  global_load_dwordx2 v[36:37], v5, s[14:15] offset:64
  global_load_dwordx2 v[38:39], v5, s[14:15] offset:96
  v_add_u32 v5, 20480, v5
  global_load_dwordx2 v[40:41], v5, s[14:15] offset:0
  global_load_dwordx2 v[42:43], v5, s[14:15] offset:32
  global_load_dwordx2 v[44:45], v5, s[14:15] offset:64
  global_load_dwordx2 v[46:47], v5, s[14:15] offset:96
  v_add_u32 v5, 20480, v5
  global_load_dwordx2 v[48:49], v5, s[14:15] offset:0
  global_load_dwordx2 v[50:51], v5, s[14:15] offset:32
  global_load_dwordx2 v[52:53], v5, s[14:15] offset:64
  global_load_dwordx2 v[54:55], v5, s[14:15] offset:96
  v_add_u32 v5, 20480, v5
  global_load_dwordx2 v[56:57], v5, s[14:15] offset:0
  global_load_dwordx2 v[58:59], v5, s[14:15] offset:32
  global_load_dwordx2 v[60:61], v5, s[14:15] offset:64
  global_load_dwordx2 v[62:63], v5, s[14:15] offset:96
  v_subrev_u32 v5, 61440, v5
  v_accvgpr_read_b32 v8, a0
  v_accvgpr_read_b32 v9, a1
  v_accvgpr_read_b32 v10, a2
  v_accvgpr_read_b32 v11, a3
  v_cvt_pk_bf16_f32 v12, v8, v9
  v_cvt_pk_bf16_f32 v13, v10, v11
  v_lshlrev_b32 v8, 16, v12
  v_and_b32 v9, s54, v12
  v_lshlrev_b32 v10, 16, v13
  v_and_b32 v11, s54, v13
  s_waitcnt vmcnt(15)
  v_lshlrev_b32 v14, 16, v32
  v_and_b32 v15, s54, v32
  v_lshlrev_b32 v16, 16, v33
  v_and_b32 v17, s54, v33
  v_add_f32 v8, v8, v14
  v_add_f32 v9, v9, v15
  v_add_f32 v10, v10, v16
  v_add_f32 v11, v11, v17
  v_cvt_pk_bf16_f32 v20, v8, v9
  v_cvt_pk_bf16_f32 v21, v10, v11
  global_store_dwordx2 v5, v[20:21], s[8:9] offset:0
  v_accvgpr_read_b32 v8, a4
  v_accvgpr_read_b32 v9, a5
  v_accvgpr_read_b32 v10, a6
  v_accvgpr_read_b32 v11, a7
  v_cvt_pk_bf16_f32 v12, v8, v9
  v_cvt_pk_bf16_f32 v13, v10, v11
  v_lshlrev_b32 v8, 16, v12
  v_and_b32 v9, s54, v12
  v_lshlrev_b32 v10, 16, v13
  v_and_b32 v11, s54, v13
  s_waitcnt vmcnt(15)
  v_lshlrev_b32 v14, 16, v34
  v_and_b32 v15, s54, v34
  v_lshlrev_b32 v16, 16, v35
  v_and_b32 v17, s54, v35
  v_add_f32 v8, v8, v14
  v_add_f32 v9, v9, v15
  v_add_f32 v10, v10, v16
  v_add_f32 v11, v11, v17
  v_cvt_pk_bf16_f32 v22, v8, v9
  v_cvt_pk_bf16_f32 v23, v10, v11
  global_store_dwordx2 v5, v[22:23], s[8:9] offset:32
  v_accvgpr_read_b32 v8, a8
  v_accvgpr_read_b32 v9, a9
  v_accvgpr_read_b32 v10, a10
  v_accvgpr_read_b32 v11, a11
  v_cvt_pk_bf16_f32 v12, v8, v9
  v_cvt_pk_bf16_f32 v13, v10, v11
  v_lshlrev_b32 v8, 16, v12
  v_and_b32 v9, s54, v12
  v_lshlrev_b32 v10, 16, v13
  v_and_b32 v11, s54, v13
  s_waitcnt vmcnt(15)
  v_lshlrev_b32 v14, 16, v36
  v_and_b32 v15, s54, v36
  v_lshlrev_b32 v16, 16, v37
  v_and_b32 v17, s54, v37
  v_add_f32 v8, v8, v14
  v_add_f32 v9, v9, v15
  v_add_f32 v10, v10, v16
  v_add_f32 v11, v11, v17
  v_cvt_pk_bf16_f32 v24, v8, v9
  v_cvt_pk_bf16_f32 v25, v10, v11
  global_store_dwordx2 v5, v[24:25], s[8:9] offset:64
  v_accvgpr_read_b32 v8, a12
  v_accvgpr_read_b32 v9, a13
  v_accvgpr_read_b32 v10, a14
  v_accvgpr_read_b32 v11, a15
  v_cvt_pk_bf16_f32 v12, v8, v9
  v_cvt_pk_bf16_f32 v13, v10, v11
  v_lshlrev_b32 v8, 16, v12
  v_and_b32 v9, s54, v12
  v_lshlrev_b32 v10, 16, v13
  v_and_b32 v11, s54, v13
  s_waitcnt vmcnt(15)
  v_lshlrev_b32 v14, 16, v38
  v_and_b32 v15, s54, v38
  v_lshlrev_b32 v16, 16, v39
  v_and_b32 v17, s54, v39
  v_add_f32 v8, v8, v14
  v_add_f32 v9, v9, v15
  v_add_f32 v10, v10, v16
  v_add_f32 v11, v11, v17
  v_cvt_pk_bf16_f32 v26, v8, v9
  v_cvt_pk_bf16_f32 v27, v10, v11
  global_store_dwordx2 v5, v[26:27], s[8:9] offset:96
  v_add_u32 v5, 20480, v5
  v_accvgpr_read_b32 v8, a16
  v_accvgpr_read_b32 v9, a17
  v_accvgpr_read_b32 v10, a18
  v_accvgpr_read_b32 v11, a19
  v_cvt_pk_bf16_f32 v12, v8, v9
  v_cvt_pk_bf16_f32 v13, v10, v11
  v_lshlrev_b32 v8, 16, v12
  v_and_b32 v9, s54, v12
  v_lshlrev_b32 v10, 16, v13
  v_and_b32 v11, s54, v13
  s_waitcnt vmcnt(15)
  v_lshlrev_b32 v14, 16, v40
  v_and_b32 v15, s54, v40
  v_lshlrev_b32 v16, 16, v41
  v_and_b32 v17, s54, v41
  v_add_f32 v8, v8, v14
  v_add_f32 v9, v9, v15
  v_add_f32 v10, v10, v16
  v_add_f32 v11, v11, v17
  v_cvt_pk_bf16_f32 v20, v8, v9
  v_cvt_pk_bf16_f32 v21, v10, v11
  global_store_dwordx2 v5, v[20:21], s[8:9] offset:0
  v_accvgpr_read_b32 v8, a20
  v_accvgpr_read_b32 v9, a21
  v_accvgpr_read_b32 v10, a22
  v_accvgpr_read_b32 v11, a23
  v_cvt_pk_bf16_f32 v12, v8, v9
  v_cvt_pk_bf16_f32 v13, v10, v11
  v_lshlrev_b32 v8, 16, v12
  v_and_b32 v9, s54, v12
  v_lshlrev_b32 v10, 16, v13
  v_and_b32 v11, s54, v13
  s_waitcnt vmcnt(15)
  v_lshlrev_b32 v14, 16, v42
  v_and_b32 v15, s54, v42
  v_lshlrev_b32 v16, 16, v43
  v_and_b32 v17, s54, v43
  v_add_f32 v8, v8, v14
  v_add_f32 v9, v9, v15
  v_add_f32 v10, v10, v16
  v_add_f32 v11, v11, v17
  v_cvt_pk_bf16_f32 v22, v8, v9
  v_cvt_pk_bf16_f32 v23, v10, v11
  global_store_dwordx2 v5, v[22:23], s[8:9] offset:32
  v_accvgpr_read_b32 v8, a24
  v_accvgpr_read_b32 v9, a25
  v_accvgpr_read_b32 v10, a26
  v_accvgpr_read_b32 v11, a27
  v_cvt_pk_bf16_f32 v12, v8, v9
  v_cvt_pk_bf16_f32 v13, v10, v11
  v_lshlrev_b32 v8, 16, v12
  v_and_b32 v9, s54, v12
  v_lshlrev_b32 v10, 16, v13
  v_and_b32 v11, s54, v13
  s_waitcnt vmcnt(15)
  v_lshlrev_b32 v14, 16, v44
  v_and_b32 v15, s54, v44
  v_lshlrev_b32 v16, 16, v45
  v_and_b32 v17, s54, v45
  v_add_f32 v8, v8, v14
  v_add_f32 v9, v9, v15
  v_add_f32 v10, v10, v16
  v_add_f32 v11, v11, v17
  v_cvt_pk_bf16_f32 v24, v8, v9
  v_cvt_pk_bf16_f32 v25, v10, v11
  global_store_dwordx2 v5, v[24:25], s[8:9] offset:64
  v_accvgpr_read_b32 v8, a28
  v_accvgpr_read_b32 v9, a29
  v_accvgpr_read_b32 v10, a30
  v_accvgpr_read_b32 v11, a31
  v_cvt_pk_bf16_f32 v12, v8, v9
  v_cvt_pk_bf16_f32 v13, v10, v11
  v_lshlrev_b32 v8, 16, v12
  v_and_b32 v9, s54, v12
  v_lshlrev_b32 v10, 16, v13
  v_and_b32 v11, s54, v13
  s_waitcnt vmcnt(15)
  v_lshlrev_b32 v14, 16, v46
  v_and_b32 v15, s54, v46
  v_lshlrev_b32 v16, 16, v47
  v_and_b32 v17, s54, v47
  v_add_f32 v8, v8, v14
  v_add_f32 v9, v9, v15
  v_add_f32 v10, v10, v16
  v_add_f32 v11, v11, v17
  v_cvt_pk_bf16_f32 v26, v8, v9
  v_cvt_pk_bf16_f32 v27, v10, v11
  global_store_dwordx2 v5, v[26:27], s[8:9] offset:96
  v_add_u32 v5, 20480, v5
  v_accvgpr_read_b32 v8, a32
  v_accvgpr_read_b32 v9, a33
  v_accvgpr_read_b32 v10, a34
  v_accvgpr_read_b32 v11, a35
  v_cvt_pk_bf16_f32 v12, v8, v9
  v_cvt_pk_bf16_f32 v13, v10, v11
  v_lshlrev_b32 v8, 16, v12
  v_and_b32 v9, s54, v12
  v_lshlrev_b32 v10, 16, v13
  v_and_b32 v11, s54, v13
  s_waitcnt vmcnt(15)
  v_lshlrev_b32 v14, 16, v48
  v_and_b32 v15, s54, v48
  v_lshlrev_b32 v16, 16, v49
  v_and_b32 v17, s54, v49
  v_add_f32 v8, v8, v14
  v_add_f32 v9, v9, v15
  v_add_f32 v10, v10, v16
  v_add_f32 v11, v11, v17
  v_cvt_pk_bf16_f32 v20, v8, v9
  v_cvt_pk_bf16_f32 v21, v10, v11
  global_store_dwordx2 v5, v[20:21], s[8:9] offset:0
  v_accvgpr_read_b32 v8, a36
  v_accvgpr_read_b32 v9, a37
  v_accvgpr_read_b32 v10, a38
  v_accvgpr_read_b32 v11, a39
  v_cvt_pk_bf16_f32 v12, v8, v9
  v_cvt_pk_bf16_f32 v13, v10, v11
  v_lshlrev_b32 v8, 16, v12
  v_and_b32 v9, s54, v12
  v_lshlrev_b32 v10, 16, v13
  v_and_b32 v11, s54, v13
  s_waitcnt vmcnt(15)
  v_lshlrev_b32 v14, 16, v50
  v_and_b32 v15, s54, v50
  v_lshlrev_b32 v16, 16, v51
  v_and_b32 v17, s54, v51
  v_add_f32 v8, v8, v14
  v_add_f32 v9, v9, v15
  v_add_f32 v10, v10, v16
  v_add_f32 v11, v11, v17
  v_cvt_pk_bf16_f32 v22, v8, v9
  v_cvt_pk_bf16_f32 v23, v10, v11
  global_store_dwordx2 v5, v[22:23], s[8:9] offset:32
  v_accvgpr_read_b32 v8, a40
  v_accvgpr_read_b32 v9, a41
  v_accvgpr_read_b32 v10, a42
  v_accvgpr_read_b32 v11, a43
  v_cvt_pk_bf16_f32 v12, v8, v9
  v_cvt_pk_bf16_f32 v13, v10, v11
  v_lshlrev_b32 v8, 16, v12
  v_and_b32 v9, s54, v12
  v_lshlrev_b32 v10, 16, v13
  v_and_b32 v11, s54, v13
  s_waitcnt vmcnt(15)
  v_lshlrev_b32 v14, 16, v52
  v_and_b32 v15, s54, v52
  v_lshlrev_b32 v16, 16, v53
  v_and_b32 v17, s54, v53
  v_add_f32 v8, v8, v14
  v_add_f32 v9, v9, v15
  v_add_f32 v10, v10, v16
  v_add_f32 v11, v11, v17
  v_cvt_pk_bf16_f32 v24, v8, v9
  v_cvt_pk_bf16_f32 v25, v10, v11
  global_store_dwordx2 v5, v[24:25], s[8:9] offset:64
  v_accvgpr_read_b32 v8, a44
  v_accvgpr_read_b32 v9, a45
  v_accvgpr_read_b32 v10, a46
  v_accvgpr_read_b32 v11, a47
  v_cvt_pk_bf16_f32 v12, v8, v9
  v_cvt_pk_bf16_f32 v13, v10, v11
  v_lshlrev_b32 v8, 16, v12
  v_and_b32 v9, s54, v12
  v_lshlrev_b32 v10, 16, v13
  v_and_b32 v11, s54, v13
  s_waitcnt vmcnt(15)
  v_lshlrev_b32 v14, 16, v54
  v_and_b32 v15, s54, v54
  v_lshlrev_b32 v16, 16, v55
  v_and_b32 v17, s54, v55
  v_add_f32 v8, v8, v14
  v_add_f32 v9, v9, v15
  v_add_f32 v10, v10, v16
  v_add_f32 v11, v11, v17
  v_cvt_pk_bf16_f32 v26, v8, v9
  v_cvt_pk_bf16_f32 v27, v10, v11
  global_store_dwordx2 v5, v[26:27], s[8:9] offset:96
  v_add_u32 v5, 20480, v5
  v_accvgpr_read_b32 v8, a48
  v_accvgpr_read_b32 v9, a49
  v_accvgpr_read_b32 v10, a50
  v_accvgpr_read_b32 v11, a51
  v_cvt_pk_bf16_f32 v12, v8, v9
  v_cvt_pk_bf16_f32 v13, v10, v11
  v_lshlrev_b32 v8, 16, v12
  v_and_b32 v9, s54, v12
  v_lshlrev_b32 v10, 16, v13
  v_and_b32 v11, s54, v13
  s_waitcnt vmcnt(15)
  v_lshlrev_b32 v14, 16, v56
  v_and_b32 v15, s54, v56
  v_lshlrev_b32 v16, 16, v57
  v_and_b32 v17, s54, v57
  v_add_f32 v8, v8, v14
  v_add_f32 v9, v9, v15
  v_add_f32 v10, v10, v16
  v_add_f32 v11, v11, v17
  v_cvt_pk_bf16_f32 v20, v8, v9
  v_cvt_pk_bf16_f32 v21, v10, v11
  global_store_dwordx2 v5, v[20:21], s[8:9] offset:0
  v_accvgpr_read_b32 v8, a52
  v_accvgpr_read_b32 v9, a53
  v_accvgpr_read_b32 v10, a54
  v_accvgpr_read_b32 v11, a55
  v_cvt_pk_bf16_f32 v12, v8, v9
  v_cvt_pk_bf16_f32 v13, v10, v11
  v_lshlrev_b32 v8, 16, v12
  v_and_b32 v9, s54, v12
  v_lshlrev_b32 v10, 16, v13
  v_and_b32 v11, s54, v13
  s_waitcnt vmcnt(15)
  v_lshlrev_b32 v14, 16, v58
  v_and_b32 v15, s54, v58
  v_lshlrev_b32 v16, 16, v59
  v_and_b32 v17, s54, v59
  v_add_f32 v8, v8, v14
  v_add_f32 v9, v9, v15
  v_add_f32 v10, v10, v16
  v_add_f32 v11, v11, v17
  v_cvt_pk_bf16_f32 v22, v8, v9
  v_cvt_pk_bf16_f32 v23, v10, v11
  global_store_dwordx2 v5, v[22:23], s[8:9] offset:32
  v_accvgpr_read_b32 v8, a56
  v_accvgpr_read_b32 v9, a57
  v_accvgpr_read_b32 v10, a58
  v_accvgpr_read_b32 v11, a59
  v_cvt_pk_bf16_f32 v12, v8, v9
  v_cvt_pk_bf16_f32 v13, v10, v11
  v_lshlrev_b32 v8, 16, v12
  v_and_b32 v9, s54, v12
  v_lshlrev_b32 v10, 16, v13
  v_and_b32 v11, s54, v13
  s_waitcnt vmcnt(15)
  v_lshlrev_b32 v14, 16, v60
  v_and_b32 v15, s54, v60
  v_lshlrev_b32 v16, 16, v61
  v_and_b32 v17, s54, v61
  v_add_f32 v8, v8, v14
  v_add_f32 v9, v9, v15
  v_add_f32 v10, v10, v16
  v_add_f32 v11, v11, v17
  v_cvt_pk_bf16_f32 v24, v8, v9
  v_cvt_pk_bf16_f32 v25, v10, v11
  global_store_dwordx2 v5, v[24:25], s[8:9] offset:64
  v_accvgpr_read_b32 v8, a60
  v_accvgpr_read_b32 v9, a61
  v_accvgpr_read_b32 v10, a62
  v_accvgpr_read_b32 v11, a63
  v_cvt_pk_bf16_f32 v12, v8, v9
  v_cvt_pk_bf16_f32 v13, v10, v11
  v_lshlrev_b32 v8, 16, v12
  v_and_b32 v9, s54, v12
  v_lshlrev_b32 v10, 16, v13
  v_and_b32 v11, s54, v13
  s_waitcnt vmcnt(15)
  v_lshlrev_b32 v14, 16, v62
  v_and_b32 v15, s54, v62
  v_lshlrev_b32 v16, 16, v63
  v_and_b32 v17, s54, v63
  v_add_f32 v8, v8, v14
  v_add_f32 v9, v9, v15
  v_add_f32 v10, v10, v16
  v_add_f32 v11, v11, v17
  v_cvt_pk_bf16_f32 v26, v8, v9
  v_cvt_pk_bf16_f32 v27, v10, v11
  global_store_dwordx2 v5, v[26:27], s[8:9] offset:96
ffn2_kernel_done:
  s_endpgm
.section .rodata,"a"
.p2align 6
.amdhsa_kernel prep_kernel
  .amdhsa_next_free_vgpr 128
  .amdhsa_next_free_sgpr 64
  .amdhsa_accum_offset 128
  .amdhsa_group_segment_fixed_size 0
  .amdhsa_kernarg_size 112
  .amdhsa_user_sgpr_count 2
  .amdhsa_user_sgpr_kernarg_segment_ptr 1
  .amdhsa_system_sgpr_workgroup_id_x 1
.end_amdhsa_kernel
.p2align 6
.amdhsa_kernel qkv_kernel
  .amdhsa_next_free_vgpr 96
  .amdhsa_next_free_sgpr 64
  .amdhsa_accum_offset 64
  .amdhsa_group_segment_fixed_size 0
  .amdhsa_kernarg_size 112
  .amdhsa_user_sgpr_count 2
  .amdhsa_user_sgpr_kernarg_segment_ptr 1
  .amdhsa_system_sgpr_workgroup_id_x 1
.end_amdhsa_kernel
.p2align 6
.amdhsa_kernel chain_kernel
  .amdhsa_next_free_vgpr 512
  .amdhsa_next_free_sgpr 100
  .amdhsa_accum_offset 256
  .amdhsa_group_segment_fixed_size 0
  .amdhsa_kernarg_size 112
  .amdhsa_user_sgpr_count 2
  .amdhsa_user_sgpr_kernarg_segment_ptr 1
  .amdhsa_system_sgpr_workgroup_id_x 1
.end_amdhsa_kernel
.p2align 6
.amdhsa_kernel awl_kernel
  .amdhsa_next_free_vgpr 352
  .amdhsa_next_free_sgpr 96
  .amdhsa_accum_offset 192
  .amdhsa_group_segment_fixed_size 0
  .amdhsa_kernarg_size 112
  .amdhsa_user_sgpr_count 2
  .amdhsa_user_sgpr_kernarg_segment_ptr 1
  .amdhsa_system_sgpr_workgroup_id_x 1
.end_amdhsa_kernel
.p2align 6
.amdhsa_kernel ffn1_kernel
  .amdhsa_next_free_vgpr 136
  .amdhsa_next_free_sgpr 64
  .amdhsa_accum_offset 72
  .amdhsa_group_segment_fixed_size 0
  .amdhsa_kernarg_size 112
  .amdhsa_user_sgpr_count 2
  .amdhsa_user_sgpr_kernarg_segment_ptr 1
  .amdhsa_system_sgpr_workgroup_id_x 1
.end_amdhsa_kernel
.p2align 6
.amdhsa_kernel ffn2_kernel
  .amdhsa_next_free_vgpr 144
  .amdhsa_next_free_sgpr 64
  .amdhsa_accum_offset 80
  .amdhsa_group_segment_fixed_size 0
  .amdhsa_kernarg_size 112
  .amdhsa_user_sgpr_count 2
  .amdhsa_user_sgpr_kernarg_segment_ptr 1
  .amdhsa_system_sgpr_workgroup_id_x 1
.end_amdhsa_kernel
```
